```python
import torch

def _softmax(x, axis=-1):
    return torch.softmax(x, dim=axis)
def _gelu(x):
    return torch.nn.functional.gelu(x, approximate="tanh")
def _silu(x):
    return torch.nn.functional.silu(x)
def _sigmoid(x):
    return torch.sigmoid(x)
def _layernorm(x, axis=-1, eps=1e-5):
    m = x.mean(dim=axis, keepdim=True)
    v = x.var(dim=axis, keepdim=True, unbiased=False)
    return (x - m) / torch.sqrt(v + eps)
def _scatter_add(tgt, idx, src, axis=0):
    return tgt.clone().index_add_(axis, idx, src)
def _segment_sum(src, seg, n):
    out = torch.zeros((n,) + src.shape[1:], dtype=src.dtype)
    return out.index_add_(0, seg, src)
def _pad(x, pw):
    flat = tuple(v for pair in reversed(pw) for v in pair)
    return torch.nn.functional.pad(x, flat)

kernel_name = 'concat_heads__mha_block_cached__gqa_block_cached__near_ridge'

def setup_inputs():

    _w = (lambda a: (lambda t: t.to(torch.bfloat16) if t.is_floating_point() else t)(torch.as_tensor(a)))
    def _A_setup():
        B, Sq, D = 8, 160, 1024
        H, Sk, Dh = 32, 1024, 128
        return {
            "x": _w((lambda *s: torch.randn(*s, dtype=torch.bfloat16) * 0.8)(B, Sq, D)),
            "k_cache": _w((lambda *s: torch.randn(*s, dtype=torch.bfloat16) * 0.8)(B, H, Sk, Dh)),
            "v_cache": _w((lambda *s: torch.randn(*s, dtype=torch.bfloat16) * 0.05)(B, H, Sk, Dh)),
            "wq": _w((lambda *s: torch.randn(*s, dtype=torch.bfloat16) * 0.8)(D, H * Dh) * (D ** -0.5)),
            "wo": _w((lambda *s: torch.randn(*s, dtype=torch.bfloat16) * 0.05)(H * Dh, D) * ((H * Dh) ** -0.5)),
        }
    _A_in = _A_setup()

    def _B_setup():
        B, Sq, D = 8, 160, 1024
        Hq, Hkv, Sk, Dh = 32, 32, 1024, 128
        assert Hq % Hkv == 0, (Hq, Hkv)
        return {
            "x": _w((lambda *s: torch.randn(*s, dtype=torch.bfloat16) * 0.8)(B, Sq, D)),
            "k_cache": _w((lambda *s: torch.randn(*s, dtype=torch.bfloat16) * 0.8)(B, Hkv, Sk, Dh)),
            "v_cache": _w((lambda *s: torch.randn(*s, dtype=torch.bfloat16) * 0.05)(B, Hkv, Sk, Dh)),
            "wq": _w((lambda *s: torch.randn(*s, dtype=torch.bfloat16) * 0.8)(D, Hq * Dh) * (D ** -0.5)),
            "wo": _w((lambda *s: torch.randn(*s, dtype=torch.bfloat16) * 0.05)(Hq * Dh, D) * ((Hq * Dh) ** -0.5)),
        }
    _B_in = _B_setup()

    return {
        "A_x": _A_in["x"],
        "A_k_cache": _A_in["k_cache"],
        "A_v_cache": _A_in["v_cache"],
        "A_wq": _A_in["wq"],
        "A_wo": _A_in["wo"],
        "B_x": _B_in["x"],
        "B_k_cache": _B_in["k_cache"],
        "B_v_cache": _B_in["v_cache"],
        "B_wq": _B_in["wq"],
        "B_wo": _B_in["wo"],
    }

def reference(A_x, A_k_cache, A_v_cache, A_wq, A_wo, B_x, B_k_cache, B_v_cache, B_wq, B_wo):
    def _A_ref(x, k_cache, v_cache, wq, wo):
        B, Sq, D = x.shape
        H, Dh = 32, 128
        q = (lambda x, *d: x.permute(*d))((x @ wq).reshape(B, Sq, H, Dh), 0, 2, 1, 3)
        scores = torch.einsum("bhqd,bhkd->bhqk", q, k_cache) * (Dh ** -0.5)
        p = _softmax(scores, axis=-1)
        o = torch.einsum("bhqk,bhkd->bhqd", p, v_cache)
        return (lambda x, *d: x.permute(*d))(o, 0, 2, 1, 3).reshape(B, Sq, H * Dh) @ wo

    def _B_ref(x, k_cache, v_cache, wq, wo):
        B, Sq, D = x.shape
        Hq, Dh = 32, 128
        Hkv = k_cache.shape[1]
        rep = Hq // Hkv
        q = (lambda x, *d: x.permute(*d))((x @ wq).reshape(B, Sq, Hq, Dh), 0, 2, 1, 3)
        k = (lambda x, n, axis: torch.repeat_interleave(x, n, dim=axis))(k_cache, rep, axis=1)
        v = (lambda x, n, axis: torch.repeat_interleave(x, n, dim=axis))(v_cache, rep, axis=1)
        scores = torch.einsum("bhqd,bhkd->bhqk", q, k) * (Dh ** -0.5)
        p = _softmax(scores, axis=-1)
        o = torch.einsum("bhqk,bhkd->bhqd", p, v)
        return (lambda x, *d: x.permute(*d))(o, 0, 2, 1, 3).reshape(B, Sq, Hq * Dh) @ wo

    a = _A_ref(A_x, A_k_cache, A_v_cache, A_wq, A_wo)
    b = _B_ref(B_x, B_k_cache, B_v_cache, B_wq, B_wo)
    return torch.concatenate([a, b], axis=-1)
```

```asm
; @launch grid=(256,1,1) block=(256,1,1) lds=163840
.amdgcn_target "amdgcn-amd-amdhsa--gfx950"
.text
.globl concat_heads__mha_block_cached__gqa_block_cached__near_ridge_kernel
.p2align 8
.type concat_heads__mha_block_cached__gqa_block_cached__near_ridge_kernel,@function
concat_heads__mha_block_cached__gqa_block_cached__near_ridge_kernel:
s_cmp_ge_u32 s2, 256
s_cbranch_scc1 L_done
s_and_b32 s3, s2, 4
s_mul_i32 s3, s3, 10
s_add_u32 s66, s0, s3
s_addc_u32 s67, s1, 0
s_load_dwordx8 s[56:63], s[66:67], 0
s_load_dwordx2 s[64:65], s[66:67], 32
s_load_dwordx4 s[4:7], s[0:1], 80
s_load_dwordx2 s[90:91], s[0:1], 96
s_getpc_b64 s[50:51]
L_pc:
s_lshr_b32 s49, s2, 3
s_lshl_b32 s49, s49, 7
v_and_b32 v1, 31, v0
v_lshl_add_u32 v1, v1, 12, s49
v_min_u32 v1, L_end-L_pc-4, v1
global_load_dword v253, v1, s[50:51]
v_lshrrev_b32 v1, 6, v0
v_and_b32 v226, 63, v0
v_readfirstlane_b32 s28, v1
s_bfe_u32 s31, s2, 0x10002
s_lshr_b32 s32, s2, 5
s_and_b32 s99, s2, 3
s_bfe_u32 s98, s2, 0x20003
s_lshl_b32 s49, s98, 2
s_add_u32 s49, s49, s99
s_lshr_b32 s29, s28, 1
s_and_b32 s30, s28, 1
s_lshl_b32 s33, s49, 1
s_add_u32 s33, s33, s29
v_lshrrev_b32 v227, 4, v226
v_and_b32 v228, 15, v226
s_lshl_b32 s49, s30, 17
v_lshlrev_b32 v229, 1, v227
v_xor_b32 v229, v229, v228
v_lshlrev_b32 v231, 4, v229
v_and_b32 v230, 0x70, v231
v_lshrrev_b32 v229, 3, v229
v_lshl_add_u32 v229, v229, 18, v230
v_lshl_add_u32 v229, v227, 13, v229
v_add_u32 v248, s49, v229
v_add_u32 v249, 31744, v248
v_xor_b32 v229, 0x40000, v248
v_add_u32 v250, 63488, v229
v_add_u32 v251, 95232, v229
v_lshl_add_u32 v220, v227, 8, v231
v_lshrrev_b32 v229, 3, v226
v_and_b32 v230, 7, v226
v_xor_b32 v230, v230, v227
v_lshlrev_b32 v230, 4, v230
v_lshl_add_u32 v229, v229, 11, v230
s_lshl_b32 s49, s30, 6
v_xor_b32 v229, s49, v229
s_mul_i32 s49, s28, 81920
v_add_u32 v243, s49, v229
v_xor_b32 v229, 64, v243
v_add_u32 v244, 15360, v229
v_add_u32 v245, 30720, v243
v_add_u32 v246, 46080, v229
v_add_u32 v247, 65536, v243
s_and_b32 s100, s98, 1
s_lshl_b32 s100, s100, 1
s_lshr_b32 s49, s98, 1
s_lshl_b32 s49, s49, 2
s_xor_b32 s100, s100, s49
s_and_b32 s100, s100, 31
s_xor_b32 s100, s100, s32
s_and_b32 s45, s100, 1
s_lshl_b32 s45, s45, 7
s_lshr_b32 s100, s100, 1
s_lshl_b32 s48, s28, 12
s_mul_i32 s39, s28, 5120
s_mul_i32 s49, s32, 327680
s_lshl_b32 s50, s33, 8
s_waitcnt lgkmcnt(0)
s_lshl_b32 s66, s100, 19
s_or_b32 s66, s66, s45
s_lshl_b32 s67, s100, 7
s_add_u32 s12, s62, s50
s_addc_u32 s13, s63, 0
s_and_b32 s13, s13, 0xffff
s_mov_b32 s14, 8380672
s_mov_b32 s15, 0x20000
s_add_u32 s8, s56, s49
s_addc_u32 s9, s57, 0
s_and_b32 s9, s9, 0xffff
s_mov_b32 s10, 327680
s_mov_b32 s11, 0x20000
s_add_u32 m0, s48, 32768
s_xor_b32 s35, s66, 0
buffer_load_dwordx4 v248, s[12:15], s35 offen offset:0 lds
s_add_u32 m0, s48, 32768
s_nop 0
buffer_load_dwordx4 v249, s[12:15], s35 offen offset:1024 lds
s_add_u32 m0, s48, 32768
s_nop 0
buffer_load_dwordx4 v250, s[12:15], s35 offen offset:2048 lds
s_add_u32 m0, s48, 32768
s_nop 0
buffer_load_dwordx4 v251, s[12:15], s35 offen offset:3072 lds
s_add_u32 m0, s39, 139264
s_xor_b32 s34, s67, 0
buffer_load_dwordx4 v243, s[8:11], s34 offen offset:0 lds
s_add_u32 m0, s39, 139264
s_nop 0
buffer_load_dwordx4 v244, s[8:11], s34 offen offset:1024 lds
s_add_u32 m0, s39, 139264
s_nop 0
buffer_load_dwordx4 v245, s[8:11], s34 offen offset:2048 lds
s_add_u32 m0, s39, 139264
s_nop 0
buffer_load_dwordx4 v246, s[8:11], s34 offen offset:3072 lds
s_add_u32 m0, s39, 143360
s_nop 0
buffer_load_dwordx4 v247, s[8:11], s34 offen lds
s_add_u32 m0, s48, 49152
s_xor_b32 s35, s66, 128
buffer_load_dwordx4 v248, s[12:15], s35 offen offset:0 lds
s_add_u32 m0, s48, 49152
s_nop 0
buffer_load_dwordx4 v249, s[12:15], s35 offen offset:1024 lds
s_add_u32 m0, s48, 49152
s_nop 0
buffer_load_dwordx4 v250, s[12:15], s35 offen offset:2048 lds
s_add_u32 m0, s48, 49152
s_nop 0
buffer_load_dwordx4 v251, s[12:15], s35 offen offset:3072 lds
v_bfe_u32 v229, v226, 2, 2
v_lshl_add_u32 v230, v227, 3, v229
v_lshlrev_b32 v230, 8, v230
s_lshl_b32 s49, s29, 13
s_add_u32 s49, s49, 32768
v_add_u32 v230, s49, v230
v_bfe_u32 v231, v226, 2, 3
v_lshlrev_b32 v231, 1, v231
v_and_b32 v229, 3, v226
v_xor_b32 v231, v231, v229
v_lshl_add_u32 v233, v231, 4, v230
v_xor_b32 v234, 64, v233
v_xor_b32 v235, 128, v233
v_xor_b32 v236, 192, v233
s_mul_i32 s49, s30, 10240
s_add_u32 s49, s49, 98304
v_lshlrev_b32 v230, 7, v228
v_add_u32 v230, s49, v230
v_lshrrev_b32 v231, 1, v228
v_xor_b32 v232, v227, v231
v_lshl_add_u32 v241, v232, 4, v230
v_xor_b32 v242, 64, v241
s_lshl_b32 s49, s32, 5
s_add_u32 s49, s49, s33
s_lshl_b32 s50, s49, 18
s_add_u32 s16, s58, s50
s_addc_u32 s17, s59, 0
s_and_b32 s17, s17, 0xffff
s_mov_b32 s18, 262144
s_mov_b32 s19, 0x20000
s_add_u32 s20, s60, s50
s_addc_u32 s21, s61, 0
s_and_b32 s21, s21, 0xffff
s_mov_b32 s22, 262144
s_mov_b32 s23, 0x20000
s_lshl_b32 s49, s31, 3
s_add_u32 s49, s49, s32
s_lshl_b32 s49, s49, 2
s_add_u32 s49, s49, s99
s_lshl_b32 s49, s49, 2
s_add_u32 s49, s49, s98
s_mul_i32 s49, s49, 81920
s_add_u32 s24, s90, s49
s_addc_u32 s25, s91, 0
s_and_b32 s25, s25, 0xffff
s_mov_b32 s26, 81920
s_mov_b32 s27, 0x20000
s_add_u32 s92, s90, 58720256
s_addc_u32 s93, s91, 0
s_and_b32 s93, s93, 0xffff
s_mov_b32 s94, 32768
s_mov_b32 s95, 0x20000
s_lshr_b32 s49, s33, 1
s_lshl_b32 s49, s49, 19
s_lshl_b32 s50, s32, 16
s_add_u32 s49, s49, s50
s_lshl_b32 s50, s29, 15
s_add_u32 s49, s49, s50
s_add_u32 s60, s64, s49
s_addc_u32 s61, s65, 0
s_and_b32 s61, s61, 0xffff
s_mov_b32 s62, 32768
s_mov_b32 s63, 0x20000
s_lshl_b32 s3, s29, 14
s_lshl_b32 s49, s30, 12
s_mov_b32 s53, 1040356334
v_add_u32 v220, s49, v220
v_xor_b32 v221, 128, v220
v_xor_b32 v222, 144, v220
v_xor_b32 v223, 16, v220
s_lshl_b32 s49, s2, 7
s_lshl_b32 s50, s28, 2
s_add_u32 s49, s49, s50
v_lshlrev_b32 v255, 20, v226
v_add_u32 v255, s49, v255
v_mov_b32 v254, 0
s_mov_b32 s101, 0
v_mov_b32 v229, 0x3f803f80
v_accvgpr_write_b32 a180, v229
v_accvgpr_write_b32 a181, v229
v_accvgpr_write_b32 a182, v229
v_accvgpr_write_b32 a183, v229
s_add_u32 m0, s39, 98304
s_xor_b32 s34, s67, 128
buffer_load_dwordx4 v243, s[8:11], s34 offen offset:0 lds
s_add_u32 m0, s39, 98304
s_nop 0
buffer_load_dwordx4 v244, s[8:11], s34 offen offset:1024 lds
s_add_u32 m0, s39, 98304
s_nop 0
buffer_load_dwordx4 v245, s[8:11], s34 offen offset:2048 lds
s_add_u32 m0, s39, 98304
s_nop 0
buffer_load_dwordx4 v246, s[8:11], s34 offen offset:3072 lds
s_add_u32 m0, s39, 102400
s_nop 0
buffer_load_dwordx4 v247, s[8:11], s34 offen lds
s_add_u32 m0, s48, 65536
s_xor_b32 s35, s66, 524288
buffer_load_dwordx4 v248, s[12:15], s35 offen offset:0 lds
s_add_u32 m0, s48, 65536
s_nop 0
buffer_load_dwordx4 v249, s[12:15], s35 offen offset:1024 lds
s_add_u32 m0, s48, 65536
s_nop 0
buffer_load_dwordx4 v250, s[12:15], s35 offen offset:2048 lds
s_add_u32 m0, s48, 65536
s_nop 0
buffer_load_dwordx4 v251, s[12:15], s35 offen offset:3072 lds
s_waitcnt vmcnt(13)
s_barrier
ds_read_b64_tr_b16 a[184:185], v233 offset:0
ds_read_b64_tr_b16 a[186:187], v233 offset:1024
ds_read_b64_tr_b16 a[188:189], v235 offset:0
ds_read_b64_tr_b16 a[190:191], v235 offset:1024
ds_read_b128 a[200:203], v241 offset:40960
ds_read_b128 a[220:223], v242 offset:40960
ds_read_b128 a[204:207], v241 offset:43008
ds_read_b128 a[224:227], v242 offset:43008
ds_read_b128 a[208:211], v241 offset:45056
ds_read_b128 a[228:231], v242 offset:45056
ds_read_b128 a[212:215], v241 offset:47104
ds_read_b128 a[232:235], v242 offset:47104
ds_read_b128 a[216:219], v241 offset:49152
ds_read_b128 a[236:239], v242 offset:49152
ds_read_b64_tr_b16 a[192:193], v233 offset:8
ds_read_b64_tr_b16 a[194:195], v233 offset:1032
ds_read_b64_tr_b16 a[196:197], v235 offset:8
ds_read_b64_tr_b16 a[198:199], v235 offset:1032
ds_read_b64_tr_b16 a[240:241], v234 offset:0
ds_read_b64_tr_b16 a[242:243], v234 offset:1024
ds_read_b64_tr_b16 a[244:245], v236 offset:0
ds_read_b64_tr_b16 a[246:247], v236 offset:1024
s_waitcnt lgkmcnt(13)
v_mfma_f32_16x16x32_bf16 v[80:83], a[184:187], a[200:203], 0
ds_read_b64_tr_b16 a[248:249], v234 offset:8
v_mfma_f32_16x16x32_bf16 v[80:83], a[188:191], a[220:223], v[80:83]
ds_read_b64_tr_b16 a[250:251], v234 offset:1032
s_add_u32 m0, s48, 81920
s_xor_b32 s35, s66, 524416
v_mfma_f32_16x16x32_bf16 v[84:87], a[188:191], a[224:227], 0
ds_read_b64_tr_b16 a[252:253], v236 offset:8
buffer_load_dwordx4 v248, s[12:15], s35 offen offset:0 lds
v_mfma_f32_16x16x32_bf16 v[84:87], a[184:187], a[204:207], v[84:87]
ds_read_b64_tr_b16 a[254:255], v236 offset:1032
v_mfma_f32_16x16x32_bf16 v[88:91], a[184:187], a[208:211], 0
s_add_u32 m0, s48, 81920
s_waitcnt lgkmcnt(4)
v_mfma_f32_16x16x32_bf16 v[88:91], a[188:191], a[228:231], v[88:91]
buffer_load_dwordx4 v249, s[12:15], s35 offen offset:1024 lds
v_mfma_f32_16x16x32_bf16 v[92:95], a[188:191], a[232:235], 0
s_add_u32 m0, s48, 81920
v_mfma_f32_16x16x32_bf16 v[92:95], a[184:187], a[212:215], v[92:95]
buffer_load_dwordx4 v250, s[12:15], s35 offen offset:2048 lds
v_mfma_f32_16x16x32_bf16 v[96:99], a[184:187], a[216:219], 0
v_mfma_f32_16x16x32_bf16 v[96:99], a[188:191], a[236:239], v[96:99]
s_waitcnt vmcnt(12) lgkmcnt(0)
s_barrier
v_mfma_f32_16x16x32_bf16 v[100:103], a[192:195], a[200:203], 0
ds_read_b64_tr_b16 a[184:185], v233 offset:16384
v_mfma_f32_16x16x32_bf16 v[100:103], a[196:199], a[220:223], v[100:103]
ds_read_b64_tr_b16 a[186:187], v233 offset:17408
s_add_u32 m0, s48, 81920
v_mfma_f32_16x16x32_bf16 v[104:107], a[196:199], a[224:227], 0
buffer_load_dwordx4 v251, s[12:15], s35 offen offset:3072 lds
v_mfma_f32_16x16x32_bf16 v[104:107], a[192:195], a[204:207], v[104:107]
ds_read_b64_tr_b16 a[188:189], v235 offset:16384
v_mfma_f32_16x16x32_bf16 v[108:111], a[192:195], a[208:211], 0
ds_read_b64_tr_b16 a[190:191], v235 offset:17408
s_add_u32 m0, s39, 118784
s_xor_b32 s34, s67, 256
v_mfma_f32_16x16x32_bf16 v[108:111], a[196:199], a[228:231], v[108:111]
buffer_load_dwordx4 v243, s[8:11], s34 offen offset:0 lds
v_mfma_f32_16x16x32_bf16 v[112:115], a[196:199], a[232:235], 0
v_mfma_f32_16x16x32_bf16 v[112:115], a[192:195], a[212:215], v[112:115]
s_add_u32 m0, s39, 118784
v_mfma_f32_16x16x32_bf16 v[116:119], a[192:195], a[216:219], 0
buffer_load_dwordx4 v244, s[8:11], s34 offen offset:1024 lds
v_mfma_f32_16x16x32_bf16 v[116:119], a[196:199], a[236:239], v[116:119]
v_mfma_f32_16x16x32_bf16 v[60:63], a[240:243], a[200:203], 0
ds_read_b64_tr_b16 a[192:193], v233 offset:16392
v_mfma_f32_16x16x32_bf16 v[60:63], a[244:247], a[220:223], v[60:63]
ds_read_b64_tr_b16 a[194:195], v233 offset:17416
s_add_u32 m0, s39, 118784
v_mfma_f32_16x16x32_bf16 v[64:67], a[244:247], a[224:227], 0
buffer_load_dwordx4 v245, s[8:11], s34 offen offset:2048 lds
v_mfma_f32_16x16x32_bf16 v[64:67], a[240:243], a[204:207], v[64:67]
ds_read_b64_tr_b16 a[196:197], v235 offset:16392
v_mfma_f32_16x16x32_bf16 v[68:71], a[240:243], a[208:211], 0
ds_read_b64_tr_b16 a[198:199], v235 offset:17416
s_add_u32 m0, s39, 118784
v_mfma_f32_16x16x32_bf16 v[68:71], a[244:247], a[228:231], v[68:71]
buffer_load_dwordx4 v246, s[8:11], s34 offen offset:3072 lds
v_mfma_f32_16x16x32_bf16 v[72:75], a[244:247], a[232:235], 0
v_mfma_f32_16x16x32_bf16 v[72:75], a[240:243], a[212:215], v[72:75]
s_add_u32 m0, s39, 122880
v_mfma_f32_16x16x32_bf16 v[76:79], a[240:243], a[216:219], 0
buffer_load_dwordx4 v247, s[8:11], s34 offen lds
v_mfma_f32_16x16x32_bf16 v[76:79], a[244:247], a[236:239], v[76:79]
v_mfma_f32_16x16x32_bf16 v[120:123], a[248:251], a[200:203], 0
ds_read_b64_tr_b16 a[240:241], v234 offset:16384
v_mfma_f32_16x16x32_bf16 v[120:123], a[252:255], a[220:223], v[120:123]
ds_read_b64_tr_b16 a[242:243], v234 offset:17408
s_add_u32 m0, s48, 32768
s_xor_b32 s35, s66, 1048576
v_mfma_f32_16x16x32_bf16 v[124:127], a[252:255], a[224:227], 0
buffer_load_dwordx4 v248, s[12:15], s35 offen offset:0 lds
v_mfma_f32_16x16x32_bf16 v[124:127], a[248:251], a[204:207], v[124:127]
ds_read_b64_tr_b16 a[244:245], v236 offset:16384
v_mfma_f32_16x16x32_bf16 v[128:131], a[248:251], a[208:211], 0
ds_read_b64_tr_b16 a[246:247], v236 offset:17408
s_add_u32 m0, s48, 32768
v_mfma_f32_16x16x32_bf16 v[128:131], a[252:255], a[228:231], v[128:131]
buffer_load_dwordx4 v249, s[12:15], s35 offen offset:1024 lds
v_mfma_f32_16x16x32_bf16 v[132:135], a[252:255], a[232:235], 0
v_mfma_f32_16x16x32_bf16 v[132:135], a[248:251], a[212:215], v[132:135]
s_add_u32 m0, s48, 32768
v_mfma_f32_16x16x32_bf16 v[136:139], a[248:251], a[216:219], 0
buffer_load_dwordx4 v250, s[12:15], s35 offen offset:2048 lds
v_mfma_f32_16x16x32_bf16 v[136:139], a[252:255], a[236:239], v[136:139]
s_waitcnt lgkmcnt(4)
v_mfma_f32_16x16x32_bf16 v[140:143], a[184:187], a[200:203], 0
ds_read_b64_tr_b16 a[248:249], v234 offset:16392
v_mfma_f32_16x16x32_bf16 v[140:143], a[188:191], a[220:223], v[140:143]
ds_read_b64_tr_b16 a[250:251], v234 offset:17416
s_add_u32 m0, s48, 32768
v_mfma_f32_16x16x32_bf16 v[144:147], a[188:191], a[224:227], 0
ds_read_b64_tr_b16 a[252:253], v236 offset:16392
buffer_load_dwordx4 v251, s[12:15], s35 offen offset:3072 lds
v_mfma_f32_16x16x32_bf16 v[144:147], a[184:187], a[204:207], v[144:147]
ds_read_b64_tr_b16 a[254:255], v236 offset:17416
v_mfma_f32_16x16x32_bf16 v[148:151], a[184:187], a[208:211], 0
s_add_u32 m0, s39, 139264
s_xor_b32 s34, s67, 384
v_mfma_f32_16x16x32_bf16 v[148:151], a[188:191], a[228:231], v[148:151]
buffer_load_dwordx4 v243, s[8:11], s34 offen offset:0 lds
v_mfma_f32_16x16x32_bf16 v[152:155], a[188:191], a[232:235], 0
v_mfma_f32_16x16x32_bf16 v[152:155], a[184:187], a[212:215], v[152:155]
buffer_store_dword v254, v255, s[92:95], 0 offen sc1
v_mfma_f32_16x16x32_bf16 v[156:159], a[184:187], a[216:219], 0
v_mfma_f32_16x16x32_bf16 v[156:159], a[188:191], a[236:239], v[156:159]
s_waitcnt vmcnt(15) lgkmcnt(0)
s_barrier
v_mfma_f32_16x16x32_bf16 v[160:163], a[192:195], a[200:203], 0
ds_read_b64_tr_b16 a[184:185], v233 offset:32768
v_mfma_f32_16x16x32_bf16 v[160:163], a[196:199], a[220:223], v[160:163]
ds_read_b64_tr_b16 a[186:187], v233 offset:33792
s_add_u32 m0, s48, 49152
s_xor_b32 s35, s66, 1048704
v_mfma_f32_16x16x32_bf16 v[164:167], a[196:199], a[224:227], 0
buffer_load_dwordx4 v248, s[12:15], s35 offen offset:0 lds
v_mfma_f32_16x16x32_bf16 v[164:167], a[192:195], a[204:207], v[164:167]
ds_read_b64_tr_b16 a[188:189], v235 offset:32768
v_mfma_f32_16x16x32_bf16 v[168:171], a[192:195], a[208:211], 0
ds_read_b64_tr_b16 a[190:191], v235 offset:33792
s_add_u32 m0, s39, 139264
v_mfma_f32_16x16x32_bf16 v[168:171], a[196:199], a[228:231], v[168:171]
ds_read_b128 a[120:123], v241 offset:0
buffer_load_dwordx4 v244, s[8:11], s34 offen offset:1024 lds
v_mfma_f32_16x16x32_bf16 v[172:175], a[196:199], a[232:235], 0
ds_read_b128 a[140:143], v242 offset:0
v_mfma_f32_16x16x32_bf16 v[172:175], a[192:195], a[212:215], v[172:175]
buffer_store_dword v254, v255, s[92:95], 0 offen offset:16 sc1
v_mfma_f32_16x16x32_bf16 v[176:179], a[192:195], a[216:219], 0
ds_read_b128 a[124:127], v241 offset:2048
s_add_u32 m0, s39, 139264
v_mfma_f32_16x16x32_bf16 v[176:179], a[196:199], a[236:239], v[176:179]
ds_read_b128 a[144:147], v242 offset:2048
buffer_load_dwordx4 v245, s[8:11], s34 offen offset:2048 lds
v_mfma_f32_16x16x32_bf16 v[180:183], a[240:243], a[200:203], 0
ds_read_b64_tr_b16 a[192:193], v233 offset:32776
v_mfma_f32_16x16x32_bf16 v[180:183], a[244:247], a[220:223], v[180:183]
ds_read_b64_tr_b16 a[194:195], v233 offset:33800
s_add_u32 m0, s48, 49152
v_mfma_f32_16x16x32_bf16 v[184:187], a[244:247], a[224:227], 0
buffer_load_dwordx4 v249, s[12:15], s35 offen offset:1024 lds
v_mfma_f32_16x16x32_bf16 v[184:187], a[240:243], a[204:207], v[184:187]
ds_read_b64_tr_b16 a[196:197], v235 offset:32776
v_mfma_f32_16x16x32_bf16 v[188:191], a[240:243], a[208:211], 0
ds_read_b64_tr_b16 a[198:199], v235 offset:33800
v_mfma_f32_16x16x32_bf16 v[188:191], a[244:247], a[228:231], v[188:191]
ds_read_b128 a[128:131], v241 offset:4096
v_mfma_f32_16x16x32_bf16 v[192:195], a[244:247], a[232:235], 0
ds_read_b128 a[148:151], v242 offset:4096
s_add_u32 m0, s48, 49152
v_mfma_f32_16x16x32_bf16 v[192:195], a[240:243], a[212:215], v[192:195]
buffer_load_dwordx4 v250, s[12:15], s35 offen offset:2048 lds
v_mfma_f32_16x16x32_bf16 v[196:199], a[240:243], a[216:219], 0
ds_read_b128 a[132:135], v241 offset:6144
v_mfma_f32_16x16x32_bf16 v[196:199], a[244:247], a[236:239], v[196:199]
ds_read_b128 a[152:155], v242 offset:6144
s_add_u32 m0, s39, 139264
v_mfma_f32_16x16x32_bf16 v[200:203], a[248:251], a[200:203], 0
ds_read_b64_tr_b16 a[240:241], v234 offset:32768
buffer_load_dwordx4 v246, s[8:11], s34 offen offset:3072 lds
v_mfma_f32_16x16x32_bf16 v[200:203], a[252:255], a[220:223], v[200:203]
ds_read_b64_tr_b16 a[242:243], v234 offset:33792
v_mfma_f32_16x16x32_bf16 v[204:207], a[252:255], a[224:227], 0
ds_read_b128 a[136:139], v241 offset:8192
v_mfma_f32_16x16x32_bf16 v[204:207], a[248:251], a[204:207], v[204:207]
ds_read_b64_tr_b16 a[244:245], v236 offset:32768
s_add_u32 m0, s39, 143360
v_mfma_f32_16x16x32_bf16 v[208:211], a[248:251], a[208:211], 0
ds_read_b64_tr_b16 a[246:247], v236 offset:33792
buffer_load_dwordx4 v247, s[8:11], s34 offen lds
v_mfma_f32_16x16x32_bf16 v[208:211], a[252:255], a[228:231], v[208:211]
ds_read_b128 a[156:159], v242 offset:8192
v_mfma_f32_16x16x32_bf16 v[212:215], a[252:255], a[232:235], 0
s_add_u32 m0, s48, 49152
v_mfma_f32_16x16x32_bf16 v[212:215], a[248:251], a[212:215], v[212:215]
buffer_load_dwordx4 v251, s[12:15], s35 offen offset:3072 lds
v_mfma_f32_16x16x32_bf16 v[216:219], a[248:251], a[216:219], 0
v_mfma_f32_16x16x32_bf16 v[216:219], a[252:255], a[236:239], v[216:219]
s_waitcnt lgkmcnt(1)
v_mfma_f32_16x16x32_bf16 v[80:83], a[184:187], a[120:123], v[80:83]
ds_read_b64_tr_b16 a[248:249], v234 offset:32776
v_mfma_f32_16x16x32_bf16 v[80:83], a[188:191], a[140:143], v[80:83]
ds_read_b64_tr_b16 a[250:251], v234 offset:33800
s_add_u32 m0, s48, 0
s_xor_b32 s36, s3, 0
v_mfma_f32_16x16x32_bf16 v[84:87], a[188:191], a[144:147], v[84:87]
ds_read_b64_tr_b16 a[252:253], v236 offset:32776
buffer_load_dwordx4 v220, s[16:19], s36 offen offset:0 nt lds
v_mfma_f32_16x16x32_bf16 v[84:87], a[184:187], a[124:127], v[84:87]
ds_read_b64_tr_b16 a[254:255], v236 offset:33800
v_mfma_f32_16x16x32_bf16 v[88:91], a[184:187], a[128:131], v[88:91]
s_add_u32 m0, s48, 0
v_mfma_f32_16x16x32_bf16 v[88:91], a[188:191], a[148:151], v[88:91]
buffer_load_dwordx4 v221, s[16:19], s36 offen offset:1024 nt lds
v_mfma_f32_16x16x32_bf16 v[92:95], a[188:191], a[152:155], v[92:95]
s_add_u32 m0, s48, 0
v_mfma_f32_16x16x32_bf16 v[92:95], a[184:187], a[132:135], v[92:95]
buffer_load_dwordx4 v222, s[16:19], s36 offen offset:2048 nt lds
v_mfma_f32_16x16x32_bf16 v[96:99], a[184:187], a[136:139], v[96:99]
s_waitcnt lgkmcnt(2)
v_mfma_f32_16x16x32_bf16 v[96:99], a[188:191], a[156:159], v[96:99]
s_waitcnt vmcnt(23) lgkmcnt(0)
s_barrier
v_mfma_f32_16x16x32_bf16 v[100:103], a[192:195], a[120:123], v[100:103]
ds_read_b64_tr_b16 a[184:185], v233 offset:49152
v_mfma_f32_16x16x32_bf16 v[100:103], a[196:199], a[140:143], v[100:103]
ds_read_b64_tr_b16 a[186:187], v233 offset:50176
s_add_u32 m0, s48, 65536
s_xor_b32 s35, s66, 1572864
v_mfma_f32_16x16x32_bf16 v[104:107], a[196:199], a[144:147], v[104:107]
buffer_load_dwordx4 v248, s[12:15], s35 offen offset:0 lds
v_mfma_f32_16x16x32_bf16 v[104:107], a[192:195], a[124:127], v[104:107]
ds_read_b64_tr_b16 a[188:189], v235 offset:49152
v_mfma_f32_16x16x32_bf16 v[108:111], a[192:195], a[128:131], v[108:111]
ds_read_b64_tr_b16 a[190:191], v235 offset:50176
v_mfma_f32_16x16x32_bf16 v[108:111], a[196:199], a[148:151], v[108:111]
v_mfma_f32_16x16x32_bf16 v[112:115], a[196:199], a[152:155], v[112:115]
s_add_u32 m0, s39, 98304
s_xor_b32 s34, s67, 512
v_mfma_f32_16x16x32_bf16 v[112:115], a[192:195], a[132:135], v[112:115]
buffer_load_dwordx4 v243, s[8:11], s34 offen offset:0 lds
v_mfma_f32_16x16x32_bf16 v[116:119], a[192:195], a[136:139], v[116:119]
v_mfma_f32_16x16x32_bf16 v[116:119], a[196:199], a[156:159], v[116:119]
v_mfma_f32_16x16x32_bf16 v[60:63], a[240:243], a[120:123], v[60:63]
ds_read_b64_tr_b16 a[192:193], v233 offset:49160
v_mfma_f32_16x16x32_bf16 v[60:63], a[244:247], a[140:143], v[60:63]
ds_read_b64_tr_b16 a[194:195], v233 offset:50184
s_add_u32 m0, s48, 65536
v_mfma_f32_16x16x32_bf16 v[64:67], a[244:247], a[144:147], v[64:67]
buffer_load_dwordx4 v249, s[12:15], s35 offen offset:1024 lds
v_mfma_f32_16x16x32_bf16 v[64:67], a[240:243], a[124:127], v[64:67]
ds_read_b64_tr_b16 a[196:197], v235 offset:49160
v_mfma_f32_16x16x32_bf16 v[68:71], a[240:243], a[128:131], v[68:71]
ds_read_b64_tr_b16 a[198:199], v235 offset:50184
v_mfma_f32_16x16x32_bf16 v[68:71], a[244:247], a[148:151], v[68:71]
v_mfma_f32_16x16x32_bf16 v[72:75], a[244:247], a[152:155], v[72:75]
s_add_u32 m0, s48, 65536
v_mfma_f32_16x16x32_bf16 v[72:75], a[240:243], a[132:135], v[72:75]
buffer_load_dwordx4 v250, s[12:15], s35 offen offset:2048 lds
v_mfma_f32_16x16x32_bf16 v[76:79], a[240:243], a[136:139], v[76:79]
v_mfma_f32_16x16x32_bf16 v[76:79], a[244:247], a[156:159], v[76:79]
v_mfma_f32_16x16x32_bf16 v[120:123], a[248:251], a[120:123], v[120:123]
ds_read_b64_tr_b16 a[240:241], v234 offset:49152
v_mfma_f32_16x16x32_bf16 v[120:123], a[252:255], a[140:143], v[120:123]
ds_read_b64_tr_b16 a[242:243], v234 offset:50176
s_add_u32 m0, s39, 98304
v_mfma_f32_16x16x32_bf16 v[124:127], a[252:255], a[144:147], v[124:127]
buffer_load_dwordx4 v244, s[8:11], s34 offen offset:1024 lds
v_mfma_f32_16x16x32_bf16 v[124:127], a[248:251], a[124:127], v[124:127]
ds_read_b64_tr_b16 a[244:245], v236 offset:49152
v_mfma_f32_16x16x32_bf16 v[128:131], a[248:251], a[128:131], v[128:131]
ds_read_b64_tr_b16 a[246:247], v236 offset:50176
v_mfma_f32_16x16x32_bf16 v[128:131], a[252:255], a[148:151], v[128:131]
v_mfma_f32_16x16x32_bf16 v[132:135], a[252:255], a[152:155], v[132:135]
s_add_u32 m0, s48, 65536
v_mfma_f32_16x16x32_bf16 v[132:135], a[248:251], a[132:135], v[132:135]
buffer_load_dwordx4 v251, s[12:15], s35 offen offset:3072 lds
v_mfma_f32_16x16x32_bf16 v[136:139], a[248:251], a[136:139], v[136:139]
v_mfma_f32_16x16x32_bf16 v[136:139], a[252:255], a[156:159], v[136:139]
s_waitcnt lgkmcnt(4)
v_mfma_f32_16x16x32_bf16 v[140:143], a[184:187], a[120:123], v[140:143]
ds_read_b64_tr_b16 a[248:249], v234 offset:49160
v_mfma_f32_16x16x32_bf16 v[140:143], a[188:191], a[140:143], v[140:143]
ds_read_b64_tr_b16 a[250:251], v234 offset:50184
s_add_u32 m0, s39, 98304
v_mfma_f32_16x16x32_bf16 v[144:147], a[188:191], a[144:147], v[144:147]
ds_read_b64_tr_b16 a[252:253], v236 offset:49160
buffer_load_dwordx4 v245, s[8:11], s34 offen offset:2048 lds
v_mfma_f32_16x16x32_bf16 v[144:147], a[184:187], a[124:127], v[144:147]
ds_read_b64_tr_b16 a[254:255], v236 offset:50184
v_mfma_f32_16x16x32_bf16 v[148:151], a[184:187], a[128:131], v[148:151]
v_mfma_f32_16x16x32_bf16 v[148:151], a[188:191], a[148:151], v[148:151]
v_mfma_f32_16x16x32_bf16 v[152:155], a[188:191], a[152:155], v[152:155]
s_add_u32 m0, s39, 98304
v_mfma_f32_16x16x32_bf16 v[152:155], a[184:187], a[132:135], v[152:155]
buffer_load_dwordx4 v246, s[8:11], s34 offen offset:3072 lds
v_mfma_f32_16x16x32_bf16 v[156:159], a[184:187], a[136:139], v[156:159]
v_mfma_f32_16x16x32_bf16 v[156:159], a[188:191], a[156:159], v[156:159]
s_waitcnt vmcnt(22) lgkmcnt(0)
s_barrier
v_mfma_f32_16x16x32_bf16 v[160:163], a[192:195], a[120:123], v[160:163]
ds_read_b64_tr_b16 a[184:185], v233 offset:0
v_mfma_f32_16x16x32_bf16 v[160:163], a[196:199], a[140:143], v[160:163]
ds_read_b64_tr_b16 a[186:187], v233 offset:1024
s_add_u32 m0, s48, 81920
s_xor_b32 s35, s66, 1572992
v_mfma_f32_16x16x32_bf16 v[164:167], a[196:199], a[144:147], v[164:167]
buffer_load_dwordx4 v248, s[12:15], s35 offen offset:0 lds
v_mfma_f32_16x16x32_bf16 v[164:167], a[192:195], a[124:127], v[164:167]
ds_read_b64_tr_b16 a[188:189], v235 offset:0
v_mfma_f32_16x16x32_bf16 v[168:171], a[192:195], a[128:131], v[168:171]
ds_read_b64_tr_b16 a[190:191], v235 offset:1024
v_mfma_f32_16x16x32_bf16 v[168:171], a[196:199], a[148:151], v[168:171]
ds_read_b128 a[200:203], v241 offset:20480
v_mfma_f32_16x16x32_bf16 v[172:175], a[196:199], a[152:155], v[172:175]
ds_read_b128 a[220:223], v242 offset:20480
s_add_u32 m0, s39, 102400
v_mfma_f32_16x16x32_bf16 v[172:175], a[192:195], a[132:135], v[172:175]
buffer_load_dwordx4 v247, s[8:11], s34 offen lds
v_mfma_f32_16x16x32_bf16 v[176:179], a[192:195], a[136:139], v[176:179]
ds_read_b128 a[204:207], v241 offset:22528
v_mfma_f32_16x16x32_bf16 v[176:179], a[196:199], a[156:159], v[176:179]
ds_read_b128 a[224:227], v242 offset:22528
v_mfma_f32_16x16x32_bf16 v[180:183], a[240:243], a[120:123], v[180:183]
ds_read_b64_tr_b16 a[192:193], v233 offset:8
v_mfma_f32_16x16x32_bf16 v[180:183], a[244:247], a[140:143], v[180:183]
ds_read_b64_tr_b16 a[194:195], v233 offset:1032
s_add_u32 m0, s48, 81920
v_mfma_f32_16x16x32_bf16 v[184:187], a[244:247], a[144:147], v[184:187]
buffer_load_dwordx4 v249, s[12:15], s35 offen offset:1024 lds
v_mfma_f32_16x16x32_bf16 v[184:187], a[240:243], a[124:127], v[184:187]
ds_read_b64_tr_b16 a[196:197], v235 offset:8
v_mfma_f32_16x16x32_bf16 v[188:191], a[240:243], a[128:131], v[188:191]
ds_read_b64_tr_b16 a[198:199], v235 offset:1032
v_mfma_f32_16x16x32_bf16 v[188:191], a[244:247], a[148:151], v[188:191]
ds_read_b128 a[208:211], v241 offset:24576
v_mfma_f32_16x16x32_bf16 v[192:195], a[244:247], a[152:155], v[192:195]
ds_read_b128 a[228:231], v242 offset:24576
s_add_u32 m0, s48, 81920
v_mfma_f32_16x16x32_bf16 v[192:195], a[240:243], a[132:135], v[192:195]
buffer_load_dwordx4 v250, s[12:15], s35 offen offset:2048 lds
v_mfma_f32_16x16x32_bf16 v[196:199], a[240:243], a[136:139], v[196:199]
ds_read_b128 a[212:215], v241 offset:26624
v_mfma_f32_16x16x32_bf16 v[196:199], a[244:247], a[156:159], v[196:199]
ds_read_b128 a[232:235], v242 offset:26624
v_mfma_f32_16x16x32_bf16 v[200:203], a[248:251], a[120:123], v[200:203]
ds_read_b64_tr_b16 a[240:241], v234 offset:0
v_mfma_f32_16x16x32_bf16 v[200:203], a[252:255], a[140:143], v[200:203]
ds_read_b64_tr_b16 a[242:243], v234 offset:1024
s_add_u32 m0, s48, 0
v_mfma_f32_16x16x32_bf16 v[204:207], a[252:255], a[144:147], v[204:207]
ds_read_b128 a[216:219], v241 offset:28672
buffer_load_dwordx4 v223, s[16:19], s36 offen offset:3072 nt lds
v_mfma_f32_16x16x32_bf16 v[204:207], a[248:251], a[124:127], v[204:207]
ds_read_b64_tr_b16 a[244:245], v236 offset:0
v_mfma_f32_16x16x32_bf16 v[208:211], a[248:251], a[128:131], v[208:211]
ds_read_b64_tr_b16 a[246:247], v236 offset:1024
v_mfma_f32_16x16x32_bf16 v[208:211], a[252:255], a[148:151], v[208:211]
ds_read_b128 a[236:239], v242 offset:28672
v_mfma_f32_16x16x32_bf16 v[212:215], a[252:255], a[152:155], v[212:215]
s_add_u32 m0, s48, 81920
v_mfma_f32_16x16x32_bf16 v[212:215], a[248:251], a[132:135], v[212:215]
buffer_load_dwordx4 v251, s[12:15], s35 offen offset:3072 lds
v_mfma_f32_16x16x32_bf16 v[216:219], a[248:251], a[136:139], v[216:219]
v_mfma_f32_16x16x32_bf16 v[216:219], a[252:255], a[156:159], v[216:219]
s_waitcnt lgkmcnt(1)
v_mfma_f32_16x16x32_bf16 v[80:83], a[184:187], a[200:203], v[80:83]
ds_read_b64_tr_b16 a[248:249], v234 offset:8
v_mfma_f32_16x16x32_bf16 v[80:83], a[188:191], a[220:223], v[80:83]
ds_read_b64_tr_b16 a[250:251], v234 offset:1032
s_add_u32 m0, s48, 16384
s_xor_b32 s37, s3, 0
v_mfma_f32_16x16x32_bf16 v[84:87], a[188:191], a[224:227], v[84:87]
ds_read_b64_tr_b16 a[252:253], v236 offset:8
buffer_load_dwordx4 v220, s[20:23], s37 offen offset:0 nt lds
v_mfma_f32_16x16x32_bf16 v[84:87], a[184:187], a[204:207], v[84:87]
ds_read_b64_tr_b16 a[254:255], v236 offset:1032
v_mfma_f32_16x16x32_bf16 v[88:91], a[184:187], a[208:211], v[88:91]
s_add_u32 m0, s48, 16384
v_mfma_f32_16x16x32_bf16 v[88:91], a[188:191], a[228:231], v[88:91]
buffer_load_dwordx4 v221, s[20:23], s37 offen offset:1024 nt lds
v_mfma_f32_16x16x32_bf16 v[92:95], a[188:191], a[232:235], v[92:95]
s_add_u32 m0, s48, 16384
v_mfma_f32_16x16x32_bf16 v[92:95], a[184:187], a[212:215], v[92:95]
buffer_load_dwordx4 v222, s[20:23], s37 offen offset:2048 nt lds
v_mfma_f32_16x16x32_bf16 v[96:99], a[184:187], a[216:219], v[96:99]
s_waitcnt lgkmcnt(2)
v_mfma_f32_16x16x32_bf16 v[96:99], a[188:191], a[236:239], v[96:99]
s_waitcnt vmcnt(20) lgkmcnt(0)
s_barrier
v_mfma_f32_16x16x32_bf16 v[100:103], a[192:195], a[200:203], v[100:103]
ds_read_b64_tr_b16 a[184:185], v233 offset:16384
v_mfma_f32_16x16x32_bf16 v[100:103], a[196:199], a[220:223], v[100:103]
ds_read_b64_tr_b16 a[186:187], v233 offset:17408
s_add_u32 m0, s48, 32768
s_xor_b32 s35, s66, 2097152
v_mfma_f32_16x16x32_bf16 v[104:107], a[196:199], a[224:227], v[104:107]
buffer_load_dwordx4 v248, s[12:15], s35 offen offset:0 lds
v_mfma_f32_16x16x32_bf16 v[104:107], a[192:195], a[204:207], v[104:107]
ds_read_b64_tr_b16 a[188:189], v235 offset:16384
v_mfma_f32_16x16x32_bf16 v[108:111], a[192:195], a[208:211], v[108:111]
ds_read_b64_tr_b16 a[190:191], v235 offset:17408
v_mfma_f32_16x16x32_bf16 v[108:111], a[196:199], a[228:231], v[108:111]
v_mfma_f32_16x16x32_bf16 v[112:115], a[196:199], a[232:235], v[112:115]
s_add_u32 m0, s39, 118784
s_xor_b32 s34, s67, 640
v_mfma_f32_16x16x32_bf16 v[112:115], a[192:195], a[212:215], v[112:115]
buffer_load_dwordx4 v243, s[8:11], s34 offen offset:0 lds
v_mfma_f32_16x16x32_bf16 v[116:119], a[192:195], a[216:219], v[116:119]
v_mfma_f32_16x16x32_bf16 v[116:119], a[196:199], a[236:239], v[116:119]
v_mfma_f32_16x16x32_bf16 v[60:63], a[240:243], a[200:203], v[60:63]
ds_read_b64_tr_b16 a[192:193], v233 offset:16392
v_mfma_f32_16x16x32_bf16 v[60:63], a[244:247], a[220:223], v[60:63]
ds_read_b64_tr_b16 a[194:195], v233 offset:17416
s_add_u32 m0, s48, 32768
v_mfma_f32_16x16x32_bf16 v[64:67], a[244:247], a[224:227], v[64:67]
buffer_load_dwordx4 v249, s[12:15], s35 offen offset:1024 lds
v_mfma_f32_16x16x32_bf16 v[64:67], a[240:243], a[204:207], v[64:67]
ds_read_b64_tr_b16 a[196:197], v235 offset:16392
v_mfma_f32_16x16x32_bf16 v[68:71], a[240:243], a[208:211], v[68:71]
ds_read_b64_tr_b16 a[198:199], v235 offset:17416
v_mfma_f32_16x16x32_bf16 v[68:71], a[244:247], a[228:231], v[68:71]
v_mfma_f32_16x16x32_bf16 v[72:75], a[244:247], a[232:235], v[72:75]
s_add_u32 m0, s48, 32768
v_mfma_f32_16x16x32_bf16 v[72:75], a[240:243], a[212:215], v[72:75]
buffer_load_dwordx4 v250, s[12:15], s35 offen offset:2048 lds
v_mfma_f32_16x16x32_bf16 v[76:79], a[240:243], a[216:219], v[76:79]
v_mfma_f32_16x16x32_bf16 v[76:79], a[244:247], a[236:239], v[76:79]
v_mfma_f32_16x16x32_bf16 v[120:123], a[248:251], a[200:203], v[120:123]
ds_read_b64_tr_b16 a[240:241], v234 offset:16384
v_mfma_f32_16x16x32_bf16 v[120:123], a[252:255], a[220:223], v[120:123]
ds_read_b64_tr_b16 a[242:243], v234 offset:17408
s_add_u32 m0, s39, 118784
v_mfma_f32_16x16x32_bf16 v[124:127], a[252:255], a[224:227], v[124:127]
buffer_load_dwordx4 v244, s[8:11], s34 offen offset:1024 lds
v_mfma_f32_16x16x32_bf16 v[124:127], a[248:251], a[204:207], v[124:127]
ds_read_b64_tr_b16 a[244:245], v236 offset:16384
v_mfma_f32_16x16x32_bf16 v[128:131], a[248:251], a[208:211], v[128:131]
ds_read_b64_tr_b16 a[246:247], v236 offset:17408
v_mfma_f32_16x16x32_bf16 v[128:131], a[252:255], a[228:231], v[128:131]
v_mfma_f32_16x16x32_bf16 v[132:135], a[252:255], a[232:235], v[132:135]
s_add_u32 m0, s48, 32768
v_mfma_f32_16x16x32_bf16 v[132:135], a[248:251], a[212:215], v[132:135]
buffer_load_dwordx4 v251, s[12:15], s35 offen offset:3072 lds
v_mfma_f32_16x16x32_bf16 v[136:139], a[248:251], a[216:219], v[136:139]
v_mfma_f32_16x16x32_bf16 v[136:139], a[252:255], a[236:239], v[136:139]
s_waitcnt lgkmcnt(4)
v_mfma_f32_16x16x32_bf16 v[140:143], a[184:187], a[200:203], v[140:143]
ds_read_b64_tr_b16 a[248:249], v234 offset:16392
v_mfma_f32_16x16x32_bf16 v[140:143], a[188:191], a[220:223], v[140:143]
ds_read_b64_tr_b16 a[250:251], v234 offset:17416
s_add_u32 m0, s39, 118784
v_mfma_f32_16x16x32_bf16 v[144:147], a[188:191], a[224:227], v[144:147]
ds_read_b64_tr_b16 a[252:253], v236 offset:16392
buffer_load_dwordx4 v245, s[8:11], s34 offen offset:2048 lds
v_mfma_f32_16x16x32_bf16 v[144:147], a[184:187], a[204:207], v[144:147]
ds_read_b64_tr_b16 a[254:255], v236 offset:17416
v_mfma_f32_16x16x32_bf16 v[148:151], a[184:187], a[208:211], v[148:151]
v_mfma_f32_16x16x32_bf16 v[148:151], a[188:191], a[228:231], v[148:151]
v_mfma_f32_16x16x32_bf16 v[152:155], a[188:191], a[232:235], v[152:155]
s_add_u32 m0, s39, 118784
v_mfma_f32_16x16x32_bf16 v[152:155], a[184:187], a[212:215], v[152:155]
buffer_load_dwordx4 v246, s[8:11], s34 offen offset:3072 lds
v_mfma_f32_16x16x32_bf16 v[156:159], a[184:187], a[216:219], v[156:159]
v_mfma_f32_16x16x32_bf16 v[156:159], a[188:191], a[236:239], v[156:159]
s_waitcnt vmcnt(19) lgkmcnt(0)
s_barrier
v_mfma_f32_16x16x32_bf16 v[160:163], a[192:195], a[200:203], v[160:163]
ds_read_b64_tr_b16 a[184:185], v233 offset:32768
v_mfma_f32_16x16x32_bf16 v[160:163], a[196:199], a[220:223], v[160:163]
ds_read_b64_tr_b16 a[186:187], v233 offset:33792
s_add_u32 m0, s48, 49152
s_xor_b32 s35, s66, 2097280
v_mfma_f32_16x16x32_bf16 v[164:167], a[196:199], a[224:227], v[164:167]
buffer_load_dwordx4 v248, s[12:15], s35 offen offset:0 lds
v_mfma_f32_16x16x32_bf16 v[164:167], a[192:195], a[204:207], v[164:167]
ds_read_b64_tr_b16 a[188:189], v235 offset:32768
v_mfma_f32_16x16x32_bf16 v[168:171], a[192:195], a[208:211], v[168:171]
ds_read_b64_tr_b16 a[190:191], v235 offset:33792
v_mfma_f32_16x16x32_bf16 v[168:171], a[196:199], a[228:231], v[168:171]
ds_read_b128 a[120:123], v241 offset:40960
v_mfma_f32_16x16x32_bf16 v[172:175], a[196:199], a[232:235], v[172:175]
ds_read_b128 a[140:143], v242 offset:40960
s_add_u32 m0, s39, 122880
v_mfma_f32_16x16x32_bf16 v[172:175], a[192:195], a[212:215], v[172:175]
buffer_load_dwordx4 v247, s[8:11], s34 offen lds
v_mfma_f32_16x16x32_bf16 v[176:179], a[192:195], a[216:219], v[176:179]
ds_read_b128 a[124:127], v241 offset:43008
v_mfma_f32_16x16x32_bf16 v[176:179], a[196:199], a[236:239], v[176:179]
ds_read_b128 a[144:147], v242 offset:43008
v_mfma_f32_16x16x32_bf16 v[180:183], a[240:243], a[200:203], v[180:183]
ds_read_b64_tr_b16 a[192:193], v233 offset:32776
v_mfma_f32_16x16x32_bf16 v[180:183], a[244:247], a[220:223], v[180:183]
ds_read_b64_tr_b16 a[194:195], v233 offset:33800
s_add_u32 m0, s48, 49152
v_mfma_f32_16x16x32_bf16 v[184:187], a[244:247], a[224:227], v[184:187]
buffer_load_dwordx4 v249, s[12:15], s35 offen offset:1024 lds
v_mfma_f32_16x16x32_bf16 v[184:187], a[240:243], a[204:207], v[184:187]
ds_read_b64_tr_b16 a[196:197], v235 offset:32776
v_mfma_f32_16x16x32_bf16 v[188:191], a[240:243], a[208:211], v[188:191]
ds_read_b64_tr_b16 a[198:199], v235 offset:33800
v_mfma_f32_16x16x32_bf16 v[188:191], a[244:247], a[228:231], v[188:191]
ds_read_b128 a[128:131], v241 offset:45056
v_mfma_f32_16x16x32_bf16 v[192:195], a[244:247], a[232:235], v[192:195]
ds_read_b128 a[148:151], v242 offset:45056
s_add_u32 m0, s48, 49152
v_mfma_f32_16x16x32_bf16 v[192:195], a[240:243], a[212:215], v[192:195]
buffer_load_dwordx4 v250, s[12:15], s35 offen offset:2048 lds
v_mfma_f32_16x16x32_bf16 v[196:199], a[240:243], a[216:219], v[196:199]
ds_read_b128 a[132:135], v241 offset:47104
v_mfma_f32_16x16x32_bf16 v[196:199], a[244:247], a[236:239], v[196:199]
ds_read_b128 a[152:155], v242 offset:47104
v_mfma_f32_16x16x32_bf16 v[200:203], a[248:251], a[200:203], v[200:203]
ds_read_b64_tr_b16 a[240:241], v234 offset:32768
v_mfma_f32_16x16x32_bf16 v[200:203], a[252:255], a[220:223], v[200:203]
ds_read_b64_tr_b16 a[242:243], v234 offset:33792
s_add_u32 m0, s48, 16384
v_mfma_f32_16x16x32_bf16 v[204:207], a[252:255], a[224:227], v[204:207]
ds_read_b128 a[136:139], v241 offset:49152
buffer_load_dwordx4 v223, s[20:23], s37 offen offset:3072 nt lds
v_mfma_f32_16x16x32_bf16 v[204:207], a[248:251], a[204:207], v[204:207]
ds_read_b64_tr_b16 a[244:245], v236 offset:32768
v_mfma_f32_16x16x32_bf16 v[208:211], a[248:251], a[208:211], v[208:211]
ds_read_b64_tr_b16 a[246:247], v236 offset:33792
v_mfma_f32_16x16x32_bf16 v[208:211], a[252:255], a[228:231], v[208:211]
ds_read_b128 a[156:159], v242 offset:49152
v_mfma_f32_16x16x32_bf16 v[212:215], a[252:255], a[232:235], v[212:215]
s_add_u32 m0, s48, 49152
v_mfma_f32_16x16x32_bf16 v[212:215], a[248:251], a[212:215], v[212:215]
buffer_load_dwordx4 v251, s[12:15], s35 offen offset:3072 lds
v_mfma_f32_16x16x32_bf16 v[216:219], a[248:251], a[216:219], v[216:219]
v_mfma_f32_16x16x32_bf16 v[216:219], a[252:255], a[236:239], v[216:219]
s_waitcnt lgkmcnt(1)
v_mfma_f32_16x16x32_bf16 v[80:83], a[184:187], a[120:123], v[80:83]
ds_read_b64_tr_b16 a[248:249], v234 offset:32776
v_mfma_f32_16x16x32_bf16 v[80:83], a[188:191], a[140:143], v[80:83]
ds_read_b64_tr_b16 a[250:251], v234 offset:33800
v_mfma_f32_16x16x32_bf16 v[84:87], a[188:191], a[144:147], v[84:87]
ds_read_b64_tr_b16 a[252:253], v236 offset:32776
v_mfma_f32_16x16x32_bf16 v[84:87], a[184:187], a[124:127], v[84:87]
ds_read_b64_tr_b16 a[254:255], v236 offset:33800
v_mfma_f32_16x16x32_bf16 v[88:91], a[184:187], a[128:131], v[88:91]
v_mfma_f32_16x16x32_bf16 v[88:91], a[188:191], a[148:151], v[88:91]
v_mfma_f32_16x16x32_bf16 v[92:95], a[188:191], a[152:155], v[92:95]
v_mfma_f32_16x16x32_bf16 v[92:95], a[184:187], a[132:135], v[92:95]
v_mfma_f32_16x16x32_bf16 v[96:99], a[184:187], a[136:139], v[96:99]
s_waitcnt lgkmcnt(4)
v_mfma_f32_16x16x32_bf16 v[96:99], a[188:191], a[156:159], v[96:99]
s_waitcnt vmcnt(17) lgkmcnt(0)
s_barrier
v_mfma_f32_16x16x32_bf16 v[100:103], a[192:195], a[120:123], v[100:103]
ds_read_b64_tr_b16 a[184:185], v233 offset:49152
v_mfma_f32_16x16x32_bf16 v[100:103], a[196:199], a[140:143], v[100:103]
ds_read_b64_tr_b16 a[186:187], v233 offset:50176
s_add_u32 m0, s48, 65536
s_xor_b32 s35, s66, 2621440
v_mfma_f32_16x16x32_bf16 v[104:107], a[196:199], a[144:147], v[104:107]
buffer_load_dwordx4 v248, s[12:15], s35 offen offset:0 lds
v_mfma_f32_16x16x32_bf16 v[104:107], a[192:195], a[124:127], v[104:107]
ds_read_b64_tr_b16 a[188:189], v235 offset:49152
v_mfma_f32_16x16x32_bf16 v[108:111], a[192:195], a[128:131], v[108:111]
ds_read_b64_tr_b16 a[190:191], v235 offset:50176
v_mfma_f32_16x16x32_bf16 v[108:111], a[196:199], a[148:151], v[108:111]
v_mfma_f32_16x16x32_bf16 v[112:115], a[196:199], a[152:155], v[112:115]
s_add_u32 m0, s39, 139264
s_xor_b32 s34, s67, 768
v_mfma_f32_16x16x32_bf16 v[112:115], a[192:195], a[132:135], v[112:115]
buffer_load_dwordx4 v243, s[8:11], s34 offen offset:0 lds
v_mfma_f32_16x16x32_bf16 v[116:119], a[192:195], a[136:139], v[116:119]
v_mfma_f32_16x16x32_bf16 v[116:119], a[196:199], a[156:159], v[116:119]
v_mfma_f32_16x16x32_bf16 v[60:63], a[240:243], a[120:123], v[60:63]
ds_read_b64_tr_b16 a[192:193], v233 offset:49160
v_mfma_f32_16x16x32_bf16 v[60:63], a[244:247], a[140:143], v[60:63]
ds_read_b64_tr_b16 a[194:195], v233 offset:50184
s_add_u32 m0, s48, 65536
v_mfma_f32_16x16x32_bf16 v[64:67], a[244:247], a[144:147], v[64:67]
buffer_load_dwordx4 v249, s[12:15], s35 offen offset:1024 lds
v_mfma_f32_16x16x32_bf16 v[64:67], a[240:243], a[124:127], v[64:67]
ds_read_b64_tr_b16 a[196:197], v235 offset:49160
v_mfma_f32_16x16x32_bf16 v[68:71], a[240:243], a[128:131], v[68:71]
ds_read_b64_tr_b16 a[198:199], v235 offset:50184
v_mfma_f32_16x16x32_bf16 v[68:71], a[244:247], a[148:151], v[68:71]
v_mfma_f32_16x16x32_bf16 v[72:75], a[244:247], a[152:155], v[72:75]
s_add_u32 m0, s48, 65536
v_mfma_f32_16x16x32_bf16 v[72:75], a[240:243], a[132:135], v[72:75]
buffer_load_dwordx4 v250, s[12:15], s35 offen offset:2048 lds
v_mfma_f32_16x16x32_bf16 v[76:79], a[240:243], a[136:139], v[76:79]
v_mfma_f32_16x16x32_bf16 v[76:79], a[244:247], a[156:159], v[76:79]
v_mfma_f32_16x16x32_bf16 v[120:123], a[248:251], a[120:123], v[120:123]
ds_read_b64_tr_b16 a[240:241], v234 offset:49152
v_mfma_f32_16x16x32_bf16 v[120:123], a[252:255], a[140:143], v[120:123]
ds_read_b64_tr_b16 a[242:243], v234 offset:50176
s_add_u32 m0, s39, 139264
v_mfma_f32_16x16x32_bf16 v[124:127], a[252:255], a[144:147], v[124:127]
buffer_load_dwordx4 v244, s[8:11], s34 offen offset:1024 lds
v_mfma_f32_16x16x32_bf16 v[124:127], a[248:251], a[124:127], v[124:127]
ds_read_b64_tr_b16 a[244:245], v236 offset:49152
v_mfma_f32_16x16x32_bf16 v[128:131], a[248:251], a[128:131], v[128:131]
ds_read_b64_tr_b16 a[246:247], v236 offset:50176
v_mfma_f32_16x16x32_bf16 v[128:131], a[252:255], a[148:151], v[128:131]
v_mfma_f32_16x16x32_bf16 v[132:135], a[252:255], a[152:155], v[132:135]
s_add_u32 m0, s48, 65536
v_mfma_f32_16x16x32_bf16 v[132:135], a[248:251], a[132:135], v[132:135]
buffer_load_dwordx4 v251, s[12:15], s35 offen offset:3072 lds
v_mfma_f32_16x16x32_bf16 v[136:139], a[248:251], a[136:139], v[136:139]
v_mfma_f32_16x16x32_bf16 v[136:139], a[252:255], a[156:159], v[136:139]
s_waitcnt lgkmcnt(4)
v_mfma_f32_16x16x32_bf16 v[140:143], a[184:187], a[120:123], v[140:143]
ds_read_b64_tr_b16 a[248:249], v234 offset:49160
v_mfma_f32_16x16x32_bf16 v[140:143], a[188:191], a[140:143], v[140:143]
ds_read_b64_tr_b16 a[250:251], v234 offset:50184
s_add_u32 m0, s39, 139264
v_mfma_f32_16x16x32_bf16 v[144:147], a[188:191], a[144:147], v[144:147]
ds_read_b64_tr_b16 a[252:253], v236 offset:49160
buffer_load_dwordx4 v245, s[8:11], s34 offen offset:2048 lds
v_mfma_f32_16x16x32_bf16 v[144:147], a[184:187], a[124:127], v[144:147]
ds_read_b64_tr_b16 a[254:255], v236 offset:50184
v_mfma_f32_16x16x32_bf16 v[148:151], a[184:187], a[128:131], v[148:151]
v_mfma_f32_16x16x32_bf16 v[148:151], a[188:191], a[148:151], v[148:151]
v_mfma_f32_16x16x32_bf16 v[152:155], a[188:191], a[152:155], v[152:155]
s_add_u32 m0, s39, 139264
v_mfma_f32_16x16x32_bf16 v[152:155], a[184:187], a[132:135], v[152:155]
buffer_load_dwordx4 v246, s[8:11], s34 offen offset:3072 lds
v_mfma_f32_16x16x32_bf16 v[156:159], a[184:187], a[136:139], v[156:159]
v_mfma_f32_16x16x32_bf16 v[156:159], a[188:191], a[156:159], v[156:159]
s_waitcnt vmcnt(16) lgkmcnt(0)
s_barrier
v_mfma_f32_16x16x32_bf16 v[160:163], a[192:195], a[120:123], v[160:163]
ds_read_b64_tr_b16 a[184:185], v233 offset:0
v_mfma_f32_16x16x32_bf16 v[160:163], a[196:199], a[140:143], v[160:163]
ds_read_b64_tr_b16 a[186:187], v233 offset:1024
s_add_u32 m0, s48, 81920
s_xor_b32 s35, s66, 2621568
v_mfma_f32_16x16x32_bf16 v[164:167], a[196:199], a[144:147], v[164:167]
buffer_load_dwordx4 v248, s[12:15], s35 offen offset:0 lds
v_mfma_f32_16x16x32_bf16 v[164:167], a[192:195], a[124:127], v[164:167]
ds_read_b64_tr_b16 a[188:189], v235 offset:0
v_mfma_f32_16x16x32_bf16 v[168:171], a[192:195], a[128:131], v[168:171]
ds_read_b64_tr_b16 a[190:191], v235 offset:1024
v_mfma_f32_16x16x32_bf16 v[168:171], a[196:199], a[148:151], v[168:171]
ds_read_b128 a[200:203], v241 offset:0
v_mfma_f32_16x16x32_bf16 v[172:175], a[196:199], a[152:155], v[172:175]
ds_read_b128 a[220:223], v242 offset:0
s_add_u32 m0, s39, 143360
v_mfma_f32_16x16x32_bf16 v[172:175], a[192:195], a[132:135], v[172:175]
buffer_load_dwordx4 v247, s[8:11], s34 offen lds
v_mfma_f32_16x16x32_bf16 v[176:179], a[192:195], a[136:139], v[176:179]
ds_read_b128 a[204:207], v241 offset:2048
v_mfma_f32_16x16x32_bf16 v[176:179], a[196:199], a[156:159], v[176:179]
ds_read_b128 a[224:227], v242 offset:2048
v_mfma_f32_16x16x32_bf16 v[180:183], a[240:243], a[120:123], v[180:183]
ds_read_b64_tr_b16 a[192:193], v233 offset:8
v_mfma_f32_16x16x32_bf16 v[180:183], a[244:247], a[140:143], v[180:183]
ds_read_b64_tr_b16 a[194:195], v233 offset:1032
s_add_u32 m0, s48, 81920
v_mfma_f32_16x16x32_bf16 v[184:187], a[244:247], a[144:147], v[184:187]
buffer_load_dwordx4 v249, s[12:15], s35 offen offset:1024 lds
v_mfma_f32_16x16x32_bf16 v[184:187], a[240:243], a[124:127], v[184:187]
ds_read_b64_tr_b16 a[196:197], v235 offset:8
v_mfma_f32_16x16x32_bf16 v[188:191], a[240:243], a[128:131], v[188:191]
ds_read_b64_tr_b16 a[198:199], v235 offset:1032
v_mfma_f32_16x16x32_bf16 v[188:191], a[244:247], a[148:151], v[188:191]
ds_read_b128 a[208:211], v241 offset:4096
v_mfma_f32_16x16x32_bf16 v[192:195], a[244:247], a[152:155], v[192:195]
ds_read_b128 a[228:231], v242 offset:4096
s_add_u32 m0, s48, 81920
v_mfma_f32_16x16x32_bf16 v[192:195], a[240:243], a[132:135], v[192:195]
buffer_load_dwordx4 v250, s[12:15], s35 offen offset:2048 lds
v_mfma_f32_16x16x32_bf16 v[196:199], a[240:243], a[136:139], v[196:199]
ds_read_b128 a[212:215], v241 offset:6144
v_mfma_f32_16x16x32_bf16 v[196:199], a[244:247], a[156:159], v[196:199]
ds_read_b128 a[232:235], v242 offset:6144
v_mfma_f32_16x16x32_bf16 v[200:203], a[248:251], a[120:123], v[200:203]
ds_read_b64_tr_b16 a[240:241], v234 offset:0
v_mfma_f32_16x16x32_bf16 v[200:203], a[252:255], a[140:143], v[200:203]
ds_read_b64_tr_b16 a[242:243], v234 offset:1024
s_xor_b32 s38, s3, 24576
v_mfma_f32_16x16x32_bf16 v[204:207], a[252:255], a[144:147], v[204:207]
ds_read_b128 a[216:219], v241 offset:8192
buffer_load_dwordx4 a[0:3], v220, s[16:19], s38 offen offset:0 nt
v_mfma_f32_16x16x32_bf16 v[204:207], a[248:251], a[124:127], v[204:207]
ds_read_b64_tr_b16 a[244:245], v236 offset:0
v_mfma_f32_16x16x32_bf16 v[208:211], a[248:251], a[128:131], v[208:211]
ds_read_b64_tr_b16 a[246:247], v236 offset:1024
v_mfma_f32_16x16x32_bf16 v[208:211], a[252:255], a[148:151], v[208:211]
ds_read_b128 a[236:239], v242 offset:8192
v_mfma_f32_16x16x32_bf16 v[212:215], a[252:255], a[152:155], v[212:215]
s_add_u32 m0, s48, 81920
v_mfma_f32_16x16x32_bf16 v[212:215], a[248:251], a[132:135], v[212:215]
buffer_load_dwordx4 v251, s[12:15], s35 offen offset:3072 lds
v_mfma_f32_16x16x32_bf16 v[216:219], a[248:251], a[136:139], v[216:219]
v_mfma_f32_16x16x32_bf16 v[216:219], a[252:255], a[156:159], v[216:219]
s_waitcnt lgkmcnt(1)
v_mfma_f32_16x16x32_bf16 v[80:83], a[184:187], a[200:203], v[80:83]
ds_read_b64_tr_b16 a[248:249], v234 offset:8
v_mfma_f32_16x16x32_bf16 v[80:83], a[188:191], a[220:223], v[80:83]
ds_read_b64_tr_b16 a[250:251], v234 offset:1032
s_xor_b32 s38, s3, 24576
v_mfma_f32_16x16x32_bf16 v[84:87], a[188:191], a[224:227], v[84:87]
ds_read_b64_tr_b16 a[252:253], v236 offset:8
buffer_load_dwordx4 a[4:7], v221, s[16:19], s38 offen offset:1024 nt
v_mfma_f32_16x16x32_bf16 v[84:87], a[184:187], a[204:207], v[84:87]
ds_read_b64_tr_b16 a[254:255], v236 offset:1032
v_mfma_f32_16x16x32_bf16 v[88:91], a[184:187], a[208:211], v[88:91]
v_mfma_f32_16x16x32_bf16 v[88:91], a[188:191], a[228:231], v[88:91]
v_mfma_f32_16x16x32_bf16 v[92:95], a[188:191], a[232:235], v[92:95]
v_mfma_f32_16x16x32_bf16 v[92:95], a[184:187], a[212:215], v[92:95]
v_mfma_f32_16x16x32_bf16 v[96:99], a[184:187], a[216:219], v[96:99]
s_waitcnt lgkmcnt(3)
v_mfma_f32_16x16x32_bf16 v[96:99], a[188:191], a[236:239], v[96:99]
s_waitcnt vmcnt(15) lgkmcnt(0)
s_barrier
v_mfma_f32_16x16x32_bf16 v[100:103], a[192:195], a[200:203], v[100:103]
ds_read_b64_tr_b16 a[184:185], v233 offset:16384
v_mfma_f32_16x16x32_bf16 v[100:103], a[196:199], a[220:223], v[100:103]
ds_read_b64_tr_b16 a[186:187], v233 offset:17408
s_add_u32 m0, s48, 32768
s_xor_b32 s35, s66, 3145728
v_mfma_f32_16x16x32_bf16 v[104:107], a[196:199], a[224:227], v[104:107]
buffer_load_dwordx4 v248, s[12:15], s35 offen offset:0 lds
v_mfma_f32_16x16x32_bf16 v[104:107], a[192:195], a[204:207], v[104:107]
ds_read_b64_tr_b16 a[188:189], v235 offset:16384
v_mfma_f32_16x16x32_bf16 v[108:111], a[192:195], a[208:211], v[108:111]
ds_read_b64_tr_b16 a[190:191], v235 offset:17408
v_mfma_f32_16x16x32_bf16 v[108:111], a[196:199], a[228:231], v[108:111]
v_mfma_f32_16x16x32_bf16 v[112:115], a[196:199], a[232:235], v[112:115]
s_add_u32 m0, s39, 98304
s_xor_b32 s34, s67, 896
v_mfma_f32_16x16x32_bf16 v[112:115], a[192:195], a[212:215], v[112:115]
buffer_load_dwordx4 v243, s[8:11], s34 offen offset:0 lds
v_mfma_f32_16x16x32_bf16 v[116:119], a[192:195], a[216:219], v[116:119]
v_mfma_f32_16x16x32_bf16 v[116:119], a[196:199], a[236:239], v[116:119]
v_mfma_f32_16x16x32_bf16 v[60:63], a[240:243], a[200:203], v[60:63]
ds_read_b64_tr_b16 a[192:193], v233 offset:16392
v_mfma_f32_16x16x32_bf16 v[60:63], a[244:247], a[220:223], v[60:63]
ds_read_b64_tr_b16 a[194:195], v233 offset:17416
s_add_u32 m0, s48, 32768
v_mfma_f32_16x16x32_bf16 v[64:67], a[244:247], a[224:227], v[64:67]
buffer_load_dwordx4 v249, s[12:15], s35 offen offset:1024 lds
v_mfma_f32_16x16x32_bf16 v[64:67], a[240:243], a[204:207], v[64:67]
ds_read_b64_tr_b16 a[196:197], v235 offset:16392
v_mfma_f32_16x16x32_bf16 v[68:71], a[240:243], a[208:211], v[68:71]
ds_read_b64_tr_b16 a[198:199], v235 offset:17416
v_mfma_f32_16x16x32_bf16 v[68:71], a[244:247], a[228:231], v[68:71]
v_mfma_f32_16x16x32_bf16 v[72:75], a[244:247], a[232:235], v[72:75]
s_add_u32 m0, s48, 32768
v_mfma_f32_16x16x32_bf16 v[72:75], a[240:243], a[212:215], v[72:75]
buffer_load_dwordx4 v250, s[12:15], s35 offen offset:2048 lds
v_mfma_f32_16x16x32_bf16 v[76:79], a[240:243], a[216:219], v[76:79]
v_mfma_f32_16x16x32_bf16 v[76:79], a[244:247], a[236:239], v[76:79]
v_mfma_f32_16x16x32_bf16 v[120:123], a[248:251], a[200:203], v[120:123]
ds_read_b64_tr_b16 a[240:241], v234 offset:16384
v_mfma_f32_16x16x32_bf16 v[120:123], a[252:255], a[220:223], v[120:123]
ds_read_b64_tr_b16 a[242:243], v234 offset:17408
s_add_u32 m0, s39, 98304
v_mfma_f32_16x16x32_bf16 v[124:127], a[252:255], a[224:227], v[124:127]
buffer_load_dwordx4 v244, s[8:11], s34 offen offset:1024 lds
v_mfma_f32_16x16x32_bf16 v[124:127], a[248:251], a[204:207], v[124:127]
ds_read_b64_tr_b16 a[244:245], v236 offset:16384
v_mfma_f32_16x16x32_bf16 v[128:131], a[248:251], a[208:211], v[128:131]
ds_read_b64_tr_b16 a[246:247], v236 offset:17408
v_mfma_f32_16x16x32_bf16 v[128:131], a[252:255], a[228:231], v[128:131]
v_mfma_f32_16x16x32_bf16 v[132:135], a[252:255], a[232:235], v[132:135]
s_add_u32 m0, s48, 32768
v_mfma_f32_16x16x32_bf16 v[132:135], a[248:251], a[212:215], v[132:135]
buffer_load_dwordx4 v251, s[12:15], s35 offen offset:3072 lds
v_mfma_f32_16x16x32_bf16 v[136:139], a[248:251], a[216:219], v[136:139]
v_mfma_f32_16x16x32_bf16 v[136:139], a[252:255], a[236:239], v[136:139]
s_waitcnt lgkmcnt(4)
v_mfma_f32_16x16x32_bf16 v[140:143], a[184:187], a[200:203], v[140:143]
ds_read_b64_tr_b16 a[248:249], v234 offset:16392
v_mfma_f32_16x16x32_bf16 v[140:143], a[188:191], a[220:223], v[140:143]
ds_read_b64_tr_b16 a[250:251], v234 offset:17416
s_add_u32 m0, s39, 98304
v_mfma_f32_16x16x32_bf16 v[144:147], a[188:191], a[224:227], v[144:147]
ds_read_b64_tr_b16 a[252:253], v236 offset:16392
buffer_load_dwordx4 v245, s[8:11], s34 offen offset:2048 lds
v_mfma_f32_16x16x32_bf16 v[144:147], a[184:187], a[204:207], v[144:147]
ds_read_b64_tr_b16 a[254:255], v236 offset:17416
v_mfma_f32_16x16x32_bf16 v[148:151], a[184:187], a[208:211], v[148:151]
v_mfma_f32_16x16x32_bf16 v[148:151], a[188:191], a[228:231], v[148:151]
v_mfma_f32_16x16x32_bf16 v[152:155], a[188:191], a[232:235], v[152:155]
s_add_u32 m0, s39, 98304
v_mfma_f32_16x16x32_bf16 v[152:155], a[184:187], a[212:215], v[152:155]
buffer_load_dwordx4 v246, s[8:11], s34 offen offset:3072 lds
v_mfma_f32_16x16x32_bf16 v[156:159], a[184:187], a[216:219], v[156:159]
v_mfma_f32_16x16x32_bf16 v[156:159], a[188:191], a[236:239], v[156:159]
s_waitcnt vmcnt(17) lgkmcnt(0)
s_barrier
v_mfma_f32_16x16x32_bf16 v[160:163], a[192:195], a[200:203], v[160:163]
ds_read_b64_tr_b16 a[184:185], v233 offset:32768
v_mfma_f32_16x16x32_bf16 v[160:163], a[196:199], a[220:223], v[160:163]
ds_read_b64_tr_b16 a[186:187], v233 offset:33792
s_add_u32 m0, s48, 49152
s_xor_b32 s35, s66, 3145856
v_mfma_f32_16x16x32_bf16 v[164:167], a[196:199], a[224:227], v[164:167]
buffer_load_dwordx4 v248, s[12:15], s35 offen offset:0 lds
v_mfma_f32_16x16x32_bf16 v[164:167], a[192:195], a[204:207], v[164:167]
ds_read_b64_tr_b16 a[188:189], v235 offset:32768
v_mfma_f32_16x16x32_bf16 v[168:171], a[192:195], a[208:211], v[168:171]
ds_read_b64_tr_b16 a[190:191], v235 offset:33792
v_mfma_f32_16x16x32_bf16 v[168:171], a[196:199], a[228:231], v[168:171]
ds_read_b128 a[120:123], v241 offset:20480
v_mfma_f32_16x16x32_bf16 v[172:175], a[196:199], a[232:235], v[172:175]
ds_read_b128 a[140:143], v242 offset:20480
s_add_u32 m0, s39, 102400
v_mfma_f32_16x16x32_bf16 v[172:175], a[192:195], a[212:215], v[172:175]
buffer_load_dwordx4 v247, s[8:11], s34 offen lds
v_mfma_f32_16x16x32_bf16 v[176:179], a[192:195], a[216:219], v[176:179]
ds_read_b128 a[124:127], v241 offset:22528
v_mfma_f32_16x16x32_bf16 v[176:179], a[196:199], a[236:239], v[176:179]
ds_read_b128 a[144:147], v242 offset:22528
v_mfma_f32_16x16x32_bf16 v[180:183], a[240:243], a[200:203], v[180:183]
ds_read_b64_tr_b16 a[192:193], v233 offset:32776
v_mfma_f32_16x16x32_bf16 v[180:183], a[244:247], a[220:223], v[180:183]
ds_read_b64_tr_b16 a[194:195], v233 offset:33800
s_add_u32 m0, s48, 49152
v_mfma_f32_16x16x32_bf16 v[184:187], a[244:247], a[224:227], v[184:187]
buffer_load_dwordx4 v249, s[12:15], s35 offen offset:1024 lds
v_mfma_f32_16x16x32_bf16 v[184:187], a[240:243], a[204:207], v[184:187]
ds_read_b64_tr_b16 a[196:197], v235 offset:32776
v_mfma_f32_16x16x32_bf16 v[188:191], a[240:243], a[208:211], v[188:191]
ds_read_b64_tr_b16 a[198:199], v235 offset:33800
v_mfma_f32_16x16x32_bf16 v[188:191], a[244:247], a[228:231], v[188:191]
ds_read_b128 a[128:131], v241 offset:24576
v_mfma_f32_16x16x32_bf16 v[192:195], a[244:247], a[232:235], v[192:195]
ds_read_b128 a[148:151], v242 offset:24576
s_add_u32 m0, s48, 49152
v_mfma_f32_16x16x32_bf16 v[192:195], a[240:243], a[212:215], v[192:195]
buffer_load_dwordx4 v250, s[12:15], s35 offen offset:2048 lds
v_mfma_f32_16x16x32_bf16 v[196:199], a[240:243], a[216:219], v[196:199]
ds_read_b128 a[132:135], v241 offset:26624
v_mfma_f32_16x16x32_bf16 v[196:199], a[244:247], a[236:239], v[196:199]
ds_read_b128 a[152:155], v242 offset:26624
v_mfma_f32_16x16x32_bf16 v[200:203], a[248:251], a[200:203], v[200:203]
ds_read_b64_tr_b16 a[240:241], v234 offset:32768
v_mfma_f32_16x16x32_bf16 v[200:203], a[252:255], a[220:223], v[200:203]
ds_read_b64_tr_b16 a[242:243], v234 offset:33792
s_xor_b32 s38, s3, 24576
v_mfma_f32_16x16x32_bf16 v[204:207], a[252:255], a[224:227], v[204:207]
ds_read_b128 a[136:139], v241 offset:28672
buffer_load_dwordx4 a[8:11], v222, s[16:19], s38 offen offset:2048 nt
v_mfma_f32_16x16x32_bf16 v[204:207], a[248:251], a[204:207], v[204:207]
ds_read_b64_tr_b16 a[244:245], v236 offset:32768
v_mfma_f32_16x16x32_bf16 v[208:211], a[248:251], a[208:211], v[208:211]
ds_read_b64_tr_b16 a[246:247], v236 offset:33792
v_mfma_f32_16x16x32_bf16 v[208:211], a[252:255], a[228:231], v[208:211]
ds_read_b128 a[156:159], v242 offset:28672
v_mfma_f32_16x16x32_bf16 v[212:215], a[252:255], a[232:235], v[212:215]
s_add_u32 m0, s48, 49152
v_mfma_f32_16x16x32_bf16 v[212:215], a[248:251], a[212:215], v[212:215]
buffer_load_dwordx4 v251, s[12:15], s35 offen offset:3072 lds
v_mfma_f32_16x16x32_bf16 v[216:219], a[248:251], a[216:219], v[216:219]
v_mfma_f32_16x16x32_bf16 v[216:219], a[252:255], a[236:239], v[216:219]
s_waitcnt lgkmcnt(1)
v_mfma_f32_16x16x32_bf16 v[80:83], a[184:187], a[120:123], v[80:83]
ds_read_b64_tr_b16 a[248:249], v234 offset:32776
v_mfma_f32_16x16x32_bf16 v[80:83], a[188:191], a[140:143], v[80:83]
ds_read_b64_tr_b16 a[250:251], v234 offset:33800
v_mfma_f32_16x16x32_bf16 v[84:87], a[188:191], a[144:147], v[84:87]
ds_read_b64_tr_b16 a[252:253], v236 offset:32776
v_mfma_f32_16x16x32_bf16 v[84:87], a[184:187], a[124:127], v[84:87]
ds_read_b64_tr_b16 a[254:255], v236 offset:33800
v_mfma_f32_16x16x32_bf16 v[88:91], a[184:187], a[128:131], v[88:91]
v_mfma_f32_16x16x32_bf16 v[88:91], a[188:191], a[148:151], v[88:91]
v_mfma_f32_16x16x32_bf16 v[92:95], a[188:191], a[152:155], v[92:95]
v_mfma_f32_16x16x32_bf16 v[92:95], a[184:187], a[132:135], v[92:95]
v_mfma_f32_16x16x32_bf16 v[96:99], a[184:187], a[136:139], v[96:99]
s_waitcnt lgkmcnt(4)
v_mfma_f32_16x16x32_bf16 v[96:99], a[188:191], a[156:159], v[96:99]
s_waitcnt vmcnt(15) lgkmcnt(0)
s_barrier
v_mfma_f32_16x16x32_bf16 v[100:103], a[192:195], a[120:123], v[100:103]
ds_read_b64_tr_b16 a[184:185], v233 offset:49152
v_mfma_f32_16x16x32_bf16 v[100:103], a[196:199], a[140:143], v[100:103]
ds_read_b64_tr_b16 a[186:187], v233 offset:50176
s_add_u32 m0, s48, 65536
s_xor_b32 s35, s66, 3670016
v_mfma_f32_16x16x32_bf16 v[104:107], a[196:199], a[144:147], v[104:107]
buffer_load_dwordx4 v248, s[12:15], s35 offen offset:0 lds
v_mfma_f32_16x16x32_bf16 v[104:107], a[192:195], a[124:127], v[104:107]
ds_read_b64_tr_b16 a[188:189], v235 offset:49152
v_mfma_f32_16x16x32_bf16 v[108:111], a[192:195], a[128:131], v[108:111]
ds_read_b64_tr_b16 a[190:191], v235 offset:50176
v_mfma_f32_16x16x32_bf16 v[108:111], a[196:199], a[148:151], v[108:111]
v_mfma_f32_16x16x32_bf16 v[112:115], a[196:199], a[152:155], v[112:115]
s_add_u32 m0, s39, 118784
s_xor_b32 s34, s67, 1024
v_mfma_f32_16x16x32_bf16 v[112:115], a[192:195], a[132:135], v[112:115]
buffer_load_dwordx4 v243, s[8:11], s34 offen offset:0 lds
v_mfma_f32_16x16x32_bf16 v[116:119], a[192:195], a[136:139], v[116:119]
v_mfma_f32_16x16x32_bf16 v[116:119], a[196:199], a[156:159], v[116:119]
v_mfma_f32_16x16x32_bf16 v[60:63], a[240:243], a[120:123], v[60:63]
ds_read_b64_tr_b16 a[192:193], v233 offset:49160
v_mfma_f32_16x16x32_bf16 v[60:63], a[244:247], a[140:143], v[60:63]
ds_read_b64_tr_b16 a[194:195], v233 offset:50184
s_add_u32 m0, s48, 65536
v_mfma_f32_16x16x32_bf16 v[64:67], a[244:247], a[144:147], v[64:67]
buffer_load_dwordx4 v249, s[12:15], s35 offen offset:1024 lds
v_mfma_f32_16x16x32_bf16 v[64:67], a[240:243], a[124:127], v[64:67]
ds_read_b64_tr_b16 a[196:197], v235 offset:49160
v_mfma_f32_16x16x32_bf16 v[68:71], a[240:243], a[128:131], v[68:71]
ds_read_b64_tr_b16 a[198:199], v235 offset:50184
v_mfma_f32_16x16x32_bf16 v[68:71], a[244:247], a[148:151], v[68:71]
v_mfma_f32_16x16x32_bf16 v[72:75], a[244:247], a[152:155], v[72:75]
s_add_u32 m0, s48, 65536
v_mfma_f32_16x16x32_bf16 v[72:75], a[240:243], a[132:135], v[72:75]
buffer_load_dwordx4 v250, s[12:15], s35 offen offset:2048 lds
v_mfma_f32_16x16x32_bf16 v[76:79], a[240:243], a[136:139], v[76:79]
v_mfma_f32_16x16x32_bf16 v[76:79], a[244:247], a[156:159], v[76:79]
v_mfma_f32_16x16x32_bf16 v[120:123], a[248:251], a[120:123], v[120:123]
ds_read_b64_tr_b16 a[240:241], v234 offset:49152
v_mfma_f32_16x16x32_bf16 v[120:123], a[252:255], a[140:143], v[120:123]
ds_read_b64_tr_b16 a[242:243], v234 offset:50176
s_add_u32 m0, s39, 118784
v_mfma_f32_16x16x32_bf16 v[124:127], a[252:255], a[144:147], v[124:127]
buffer_load_dwordx4 v244, s[8:11], s34 offen offset:1024 lds
v_mfma_f32_16x16x32_bf16 v[124:127], a[248:251], a[124:127], v[124:127]
ds_read_b64_tr_b16 a[244:245], v236 offset:49152
v_mfma_f32_16x16x32_bf16 v[128:131], a[248:251], a[128:131], v[128:131]
ds_read_b64_tr_b16 a[246:247], v236 offset:50176
v_mfma_f32_16x16x32_bf16 v[128:131], a[252:255], a[148:151], v[128:131]
v_mfma_f32_16x16x32_bf16 v[132:135], a[252:255], a[152:155], v[132:135]
s_add_u32 m0, s48, 65536
v_mfma_f32_16x16x32_bf16 v[132:135], a[248:251], a[132:135], v[132:135]
buffer_load_dwordx4 v251, s[12:15], s35 offen offset:3072 lds
v_mfma_f32_16x16x32_bf16 v[136:139], a[248:251], a[136:139], v[136:139]
v_mfma_f32_16x16x32_bf16 v[136:139], a[252:255], a[156:159], v[136:139]
s_waitcnt lgkmcnt(4)
v_mfma_f32_16x16x32_bf16 v[140:143], a[184:187], a[120:123], v[140:143]
ds_read_b64_tr_b16 a[248:249], v234 offset:49160
v_mfma_f32_16x16x32_bf16 v[140:143], a[188:191], a[140:143], v[140:143]
ds_read_b64_tr_b16 a[250:251], v234 offset:50184
s_add_u32 m0, s39, 118784
v_mfma_f32_16x16x32_bf16 v[144:147], a[188:191], a[144:147], v[144:147]
ds_read_b64_tr_b16 a[252:253], v236 offset:49160
buffer_load_dwordx4 v245, s[8:11], s34 offen offset:2048 lds
v_mfma_f32_16x16x32_bf16 v[144:147], a[184:187], a[124:127], v[144:147]
ds_read_b64_tr_b16 a[254:255], v236 offset:50184
v_mfma_f32_16x16x32_bf16 v[148:151], a[184:187], a[128:131], v[148:151]
v_mfma_f32_16x16x32_bf16 v[148:151], a[188:191], a[148:151], v[148:151]
v_mfma_f32_16x16x32_bf16 v[152:155], a[188:191], a[152:155], v[152:155]
s_add_u32 m0, s39, 118784
v_mfma_f32_16x16x32_bf16 v[152:155], a[184:187], a[132:135], v[152:155]
buffer_load_dwordx4 v246, s[8:11], s34 offen offset:3072 lds
v_mfma_f32_16x16x32_bf16 v[156:159], a[184:187], a[136:139], v[156:159]
v_mfma_f32_16x16x32_bf16 v[156:159], a[188:191], a[156:159], v[156:159]
s_waitcnt vmcnt(16) lgkmcnt(0)
s_barrier
v_mfma_f32_16x16x32_bf16 v[160:163], a[192:195], a[120:123], v[160:163]
ds_read_b64_tr_b16 a[184:185], v233 offset:0
v_mfma_f32_16x16x32_bf16 v[160:163], a[196:199], a[140:143], v[160:163]
ds_read_b64_tr_b16 a[186:187], v233 offset:1024
s_add_u32 m0, s48, 81920
s_xor_b32 s35, s66, 3670144
v_mfma_f32_16x16x32_bf16 v[164:167], a[196:199], a[144:147], v[164:167]
buffer_load_dwordx4 v248, s[12:15], s35 offen offset:0 lds
v_mfma_f32_16x16x32_bf16 v[164:167], a[192:195], a[124:127], v[164:167]
ds_read_b64_tr_b16 a[188:189], v235 offset:0
v_mfma_f32_16x16x32_bf16 v[168:171], a[192:195], a[128:131], v[168:171]
ds_read_b64_tr_b16 a[190:191], v235 offset:1024
v_mfma_f32_16x16x32_bf16 v[168:171], a[196:199], a[148:151], v[168:171]
ds_read_b128 a[200:203], v241 offset:40960
v_mfma_f32_16x16x32_bf16 v[172:175], a[196:199], a[152:155], v[172:175]
ds_read_b128 a[220:223], v242 offset:40960
s_add_u32 m0, s39, 122880
v_mfma_f32_16x16x32_bf16 v[172:175], a[192:195], a[132:135], v[172:175]
buffer_load_dwordx4 v247, s[8:11], s34 offen lds
v_mfma_f32_16x16x32_bf16 v[176:179], a[192:195], a[136:139], v[176:179]
ds_read_b128 a[204:207], v241 offset:43008
v_mfma_f32_16x16x32_bf16 v[176:179], a[196:199], a[156:159], v[176:179]
ds_read_b128 a[224:227], v242 offset:43008
v_mfma_f32_16x16x32_bf16 v[180:183], a[240:243], a[120:123], v[180:183]
ds_read_b64_tr_b16 a[192:193], v233 offset:8
v_mfma_f32_16x16x32_bf16 v[180:183], a[244:247], a[140:143], v[180:183]
ds_read_b64_tr_b16 a[194:195], v233 offset:1032
s_add_u32 m0, s48, 81920
v_mfma_f32_16x16x32_bf16 v[184:187], a[244:247], a[144:147], v[184:187]
buffer_load_dwordx4 v249, s[12:15], s35 offen offset:1024 lds
v_mfma_f32_16x16x32_bf16 v[184:187], a[240:243], a[124:127], v[184:187]
ds_read_b64_tr_b16 a[196:197], v235 offset:8
v_mfma_f32_16x16x32_bf16 v[188:191], a[240:243], a[128:131], v[188:191]
ds_read_b64_tr_b16 a[198:199], v235 offset:1032
v_mfma_f32_16x16x32_bf16 v[188:191], a[244:247], a[148:151], v[188:191]
ds_read_b128 a[208:211], v241 offset:45056
v_mfma_f32_16x16x32_bf16 v[192:195], a[244:247], a[152:155], v[192:195]
ds_read_b128 a[228:231], v242 offset:45056
s_add_u32 m0, s48, 81920
v_mfma_f32_16x16x32_bf16 v[192:195], a[240:243], a[132:135], v[192:195]
buffer_load_dwordx4 v250, s[12:15], s35 offen offset:2048 lds
v_mfma_f32_16x16x32_bf16 v[196:199], a[240:243], a[136:139], v[196:199]
ds_read_b128 a[212:215], v241 offset:47104
v_mfma_f32_16x16x32_bf16 v[196:199], a[244:247], a[156:159], v[196:199]
ds_read_b128 a[232:235], v242 offset:47104
v_mfma_f32_16x16x32_bf16 v[200:203], a[248:251], a[120:123], v[200:203]
ds_read_b64_tr_b16 a[240:241], v234 offset:0
v_mfma_f32_16x16x32_bf16 v[200:203], a[252:255], a[140:143], v[200:203]
ds_read_b64_tr_b16 a[242:243], v234 offset:1024
s_xor_b32 s38, s3, 24576
v_mfma_f32_16x16x32_bf16 v[204:207], a[252:255], a[144:147], v[204:207]
ds_read_b128 a[216:219], v241 offset:49152
buffer_load_dwordx4 a[12:15], v223, s[16:19], s38 offen offset:3072 nt
v_mfma_f32_16x16x32_bf16 v[204:207], a[248:251], a[124:127], v[204:207]
ds_read_b64_tr_b16 a[244:245], v236 offset:0
v_mfma_f32_16x16x32_bf16 v[208:211], a[248:251], a[128:131], v[208:211]
ds_read_b64_tr_b16 a[246:247], v236 offset:1024
v_mfma_f32_16x16x32_bf16 v[208:211], a[252:255], a[148:151], v[208:211]
ds_read_b128 a[236:239], v242 offset:49152
v_mfma_f32_16x16x32_bf16 v[212:215], a[252:255], a[152:155], v[212:215]
s_add_u32 m0, s48, 81920
v_mfma_f32_16x16x32_bf16 v[212:215], a[248:251], a[132:135], v[212:215]
buffer_load_dwordx4 v251, s[12:15], s35 offen offset:3072 lds
v_mfma_f32_16x16x32_bf16 v[216:219], a[248:251], a[136:139], v[216:219]
v_mfma_f32_16x16x32_bf16 v[216:219], a[252:255], a[156:159], v[216:219]
s_waitcnt lgkmcnt(1)
v_mfma_f32_16x16x32_bf16 v[80:83], a[184:187], a[200:203], v[80:83]
ds_read_b64_tr_b16 a[248:249], v234 offset:8
v_mfma_f32_16x16x32_bf16 v[80:83], a[188:191], a[220:223], v[80:83]
ds_read_b64_tr_b16 a[250:251], v234 offset:1032
v_mfma_f32_16x16x32_bf16 v[84:87], a[188:191], a[224:227], v[84:87]
ds_read_b64_tr_b16 a[252:253], v236 offset:8
v_mfma_f32_16x16x32_bf16 v[84:87], a[184:187], a[204:207], v[84:87]
ds_read_b64_tr_b16 a[254:255], v236 offset:1032
v_mfma_f32_16x16x32_bf16 v[88:91], a[184:187], a[208:211], v[88:91]
v_mfma_f32_16x16x32_bf16 v[88:91], a[188:191], a[228:231], v[88:91]
v_mfma_f32_16x16x32_bf16 v[92:95], a[188:191], a[232:235], v[92:95]
v_mfma_f32_16x16x32_bf16 v[92:95], a[184:187], a[212:215], v[92:95]
v_mfma_f32_16x16x32_bf16 v[96:99], a[184:187], a[216:219], v[96:99]
s_waitcnt lgkmcnt(4)
v_mfma_f32_16x16x32_bf16 v[96:99], a[188:191], a[236:239], v[96:99]
s_waitcnt vmcnt(14) lgkmcnt(0)
s_barrier
v_mfma_f32_16x16x32_bf16 v[100:103], a[192:195], a[200:203], v[100:103]
ds_read_b64_tr_b16 a[184:185], v233 offset:16384
v_mfma_f32_16x16x32_bf16 v[100:103], a[196:199], a[220:223], v[100:103]
ds_read_b64_tr_b16 a[186:187], v233 offset:17408
s_add_u32 m0, s48, 32768
s_xor_b32 s35, s66, 4194304
v_mfma_f32_16x16x32_bf16 v[104:107], a[196:199], a[224:227], v[104:107]
buffer_load_dwordx4 v248, s[12:15], s35 offen offset:0 lds
v_mfma_f32_16x16x32_bf16 v[104:107], a[192:195], a[204:207], v[104:107]
ds_read_b64_tr_b16 a[188:189], v235 offset:16384
v_mfma_f32_16x16x32_bf16 v[108:111], a[192:195], a[208:211], v[108:111]
ds_read_b64_tr_b16 a[190:191], v235 offset:17408
v_mfma_f32_16x16x32_bf16 v[108:111], a[196:199], a[228:231], v[108:111]
v_mfma_f32_16x16x32_bf16 v[112:115], a[196:199], a[232:235], v[112:115]
s_add_u32 m0, s39, 139264
s_xor_b32 s34, s67, 1152
v_mfma_f32_16x16x32_bf16 v[112:115], a[192:195], a[212:215], v[112:115]
buffer_load_dwordx4 v243, s[8:11], s34 offen offset:0 lds
v_mfma_f32_16x16x32_bf16 v[116:119], a[192:195], a[216:219], v[116:119]
v_mfma_f32_16x16x32_bf16 v[116:119], a[196:199], a[236:239], v[116:119]
v_mfma_f32_16x16x32_bf16 v[60:63], a[240:243], a[200:203], v[60:63]
ds_read_b64_tr_b16 a[192:193], v233 offset:16392
v_mfma_f32_16x16x32_bf16 v[60:63], a[244:247], a[220:223], v[60:63]
ds_read_b64_tr_b16 a[194:195], v233 offset:17416
s_add_u32 m0, s48, 32768
v_mfma_f32_16x16x32_bf16 v[64:67], a[244:247], a[224:227], v[64:67]
buffer_load_dwordx4 v249, s[12:15], s35 offen offset:1024 lds
v_mfma_f32_16x16x32_bf16 v[64:67], a[240:243], a[204:207], v[64:67]
ds_read_b64_tr_b16 a[196:197], v235 offset:16392
v_mfma_f32_16x16x32_bf16 v[68:71], a[240:243], a[208:211], v[68:71]
ds_read_b64_tr_b16 a[198:199], v235 offset:17416
v_mfma_f32_16x16x32_bf16 v[68:71], a[244:247], a[228:231], v[68:71]
v_mfma_f32_16x16x32_bf16 v[72:75], a[244:247], a[232:235], v[72:75]
s_add_u32 m0, s48, 32768
v_mfma_f32_16x16x32_bf16 v[72:75], a[240:243], a[212:215], v[72:75]
buffer_load_dwordx4 v250, s[12:15], s35 offen offset:2048 lds
v_mfma_f32_16x16x32_bf16 v[76:79], a[240:243], a[216:219], v[76:79]
v_mfma_f32_16x16x32_bf16 v[76:79], a[244:247], a[236:239], v[76:79]
v_mfma_f32_16x16x32_bf16 v[120:123], a[248:251], a[200:203], v[120:123]
ds_read_b64_tr_b16 a[240:241], v234 offset:16384
v_mfma_f32_16x16x32_bf16 v[120:123], a[252:255], a[220:223], v[120:123]
ds_read_b64_tr_b16 a[242:243], v234 offset:17408
s_add_u32 m0, s39, 139264
v_mfma_f32_16x16x32_bf16 v[124:127], a[252:255], a[224:227], v[124:127]
buffer_load_dwordx4 v244, s[8:11], s34 offen offset:1024 lds
v_mfma_f32_16x16x32_bf16 v[124:127], a[248:251], a[204:207], v[124:127]
ds_read_b64_tr_b16 a[244:245], v236 offset:16384
v_mfma_f32_16x16x32_bf16 v[128:131], a[248:251], a[208:211], v[128:131]
ds_read_b64_tr_b16 a[246:247], v236 offset:17408
v_mfma_f32_16x16x32_bf16 v[128:131], a[252:255], a[228:231], v[128:131]
v_mfma_f32_16x16x32_bf16 v[132:135], a[252:255], a[232:235], v[132:135]
s_add_u32 m0, s48, 32768
v_mfma_f32_16x16x32_bf16 v[132:135], a[248:251], a[212:215], v[132:135]
buffer_load_dwordx4 v251, s[12:15], s35 offen offset:3072 lds
v_mfma_f32_16x16x32_bf16 v[136:139], a[248:251], a[216:219], v[136:139]
v_mfma_f32_16x16x32_bf16 v[136:139], a[252:255], a[236:239], v[136:139]
s_waitcnt lgkmcnt(4)
v_mfma_f32_16x16x32_bf16 v[140:143], a[184:187], a[200:203], v[140:143]
ds_read_b64_tr_b16 a[248:249], v234 offset:16392
v_mfma_f32_16x16x32_bf16 v[140:143], a[188:191], a[220:223], v[140:143]
ds_read_b64_tr_b16 a[250:251], v234 offset:17416
s_add_u32 m0, s39, 139264
v_mfma_f32_16x16x32_bf16 v[144:147], a[188:191], a[224:227], v[144:147]
ds_read_b64_tr_b16 a[252:253], v236 offset:16392
buffer_load_dwordx4 v245, s[8:11], s34 offen offset:2048 lds
v_mfma_f32_16x16x32_bf16 v[144:147], a[184:187], a[204:207], v[144:147]
ds_read_b64_tr_b16 a[254:255], v236 offset:17416
v_mfma_f32_16x16x32_bf16 v[148:151], a[184:187], a[208:211], v[148:151]
v_mfma_f32_16x16x32_bf16 v[148:151], a[188:191], a[228:231], v[148:151]
v_mfma_f32_16x16x32_bf16 v[152:155], a[188:191], a[232:235], v[152:155]
s_add_u32 m0, s39, 139264
v_mfma_f32_16x16x32_bf16 v[152:155], a[184:187], a[212:215], v[152:155]
buffer_load_dwordx4 v246, s[8:11], s34 offen offset:3072 lds
v_mfma_f32_16x16x32_bf16 v[156:159], a[184:187], a[216:219], v[156:159]
v_mfma_f32_16x16x32_bf16 v[156:159], a[188:191], a[236:239], v[156:159]
s_waitcnt vmcnt(16) lgkmcnt(0)
s_barrier
v_mfma_f32_16x16x32_bf16 v[160:163], a[192:195], a[200:203], v[160:163]
ds_read_b64_tr_b16 a[184:185], v233 offset:32768
v_mfma_f32_16x16x32_bf16 v[160:163], a[196:199], a[220:223], v[160:163]
ds_read_b64_tr_b16 a[186:187], v233 offset:33792
s_add_u32 m0, s48, 49152
s_xor_b32 s35, s66, 4194432
v_mfma_f32_16x16x32_bf16 v[164:167], a[196:199], a[224:227], v[164:167]
buffer_load_dwordx4 v248, s[12:15], s35 offen offset:0 lds
v_mfma_f32_16x16x32_bf16 v[164:167], a[192:195], a[204:207], v[164:167]
ds_read_b64_tr_b16 a[188:189], v235 offset:32768
v_mfma_f32_16x16x32_bf16 v[168:171], a[192:195], a[208:211], v[168:171]
ds_read_b64_tr_b16 a[190:191], v235 offset:33792
v_mfma_f32_16x16x32_bf16 v[168:171], a[196:199], a[228:231], v[168:171]
ds_read_b128 a[120:123], v241 offset:0
v_mfma_f32_16x16x32_bf16 v[172:175], a[196:199], a[232:235], v[172:175]
ds_read_b128 a[140:143], v242 offset:0
s_add_u32 m0, s39, 143360
v_mfma_f32_16x16x32_bf16 v[172:175], a[192:195], a[212:215], v[172:175]
buffer_load_dwordx4 v247, s[8:11], s34 offen lds
v_mfma_f32_16x16x32_bf16 v[176:179], a[192:195], a[216:219], v[176:179]
ds_read_b128 a[124:127], v241 offset:2048
v_mfma_f32_16x16x32_bf16 v[176:179], a[196:199], a[236:239], v[176:179]
ds_read_b128 a[144:147], v242 offset:2048
v_mfma_f32_16x16x32_bf16 v[180:183], a[240:243], a[200:203], v[180:183]
ds_read_b64_tr_b16 a[192:193], v233 offset:32776
v_mfma_f32_16x16x32_bf16 v[180:183], a[244:247], a[220:223], v[180:183]
ds_read_b64_tr_b16 a[194:195], v233 offset:33800
s_add_u32 m0, s48, 49152
v_mfma_f32_16x16x32_bf16 v[184:187], a[244:247], a[224:227], v[184:187]
buffer_load_dwordx4 v249, s[12:15], s35 offen offset:1024 lds
v_mfma_f32_16x16x32_bf16 v[184:187], a[240:243], a[204:207], v[184:187]
ds_read_b64_tr_b16 a[196:197], v235 offset:32776
v_mfma_f32_16x16x32_bf16 v[188:191], a[240:243], a[208:211], v[188:191]
ds_read_b64_tr_b16 a[198:199], v235 offset:33800
v_mfma_f32_16x16x32_bf16 v[188:191], a[244:247], a[228:231], v[188:191]
ds_read_b128 a[128:131], v241 offset:4096
v_mfma_f32_16x16x32_bf16 v[192:195], a[244:247], a[232:235], v[192:195]
ds_read_b128 a[148:151], v242 offset:4096
s_add_u32 m0, s48, 49152
v_mfma_f32_16x16x32_bf16 v[192:195], a[240:243], a[212:215], v[192:195]
buffer_load_dwordx4 v250, s[12:15], s35 offen offset:2048 lds
v_mfma_f32_16x16x32_bf16 v[196:199], a[240:243], a[216:219], v[196:199]
ds_read_b128 a[132:135], v241 offset:6144
v_mfma_f32_16x16x32_bf16 v[196:199], a[244:247], a[236:239], v[196:199]
ds_read_b128 a[152:155], v242 offset:6144
v_mfma_f32_16x16x32_bf16 v[200:203], a[248:251], a[200:203], v[200:203]
ds_read_b64_tr_b16 a[240:241], v234 offset:32768
v_mfma_f32_16x16x32_bf16 v[200:203], a[252:255], a[220:223], v[200:203]
ds_read_b64_tr_b16 a[242:243], v234 offset:33792
v_mfma_f32_16x16x32_bf16 v[204:207], a[252:255], a[224:227], v[204:207]
ds_read_b128 a[136:139], v241 offset:8192
v_mfma_f32_16x16x32_bf16 v[204:207], a[248:251], a[204:207], v[204:207]
ds_read_b64_tr_b16 a[244:245], v236 offset:32768
v_mfma_f32_16x16x32_bf16 v[208:211], a[248:251], a[208:211], v[208:211]
ds_read_b64_tr_b16 a[246:247], v236 offset:33792
v_mfma_f32_16x16x32_bf16 v[208:211], a[252:255], a[228:231], v[208:211]
ds_read_b128 a[156:159], v242 offset:8192
v_mfma_f32_16x16x32_bf16 v[212:215], a[252:255], a[232:235], v[212:215]
s_add_u32 m0, s48, 49152
v_mfma_f32_16x16x32_bf16 v[212:215], a[248:251], a[212:215], v[212:215]
buffer_load_dwordx4 v251, s[12:15], s35 offen offset:3072 lds
v_mfma_f32_16x16x32_bf16 v[216:219], a[248:251], a[216:219], v[216:219]
v_mfma_f32_16x16x32_bf16 v[216:219], a[252:255], a[236:239], v[216:219]
s_waitcnt lgkmcnt(1)
v_mfma_f32_16x16x32_bf16 v[80:83], a[184:187], a[120:123], v[80:83]
ds_read_b64_tr_b16 a[248:249], v234 offset:32776
v_mfma_f32_16x16x32_bf16 v[80:83], a[188:191], a[140:143], v[80:83]
ds_read_b64_tr_b16 a[250:251], v234 offset:33800
s_mov_b32 m0, 159744
s_movk_i32 s100, 0
v_mfma_f32_16x16x32_bf16 v[84:87], a[188:191], a[144:147], v[84:87]
ds_read_b64_tr_b16 a[252:253], v236 offset:32776
buffer_load_dwordx4 v220, s[60:63], s100 offen offset:0 lds
v_mfma_f32_16x16x32_bf16 v[84:87], a[184:187], a[124:127], v[84:87]
ds_read_b64_tr_b16 a[254:255], v236 offset:33800
v_mfma_f32_16x16x32_bf16 v[88:91], a[184:187], a[128:131], v[88:91]
v_mfma_f32_16x16x32_bf16 v[88:91], a[188:191], a[148:151], v[88:91]
v_mfma_f32_16x16x32_bf16 v[92:95], a[188:191], a[152:155], v[92:95]
v_mfma_f32_16x16x32_bf16 v[92:95], a[184:187], a[132:135], v[92:95]
v_mfma_f32_16x16x32_bf16 v[96:99], a[184:187], a[136:139], v[96:99]
s_waitcnt lgkmcnt(3)
v_mfma_f32_16x16x32_bf16 v[96:99], a[188:191], a[156:159], v[96:99]
s_waitcnt vmcnt(14) lgkmcnt(0)
s_barrier
v_mfma_f32_16x16x32_bf16 v[100:103], a[192:195], a[120:123], v[100:103]
ds_read_b64_tr_b16 a[184:185], v233 offset:49152
v_mfma_f32_16x16x32_bf16 v[100:103], a[196:199], a[140:143], v[100:103]
ds_read_b64_tr_b16 a[186:187], v233 offset:50176
s_add_u32 m0, s48, 65536
s_xor_b32 s35, s66, 4718592
v_mfma_f32_16x16x32_bf16 v[104:107], a[196:199], a[144:147], v[104:107]
buffer_load_dwordx4 v248, s[12:15], s35 offen offset:0 lds
v_mfma_f32_16x16x32_bf16 v[104:107], a[192:195], a[124:127], v[104:107]
ds_read_b64_tr_b16 a[188:189], v235 offset:49152
v_mfma_f32_16x16x32_bf16 v[108:111], a[192:195], a[128:131], v[108:111]
ds_read_b64_tr_b16 a[190:191], v235 offset:50176
v_mfma_f32_16x16x32_bf16 v[108:111], a[196:199], a[148:151], v[108:111]
v_mfma_f32_16x16x32_bf16 v[112:115], a[196:199], a[152:155], v[112:115]
s_add_u32 m0, s39, 98304
s_xor_b32 s34, s67, 1280
v_mfma_f32_16x16x32_bf16 v[112:115], a[192:195], a[132:135], v[112:115]
buffer_load_dwordx4 v243, s[8:11], s34 offen offset:0 lds
v_mfma_f32_16x16x32_bf16 v[116:119], a[192:195], a[136:139], v[116:119]
v_mfma_f32_16x16x32_bf16 v[116:119], a[196:199], a[156:159], v[116:119]
v_mfma_f32_16x16x32_bf16 v[60:63], a[240:243], a[120:123], v[60:63]
ds_read_b64_tr_b16 a[192:193], v233 offset:49160
v_mfma_f32_16x16x32_bf16 v[60:63], a[244:247], a[140:143], v[60:63]
ds_read_b64_tr_b16 a[194:195], v233 offset:50184
s_add_u32 m0, s48, 65536
v_mfma_f32_16x16x32_bf16 v[64:67], a[244:247], a[144:147], v[64:67]
buffer_load_dwordx4 v249, s[12:15], s35 offen offset:1024 lds
v_mfma_f32_16x16x32_bf16 v[64:67], a[240:243], a[124:127], v[64:67]
ds_read_b64_tr_b16 a[196:197], v235 offset:49160
v_mfma_f32_16x16x32_bf16 v[68:71], a[240:243], a[128:131], v[68:71]
ds_read_b64_tr_b16 a[198:199], v235 offset:50184
v_mfma_f32_16x16x32_bf16 v[68:71], a[244:247], a[148:151], v[68:71]
v_mfma_f32_16x16x32_bf16 v[72:75], a[244:247], a[152:155], v[72:75]
s_add_u32 m0, s48, 65536
v_mfma_f32_16x16x32_bf16 v[72:75], a[240:243], a[132:135], v[72:75]
buffer_load_dwordx4 v250, s[12:15], s35 offen offset:2048 lds
v_mfma_f32_16x16x32_bf16 v[76:79], a[240:243], a[136:139], v[76:79]
v_mfma_f32_16x16x32_bf16 v[76:79], a[244:247], a[156:159], v[76:79]
v_mfma_f32_16x16x32_bf16 v[120:123], a[248:251], a[120:123], v[120:123]
ds_read_b64_tr_b16 a[240:241], v234 offset:49152
v_mfma_f32_16x16x32_bf16 v[120:123], a[252:255], a[140:143], v[120:123]
ds_read_b64_tr_b16 a[242:243], v234 offset:50176
s_add_u32 m0, s39, 98304
v_mfma_f32_16x16x32_bf16 v[124:127], a[252:255], a[144:147], v[124:127]
buffer_load_dwordx4 v244, s[8:11], s34 offen offset:1024 lds
v_mfma_f32_16x16x32_bf16 v[124:127], a[248:251], a[124:127], v[124:127]
ds_read_b64_tr_b16 a[244:245], v236 offset:49152
v_mfma_f32_16x16x32_bf16 v[128:131], a[248:251], a[128:131], v[128:131]
ds_read_b64_tr_b16 a[246:247], v236 offset:50176
v_mfma_f32_16x16x32_bf16 v[128:131], a[252:255], a[148:151], v[128:131]
v_mfma_f32_16x16x32_bf16 v[132:135], a[252:255], a[152:155], v[132:135]
s_add_u32 m0, s48, 65536
v_mfma_f32_16x16x32_bf16 v[132:135], a[248:251], a[132:135], v[132:135]
buffer_load_dwordx4 v251, s[12:15], s35 offen offset:3072 lds
v_mfma_f32_16x16x32_bf16 v[136:139], a[248:251], a[136:139], v[136:139]
v_mfma_f32_16x16x32_bf16 v[136:139], a[252:255], a[156:159], v[136:139]
s_waitcnt lgkmcnt(4)
v_mfma_f32_16x16x32_bf16 v[140:143], a[184:187], a[120:123], v[140:143]
ds_read_b64_tr_b16 a[248:249], v234 offset:49160
v_mfma_f32_16x16x32_bf16 v[140:143], a[188:191], a[140:143], v[140:143]
ds_read_b64_tr_b16 a[250:251], v234 offset:50184
s_add_u32 m0, s39, 98304
v_mfma_f32_16x16x32_bf16 v[144:147], a[188:191], a[144:147], v[144:147]
ds_read_b64_tr_b16 a[252:253], v236 offset:49160
buffer_load_dwordx4 v245, s[8:11], s34 offen offset:2048 lds
v_mfma_f32_16x16x32_bf16 v[144:147], a[184:187], a[124:127], v[144:147]
ds_read_b64_tr_b16 a[254:255], v236 offset:50184
v_mfma_f32_16x16x32_bf16 v[148:151], a[184:187], a[128:131], v[148:151]
v_mfma_f32_16x16x32_bf16 v[148:151], a[188:191], a[148:151], v[148:151]
v_mfma_f32_16x16x32_bf16 v[152:155], a[188:191], a[152:155], v[152:155]
s_add_u32 m0, s39, 98304
v_mfma_f32_16x16x32_bf16 v[152:155], a[184:187], a[132:135], v[152:155]
buffer_load_dwordx4 v246, s[8:11], s34 offen offset:3072 lds
v_mfma_f32_16x16x32_bf16 v[156:159], a[184:187], a[136:139], v[156:159]
v_mfma_f32_16x16x32_bf16 v[156:159], a[188:191], a[156:159], v[156:159]
s_waitcnt vmcnt(16) lgkmcnt(0)
s_barrier
v_mfma_f32_16x16x32_bf16 v[160:163], a[192:195], a[120:123], v[160:163]
ds_read_b64_tr_b16 a[184:185], v233 offset:0
v_mfma_f32_16x16x32_bf16 v[160:163], a[196:199], a[140:143], v[160:163]
ds_read_b64_tr_b16 a[186:187], v233 offset:1024
s_add_u32 m0, s48, 81920
s_xor_b32 s35, s66, 4718720
v_mfma_f32_16x16x32_bf16 v[164:167], a[196:199], a[144:147], v[164:167]
buffer_load_dwordx4 v248, s[12:15], s35 offen offset:0 lds
v_mfma_f32_16x16x32_bf16 v[164:167], a[192:195], a[124:127], v[164:167]
ds_read_b64_tr_b16 a[188:189], v235 offset:0
v_mfma_f32_16x16x32_bf16 v[168:171], a[192:195], a[128:131], v[168:171]
ds_read_b64_tr_b16 a[190:191], v235 offset:1024
v_mfma_f32_16x16x32_bf16 v[168:171], a[196:199], a[148:151], v[168:171]
ds_read_b128 a[200:203], v241 offset:20480
v_mfma_f32_16x16x32_bf16 v[172:175], a[196:199], a[152:155], v[172:175]
ds_read_b128 a[220:223], v242 offset:20480
s_add_u32 m0, s39, 102400
v_mfma_f32_16x16x32_bf16 v[172:175], a[192:195], a[132:135], v[172:175]
buffer_load_dwordx4 v247, s[8:11], s34 offen lds
v_mfma_f32_16x16x32_bf16 v[176:179], a[192:195], a[136:139], v[176:179]
ds_read_b128 a[204:207], v241 offset:22528
v_mfma_f32_16x16x32_bf16 v[176:179], a[196:199], a[156:159], v[176:179]
ds_read_b128 a[224:227], v242 offset:22528
v_mfma_f32_16x16x32_bf16 v[180:183], a[240:243], a[120:123], v[180:183]
ds_read_b64_tr_b16 a[192:193], v233 offset:8
v_mfma_f32_16x16x32_bf16 v[180:183], a[244:247], a[140:143], v[180:183]
ds_read_b64_tr_b16 a[194:195], v233 offset:1032
s_add_u32 m0, s48, 81920
v_mfma_f32_16x16x32_bf16 v[184:187], a[244:247], a[144:147], v[184:187]
buffer_load_dwordx4 v249, s[12:15], s35 offen offset:1024 lds
v_mfma_f32_16x16x32_bf16 v[184:187], a[240:243], a[124:127], v[184:187]
ds_read_b64_tr_b16 a[196:197], v235 offset:8
v_mfma_f32_16x16x32_bf16 v[188:191], a[240:243], a[128:131], v[188:191]
ds_read_b64_tr_b16 a[198:199], v235 offset:1032
v_mfma_f32_16x16x32_bf16 v[188:191], a[244:247], a[148:151], v[188:191]
ds_read_b128 a[208:211], v241 offset:24576
v_mfma_f32_16x16x32_bf16 v[192:195], a[244:247], a[152:155], v[192:195]
ds_read_b128 a[228:231], v242 offset:24576
s_add_u32 m0, s48, 81920
v_mfma_f32_16x16x32_bf16 v[192:195], a[240:243], a[132:135], v[192:195]
buffer_load_dwordx4 v250, s[12:15], s35 offen offset:2048 lds
v_mfma_f32_16x16x32_bf16 v[196:199], a[240:243], a[136:139], v[196:199]
ds_read_b128 a[212:215], v241 offset:26624
v_mfma_f32_16x16x32_bf16 v[196:199], a[244:247], a[156:159], v[196:199]
ds_read_b128 a[232:235], v242 offset:26624
v_mfma_f32_16x16x32_bf16 v[200:203], a[248:251], a[120:123], v[200:203]
ds_read_b64_tr_b16 a[240:241], v234 offset:0
v_mfma_f32_16x16x32_bf16 v[200:203], a[252:255], a[140:143], v[200:203]
ds_read_b64_tr_b16 a[242:243], v234 offset:1024
s_mov_b32 m0, 159744
s_movk_i32 s100, 0
v_mfma_f32_16x16x32_bf16 v[204:207], a[252:255], a[144:147], v[204:207]
ds_read_b128 a[216:219], v241 offset:28672
buffer_load_dwordx4 v221, s[60:63], s100 offen offset:1024 lds
v_mfma_f32_16x16x32_bf16 v[204:207], a[248:251], a[124:127], v[204:207]
ds_read_b64_tr_b16 a[244:245], v236 offset:0
v_mfma_f32_16x16x32_bf16 v[208:211], a[248:251], a[128:131], v[208:211]
ds_read_b64_tr_b16 a[246:247], v236 offset:1024
v_mfma_f32_16x16x32_bf16 v[208:211], a[252:255], a[148:151], v[208:211]
ds_read_b128 a[236:239], v242 offset:28672
v_mfma_f32_16x16x32_bf16 v[212:215], a[252:255], a[152:155], v[212:215]
s_add_u32 m0, s48, 81920
v_mfma_f32_16x16x32_bf16 v[212:215], a[248:251], a[132:135], v[212:215]
buffer_load_dwordx4 v251, s[12:15], s35 offen offset:3072 lds
v_mfma_f32_16x16x32_bf16 v[216:219], a[248:251], a[136:139], v[216:219]
v_mfma_f32_16x16x32_bf16 v[216:219], a[252:255], a[156:159], v[216:219]
s_waitcnt lgkmcnt(1)
v_mfma_f32_16x16x32_bf16 v[80:83], a[184:187], a[200:203], v[80:83]
ds_read_b64_tr_b16 a[248:249], v234 offset:8
v_mfma_f32_16x16x32_bf16 v[80:83], a[188:191], a[220:223], v[80:83]
ds_read_b64_tr_b16 a[250:251], v234 offset:1032
s_mov_b32 m0, 159744
s_movk_i32 s100, 0
v_mfma_f32_16x16x32_bf16 v[84:87], a[188:191], a[224:227], v[84:87]
ds_read_b64_tr_b16 a[252:253], v236 offset:8
buffer_load_dwordx4 v222, s[60:63], s100 offen offset:2048 lds
v_mfma_f32_16x16x32_bf16 v[84:87], a[184:187], a[204:207], v[84:87]
ds_read_b64_tr_b16 a[254:255], v236 offset:1032
v_mfma_f32_16x16x32_bf16 v[88:91], a[184:187], a[208:211], v[88:91]
v_mfma_f32_16x16x32_bf16 v[88:91], a[188:191], a[228:231], v[88:91]
v_mfma_f32_16x16x32_bf16 v[92:95], a[188:191], a[232:235], v[92:95]
s_mov_b32 m0, 159744
s_movk_i32 s100, 0
v_mfma_f32_16x16x32_bf16 v[92:95], a[184:187], a[212:215], v[92:95]
buffer_load_dwordx4 v223, s[60:63], s100 offen offset:3072 lds
v_mfma_f32_16x16x32_bf16 v[96:99], a[184:187], a[216:219], v[96:99]
s_waitcnt lgkmcnt(2)
v_mfma_f32_16x16x32_bf16 v[96:99], a[188:191], a[236:239], v[96:99]
s_waitcnt vmcnt(17) lgkmcnt(0)
s_barrier
v_mfma_f32_16x16x32_bf16 v[100:103], a[192:195], a[200:203], v[100:103]
ds_read_b64_tr_b16 a[184:185], v233 offset:16384
v_mfma_f32_16x16x32_bf16 v[100:103], a[196:199], a[220:223], v[100:103]
ds_read_b64_tr_b16 a[186:187], v233 offset:17408
s_add_u32 m0, s48, 32768
s_xor_b32 s35, s66, 5242880
v_mfma_f32_16x16x32_bf16 v[104:107], a[196:199], a[224:227], v[104:107]
buffer_load_dwordx4 v248, s[12:15], s35 offen offset:0 lds
v_mfma_f32_16x16x32_bf16 v[104:107], a[192:195], a[204:207], v[104:107]
ds_read_b64_tr_b16 a[188:189], v235 offset:16384
v_mfma_f32_16x16x32_bf16 v[108:111], a[192:195], a[208:211], v[108:111]
ds_read_b64_tr_b16 a[190:191], v235 offset:17408
v_mfma_f32_16x16x32_bf16 v[108:111], a[196:199], a[228:231], v[108:111]
v_mfma_f32_16x16x32_bf16 v[112:115], a[196:199], a[232:235], v[112:115]
s_add_u32 m0, s39, 118784
s_xor_b32 s34, s67, 1408
v_mfma_f32_16x16x32_bf16 v[112:115], a[192:195], a[212:215], v[112:115]
buffer_load_dwordx4 v243, s[8:11], s34 offen offset:0 lds
v_mfma_f32_16x16x32_bf16 v[116:119], a[192:195], a[216:219], v[116:119]
v_mfma_f32_16x16x32_bf16 v[116:119], a[196:199], a[236:239], v[116:119]
v_mfma_f32_16x16x32_bf16 v[60:63], a[240:243], a[200:203], v[60:63]
ds_read_b64_tr_b16 a[192:193], v233 offset:16392
v_mfma_f32_16x16x32_bf16 v[60:63], a[244:247], a[220:223], v[60:63]
ds_read_b64_tr_b16 a[194:195], v233 offset:17416
s_add_u32 m0, s48, 32768
v_mfma_f32_16x16x32_bf16 v[64:67], a[244:247], a[224:227], v[64:67]
buffer_load_dwordx4 v249, s[12:15], s35 offen offset:1024 lds
v_mfma_f32_16x16x32_bf16 v[64:67], a[240:243], a[204:207], v[64:67]
ds_read_b64_tr_b16 a[196:197], v235 offset:16392
v_mfma_f32_16x16x32_bf16 v[68:71], a[240:243], a[208:211], v[68:71]
ds_read_b64_tr_b16 a[198:199], v235 offset:17416
v_mfma_f32_16x16x32_bf16 v[68:71], a[244:247], a[228:231], v[68:71]
v_mfma_f32_16x16x32_bf16 v[72:75], a[244:247], a[232:235], v[72:75]
s_add_u32 m0, s48, 32768
v_mfma_f32_16x16x32_bf16 v[72:75], a[240:243], a[212:215], v[72:75]
buffer_load_dwordx4 v250, s[12:15], s35 offen offset:2048 lds
v_mfma_f32_16x16x32_bf16 v[76:79], a[240:243], a[216:219], v[76:79]
v_mfma_f32_16x16x32_bf16 v[76:79], a[244:247], a[236:239], v[76:79]
v_mfma_f32_16x16x32_bf16 v[120:123], a[248:251], a[200:203], v[120:123]
ds_read_b64_tr_b16 a[240:241], v234 offset:16384
v_mfma_f32_16x16x32_bf16 v[120:123], a[252:255], a[220:223], v[120:123]
ds_read_b64_tr_b16 a[242:243], v234 offset:17408
s_add_u32 m0, s39, 118784
v_mfma_f32_16x16x32_bf16 v[124:127], a[252:255], a[224:227], v[124:127]
buffer_load_dwordx4 v244, s[8:11], s34 offen offset:1024 lds
v_mfma_f32_16x16x32_bf16 v[124:127], a[248:251], a[204:207], v[124:127]
ds_read_b64_tr_b16 a[244:245], v236 offset:16384
v_mfma_f32_16x16x32_bf16 v[128:131], a[248:251], a[208:211], v[128:131]
ds_read_b64_tr_b16 a[246:247], v236 offset:17408
v_mfma_f32_16x16x32_bf16 v[128:131], a[252:255], a[228:231], v[128:131]
v_mfma_f32_16x16x32_bf16 v[132:135], a[252:255], a[232:235], v[132:135]
s_add_u32 m0, s48, 32768
v_mfma_f32_16x16x32_bf16 v[132:135], a[248:251], a[212:215], v[132:135]
buffer_load_dwordx4 v251, s[12:15], s35 offen offset:3072 lds
v_mfma_f32_16x16x32_bf16 v[136:139], a[248:251], a[216:219], v[136:139]
v_mfma_f32_16x16x32_bf16 v[136:139], a[252:255], a[236:239], v[136:139]
s_waitcnt lgkmcnt(4)
v_mfma_f32_16x16x32_bf16 v[140:143], a[184:187], a[200:203], v[140:143]
ds_read_b64_tr_b16 a[248:249], v234 offset:16392
v_mfma_f32_16x16x32_bf16 v[140:143], a[188:191], a[220:223], v[140:143]
ds_read_b64_tr_b16 a[250:251], v234 offset:17416
s_add_u32 m0, s39, 118784
v_mfma_f32_16x16x32_bf16 v[144:147], a[188:191], a[224:227], v[144:147]
ds_read_b64_tr_b16 a[252:253], v236 offset:16392
buffer_load_dwordx4 v245, s[8:11], s34 offen offset:2048 lds
v_mfma_f32_16x16x32_bf16 v[144:147], a[184:187], a[204:207], v[144:147]
ds_read_b64_tr_b16 a[254:255], v236 offset:17416
v_mfma_f32_16x16x32_bf16 v[148:151], a[184:187], a[208:211], v[148:151]
v_mfma_f32_16x16x32_bf16 v[148:151], a[188:191], a[228:231], v[148:151]
v_mfma_f32_16x16x32_bf16 v[152:155], a[188:191], a[232:235], v[152:155]
s_add_u32 m0, s39, 118784
v_mfma_f32_16x16x32_bf16 v[152:155], a[184:187], a[212:215], v[152:155]
buffer_load_dwordx4 v246, s[8:11], s34 offen offset:3072 lds
v_mfma_f32_16x16x32_bf16 v[156:159], a[184:187], a[216:219], v[156:159]
v_mfma_f32_16x16x32_bf16 v[156:159], a[188:191], a[236:239], v[156:159]
s_waitcnt vmcnt(18) lgkmcnt(0)
s_barrier
v_mfma_f32_16x16x32_bf16 v[160:163], a[192:195], a[200:203], v[160:163]
ds_read_b64_tr_b16 a[184:185], v233 offset:32768
v_mfma_f32_16x16x32_bf16 v[160:163], a[196:199], a[220:223], v[160:163]
ds_read_b64_tr_b16 a[186:187], v233 offset:33792
s_add_u32 m0, s48, 49152
s_xor_b32 s35, s66, 5243008
v_mfma_f32_16x16x32_bf16 v[164:167], a[196:199], a[224:227], v[164:167]
buffer_load_dwordx4 v248, s[12:15], s35 offen offset:0 lds
v_mfma_f32_16x16x32_bf16 v[164:167], a[192:195], a[204:207], v[164:167]
ds_read_b64_tr_b16 a[188:189], v235 offset:32768
v_mfma_f32_16x16x32_bf16 v[168:171], a[192:195], a[208:211], v[168:171]
ds_read_b64_tr_b16 a[190:191], v235 offset:33792
v_mfma_f32_16x16x32_bf16 v[168:171], a[196:199], a[228:231], v[168:171]
ds_read_b128 a[120:123], v241 offset:40960
v_mfma_f32_16x16x32_bf16 v[172:175], a[196:199], a[232:235], v[172:175]
ds_read_b128 a[140:143], v242 offset:40960
s_add_u32 m0, s39, 122880
v_mfma_f32_16x16x32_bf16 v[172:175], a[192:195], a[212:215], v[172:175]
buffer_load_dwordx4 v247, s[8:11], s34 offen lds
v_mfma_f32_16x16x32_bf16 v[176:179], a[192:195], a[216:219], v[176:179]
ds_read_b128 a[124:127], v241 offset:43008
v_mfma_f32_16x16x32_bf16 v[176:179], a[196:199], a[236:239], v[176:179]
ds_read_b128 a[144:147], v242 offset:43008
v_mfma_f32_16x16x32_bf16 v[180:183], a[240:243], a[200:203], v[180:183]
ds_read_b64_tr_b16 a[192:193], v233 offset:32776
v_mfma_f32_16x16x32_bf16 v[180:183], a[244:247], a[220:223], v[180:183]
ds_read_b64_tr_b16 a[194:195], v233 offset:33800
s_add_u32 m0, s48, 49152
v_mfma_f32_16x16x32_bf16 v[184:187], a[244:247], a[224:227], v[184:187]
buffer_load_dwordx4 v249, s[12:15], s35 offen offset:1024 lds
v_mfma_f32_16x16x32_bf16 v[184:187], a[240:243], a[204:207], v[184:187]
ds_read_b64_tr_b16 a[196:197], v235 offset:32776
v_mfma_f32_16x16x32_bf16 v[188:191], a[240:243], a[208:211], v[188:191]
ds_read_b64_tr_b16 a[198:199], v235 offset:33800
v_mfma_f32_16x16x32_bf16 v[188:191], a[244:247], a[228:231], v[188:191]
ds_read_b128 a[128:131], v241 offset:45056
v_mfma_f32_16x16x32_bf16 v[192:195], a[244:247], a[232:235], v[192:195]
ds_read_b128 a[148:151], v242 offset:45056
s_add_u32 m0, s48, 49152
v_mfma_f32_16x16x32_bf16 v[192:195], a[240:243], a[212:215], v[192:195]
buffer_load_dwordx4 v250, s[12:15], s35 offen offset:2048 lds
v_mfma_f32_16x16x32_bf16 v[196:199], a[240:243], a[216:219], v[196:199]
ds_read_b128 a[132:135], v241 offset:47104
v_mfma_f32_16x16x32_bf16 v[196:199], a[244:247], a[236:239], v[196:199]
ds_read_b128 a[152:155], v242 offset:47104
v_mfma_f32_16x16x32_bf16 v[200:203], a[248:251], a[200:203], v[200:203]
ds_read_b64_tr_b16 a[240:241], v234 offset:32768
v_mfma_f32_16x16x32_bf16 v[200:203], a[252:255], a[220:223], v[200:203]
ds_read_b64_tr_b16 a[242:243], v234 offset:33792
s_mov_b32 m0, 159744
s_movk_i32 s100, 8192
v_mfma_f32_16x16x32_bf16 v[204:207], a[252:255], a[224:227], v[204:207]
ds_read_b128 a[136:139], v241 offset:49152
buffer_load_dwordx4 v220, s[60:63], s100 offen offset:0 lds
v_mfma_f32_16x16x32_bf16 v[204:207], a[248:251], a[204:207], v[204:207]
ds_read_b64_tr_b16 a[244:245], v236 offset:32768
v_mfma_f32_16x16x32_bf16 v[208:211], a[248:251], a[208:211], v[208:211]
ds_read_b64_tr_b16 a[246:247], v236 offset:33792
v_mfma_f32_16x16x32_bf16 v[208:211], a[252:255], a[228:231], v[208:211]
ds_read_b128 a[156:159], v242 offset:49152
v_mfma_f32_16x16x32_bf16 v[212:215], a[252:255], a[232:235], v[212:215]
s_add_u32 m0, s48, 49152
v_mfma_f32_16x16x32_bf16 v[212:215], a[248:251], a[212:215], v[212:215]
buffer_load_dwordx4 v251, s[12:15], s35 offen offset:3072 lds
v_mfma_f32_16x16x32_bf16 v[216:219], a[248:251], a[216:219], v[216:219]
v_mfma_f32_16x16x32_bf16 v[216:219], a[252:255], a[236:239], v[216:219]
s_waitcnt lgkmcnt(1)
v_mfma_f32_16x16x32_bf16 v[80:83], a[184:187], a[120:123], v[80:83]
ds_read_b64_tr_b16 a[248:249], v234 offset:32776
v_mfma_f32_16x16x32_bf16 v[80:83], a[188:191], a[140:143], v[80:83]
ds_read_b64_tr_b16 a[250:251], v234 offset:33800
s_mov_b32 m0, 159744
s_movk_i32 s100, 8192
v_mfma_f32_16x16x32_bf16 v[84:87], a[188:191], a[144:147], v[84:87]
ds_read_b64_tr_b16 a[252:253], v236 offset:32776
buffer_load_dwordx4 v221, s[60:63], s100 offen offset:1024 lds
v_mfma_f32_16x16x32_bf16 v[84:87], a[184:187], a[124:127], v[84:87]
ds_read_b64_tr_b16 a[254:255], v236 offset:33800
v_mfma_f32_16x16x32_bf16 v[88:91], a[184:187], a[128:131], v[88:91]
v_mfma_f32_16x16x32_bf16 v[88:91], a[188:191], a[148:151], v[88:91]
v_mfma_f32_16x16x32_bf16 v[92:95], a[188:191], a[152:155], v[92:95]
s_mov_b32 m0, 159744
s_movk_i32 s100, 8192
v_mfma_f32_16x16x32_bf16 v[92:95], a[184:187], a[132:135], v[92:95]
buffer_load_dwordx4 v222, s[60:63], s100 offen offset:2048 lds
v_mfma_f32_16x16x32_bf16 v[96:99], a[184:187], a[136:139], v[96:99]
s_waitcnt lgkmcnt(2)
v_mfma_f32_16x16x32_bf16 v[96:99], a[188:191], a[156:159], v[96:99]
s_waitcnt vmcnt(18) lgkmcnt(0)
s_barrier
v_mfma_f32_16x16x32_bf16 v[100:103], a[192:195], a[120:123], v[100:103]
ds_read_b64_tr_b16 a[184:185], v233 offset:49152
v_mfma_f32_16x16x32_bf16 v[100:103], a[196:199], a[140:143], v[100:103]
ds_read_b64_tr_b16 a[186:187], v233 offset:50176
s_add_u32 m0, s48, 65536
s_xor_b32 s35, s66, 5767168
v_mfma_f32_16x16x32_bf16 v[104:107], a[196:199], a[144:147], v[104:107]
buffer_load_dwordx4 v248, s[12:15], s35 offen offset:0 lds
v_mfma_f32_16x16x32_bf16 v[104:107], a[192:195], a[124:127], v[104:107]
ds_read_b64_tr_b16 a[188:189], v235 offset:49152
v_mfma_f32_16x16x32_bf16 v[108:111], a[192:195], a[128:131], v[108:111]
ds_read_b64_tr_b16 a[190:191], v235 offset:50176
v_mfma_f32_16x16x32_bf16 v[108:111], a[196:199], a[148:151], v[108:111]
v_mfma_f32_16x16x32_bf16 v[112:115], a[196:199], a[152:155], v[112:115]
s_add_u32 m0, s39, 139264
s_xor_b32 s34, s67, 1536
v_mfma_f32_16x16x32_bf16 v[112:115], a[192:195], a[132:135], v[112:115]
buffer_load_dwordx4 v243, s[8:11], s34 offen offset:0 lds
v_mfma_f32_16x16x32_bf16 v[116:119], a[192:195], a[136:139], v[116:119]
v_mfma_f32_16x16x32_bf16 v[116:119], a[196:199], a[156:159], v[116:119]
v_mfma_f32_16x16x32_bf16 v[60:63], a[240:243], a[120:123], v[60:63]
ds_read_b64_tr_b16 a[192:193], v233 offset:49160
v_mfma_f32_16x16x32_bf16 v[60:63], a[244:247], a[140:143], v[60:63]
ds_read_b64_tr_b16 a[194:195], v233 offset:50184
s_add_u32 m0, s48, 65536
v_mfma_f32_16x16x32_bf16 v[64:67], a[244:247], a[144:147], v[64:67]
buffer_load_dwordx4 v249, s[12:15], s35 offen offset:1024 lds
v_mfma_f32_16x16x32_bf16 v[64:67], a[240:243], a[124:127], v[64:67]
ds_read_b64_tr_b16 a[196:197], v235 offset:49160
v_mfma_f32_16x16x32_bf16 v[68:71], a[240:243], a[128:131], v[68:71]
ds_read_b64_tr_b16 a[198:199], v235 offset:50184
v_mfma_f32_16x16x32_bf16 v[68:71], a[244:247], a[148:151], v[68:71]
v_mfma_f32_16x16x32_bf16 v[72:75], a[244:247], a[152:155], v[72:75]
s_add_u32 m0, s48, 65536
v_mfma_f32_16x16x32_bf16 v[72:75], a[240:243], a[132:135], v[72:75]
buffer_load_dwordx4 v250, s[12:15], s35 offen offset:2048 lds
v_mfma_f32_16x16x32_bf16 v[76:79], a[240:243], a[136:139], v[76:79]
v_mfma_f32_16x16x32_bf16 v[76:79], a[244:247], a[156:159], v[76:79]
v_mfma_f32_16x16x32_bf16 v[120:123], a[248:251], a[120:123], v[120:123]
ds_read_b64_tr_b16 a[240:241], v234 offset:49152
v_mfma_f32_16x16x32_bf16 v[120:123], a[252:255], a[140:143], v[120:123]
ds_read_b64_tr_b16 a[242:243], v234 offset:50176
s_add_u32 m0, s39, 139264
v_mfma_f32_16x16x32_bf16 v[124:127], a[252:255], a[144:147], v[124:127]
buffer_load_dwordx4 v244, s[8:11], s34 offen offset:1024 lds
v_mfma_f32_16x16x32_bf16 v[124:127], a[248:251], a[124:127], v[124:127]
ds_read_b64_tr_b16 a[244:245], v236 offset:49152
v_mfma_f32_16x16x32_bf16 v[128:131], a[248:251], a[128:131], v[128:131]
ds_read_b64_tr_b16 a[246:247], v236 offset:50176
v_mfma_f32_16x16x32_bf16 v[128:131], a[252:255], a[148:151], v[128:131]
v_mfma_f32_16x16x32_bf16 v[132:135], a[252:255], a[152:155], v[132:135]
s_add_u32 m0, s48, 65536
v_mfma_f32_16x16x32_bf16 v[132:135], a[248:251], a[132:135], v[132:135]
buffer_load_dwordx4 v251, s[12:15], s35 offen offset:3072 lds
v_mfma_f32_16x16x32_bf16 v[136:139], a[248:251], a[136:139], v[136:139]
v_mfma_f32_16x16x32_bf16 v[136:139], a[252:255], a[156:159], v[136:139]
s_waitcnt lgkmcnt(4)
v_mfma_f32_16x16x32_bf16 v[140:143], a[184:187], a[120:123], v[140:143]
ds_read_b64_tr_b16 a[248:249], v234 offset:49160
v_mfma_f32_16x16x32_bf16 v[140:143], a[188:191], a[140:143], v[140:143]
ds_read_b64_tr_b16 a[250:251], v234 offset:50184
s_add_u32 m0, s39, 139264
v_mfma_f32_16x16x32_bf16 v[144:147], a[188:191], a[144:147], v[144:147]
ds_read_b64_tr_b16 a[252:253], v236 offset:49160
buffer_load_dwordx4 v245, s[8:11], s34 offen offset:2048 lds
v_mfma_f32_16x16x32_bf16 v[144:147], a[184:187], a[124:127], v[144:147]
ds_read_b64_tr_b16 a[254:255], v236 offset:50184
v_mfma_f32_16x16x32_bf16 v[148:151], a[184:187], a[128:131], v[148:151]
v_mfma_f32_16x16x32_bf16 v[148:151], a[188:191], a[148:151], v[148:151]
v_mfma_f32_16x16x32_bf16 v[152:155], a[188:191], a[152:155], v[152:155]
s_add_u32 m0, s39, 139264
v_mfma_f32_16x16x32_bf16 v[152:155], a[184:187], a[132:135], v[152:155]
buffer_load_dwordx4 v246, s[8:11], s34 offen offset:3072 lds
v_mfma_f32_16x16x32_bf16 v[156:159], a[184:187], a[136:139], v[156:159]
v_mfma_f32_16x16x32_bf16 v[156:159], a[188:191], a[156:159], v[156:159]
s_waitcnt vmcnt(18) lgkmcnt(0)
s_barrier
v_mfma_f32_16x16x32_bf16 v[160:163], a[192:195], a[120:123], v[160:163]
ds_read_b64_tr_b16 a[184:185], v233 offset:0
v_mfma_f32_16x16x32_bf16 v[160:163], a[196:199], a[140:143], v[160:163]
ds_read_b64_tr_b16 a[186:187], v233 offset:1024
s_add_u32 m0, s48, 81920
s_xor_b32 s35, s66, 5767296
v_mfma_f32_16x16x32_bf16 v[164:167], a[196:199], a[144:147], v[164:167]
buffer_load_dwordx4 v248, s[12:15], s35 offen offset:0 lds
v_mfma_f32_16x16x32_bf16 v[164:167], a[192:195], a[124:127], v[164:167]
ds_read_b64_tr_b16 a[188:189], v235 offset:0
v_mfma_f32_16x16x32_bf16 v[168:171], a[192:195], a[128:131], v[168:171]
ds_read_b64_tr_b16 a[190:191], v235 offset:1024
v_mfma_f32_16x16x32_bf16 v[168:171], a[196:199], a[148:151], v[168:171]
ds_read_b128 a[200:203], v241 offset:0
v_mfma_f32_16x16x32_bf16 v[172:175], a[196:199], a[152:155], v[172:175]
ds_read_b128 a[220:223], v242 offset:0
s_add_u32 m0, s39, 143360
v_mfma_f32_16x16x32_bf16 v[172:175], a[192:195], a[132:135], v[172:175]
buffer_load_dwordx4 v247, s[8:11], s34 offen lds
v_mfma_f32_16x16x32_bf16 v[176:179], a[192:195], a[136:139], v[176:179]
ds_read_b128 a[204:207], v241 offset:2048
v_mfma_f32_16x16x32_bf16 v[176:179], a[196:199], a[156:159], v[176:179]
ds_read_b128 a[224:227], v242 offset:2048
v_mfma_f32_16x16x32_bf16 v[180:183], a[240:243], a[120:123], v[180:183]
ds_read_b64_tr_b16 a[192:193], v233 offset:8
v_mfma_f32_16x16x32_bf16 v[180:183], a[244:247], a[140:143], v[180:183]
ds_read_b64_tr_b16 a[194:195], v233 offset:1032
s_add_u32 m0, s48, 81920
v_mfma_f32_16x16x32_bf16 v[184:187], a[244:247], a[144:147], v[184:187]
buffer_load_dwordx4 v249, s[12:15], s35 offen offset:1024 lds
v_mfma_f32_16x16x32_bf16 v[184:187], a[240:243], a[124:127], v[184:187]
ds_read_b64_tr_b16 a[196:197], v235 offset:8
v_mfma_f32_16x16x32_bf16 v[188:191], a[240:243], a[128:131], v[188:191]
ds_read_b64_tr_b16 a[198:199], v235 offset:1032
v_mfma_f32_16x16x32_bf16 v[188:191], a[244:247], a[148:151], v[188:191]
ds_read_b128 a[208:211], v241 offset:4096
v_mfma_f32_16x16x32_bf16 v[192:195], a[244:247], a[152:155], v[192:195]
ds_read_b128 a[228:231], v242 offset:4096
s_add_u32 m0, s48, 81920
v_mfma_f32_16x16x32_bf16 v[192:195], a[240:243], a[132:135], v[192:195]
buffer_load_dwordx4 v250, s[12:15], s35 offen offset:2048 lds
v_mfma_f32_16x16x32_bf16 v[196:199], a[240:243], a[136:139], v[196:199]
ds_read_b128 a[212:215], v241 offset:6144
v_mfma_f32_16x16x32_bf16 v[196:199], a[244:247], a[156:159], v[196:199]
ds_read_b128 a[232:235], v242 offset:6144
v_mfma_f32_16x16x32_bf16 v[200:203], a[248:251], a[120:123], v[200:203]
ds_read_b64_tr_b16 a[240:241], v234 offset:0
v_mfma_f32_16x16x32_bf16 v[200:203], a[252:255], a[140:143], v[200:203]
ds_read_b64_tr_b16 a[242:243], v234 offset:1024
s_mov_b32 m0, 159744
s_movk_i32 s100, 8192
v_mfma_f32_16x16x32_bf16 v[204:207], a[252:255], a[144:147], v[204:207]
ds_read_b128 a[216:219], v241 offset:8192
buffer_load_dwordx4 v223, s[60:63], s100 offen offset:3072 lds
v_mfma_f32_16x16x32_bf16 v[204:207], a[248:251], a[124:127], v[204:207]
ds_read_b64_tr_b16 a[244:245], v236 offset:0
v_mfma_f32_16x16x32_bf16 v[208:211], a[248:251], a[128:131], v[208:211]
ds_read_b64_tr_b16 a[246:247], v236 offset:1024
v_mfma_f32_16x16x32_bf16 v[208:211], a[252:255], a[148:151], v[208:211]
ds_read_b128 a[236:239], v242 offset:8192
v_mfma_f32_16x16x32_bf16 v[212:215], a[252:255], a[152:155], v[212:215]
s_add_u32 m0, s48, 81920
v_mfma_f32_16x16x32_bf16 v[212:215], a[248:251], a[132:135], v[212:215]
buffer_load_dwordx4 v251, s[12:15], s35 offen offset:3072 lds
v_mfma_f32_16x16x32_bf16 v[216:219], a[248:251], a[136:139], v[216:219]
v_mfma_f32_16x16x32_bf16 v[216:219], a[252:255], a[156:159], v[216:219]
s_waitcnt lgkmcnt(1)
v_mfma_f32_16x16x32_bf16 v[80:83], a[184:187], a[200:203], v[80:83]
ds_read_b64_tr_b16 a[248:249], v234 offset:8
v_mfma_f32_16x16x32_bf16 v[80:83], a[188:191], a[220:223], v[80:83]
ds_read_b64_tr_b16 a[250:251], v234 offset:1032
v_mfma_f32_16x16x32_bf16 v[84:87], a[188:191], a[224:227], v[84:87]
ds_read_b64_tr_b16 a[252:253], v236 offset:8
v_mfma_f32_16x16x32_bf16 v[84:87], a[184:187], a[204:207], v[84:87]
ds_read_b64_tr_b16 a[254:255], v236 offset:1032
v_mfma_f32_16x16x32_bf16 v[88:91], a[184:187], a[208:211], v[88:91]
v_mfma_f32_16x16x32_bf16 v[88:91], a[188:191], a[228:231], v[88:91]
v_mfma_f32_16x16x32_bf16 v[92:95], a[188:191], a[232:235], v[92:95]
v_mfma_f32_16x16x32_bf16 v[92:95], a[184:187], a[212:215], v[92:95]
v_mfma_f32_16x16x32_bf16 v[96:99], a[184:187], a[216:219], v[96:99]
s_waitcnt lgkmcnt(4)
v_mfma_f32_16x16x32_bf16 v[96:99], a[188:191], a[236:239], v[96:99]
s_waitcnt vmcnt(16) lgkmcnt(0)
s_barrier
v_mfma_f32_16x16x32_bf16 v[100:103], a[192:195], a[200:203], v[100:103]
ds_read_b64_tr_b16 a[184:185], v233 offset:16384
v_mfma_f32_16x16x32_bf16 v[100:103], a[196:199], a[220:223], v[100:103]
ds_read_b64_tr_b16 a[186:187], v233 offset:17408
s_add_u32 m0, s48, 32768
s_xor_b32 s35, s66, 6291456
v_mfma_f32_16x16x32_bf16 v[104:107], a[196:199], a[224:227], v[104:107]
buffer_load_dwordx4 v248, s[12:15], s35 offen offset:0 lds
v_mfma_f32_16x16x32_bf16 v[104:107], a[192:195], a[204:207], v[104:107]
ds_read_b64_tr_b16 a[188:189], v235 offset:16384
v_mfma_f32_16x16x32_bf16 v[108:111], a[192:195], a[208:211], v[108:111]
ds_read_b64_tr_b16 a[190:191], v235 offset:17408
v_mfma_f32_16x16x32_bf16 v[108:111], a[196:199], a[228:231], v[108:111]
v_mfma_f32_16x16x32_bf16 v[112:115], a[196:199], a[232:235], v[112:115]
s_add_u32 m0, s39, 98304
s_xor_b32 s34, s67, 1664
v_mfma_f32_16x16x32_bf16 v[112:115], a[192:195], a[212:215], v[112:115]
buffer_load_dwordx4 v243, s[8:11], s34 offen offset:0 lds
v_mfma_f32_16x16x32_bf16 v[116:119], a[192:195], a[216:219], v[116:119]
v_mfma_f32_16x16x32_bf16 v[116:119], a[196:199], a[236:239], v[116:119]
v_mfma_f32_16x16x32_bf16 v[60:63], a[240:243], a[200:203], v[60:63]
ds_read_b64_tr_b16 a[192:193], v233 offset:16392
v_mfma_f32_16x16x32_bf16 v[60:63], a[244:247], a[220:223], v[60:63]
ds_read_b64_tr_b16 a[194:195], v233 offset:17416
s_add_u32 m0, s48, 32768
v_mfma_f32_16x16x32_bf16 v[64:67], a[244:247], a[224:227], v[64:67]
buffer_load_dwordx4 v249, s[12:15], s35 offen offset:1024 lds
v_mfma_f32_16x16x32_bf16 v[64:67], a[240:243], a[204:207], v[64:67]
ds_read_b64_tr_b16 a[196:197], v235 offset:16392
v_mfma_f32_16x16x32_bf16 v[68:71], a[240:243], a[208:211], v[68:71]
ds_read_b64_tr_b16 a[198:199], v235 offset:17416
v_mfma_f32_16x16x32_bf16 v[68:71], a[244:247], a[228:231], v[68:71]
v_mfma_f32_16x16x32_bf16 v[72:75], a[244:247], a[232:235], v[72:75]
s_add_u32 m0, s48, 32768
v_mfma_f32_16x16x32_bf16 v[72:75], a[240:243], a[212:215], v[72:75]
buffer_load_dwordx4 v250, s[12:15], s35 offen offset:2048 lds
v_mfma_f32_16x16x32_bf16 v[76:79], a[240:243], a[216:219], v[76:79]
v_mfma_f32_16x16x32_bf16 v[76:79], a[244:247], a[236:239], v[76:79]
v_mfma_f32_16x16x32_bf16 v[120:123], a[248:251], a[200:203], v[120:123]
ds_read_b64_tr_b16 a[240:241], v234 offset:16384
v_mfma_f32_16x16x32_bf16 v[120:123], a[252:255], a[220:223], v[120:123]
ds_read_b64_tr_b16 a[242:243], v234 offset:17408
s_add_u32 m0, s39, 98304
v_mfma_f32_16x16x32_bf16 v[124:127], a[252:255], a[224:227], v[124:127]
buffer_load_dwordx4 v244, s[8:11], s34 offen offset:1024 lds
v_mfma_f32_16x16x32_bf16 v[124:127], a[248:251], a[204:207], v[124:127]
ds_read_b64_tr_b16 a[244:245], v236 offset:16384
v_mfma_f32_16x16x32_bf16 v[128:131], a[248:251], a[208:211], v[128:131]
ds_read_b64_tr_b16 a[246:247], v236 offset:17408
v_mfma_f32_16x16x32_bf16 v[128:131], a[252:255], a[228:231], v[128:131]
v_mfma_f32_16x16x32_bf16 v[132:135], a[252:255], a[232:235], v[132:135]
s_add_u32 m0, s48, 32768
v_mfma_f32_16x16x32_bf16 v[132:135], a[248:251], a[212:215], v[132:135]
buffer_load_dwordx4 v251, s[12:15], s35 offen offset:3072 lds
v_mfma_f32_16x16x32_bf16 v[136:139], a[248:251], a[216:219], v[136:139]
v_mfma_f32_16x16x32_bf16 v[136:139], a[252:255], a[236:239], v[136:139]
s_waitcnt lgkmcnt(4)
v_mfma_f32_16x16x32_bf16 v[140:143], a[184:187], a[200:203], v[140:143]
ds_read_b64_tr_b16 a[248:249], v234 offset:16392
v_mfma_f32_16x16x32_bf16 v[140:143], a[188:191], a[220:223], v[140:143]
ds_read_b64_tr_b16 a[250:251], v234 offset:17416
s_add_u32 m0, s39, 98304
v_mfma_f32_16x16x32_bf16 v[144:147], a[188:191], a[224:227], v[144:147]
ds_read_b64_tr_b16 a[252:253], v236 offset:16392
buffer_load_dwordx4 v245, s[8:11], s34 offen offset:2048 lds
v_mfma_f32_16x16x32_bf16 v[144:147], a[184:187], a[204:207], v[144:147]
ds_read_b64_tr_b16 a[254:255], v236 offset:17416
v_mfma_f32_16x16x32_bf16 v[148:151], a[184:187], a[208:211], v[148:151]
v_mfma_f32_16x16x32_bf16 v[148:151], a[188:191], a[228:231], v[148:151]
v_mfma_f32_16x16x32_bf16 v[152:155], a[188:191], a[232:235], v[152:155]
s_add_u32 m0, s39, 98304
v_mfma_f32_16x16x32_bf16 v[152:155], a[184:187], a[212:215], v[152:155]
buffer_load_dwordx4 v246, s[8:11], s34 offen offset:3072 lds
v_mfma_f32_16x16x32_bf16 v[156:159], a[184:187], a[216:219], v[156:159]
v_mfma_f32_16x16x32_bf16 v[156:159], a[188:191], a[236:239], v[156:159]
s_waitcnt vmcnt(16) lgkmcnt(0)
s_barrier
v_mfma_f32_16x16x32_bf16 v[160:163], a[192:195], a[200:203], v[160:163]
ds_read_b64_tr_b16 a[184:185], v233 offset:32768
v_mfma_f32_16x16x32_bf16 v[160:163], a[196:199], a[220:223], v[160:163]
ds_read_b64_tr_b16 a[186:187], v233 offset:33792
s_add_u32 m0, s48, 49152
s_xor_b32 s35, s66, 6291584
v_mfma_f32_16x16x32_bf16 v[164:167], a[196:199], a[224:227], v[164:167]
buffer_load_dwordx4 v248, s[12:15], s35 offen offset:0 lds
v_mfma_f32_16x16x32_bf16 v[164:167], a[192:195], a[204:207], v[164:167]
ds_read_b64_tr_b16 a[188:189], v235 offset:32768
v_mfma_f32_16x16x32_bf16 v[168:171], a[192:195], a[208:211], v[168:171]
ds_read_b64_tr_b16 a[190:191], v235 offset:33792
v_mfma_f32_16x16x32_bf16 v[168:171], a[196:199], a[228:231], v[168:171]
ds_read_b128 a[120:123], v241 offset:20480
v_mfma_f32_16x16x32_bf16 v[172:175], a[196:199], a[232:235], v[172:175]
ds_read_b128 a[140:143], v242 offset:20480
s_add_u32 m0, s39, 102400
v_mfma_f32_16x16x32_bf16 v[172:175], a[192:195], a[212:215], v[172:175]
buffer_load_dwordx4 v247, s[8:11], s34 offen lds
v_mfma_f32_16x16x32_bf16 v[176:179], a[192:195], a[216:219], v[176:179]
ds_read_b128 a[124:127], v241 offset:22528
v_mfma_f32_16x16x32_bf16 v[176:179], a[196:199], a[236:239], v[176:179]
ds_read_b128 a[144:147], v242 offset:22528
v_mfma_f32_16x16x32_bf16 v[180:183], a[240:243], a[200:203], v[180:183]
ds_read_b64_tr_b16 a[192:193], v233 offset:32776
v_mfma_f32_16x16x32_bf16 v[180:183], a[244:247], a[220:223], v[180:183]
ds_read_b64_tr_b16 a[194:195], v233 offset:33800
s_add_u32 m0, s48, 49152
v_mfma_f32_16x16x32_bf16 v[184:187], a[244:247], a[224:227], v[184:187]
buffer_load_dwordx4 v249, s[12:15], s35 offen offset:1024 lds
v_mfma_f32_16x16x32_bf16 v[184:187], a[240:243], a[204:207], v[184:187]
ds_read_b64_tr_b16 a[196:197], v235 offset:32776
v_mfma_f32_16x16x32_bf16 v[188:191], a[240:243], a[208:211], v[188:191]
ds_read_b64_tr_b16 a[198:199], v235 offset:33800
v_mfma_f32_16x16x32_bf16 v[188:191], a[244:247], a[228:231], v[188:191]
ds_read_b128 a[128:131], v241 offset:24576
v_mfma_f32_16x16x32_bf16 v[192:195], a[244:247], a[232:235], v[192:195]
ds_read_b128 a[148:151], v242 offset:24576
s_add_u32 m0, s48, 49152
v_mfma_f32_16x16x32_bf16 v[192:195], a[240:243], a[212:215], v[192:195]
buffer_load_dwordx4 v250, s[12:15], s35 offen offset:2048 lds
v_mfma_f32_16x16x32_bf16 v[196:199], a[240:243], a[216:219], v[196:199]
ds_read_b128 a[132:135], v241 offset:26624
v_mfma_f32_16x16x32_bf16 v[196:199], a[244:247], a[236:239], v[196:199]
ds_read_b128 a[152:155], v242 offset:26624
v_mfma_f32_16x16x32_bf16 v[200:203], a[248:251], a[200:203], v[200:203]
ds_read_b64_tr_b16 a[240:241], v234 offset:32768
v_mfma_f32_16x16x32_bf16 v[200:203], a[252:255], a[220:223], v[200:203]
ds_read_b64_tr_b16 a[242:243], v234 offset:33792
v_mfma_f32_16x16x32_bf16 v[204:207], a[252:255], a[224:227], v[204:207]
ds_read_b128 a[136:139], v241 offset:28672
v_mfma_f32_16x16x32_bf16 v[204:207], a[248:251], a[204:207], v[204:207]
ds_read_b64_tr_b16 a[244:245], v236 offset:32768
v_mfma_f32_16x16x32_bf16 v[208:211], a[248:251], a[208:211], v[208:211]
ds_read_b64_tr_b16 a[246:247], v236 offset:33792
v_mfma_f32_16x16x32_bf16 v[208:211], a[252:255], a[228:231], v[208:211]
ds_read_b128 a[156:159], v242 offset:28672
v_mfma_f32_16x16x32_bf16 v[212:215], a[252:255], a[232:235], v[212:215]
s_add_u32 m0, s48, 49152
v_mfma_f32_16x16x32_bf16 v[212:215], a[248:251], a[212:215], v[212:215]
buffer_load_dwordx4 v251, s[12:15], s35 offen offset:3072 lds
v_mfma_f32_16x16x32_bf16 v[216:219], a[248:251], a[216:219], v[216:219]
v_mfma_f32_16x16x32_bf16 v[216:219], a[252:255], a[236:239], v[216:219]
s_waitcnt lgkmcnt(1)
v_mfma_f32_16x16x32_bf16 v[80:83], a[184:187], a[120:123], v[80:83]
ds_read_b64_tr_b16 a[248:249], v234 offset:32776
v_mfma_f32_16x16x32_bf16 v[80:83], a[188:191], a[140:143], v[80:83]
ds_read_b64_tr_b16 a[250:251], v234 offset:33800
s_mov_b32 m0, 159744
s_movk_i32 s100, 16384
v_mfma_f32_16x16x32_bf16 v[84:87], a[188:191], a[144:147], v[84:87]
ds_read_b64_tr_b16 a[252:253], v236 offset:32776
buffer_load_dwordx4 v220, s[60:63], s100 offen offset:0 lds
v_mfma_f32_16x16x32_bf16 v[84:87], a[184:187], a[124:127], v[84:87]
ds_read_b64_tr_b16 a[254:255], v236 offset:33800
v_mfma_f32_16x16x32_bf16 v[88:91], a[184:187], a[128:131], v[88:91]
v_mfma_f32_16x16x32_bf16 v[88:91], a[188:191], a[148:151], v[88:91]
v_mfma_f32_16x16x32_bf16 v[92:95], a[188:191], a[152:155], v[92:95]
v_mfma_f32_16x16x32_bf16 v[92:95], a[184:187], a[132:135], v[92:95]
v_mfma_f32_16x16x32_bf16 v[96:99], a[184:187], a[136:139], v[96:99]
s_waitcnt lgkmcnt(3)
v_mfma_f32_16x16x32_bf16 v[96:99], a[188:191], a[156:159], v[96:99]
s_waitcnt vmcnt(14) lgkmcnt(0)
s_barrier
v_mfma_f32_16x16x32_bf16 v[100:103], a[192:195], a[120:123], v[100:103]
ds_read_b64_tr_b16 a[184:185], v233 offset:49152
v_mfma_f32_16x16x32_bf16 v[100:103], a[196:199], a[140:143], v[100:103]
ds_read_b64_tr_b16 a[186:187], v233 offset:50176
s_add_u32 m0, s48, 65536
s_xor_b32 s35, s66, 6815744
v_mfma_f32_16x16x32_bf16 v[104:107], a[196:199], a[144:147], v[104:107]
buffer_load_dwordx4 v248, s[12:15], s35 offen offset:0 lds
v_mfma_f32_16x16x32_bf16 v[104:107], a[192:195], a[124:127], v[104:107]
ds_read_b64_tr_b16 a[188:189], v235 offset:49152
v_mfma_f32_16x16x32_bf16 v[108:111], a[192:195], a[128:131], v[108:111]
ds_read_b64_tr_b16 a[190:191], v235 offset:50176
v_mfma_f32_16x16x32_bf16 v[108:111], a[196:199], a[148:151], v[108:111]
v_mfma_f32_16x16x32_bf16 v[112:115], a[196:199], a[152:155], v[112:115]
s_add_u32 m0, s39, 118784
s_xor_b32 s34, s67, 1792
v_mfma_f32_16x16x32_bf16 v[112:115], a[192:195], a[132:135], v[112:115]
buffer_load_dwordx4 v243, s[8:11], s34 offen offset:0 lds
v_mfma_f32_16x16x32_bf16 v[116:119], a[192:195], a[136:139], v[116:119]
v_mfma_f32_16x16x32_bf16 v[116:119], a[196:199], a[156:159], v[116:119]
v_mfma_f32_16x16x32_bf16 v[60:63], a[240:243], a[120:123], v[60:63]
ds_read_b64_tr_b16 a[192:193], v233 offset:49160
v_mfma_f32_16x16x32_bf16 v[60:63], a[244:247], a[140:143], v[60:63]
ds_read_b64_tr_b16 a[194:195], v233 offset:50184
s_add_u32 m0, s48, 65536
v_mfma_f32_16x16x32_bf16 v[64:67], a[244:247], a[144:147], v[64:67]
buffer_load_dwordx4 v249, s[12:15], s35 offen offset:1024 lds
v_mfma_f32_16x16x32_bf16 v[64:67], a[240:243], a[124:127], v[64:67]
ds_read_b64_tr_b16 a[196:197], v235 offset:49160
v_mfma_f32_16x16x32_bf16 v[68:71], a[240:243], a[128:131], v[68:71]
ds_read_b64_tr_b16 a[198:199], v235 offset:50184
v_mfma_f32_16x16x32_bf16 v[68:71], a[244:247], a[148:151], v[68:71]
v_mfma_f32_16x16x32_bf16 v[72:75], a[244:247], a[152:155], v[72:75]
s_add_u32 m0, s48, 65536
v_mfma_f32_16x16x32_bf16 v[72:75], a[240:243], a[132:135], v[72:75]
buffer_load_dwordx4 v250, s[12:15], s35 offen offset:2048 lds
v_mfma_f32_16x16x32_bf16 v[76:79], a[240:243], a[136:139], v[76:79]
v_mfma_f32_16x16x32_bf16 v[76:79], a[244:247], a[156:159], v[76:79]
v_mfma_f32_16x16x32_bf16 v[120:123], a[248:251], a[120:123], v[120:123]
ds_read_b64_tr_b16 a[240:241], v234 offset:49152
v_mfma_f32_16x16x32_bf16 v[120:123], a[252:255], a[140:143], v[120:123]
ds_read_b64_tr_b16 a[242:243], v234 offset:50176
s_add_u32 m0, s39, 118784
v_mfma_f32_16x16x32_bf16 v[124:127], a[252:255], a[144:147], v[124:127]
buffer_load_dwordx4 v244, s[8:11], s34 offen offset:1024 lds
v_mfma_f32_16x16x32_bf16 v[124:127], a[248:251], a[124:127], v[124:127]
ds_read_b64_tr_b16 a[244:245], v236 offset:49152
v_mfma_f32_16x16x32_bf16 v[128:131], a[248:251], a[128:131], v[128:131]
ds_read_b64_tr_b16 a[246:247], v236 offset:50176
v_mfma_f32_16x16x32_bf16 v[128:131], a[252:255], a[148:151], v[128:131]
v_mfma_f32_16x16x32_bf16 v[132:135], a[252:255], a[152:155], v[132:135]
s_add_u32 m0, s48, 65536
v_mfma_f32_16x16x32_bf16 v[132:135], a[248:251], a[132:135], v[132:135]
buffer_load_dwordx4 v251, s[12:15], s35 offen offset:3072 lds
v_mfma_f32_16x16x32_bf16 v[136:139], a[248:251], a[136:139], v[136:139]
v_mfma_f32_16x16x32_bf16 v[136:139], a[252:255], a[156:159], v[136:139]
s_waitcnt lgkmcnt(4)
v_mfma_f32_16x16x32_bf16 v[140:143], a[184:187], a[120:123], v[140:143]
ds_read_b64_tr_b16 a[248:249], v234 offset:49160
v_mfma_f32_16x16x32_bf16 v[140:143], a[188:191], a[140:143], v[140:143]
ds_read_b64_tr_b16 a[250:251], v234 offset:50184
s_add_u32 m0, s39, 118784
v_mfma_f32_16x16x32_bf16 v[144:147], a[188:191], a[144:147], v[144:147]
ds_read_b64_tr_b16 a[252:253], v236 offset:49160
buffer_load_dwordx4 v245, s[8:11], s34 offen offset:2048 lds
v_mfma_f32_16x16x32_bf16 v[144:147], a[184:187], a[124:127], v[144:147]
ds_read_b64_tr_b16 a[254:255], v236 offset:50184
v_mfma_f32_16x16x32_bf16 v[148:151], a[184:187], a[128:131], v[148:151]
v_mfma_f32_16x16x32_bf16 v[148:151], a[188:191], a[148:151], v[148:151]
v_mfma_f32_16x16x32_bf16 v[152:155], a[188:191], a[152:155], v[152:155]
s_add_u32 m0, s39, 118784
v_mfma_f32_16x16x32_bf16 v[152:155], a[184:187], a[132:135], v[152:155]
buffer_load_dwordx4 v246, s[8:11], s34 offen offset:3072 lds
v_mfma_f32_16x16x32_bf16 v[156:159], a[184:187], a[136:139], v[156:159]
v_mfma_f32_16x16x32_bf16 v[156:159], a[188:191], a[156:159], v[156:159]
s_waitcnt vmcnt(16) lgkmcnt(0)
s_barrier
v_mfma_f32_16x16x32_bf16 v[160:163], a[192:195], a[120:123], v[160:163]
ds_read_b64_tr_b16 a[184:185], v233 offset:0
v_mfma_f32_16x16x32_bf16 v[160:163], a[196:199], a[140:143], v[160:163]
ds_read_b64_tr_b16 a[186:187], v233 offset:1024
s_add_u32 m0, s48, 81920
s_xor_b32 s35, s66, 6815872
v_mfma_f32_16x16x32_bf16 v[164:167], a[196:199], a[144:147], v[164:167]
buffer_load_dwordx4 v248, s[12:15], s35 offen offset:0 lds
v_mfma_f32_16x16x32_bf16 v[164:167], a[192:195], a[124:127], v[164:167]
ds_read_b64_tr_b16 a[188:189], v235 offset:0
v_mfma_f32_16x16x32_bf16 v[168:171], a[192:195], a[128:131], v[168:171]
ds_read_b64_tr_b16 a[190:191], v235 offset:1024
v_mfma_f32_16x16x32_bf16 v[168:171], a[196:199], a[148:151], v[168:171]
ds_read_b128 a[200:203], v241 offset:40960
v_mfma_f32_16x16x32_bf16 v[172:175], a[196:199], a[152:155], v[172:175]
ds_read_b128 a[220:223], v242 offset:40960
s_add_u32 m0, s39, 122880
v_mfma_f32_16x16x32_bf16 v[172:175], a[192:195], a[132:135], v[172:175]
buffer_load_dwordx4 v247, s[8:11], s34 offen lds
v_mfma_f32_16x16x32_bf16 v[176:179], a[192:195], a[136:139], v[176:179]
ds_read_b128 a[204:207], v241 offset:43008
v_mfma_f32_16x16x32_bf16 v[176:179], a[196:199], a[156:159], v[176:179]
ds_read_b128 a[224:227], v242 offset:43008
v_mfma_f32_16x16x32_bf16 v[180:183], a[240:243], a[120:123], v[180:183]
ds_read_b64_tr_b16 a[192:193], v233 offset:8
v_mfma_f32_16x16x32_bf16 v[180:183], a[244:247], a[140:143], v[180:183]
ds_read_b64_tr_b16 a[194:195], v233 offset:1032
s_add_u32 m0, s48, 81920
v_mfma_f32_16x16x32_bf16 v[184:187], a[244:247], a[144:147], v[184:187]
buffer_load_dwordx4 v249, s[12:15], s35 offen offset:1024 lds
v_mfma_f32_16x16x32_bf16 v[184:187], a[240:243], a[124:127], v[184:187]
ds_read_b64_tr_b16 a[196:197], v235 offset:8
v_mfma_f32_16x16x32_bf16 v[188:191], a[240:243], a[128:131], v[188:191]
ds_read_b64_tr_b16 a[198:199], v235 offset:1032
v_mfma_f32_16x16x32_bf16 v[188:191], a[244:247], a[148:151], v[188:191]
ds_read_b128 a[208:211], v241 offset:45056
v_mfma_f32_16x16x32_bf16 v[192:195], a[244:247], a[152:155], v[192:195]
ds_read_b128 a[228:231], v242 offset:45056
s_add_u32 m0, s48, 81920
v_mfma_f32_16x16x32_bf16 v[192:195], a[240:243], a[132:135], v[192:195]
buffer_load_dwordx4 v250, s[12:15], s35 offen offset:2048 lds
v_mfma_f32_16x16x32_bf16 v[196:199], a[240:243], a[136:139], v[196:199]
ds_read_b128 a[212:215], v241 offset:47104
v_mfma_f32_16x16x32_bf16 v[196:199], a[244:247], a[156:159], v[196:199]
ds_read_b128 a[232:235], v242 offset:47104
v_mfma_f32_16x16x32_bf16 v[200:203], a[248:251], a[120:123], v[200:203]
ds_read_b64_tr_b16 a[240:241], v234 offset:0
v_mfma_f32_16x16x32_bf16 v[200:203], a[252:255], a[140:143], v[200:203]
ds_read_b64_tr_b16 a[242:243], v234 offset:1024
s_mov_b32 m0, 159744
s_movk_i32 s100, 16384
v_mfma_f32_16x16x32_bf16 v[204:207], a[252:255], a[144:147], v[204:207]
ds_read_b128 a[216:219], v241 offset:49152
buffer_load_dwordx4 v221, s[60:63], s100 offen offset:1024 lds
v_mfma_f32_16x16x32_bf16 v[204:207], a[248:251], a[124:127], v[204:207]
ds_read_b64_tr_b16 a[244:245], v236 offset:0
v_mfma_f32_16x16x32_bf16 v[208:211], a[248:251], a[128:131], v[208:211]
ds_read_b64_tr_b16 a[246:247], v236 offset:1024
v_mfma_f32_16x16x32_bf16 v[208:211], a[252:255], a[148:151], v[208:211]
ds_read_b128 a[236:239], v242 offset:49152
v_mfma_f32_16x16x32_bf16 v[212:215], a[252:255], a[152:155], v[212:215]
s_add_u32 m0, s48, 81920
v_mfma_f32_16x16x32_bf16 v[212:215], a[248:251], a[132:135], v[212:215]
buffer_load_dwordx4 v251, s[12:15], s35 offen offset:3072 lds
v_mfma_f32_16x16x32_bf16 v[216:219], a[248:251], a[136:139], v[216:219]
v_mfma_f32_16x16x32_bf16 v[216:219], a[252:255], a[156:159], v[216:219]
s_waitcnt lgkmcnt(1)
v_mfma_f32_16x16x32_bf16 v[80:83], a[184:187], a[200:203], v[80:83]
ds_read_b64_tr_b16 a[248:249], v234 offset:8
v_mfma_f32_16x16x32_bf16 v[80:83], a[188:191], a[220:223], v[80:83]
ds_read_b64_tr_b16 a[250:251], v234 offset:1032
s_mov_b32 m0, 159744
s_movk_i32 s100, 16384
v_mfma_f32_16x16x32_bf16 v[84:87], a[188:191], a[224:227], v[84:87]
ds_read_b64_tr_b16 a[252:253], v236 offset:8
buffer_load_dwordx4 v222, s[60:63], s100 offen offset:2048 lds
v_mfma_f32_16x16x32_bf16 v[84:87], a[184:187], a[204:207], v[84:87]
ds_read_b64_tr_b16 a[254:255], v236 offset:1032
v_mfma_f32_16x16x32_bf16 v[88:91], a[184:187], a[208:211], v[88:91]
v_mfma_f32_16x16x32_bf16 v[88:91], a[188:191], a[228:231], v[88:91]
v_mfma_f32_16x16x32_bf16 v[92:95], a[188:191], a[232:235], v[92:95]
s_mov_b32 m0, 159744
s_movk_i32 s100, 16384
v_mfma_f32_16x16x32_bf16 v[92:95], a[184:187], a[212:215], v[92:95]
buffer_load_dwordx4 v223, s[60:63], s100 offen offset:3072 lds
v_mfma_f32_16x16x32_bf16 v[96:99], a[184:187], a[216:219], v[96:99]
s_waitcnt lgkmcnt(2)
v_mfma_f32_16x16x32_bf16 v[96:99], a[188:191], a[236:239], v[96:99]
s_waitcnt vmcnt(17) lgkmcnt(0)
s_barrier
v_mfma_f32_16x16x32_bf16 v[100:103], a[192:195], a[200:203], v[100:103]
ds_read_b64_tr_b16 a[184:185], v233 offset:16384
v_mfma_f32_16x16x32_bf16 v[100:103], a[196:199], a[220:223], v[100:103]
ds_read_b64_tr_b16 a[186:187], v233 offset:17408
s_add_u32 m0, s48, 32768
s_xor_b32 s35, s66, 7340032
v_mfma_f32_16x16x32_bf16 v[104:107], a[196:199], a[224:227], v[104:107]
buffer_load_dwordx4 v248, s[12:15], s35 offen offset:0 lds
v_mfma_f32_16x16x32_bf16 v[104:107], a[192:195], a[204:207], v[104:107]
ds_read_b64_tr_b16 a[188:189], v235 offset:16384
v_mfma_f32_16x16x32_bf16 v[108:111], a[192:195], a[208:211], v[108:111]
ds_read_b64_tr_b16 a[190:191], v235 offset:17408
v_mfma_f32_16x16x32_bf16 v[108:111], a[196:199], a[228:231], v[108:111]
v_mfma_f32_16x16x32_bf16 v[112:115], a[196:199], a[232:235], v[112:115]
s_add_u32 m0, s39, 139264
s_xor_b32 s34, s67, 1920
v_mfma_f32_16x16x32_bf16 v[112:115], a[192:195], a[212:215], v[112:115]
buffer_load_dwordx4 v243, s[8:11], s34 offen offset:0 lds
v_mfma_f32_16x16x32_bf16 v[116:119], a[192:195], a[216:219], v[116:119]
v_mfma_f32_16x16x32_bf16 v[116:119], a[196:199], a[236:239], v[116:119]
v_mfma_f32_16x16x32_bf16 v[60:63], a[240:243], a[200:203], v[60:63]
ds_read_b64_tr_b16 a[192:193], v233 offset:16392
v_mfma_f32_16x16x32_bf16 v[60:63], a[244:247], a[220:223], v[60:63]
ds_read_b64_tr_b16 a[194:195], v233 offset:17416
s_add_u32 m0, s48, 32768
v_mfma_f32_16x16x32_bf16 v[64:67], a[244:247], a[224:227], v[64:67]
buffer_load_dwordx4 v249, s[12:15], s35 offen offset:1024 lds
v_mfma_f32_16x16x32_bf16 v[64:67], a[240:243], a[204:207], v[64:67]
ds_read_b64_tr_b16 a[196:197], v235 offset:16392
v_mfma_f32_16x16x32_bf16 v[68:71], a[240:243], a[208:211], v[68:71]
ds_read_b64_tr_b16 a[198:199], v235 offset:17416
v_mfma_f32_16x16x32_bf16 v[68:71], a[244:247], a[228:231], v[68:71]
v_mfma_f32_16x16x32_bf16 v[72:75], a[244:247], a[232:235], v[72:75]
s_add_u32 m0, s48, 32768
v_mfma_f32_16x16x32_bf16 v[72:75], a[240:243], a[212:215], v[72:75]
buffer_load_dwordx4 v250, s[12:15], s35 offen offset:2048 lds
v_mfma_f32_16x16x32_bf16 v[76:79], a[240:243], a[216:219], v[76:79]
v_mfma_f32_16x16x32_bf16 v[76:79], a[244:247], a[236:239], v[76:79]
v_mfma_f32_16x16x32_bf16 v[120:123], a[248:251], a[200:203], v[120:123]
ds_read_b64_tr_b16 a[240:241], v234 offset:16384
v_mfma_f32_16x16x32_bf16 v[120:123], a[252:255], a[220:223], v[120:123]
ds_read_b64_tr_b16 a[242:243], v234 offset:17408
s_add_u32 m0, s39, 139264
v_mfma_f32_16x16x32_bf16 v[124:127], a[252:255], a[224:227], v[124:127]
buffer_load_dwordx4 v244, s[8:11], s34 offen offset:1024 lds
v_mfma_f32_16x16x32_bf16 v[124:127], a[248:251], a[204:207], v[124:127]
ds_read_b64_tr_b16 a[244:245], v236 offset:16384
v_mfma_f32_16x16x32_bf16 v[128:131], a[248:251], a[208:211], v[128:131]
ds_read_b64_tr_b16 a[246:247], v236 offset:17408
v_mfma_f32_16x16x32_bf16 v[128:131], a[252:255], a[228:231], v[128:131]
v_mfma_f32_16x16x32_bf16 v[132:135], a[252:255], a[232:235], v[132:135]
s_add_u32 m0, s48, 32768
v_mfma_f32_16x16x32_bf16 v[132:135], a[248:251], a[212:215], v[132:135]
buffer_load_dwordx4 v251, s[12:15], s35 offen offset:3072 lds
v_mfma_f32_16x16x32_bf16 v[136:139], a[248:251], a[216:219], v[136:139]
v_mfma_f32_16x16x32_bf16 v[136:139], a[252:255], a[236:239], v[136:139]
s_waitcnt lgkmcnt(4)
v_mfma_f32_16x16x32_bf16 v[140:143], a[184:187], a[200:203], v[140:143]
ds_read_b64_tr_b16 a[248:249], v234 offset:16392
v_mfma_f32_16x16x32_bf16 v[140:143], a[188:191], a[220:223], v[140:143]
ds_read_b64_tr_b16 a[250:251], v234 offset:17416
s_add_u32 m0, s39, 139264
v_mfma_f32_16x16x32_bf16 v[144:147], a[188:191], a[224:227], v[144:147]
ds_read_b64_tr_b16 a[252:253], v236 offset:16392
buffer_load_dwordx4 v245, s[8:11], s34 offen offset:2048 lds
v_mfma_f32_16x16x32_bf16 v[144:147], a[184:187], a[204:207], v[144:147]
ds_read_b64_tr_b16 a[254:255], v236 offset:17416
v_mfma_f32_16x16x32_bf16 v[148:151], a[184:187], a[208:211], v[148:151]
v_mfma_f32_16x16x32_bf16 v[148:151], a[188:191], a[228:231], v[148:151]
v_mfma_f32_16x16x32_bf16 v[152:155], a[188:191], a[232:235], v[152:155]
s_add_u32 m0, s39, 139264
v_mfma_f32_16x16x32_bf16 v[152:155], a[184:187], a[212:215], v[152:155]
buffer_load_dwordx4 v246, s[8:11], s34 offen offset:3072 lds
v_mfma_f32_16x16x32_bf16 v[156:159], a[184:187], a[216:219], v[156:159]
v_mfma_f32_16x16x32_bf16 v[156:159], a[188:191], a[236:239], v[156:159]
s_waitcnt vmcnt(18) lgkmcnt(0)
s_barrier
v_mfma_f32_16x16x32_bf16 v[160:163], a[192:195], a[200:203], v[160:163]
ds_read_b64_tr_b16 a[184:185], v233 offset:32768
v_mfma_f32_16x16x32_bf16 v[160:163], a[196:199], a[220:223], v[160:163]
ds_read_b64_tr_b16 a[186:187], v233 offset:33792
s_add_u32 m0, s48, 49152
s_xor_b32 s35, s66, 7340160
v_mfma_f32_16x16x32_bf16 v[164:167], a[196:199], a[224:227], v[164:167]
buffer_load_dwordx4 v248, s[12:15], s35 offen offset:0 lds
v_mfma_f32_16x16x32_bf16 v[164:167], a[192:195], a[204:207], v[164:167]
ds_read_b64_tr_b16 a[188:189], v235 offset:32768
v_mfma_f32_16x16x32_bf16 v[168:171], a[192:195], a[208:211], v[168:171]
ds_read_b64_tr_b16 a[190:191], v235 offset:33792
v_mfma_f32_16x16x32_bf16 v[168:171], a[196:199], a[228:231], v[168:171]
ds_read_b128 a[120:123], v241 offset:0
v_mfma_f32_16x16x32_bf16 v[172:175], a[196:199], a[232:235], v[172:175]
ds_read_b128 a[140:143], v242 offset:0
s_add_u32 m0, s39, 143360
v_mfma_f32_16x16x32_bf16 v[172:175], a[192:195], a[212:215], v[172:175]
buffer_load_dwordx4 v247, s[8:11], s34 offen lds
v_mfma_f32_16x16x32_bf16 v[176:179], a[192:195], a[216:219], v[176:179]
ds_read_b128 a[124:127], v241 offset:2048
v_mfma_f32_16x16x32_bf16 v[176:179], a[196:199], a[236:239], v[176:179]
ds_read_b128 a[144:147], v242 offset:2048
v_mfma_f32_16x16x32_bf16 v[180:183], a[240:243], a[200:203], v[180:183]
ds_read_b64_tr_b16 a[192:193], v233 offset:32776
v_mfma_f32_16x16x32_bf16 v[180:183], a[244:247], a[220:223], v[180:183]
ds_read_b64_tr_b16 a[194:195], v233 offset:33800
s_add_u32 m0, s48, 49152
v_mfma_f32_16x16x32_bf16 v[184:187], a[244:247], a[224:227], v[184:187]
buffer_load_dwordx4 v249, s[12:15], s35 offen offset:1024 lds
v_mfma_f32_16x16x32_bf16 v[184:187], a[240:243], a[204:207], v[184:187]
ds_read_b64_tr_b16 a[196:197], v235 offset:32776
v_mfma_f32_16x16x32_bf16 v[188:191], a[240:243], a[208:211], v[188:191]
ds_read_b64_tr_b16 a[198:199], v235 offset:33800
v_mfma_f32_16x16x32_bf16 v[188:191], a[244:247], a[228:231], v[188:191]
ds_read_b128 a[128:131], v241 offset:4096
v_mfma_f32_16x16x32_bf16 v[192:195], a[244:247], a[232:235], v[192:195]
ds_read_b128 a[148:151], v242 offset:4096
s_add_u32 m0, s48, 49152
v_mfma_f32_16x16x32_bf16 v[192:195], a[240:243], a[212:215], v[192:195]
buffer_load_dwordx4 v250, s[12:15], s35 offen offset:2048 lds
v_mfma_f32_16x16x32_bf16 v[196:199], a[240:243], a[216:219], v[196:199]
ds_read_b128 a[132:135], v241 offset:6144
v_mfma_f32_16x16x32_bf16 v[196:199], a[244:247], a[236:239], v[196:199]
ds_read_b128 a[152:155], v242 offset:6144
v_mfma_f32_16x16x32_bf16 v[200:203], a[248:251], a[200:203], v[200:203]
ds_read_b64_tr_b16 a[240:241], v234 offset:32768
v_mfma_f32_16x16x32_bf16 v[200:203], a[252:255], a[220:223], v[200:203]
ds_read_b64_tr_b16 a[242:243], v234 offset:33792
s_mov_b32 m0, 159744
s_movk_i32 s100, 24576
v_mfma_f32_16x16x32_bf16 v[204:207], a[252:255], a[224:227], v[204:207]
ds_read_b128 a[136:139], v241 offset:8192
buffer_load_dwordx4 v220, s[60:63], s100 offen offset:0 lds
v_mfma_f32_16x16x32_bf16 v[204:207], a[248:251], a[204:207], v[204:207]
ds_read_b64_tr_b16 a[244:245], v236 offset:32768
v_mfma_f32_16x16x32_bf16 v[208:211], a[248:251], a[208:211], v[208:211]
ds_read_b64_tr_b16 a[246:247], v236 offset:33792
v_mfma_f32_16x16x32_bf16 v[208:211], a[252:255], a[228:231], v[208:211]
ds_read_b128 a[156:159], v242 offset:8192
v_mfma_f32_16x16x32_bf16 v[212:215], a[252:255], a[232:235], v[212:215]
s_add_u32 m0, s48, 49152
v_mfma_f32_16x16x32_bf16 v[212:215], a[248:251], a[212:215], v[212:215]
buffer_load_dwordx4 v251, s[12:15], s35 offen offset:3072 lds
v_mfma_f32_16x16x32_bf16 v[216:219], a[248:251], a[216:219], v[216:219]
v_mfma_f32_16x16x32_bf16 v[216:219], a[252:255], a[236:239], v[216:219]
s_waitcnt lgkmcnt(1)
v_mfma_f32_16x16x32_bf16 v[80:83], a[184:187], a[120:123], v[80:83]
ds_read_b64_tr_b16 a[248:249], v234 offset:32776
v_mfma_f32_16x16x32_bf16 v[80:83], a[188:191], a[140:143], v[80:83]
ds_read_b64_tr_b16 a[250:251], v234 offset:33800
s_mov_b32 m0, 159744
s_movk_i32 s100, 24576
v_mfma_f32_16x16x32_bf16 v[84:87], a[188:191], a[144:147], v[84:87]
ds_read_b64_tr_b16 a[252:253], v236 offset:32776
buffer_load_dwordx4 v221, s[60:63], s100 offen offset:1024 lds
v_mfma_f32_16x16x32_bf16 v[84:87], a[184:187], a[124:127], v[84:87]
ds_read_b64_tr_b16 a[254:255], v236 offset:33800
v_mfma_f32_16x16x32_bf16 v[88:91], a[184:187], a[128:131], v[88:91]
v_mfma_f32_16x16x32_bf16 v[88:91], a[188:191], a[148:151], v[88:91]
v_mfma_f32_16x16x32_bf16 v[92:95], a[188:191], a[152:155], v[92:95]
s_mov_b32 m0, 159744
s_movk_i32 s100, 24576
v_mfma_f32_16x16x32_bf16 v[92:95], a[184:187], a[132:135], v[92:95]
buffer_load_dwordx4 v222, s[60:63], s100 offen offset:2048 lds
v_mfma_f32_16x16x32_bf16 v[96:99], a[184:187], a[136:139], v[96:99]
s_waitcnt lgkmcnt(2)
v_mfma_f32_16x16x32_bf16 v[96:99], a[188:191], a[156:159], v[96:99]
s_waitcnt vmcnt(18) lgkmcnt(0)
s_barrier
v_mfma_f32_16x16x32_bf16 v[100:103], a[192:195], a[120:123], v[100:103]
ds_read_b64_tr_b16 a[184:185], v233 offset:49152
v_mfma_f32_16x16x32_bf16 v[100:103], a[196:199], a[140:143], v[100:103]
ds_read_b64_tr_b16 a[186:187], v233 offset:50176
s_add_u32 m0, s48, 65536
s_xor_b32 s35, s66, 7864320
v_mfma_f32_16x16x32_bf16 v[104:107], a[196:199], a[144:147], v[104:107]
buffer_load_dwordx4 v248, s[12:15], s35 offen offset:0 lds
v_mfma_f32_16x16x32_bf16 v[104:107], a[192:195], a[124:127], v[104:107]
ds_read_b64_tr_b16 a[188:189], v235 offset:49152
v_mfma_f32_16x16x32_bf16 v[108:111], a[192:195], a[128:131], v[108:111]
ds_read_b64_tr_b16 a[190:191], v235 offset:50176
v_mfma_f32_16x16x32_bf16 v[108:111], a[196:199], a[148:151], v[108:111]
v_mfma_f32_16x16x32_bf16 v[112:115], a[196:199], a[152:155], v[112:115]
v_mfma_f32_16x16x32_bf16 v[112:115], a[192:195], a[132:135], v[112:115]
v_mfma_f32_16x16x32_bf16 v[116:119], a[192:195], a[136:139], v[116:119]
v_mfma_f32_16x16x32_bf16 v[116:119], a[196:199], a[156:159], v[116:119]
v_mfma_f32_16x16x32_bf16 v[60:63], a[240:243], a[120:123], v[60:63]
ds_read_b64_tr_b16 a[192:193], v233 offset:49160
v_mfma_f32_16x16x32_bf16 v[60:63], a[244:247], a[140:143], v[60:63]
ds_read_b64_tr_b16 a[194:195], v233 offset:50184
s_add_u32 m0, s48, 65536
v_mfma_f32_16x16x32_bf16 v[64:67], a[244:247], a[144:147], v[64:67]
buffer_load_dwordx4 v249, s[12:15], s35 offen offset:1024 lds
v_mfma_f32_16x16x32_bf16 v[64:67], a[240:243], a[124:127], v[64:67]
ds_read_b64_tr_b16 a[196:197], v235 offset:49160
v_mfma_f32_16x16x32_bf16 v[68:71], a[240:243], a[128:131], v[68:71]
ds_read_b64_tr_b16 a[198:199], v235 offset:50184
v_mfma_f32_16x16x32_bf16 v[68:71], a[244:247], a[148:151], v[68:71]
v_mfma_f32_16x16x32_bf16 v[72:75], a[244:247], a[152:155], v[72:75]
s_add_u32 m0, s48, 65536
v_mfma_f32_16x16x32_bf16 v[72:75], a[240:243], a[132:135], v[72:75]
buffer_load_dwordx4 v250, s[12:15], s35 offen offset:2048 lds
v_mfma_f32_16x16x32_bf16 v[76:79], a[240:243], a[136:139], v[76:79]
v_mfma_f32_16x16x32_bf16 v[76:79], a[244:247], a[156:159], v[76:79]
v_mfma_f32_16x16x32_bf16 v[120:123], a[248:251], a[120:123], v[120:123]
ds_read_b64_tr_b16 a[240:241], v234 offset:49152
v_mfma_f32_16x16x32_bf16 v[120:123], a[252:255], a[140:143], v[120:123]
ds_read_b64_tr_b16 a[242:243], v234 offset:50176
v_mfma_f32_16x16x32_bf16 v[124:127], a[252:255], a[144:147], v[124:127]
v_mfma_f32_16x16x32_bf16 v[124:127], a[248:251], a[124:127], v[124:127]
ds_read_b64_tr_b16 a[244:245], v236 offset:49152
v_mfma_f32_16x16x32_bf16 v[128:131], a[248:251], a[128:131], v[128:131]
ds_read_b64_tr_b16 a[246:247], v236 offset:50176
v_mfma_f32_16x16x32_bf16 v[128:131], a[252:255], a[148:151], v[128:131]
v_mfma_f32_16x16x32_bf16 v[132:135], a[252:255], a[152:155], v[132:135]
s_add_u32 m0, s48, 65536
v_mfma_f32_16x16x32_bf16 v[132:135], a[248:251], a[132:135], v[132:135]
buffer_load_dwordx4 v251, s[12:15], s35 offen offset:3072 lds
v_mfma_f32_16x16x32_bf16 v[136:139], a[248:251], a[136:139], v[136:139]
v_mfma_f32_16x16x32_bf16 v[136:139], a[252:255], a[156:159], v[136:139]
s_waitcnt lgkmcnt(4)
v_mfma_f32_16x16x32_bf16 v[140:143], a[184:187], a[120:123], v[140:143]
ds_read_b64_tr_b16 a[248:249], v234 offset:49160
v_mfma_f32_16x16x32_bf16 v[140:143], a[188:191], a[140:143], v[140:143]
ds_read_b64_tr_b16 a[250:251], v234 offset:50184
v_mfma_f32_16x16x32_bf16 v[144:147], a[188:191], a[144:147], v[144:147]
ds_read_b64_tr_b16 a[252:253], v236 offset:49160
v_mfma_f32_16x16x32_bf16 v[144:147], a[184:187], a[124:127], v[144:147]
ds_read_b64_tr_b16 a[254:255], v236 offset:50184
v_mfma_f32_16x16x32_bf16 v[148:151], a[184:187], a[128:131], v[148:151]
v_mfma_f32_16x16x32_bf16 v[148:151], a[188:191], a[148:151], v[148:151]
v_mfma_f32_16x16x32_bf16 v[152:155], a[188:191], a[152:155], v[152:155]
v_mfma_f32_16x16x32_bf16 v[152:155], a[184:187], a[132:135], v[152:155]
v_mfma_f32_16x16x32_bf16 v[156:159], a[184:187], a[136:139], v[156:159]
v_mfma_f32_16x16x32_bf16 v[156:159], a[188:191], a[156:159], v[156:159]
s_waitcnt vmcnt(14) lgkmcnt(0)
s_barrier
v_mfma_f32_16x16x32_bf16 v[160:163], a[192:195], a[120:123], v[160:163]
ds_read_b64_tr_b16 a[184:185], v233 offset:0
v_mfma_f32_16x16x32_bf16 v[160:163], a[196:199], a[140:143], v[160:163]
ds_read_b64_tr_b16 a[186:187], v233 offset:1024
s_add_u32 m0, s48, 81920
s_xor_b32 s35, s66, 7864448
v_mfma_f32_16x16x32_bf16 v[164:167], a[196:199], a[144:147], v[164:167]
buffer_load_dwordx4 v248, s[12:15], s35 offen offset:0 lds
v_mfma_f32_16x16x32_bf16 v[164:167], a[192:195], a[124:127], v[164:167]
ds_read_b64_tr_b16 a[188:189], v235 offset:0
v_mfma_f32_16x16x32_bf16 v[168:171], a[192:195], a[128:131], v[168:171]
ds_read_b64_tr_b16 a[190:191], v235 offset:1024
v_mfma_f32_16x16x32_bf16 v[168:171], a[196:199], a[148:151], v[168:171]
ds_read_b128 a[200:203], v241 offset:20480
v_mfma_f32_16x16x32_bf16 v[172:175], a[196:199], a[152:155], v[172:175]
ds_read_b128 a[220:223], v242 offset:20480
v_mfma_f32_16x16x32_bf16 v[172:175], a[192:195], a[132:135], v[172:175]
v_mfma_f32_16x16x32_bf16 v[176:179], a[192:195], a[136:139], v[176:179]
ds_read_b128 a[204:207], v241 offset:22528
v_mfma_f32_16x16x32_bf16 v[176:179], a[196:199], a[156:159], v[176:179]
ds_read_b128 a[224:227], v242 offset:22528
v_mfma_f32_16x16x32_bf16 v[180:183], a[240:243], a[120:123], v[180:183]
ds_read_b64_tr_b16 a[192:193], v233 offset:8
v_mfma_f32_16x16x32_bf16 v[180:183], a[244:247], a[140:143], v[180:183]
ds_read_b64_tr_b16 a[194:195], v233 offset:1032
s_add_u32 m0, s48, 81920
v_mfma_f32_16x16x32_bf16 v[184:187], a[244:247], a[144:147], v[184:187]
buffer_load_dwordx4 v249, s[12:15], s35 offen offset:1024 lds
v_mfma_f32_16x16x32_bf16 v[184:187], a[240:243], a[124:127], v[184:187]
ds_read_b64_tr_b16 a[196:197], v235 offset:8
v_mfma_f32_16x16x32_bf16 v[188:191], a[240:243], a[128:131], v[188:191]
ds_read_b64_tr_b16 a[198:199], v235 offset:1032
v_mfma_f32_16x16x32_bf16 v[188:191], a[244:247], a[148:151], v[188:191]
ds_read_b128 a[208:211], v241 offset:24576
v_mfma_f32_16x16x32_bf16 v[192:195], a[244:247], a[152:155], v[192:195]
ds_read_b128 a[228:231], v242 offset:24576
s_add_u32 m0, s48, 81920
v_mfma_f32_16x16x32_bf16 v[192:195], a[240:243], a[132:135], v[192:195]
buffer_load_dwordx4 v250, s[12:15], s35 offen offset:2048 lds
v_mfma_f32_16x16x32_bf16 v[196:199], a[240:243], a[136:139], v[196:199]
ds_read_b128 a[212:215], v241 offset:26624
v_mfma_f32_16x16x32_bf16 v[196:199], a[244:247], a[156:159], v[196:199]
ds_read_b128 a[232:235], v242 offset:26624
v_mfma_f32_16x16x32_bf16 v[200:203], a[248:251], a[120:123], v[200:203]
ds_read_b64_tr_b16 a[240:241], v234 offset:0
v_mfma_f32_16x16x32_bf16 v[200:203], a[252:255], a[140:143], v[200:203]
ds_read_b64_tr_b16 a[242:243], v234 offset:1024
s_mov_b32 m0, 159744
s_movk_i32 s100, 24576
v_mfma_f32_16x16x32_bf16 v[204:207], a[252:255], a[144:147], v[204:207]
ds_read_b128 a[216:219], v241 offset:28672
buffer_load_dwordx4 v223, s[60:63], s100 offen offset:3072 lds
v_mfma_f32_16x16x32_bf16 v[204:207], a[248:251], a[124:127], v[204:207]
ds_read_b64_tr_b16 a[244:245], v236 offset:0
v_mfma_f32_16x16x32_bf16 v[208:211], a[248:251], a[128:131], v[208:211]
ds_read_b64_tr_b16 a[246:247], v236 offset:1024
v_mfma_f32_16x16x32_bf16 v[208:211], a[252:255], a[148:151], v[208:211]
ds_read_b128 a[236:239], v242 offset:28672
v_mfma_f32_16x16x32_bf16 v[212:215], a[252:255], a[152:155], v[212:215]
s_add_u32 m0, s48, 81920
v_mfma_f32_16x16x32_bf16 v[212:215], a[248:251], a[132:135], v[212:215]
buffer_load_dwordx4 v251, s[12:15], s35 offen offset:3072 lds
v_mfma_f32_16x16x32_bf16 v[216:219], a[248:251], a[136:139], v[216:219]
v_mfma_f32_16x16x32_bf16 v[216:219], a[252:255], a[156:159], v[216:219]
s_waitcnt lgkmcnt(1)
v_mfma_f32_16x16x32_bf16 v[80:83], a[184:187], a[200:203], v[80:83]
ds_read_b64_tr_b16 a[248:249], v234 offset:8
v_mfma_f32_16x16x32_bf16 v[80:83], a[188:191], a[220:223], v[80:83]
ds_read_b64_tr_b16 a[250:251], v234 offset:1032
v_mfma_f32_16x16x32_bf16 v[84:87], a[188:191], a[224:227], v[84:87]
ds_read_b64_tr_b16 a[252:253], v236 offset:8
v_mfma_f32_16x16x32_bf16 v[84:87], a[184:187], a[204:207], v[84:87]
ds_read_b64_tr_b16 a[254:255], v236 offset:1032
v_mfma_f32_16x16x32_bf16 v[88:91], a[184:187], a[208:211], v[88:91]
v_mfma_f32_16x16x32_bf16 v[88:91], a[188:191], a[228:231], v[88:91]
s_lshl_b32 s49, s31, 3
s_add_u32 s49, s49, s32
s_lshl_b32 s49, s49, 4
v_mfma_f32_16x16x32_bf16 v[92:95], a[188:191], a[232:235], v[92:95]
s_add_u32 s56, s6, s49
s_addc_u32 s57, s7, 0
s_and_b32 s57, s57, 0xffff
v_mfma_f32_16x16x32_bf16 v[92:95], a[184:187], a[212:215], v[92:95]
s_mov_b32 s58, 4
s_mov_b32 s59, 0x20000
v_mov_b32 v254, 1
v_mfma_f32_16x16x32_bf16 v[96:99], a[184:187], a[216:219], v[96:99]
s_lshl_b32 s49, s28, 8
v_lshlrev_b32 v224, 2, v226
v_add_u32 v224, s49, v224
s_waitcnt lgkmcnt(0)
v_mfma_f32_16x16x32_bf16 v[96:99], a[188:191], a[236:239], v[96:99]
s_waitcnt vmcnt(11)
s_barrier
s_lshl_b32 s49, s99, 19
v_mfma_f32_16x16x32_bf16 v[100:103], a[192:195], a[200:203], v[100:103]
ds_read_b64_tr_b16 a[184:185], v233 offset:16384
s_lshl_b32 s67, s98, 9
s_add_u32 s49, s49, s67
v_mfma_f32_16x16x32_bf16 v[100:103], a[196:199], a[220:223], v[100:103]
ds_read_b64_tr_b16 a[186:187], v233 offset:17408
s_add_u32 m0, s48, 32768
s_xor_b32 s36, s3, 8192
v_mfma_f32_16x16x32_bf16 v[104:107], a[196:199], a[224:227], v[104:107]
buffer_load_dwordx4 v220, s[16:19], s36 offen offset:0 nt lds
s_lshl_b32 s50, s29, 8
s_add_u32 s49, s49, s50
v_mfma_f32_16x16x32_bf16 v[104:107], a[192:195], a[204:207], v[104:107]
ds_read_b64_tr_b16 a[188:189], v235 offset:16384
s_add_u32 s12, s64, s49
s_addc_u32 s13, s65, 0
v_mfma_f32_16x16x32_bf16 v[108:111], a[192:195], a[208:211], v[108:111]
ds_read_b64_tr_b16 a[190:191], v235 offset:17408
s_and_b32 s13, s13, 0xffff
s_mov_b32 s14, 6813952
v_mfma_f32_16x16x32_bf16 v[108:111], a[196:199], a[228:231], v[108:111]
s_mov_b32 s15, 0x20000
s_lshl_b32 s49, s30, 14
v_lshlrev_b32 v229, 1, v227
v_mfma_f32_16x16x32_bf16 v[112:115], a[196:199], a[232:235], v[112:115]
v_xor_b32 v229, v229, v228
v_and_b32 v230, 7, v229
v_mfma_f32_16x16x32_bf16 v[112:115], a[192:195], a[212:215], v[112:115]
v_lshlrev_b32 v230, 4, v230
v_lshrrev_b32 v229, 3, v229
v_mfma_f32_16x16x32_bf16 v[116:119], a[192:195], a[216:219], v[116:119]
v_lshl_add_u32 v229, v229, 18, v230
v_lshl_add_u32 v229, v227, 11, v229
v_mfma_f32_16x16x32_bf16 v[116:119], a[196:199], a[236:239], v[116:119]
v_add_u32 v248, s49, v229
v_add_u32 v249, 31744, v248
v_mfma_f32_16x16x32_bf16 v[60:63], a[240:243], a[200:203], v[60:63]
ds_read_b64_tr_b16 a[192:193], v233 offset:16392
v_xor_b32 v229, 0x40000, v248
v_add_u32 v250, 6144, v229
v_mfma_f32_16x16x32_bf16 v[60:63], a[244:247], a[220:223], v[60:63]
ds_read_b64_tr_b16 a[194:195], v233 offset:17416
s_add_u32 m0, s48, 32768
v_add_u32 v251, 37888, v229
v_mfma_f32_16x16x32_bf16 v[64:67], a[244:247], a[224:227], v[64:67]
buffer_load_dwordx4 v221, s[16:19], s36 offen offset:1024 nt lds
s_lshl_b32 s43, s98, 21
s_lshl_b32 s49, s99, 6
v_mfma_f32_16x16x32_bf16 v[64:67], a[240:243], a[204:207], v[64:67]
ds_read_b64_tr_b16 a[196:197], v235 offset:16392
s_or_b32 s44, s43, s49
s_and_b32 s49, s49, 128
v_mfma_f32_16x16x32_bf16 v[68:71], a[240:243], a[208:211], v[68:71]
ds_read_b64_tr_b16 a[198:199], v235 offset:17416
s_or_b32 s43, s43, s49
s_and_b32 s100, s99, 1
v_mfma_f32_16x16x32_bf16 v[68:71], a[244:247], a[228:231], v[68:71]
s_lshl_b32 s100, s100, 1
s_xor_b32 s40, s98, 1
s_mul_i32 s40, s40, 81920
v_mfma_f32_16x16x32_bf16 v[72:75], a[244:247], a[232:235], v[72:75]
s_xor_b32 s41, s98, 2
s_mul_i32 s41, s41, 81920
s_xor_b32 s42, s98, 3
v_mfma_f32_16x16x32_bf16 v[72:75], a[240:243], a[212:215], v[72:75]
s_mul_i32 s42, s42, 81920
s_lshl_b32 s49, s31, 3
s_add_u32 s49, s49, s32
v_mfma_f32_16x16x32_bf16 v[76:79], a[240:243], a[216:219], v[76:79]
s_lshl_b32 s49, s49, 2
s_add_u32 s49, s49, s99
s_mul_i32 s49, s49, 327680
v_mfma_f32_16x16x32_bf16 v[76:79], a[244:247], a[236:239], v[76:79]
s_add_u32 s8, s90, s49
s_addc_u32 s9, s91, 0
s_and_b32 s9, s9, 0xffff
v_mfma_f32_16x16x32_bf16 v[120:123], a[248:251], a[200:203], v[120:123]
ds_read_b64_tr_b16 a[240:241], v234 offset:16384
s_mov_b32 s10, 327680
s_mov_b32 s11, 0x20000
v_mfma_f32_16x16x32_bf16 v[120:123], a[252:255], a[220:223], v[120:123]
ds_read_b64_tr_b16 a[242:243], v234 offset:17408
s_add_u32 m0, s48, 32768
s_mul_i32 s49, s30, 10240
v_mfma_f32_16x16x32_bf16 v[124:127], a[252:255], a[224:227], v[124:127]
buffer_load_dwordx4 v222, s[16:19], s36 offen offset:2048 nt lds
s_lshl_b32 s50, s29, 10
s_add_u32 s49, s49, s50
v_mfma_f32_16x16x32_bf16 v[124:127], a[248:251], a[204:207], v[124:127]
ds_read_b64_tr_b16 a[244:245], v236 offset:16384
v_lshlrev_b32 v229, 4, v226
v_add_u32 v244, s49, v229
v_mfma_f32_16x16x32_bf16 v[128:131], a[248:251], a[208:211], v[128:131]
ds_read_b64_tr_b16 a[246:247], v236 offset:17408
v_add_u32 v245, 40960, v244
v_add_u32 v243, s39, v229
v_mfma_f32_16x16x32_bf16 v[128:131], a[252:255], a[228:231], v[128:131]
v_add_u32 v247, 4096, v243
v_lshrrev_b32 v229, 2, v226
v_mfma_f32_16x16x32_bf16 v[132:135], a[252:255], a[232:235], v[132:135]
v_add_u32 v229, 1, v229
v_lshlrev_b32 v229, 3, v229
v_mfma_f32_16x16x32_bf16 v[132:135], a[248:251], a[212:215], v[132:135]
v_xor_b32 v229, s2, v229
v_and_b32 v230, 3, v226
v_mfma_f32_16x16x32_bf16 v[136:139], a[248:251], a[216:219], v[136:139]
v_lshlrev_b32 v230, 2, v230
v_lshl_add_u32 v252, v229, 7, v230
v_mfma_f32_16x16x32_bf16 v[136:139], a[252:255], a[236:239], v[136:139]
s_waitcnt lgkmcnt(4)
v_cmp_lt_u32 vcc, 11, v226
v_mov_b32 v229, 0x100000
v_mfma_f32_16x16x32_bf16 v[140:143], a[184:187], a[200:203], v[140:143]
ds_read_b64_tr_b16 a[248:249], v234 offset:16392
s_nop 0
v_cndmask_b32 v252, v252, v229, vcc
v_mfma_f32_16x16x32_bf16 v[140:143], a[188:191], a[220:223], v[140:143]
ds_read_b64_tr_b16 a[250:251], v234 offset:17416
s_add_u32 m0, s48, 32768
v_mfma_f32_16x16x32_bf16 v[144:147], a[188:191], a[224:227], v[144:147]
ds_read_b64_tr_b16 a[252:253], v236 offset:16392
buffer_load_dwordx4 v223, s[16:19], s36 offen offset:3072 nt lds
v_mfma_f32_16x16x32_bf16 v[144:147], a[184:187], a[204:207], v[144:147]
ds_read_b64_tr_b16 a[254:255], v236 offset:17416
v_mfma_f32_16x16x32_bf16 v[148:151], a[184:187], a[208:211], v[148:151]
v_mfma_f32_16x16x32_bf16 v[148:151], a[188:191], a[228:231], v[148:151]
v_mfma_f32_16x16x32_bf16 v[152:155], a[188:191], a[232:235], v[152:155]
v_mfma_f32_16x16x32_bf16 v[152:155], a[184:187], a[212:215], v[152:155]
v_mfma_f32_16x16x32_bf16 v[156:159], a[184:187], a[216:219], v[156:159]
v_mfma_f32_16x16x32_bf16 v[156:159], a[188:191], a[236:239], v[156:159]
s_waitcnt vmcnt(9) lgkmcnt(0)
s_barrier
v_mfma_f32_16x16x32_bf16 v[160:163], a[192:195], a[200:203], v[160:163]
ds_read_b64_tr_b16 a[184:185], v233 offset:32768
v_mfma_f32_16x16x32_bf16 v[160:163], a[196:199], a[220:223], v[160:163]
ds_read_b64_tr_b16 a[186:187], v233 offset:33792
s_add_u32 m0, s48, 49152
s_xor_b32 s37, s3, 8192
v_mfma_f32_16x16x32_bf16 v[164:167], a[196:199], a[224:227], v[164:167]
buffer_load_dwordx4 v220, s[20:23], s37 offen offset:0 nt lds
v_mfma_f32_16x16x32_bf16 v[164:167], a[192:195], a[204:207], v[164:167]
ds_read_b64_tr_b16 a[188:189], v235 offset:32768
v_mfma_f32_16x16x32_bf16 v[168:171], a[192:195], a[208:211], v[168:171]
ds_read_b64_tr_b16 a[190:191], v235 offset:33792
v_mfma_f32_16x16x32_bf16 v[168:171], a[196:199], a[228:231], v[168:171]
ds_read_b128 a[120:123], v241 offset:40960
v_mfma_f32_16x16x32_bf16 v[172:175], a[196:199], a[232:235], v[172:175]
ds_read_b128 a[140:143], v242 offset:40960
v_mfma_f32_16x16x32_bf16 v[172:175], a[192:195], a[212:215], v[172:175]
v_mfma_f32_16x16x32_bf16 v[176:179], a[192:195], a[216:219], v[176:179]
ds_read_b128 a[124:127], v241 offset:43008
v_mfma_f32_16x16x32_bf16 v[176:179], a[196:199], a[236:239], v[176:179]
ds_read_b128 a[144:147], v242 offset:43008
v_mfma_f32_16x16x32_bf16 v[180:183], a[240:243], a[200:203], v[180:183]
ds_read_b64_tr_b16 a[192:193], v233 offset:32776
v_mfma_f32_16x16x32_bf16 v[180:183], a[244:247], a[220:223], v[180:183]
ds_read_b64_tr_b16 a[194:195], v233 offset:33800
s_add_u32 m0, s48, 49152
v_mfma_f32_16x16x32_bf16 v[184:187], a[244:247], a[224:227], v[184:187]
buffer_load_dwordx4 v221, s[20:23], s37 offen offset:1024 nt lds
v_mfma_f32_16x16x32_bf16 v[184:187], a[240:243], a[204:207], v[184:187]
ds_read_b64_tr_b16 a[196:197], v235 offset:32776
v_mfma_f32_16x16x32_bf16 v[188:191], a[240:243], a[208:211], v[188:191]
ds_read_b64_tr_b16 a[198:199], v235 offset:33800
v_mfma_f32_16x16x32_bf16 v[188:191], a[244:247], a[228:231], v[188:191]
ds_read_b128 a[128:131], v241 offset:45056
v_mfma_f32_16x16x32_bf16 v[192:195], a[244:247], a[232:235], v[192:195]
ds_read_b128 a[148:151], v242 offset:45056
v_mfma_f32_16x16x32_bf16 v[192:195], a[240:243], a[212:215], v[192:195]
v_mfma_f32_16x16x32_bf16 v[196:199], a[240:243], a[216:219], v[196:199]
ds_read_b128 a[132:135], v241 offset:47104
v_mfma_f32_16x16x32_bf16 v[196:199], a[244:247], a[236:239], v[196:199]
ds_read_b128 a[152:155], v242 offset:47104
v_mfma_f32_16x16x32_bf16 v[200:203], a[248:251], a[200:203], v[200:203]
ds_read_b64_tr_b16 a[240:241], v234 offset:32768
v_mfma_f32_16x16x32_bf16 v[200:203], a[252:255], a[220:223], v[200:203]
ds_read_b64_tr_b16 a[242:243], v234 offset:33792
s_add_u32 m0, s48, 49152
v_mfma_f32_16x16x32_bf16 v[204:207], a[252:255], a[224:227], v[204:207]
ds_read_b128 a[136:139], v241 offset:49152
buffer_load_dwordx4 v222, s[20:23], s37 offen offset:2048 nt lds
v_mfma_f32_16x16x32_bf16 v[204:207], a[248:251], a[204:207], v[204:207]
ds_read_b64_tr_b16 a[244:245], v236 offset:32768
v_mfma_f32_16x16x32_bf16 v[208:211], a[248:251], a[208:211], v[208:211]
ds_read_b64_tr_b16 a[246:247], v236 offset:33792
v_mfma_f32_16x16x32_bf16 v[208:211], a[252:255], a[228:231], v[208:211]
ds_read_b128 a[156:159], v242 offset:49152
v_mfma_f32_16x16x32_bf16 v[212:215], a[252:255], a[232:235], v[212:215]
v_mfma_f32_16x16x32_bf16 v[212:215], a[248:251], a[212:215], v[212:215]
v_mfma_f32_16x16x32_bf16 v[216:219], a[248:251], a[216:219], v[216:219]
v_mfma_f32_16x16x32_bf16 v[216:219], a[252:255], a[236:239], v[216:219]
s_waitcnt lgkmcnt(1)
v_mfma_f32_16x16x32_bf16 v[80:83], a[184:187], a[120:123], v[80:83]
ds_read_b64_tr_b16 a[248:249], v234 offset:32776
s_lshl_b32 s49, s29, 13
v_lshlrev_b32 v230, 8, v228
v_mfma_f32_16x16x32_bf16 v[80:83], a[188:191], a[140:143], v[80:83]
ds_read_b64_tr_b16 a[250:251], v234 offset:33800
s_add_u32 m0, s48, 49152
v_add_u32 v230, s49, v230
v_mfma_f32_16x16x32_bf16 v[84:87], a[188:191], a[144:147], v[84:87]
ds_read_b64_tr_b16 a[252:253], v236 offset:32776
buffer_load_dwordx4 v223, s[20:23], s37 offen offset:3072 nt lds
v_lshrrev_b32 v232, 3, v228
v_mfma_f32_16x16x32_bf16 v[84:87], a[184:187], a[124:127], v[84:87]
ds_read_b64_tr_b16 a[254:255], v236 offset:33800
v_mul_u32_u24 v232, 25, v232
v_lshlrev_b32 v231, 1, v228
v_mfma_f32_16x16x32_bf16 v[88:91], a[184:187], a[128:131], v[88:91]
v_xor_b32 v231, v231, v232
v_xor_b32 v231, v227, v231
v_mfma_f32_16x16x32_bf16 v[88:91], a[188:191], a[148:151], v[88:91]
v_lshl_add_u32 v229, v231, 4, v230
v_xor_b32 v229, s45, v229
v_mfma_f32_16x16x32_bf16 v[92:95], a[188:191], a[152:155], v[92:95]
v_xor_b32 v230, 64, v229
v_xor_b32 v231, 128, v229
v_mfma_f32_16x16x32_bf16 v[92:95], a[184:187], a[132:135], v[92:95]
v_xor_b32 v232, 192, v229
s_add_u32 s49, s48, 98304
v_lshl_add_u32 v246, v226, 4, s49
v_mfma_f32_16x16x32_bf16 v[96:99], a[184:187], a[136:139], v[96:99]
s_waitcnt lgkmcnt(0)
v_mfma_f32_16x16x32_bf16 v[96:99], a[188:191], a[156:159], v[96:99]
s_waitcnt vmcnt(8)
s_barrier
v_mfma_f32_16x16x32_bf16 v[100:103], a[192:195], a[120:123], v[100:103]
ds_read_b64_tr_b16 a[184:185], v233 offset:49152
v_mfma_f32_16x16x32_bf16 v[100:103], a[196:199], a[140:143], v[100:103]
ds_read_b64_tr_b16 a[186:187], v233 offset:50176
s_add_u32 m0, s48, 65536
s_xor_b32 s36, s3, 16384
v_mfma_f32_16x16x32_bf16 v[104:107], a[196:199], a[144:147], v[104:107]
buffer_load_dwordx4 v220, s[16:19], s36 offen offset:0 nt lds
v_mfma_f32_16x16x32_bf16 v[104:107], a[192:195], a[124:127], v[104:107]
ds_read_b64_tr_b16 a[188:189], v235 offset:49152
v_mul_f32 v80, s53, v80
v_mul_f32 v81, s53, v81
v_mfma_f32_16x16x32_bf16 v[108:111], a[192:195], a[128:131], v[108:111]
ds_read_b64_tr_b16 a[190:191], v235 offset:50176
v_mul_f32 v82, s53, v82
v_mul_f32 v83, s53, v83
v_mfma_f32_16x16x32_bf16 v[108:111], a[196:199], a[148:151], v[108:111]
v_mul_f32 v84, s53, v84
v_mul_f32 v85, s53, v85
v_mfma_f32_16x16x32_bf16 v[112:115], a[196:199], a[152:155], v[112:115]
v_mul_f32 v86, s53, v86
v_mul_f32 v87, s53, v87
v_mfma_f32_16x16x32_bf16 v[112:115], a[192:195], a[132:135], v[112:115]
v_mul_f32 v88, s53, v88
v_mul_f32 v89, s53, v89
v_mfma_f32_16x16x32_bf16 v[116:119], a[192:195], a[136:139], v[116:119]
v_mul_f32 v90, s53, v90
v_mul_f32 v91, s53, v91
v_mfma_f32_16x16x32_bf16 v[116:119], a[196:199], a[156:159], v[116:119]
v_mul_f32 v92, s53, v92
v_mul_f32 v93, s53, v93
v_mfma_f32_16x16x32_bf16 v[60:63], a[240:243], a[120:123], v[60:63]
ds_read_b64_tr_b16 a[192:193], v233 offset:49160
v_mul_f32 v94, s53, v94
v_mul_f32 v95, s53, v95
v_mfma_f32_16x16x32_bf16 v[60:63], a[244:247], a[140:143], v[60:63]
ds_read_b64_tr_b16 a[194:195], v233 offset:50184
s_add_u32 m0, s48, 65536
v_mul_f32 v96, s53, v96
v_mul_f32 v97, s53, v97
v_mfma_f32_16x16x32_bf16 v[64:67], a[244:247], a[144:147], v[64:67]
buffer_load_dwordx4 v221, s[16:19], s36 offen offset:1024 nt lds
v_mul_f32 v98, s53, v98
v_mul_f32 v99, s53, v99
v_mfma_f32_16x16x32_bf16 v[64:67], a[240:243], a[124:127], v[64:67]
ds_read_b64_tr_b16 a[196:197], v235 offset:49160
v_mul_f32 v100, s53, v100
v_mul_f32 v101, s53, v101
v_mfma_f32_16x16x32_bf16 v[68:71], a[240:243], a[128:131], v[68:71]
ds_read_b64_tr_b16 a[198:199], v235 offset:50184
v_mul_f32 v102, s53, v102
v_mul_f32 v103, s53, v103
v_mfma_f32_16x16x32_bf16 v[68:71], a[244:247], a[148:151], v[68:71]
v_mul_f32 v104, s53, v104
v_mul_f32 v105, s53, v105
v_mfma_f32_16x16x32_bf16 v[72:75], a[244:247], a[152:155], v[72:75]
v_mul_f32 v106, s53, v106
v_mul_f32 v107, s53, v107
v_mfma_f32_16x16x32_bf16 v[72:75], a[240:243], a[132:135], v[72:75]
v_mul_f32 v108, s53, v108
v_mul_f32 v109, s53, v109
v_mfma_f32_16x16x32_bf16 v[76:79], a[240:243], a[136:139], v[76:79]
v_mul_f32 v110, s53, v110
v_mul_f32 v111, s53, v111
v_mfma_f32_16x16x32_bf16 v[76:79], a[244:247], a[156:159], v[76:79]
v_mul_f32 v112, s53, v112
v_mul_f32 v113, s53, v113
v_mfma_f32_16x16x32_bf16 v[120:123], a[248:251], a[120:123], v[120:123]
ds_read_b64_tr_b16 a[240:241], v234 offset:49152
v_mul_f32 v114, s53, v114
v_mul_f32 v115, s53, v115
v_mfma_f32_16x16x32_bf16 v[120:123], a[252:255], a[140:143], v[120:123]
ds_read_b64_tr_b16 a[242:243], v234 offset:50176
s_add_u32 m0, s48, 65536
v_mul_f32 v116, s53, v116
v_mul_f32 v117, s53, v117
v_mfma_f32_16x16x32_bf16 v[124:127], a[252:255], a[144:147], v[124:127]
buffer_load_dwordx4 v222, s[16:19], s36 offen offset:2048 nt lds
v_mul_f32 v118, s53, v118
v_mul_f32 v119, s53, v119
v_mfma_f32_16x16x32_bf16 v[124:127], a[248:251], a[124:127], v[124:127]
ds_read_b64_tr_b16 a[244:245], v236 offset:49152
v_cvt_pk_bf16_f32 v0, v80, v81
v_cvt_pk_bf16_f32 v1, v82, v83
v_mfma_f32_16x16x32_bf16 v[128:131], a[248:251], a[128:131], v[128:131]
ds_read_b64_tr_b16 a[246:247], v236 offset:50176
v_cvt_pk_bf16_f32 v2, v100, v101
v_cvt_pk_bf16_f32 v3, v102, v103
v_mfma_f32_16x16x32_bf16 v[128:131], a[252:255], a[148:151], v[128:131]
v_cvt_pk_bf16_f32 v4, v84, v85
v_cvt_pk_bf16_f32 v5, v86, v87
v_mfma_f32_16x16x32_bf16 v[132:135], a[252:255], a[152:155], v[132:135]
v_cvt_pk_bf16_f32 v6, v104, v105
v_cvt_pk_bf16_f32 v7, v106, v107
v_mfma_f32_16x16x32_bf16 v[132:135], a[248:251], a[132:135], v[132:135]
v_cvt_pk_bf16_f32 v8, v88, v89
v_cvt_pk_bf16_f32 v9, v90, v91
v_mfma_f32_16x16x32_bf16 v[136:139], a[248:251], a[136:139], v[136:139]
v_cvt_pk_bf16_f32 v10, v108, v109
v_cvt_pk_bf16_f32 v11, v110, v111
v_mfma_f32_16x16x32_bf16 v[136:139], a[252:255], a[156:159], v[136:139]
s_waitcnt lgkmcnt(4)
v_cvt_pk_bf16_f32 v12, v92, v93
v_cvt_pk_bf16_f32 v13, v94, v95
v_mfma_f32_16x16x32_bf16 v[140:143], a[184:187], a[120:123], v[140:143]
ds_read_b64_tr_b16 a[248:249], v234 offset:49160
v_cvt_pk_bf16_f32 v14, v112, v113
v_cvt_pk_bf16_f32 v15, v114, v115
v_mfma_f32_16x16x32_bf16 v[140:143], a[188:191], a[140:143], v[140:143]
ds_read_b64_tr_b16 a[250:251], v234 offset:50184
s_add_u32 m0, s48, 65536
v_cvt_pk_bf16_f32 v16, v96, v97
v_cvt_pk_bf16_f32 v17, v98, v99
v_mfma_f32_16x16x32_bf16 v[144:147], a[188:191], a[144:147], v[144:147]
ds_read_b64_tr_b16 a[252:253], v236 offset:49160
buffer_load_dwordx4 v223, s[16:19], s36 offen offset:3072 nt lds
v_cvt_pk_bf16_f32 v18, v116, v117
v_cvt_pk_bf16_f32 v19, v118, v119
v_mfma_f32_16x16x32_bf16 v[144:147], a[184:187], a[124:127], v[144:147]
ds_read_b64_tr_b16 a[254:255], v236 offset:50184
v_mul_f32 v60, s53, v60
v_mul_f32 v61, s53, v61
v_mul_f32 v62, s53, v62
v_mfma_f32_16x16x32_bf16 v[148:151], a[184:187], a[128:131], v[148:151]
v_mul_f32 v63, s53, v63
v_mul_f32 v64, s53, v64
v_mul_f32 v65, s53, v65
v_mfma_f32_16x16x32_bf16 v[148:151], a[188:191], a[148:151], v[148:151]
v_mul_f32 v66, s53, v66
v_mul_f32 v67, s53, v67
v_mul_f32 v68, s53, v68
v_mfma_f32_16x16x32_bf16 v[152:155], a[188:191], a[152:155], v[152:155]
v_mul_f32 v69, s53, v69
v_mul_f32 v70, s53, v70
v_mul_f32 v71, s53, v71
v_mfma_f32_16x16x32_bf16 v[152:155], a[184:187], a[132:135], v[152:155]
v_mul_f32 v72, s53, v72
v_mul_f32 v73, s53, v73
v_mul_f32 v74, s53, v74
v_mfma_f32_16x16x32_bf16 v[156:159], a[184:187], a[136:139], v[156:159]
v_mul_f32 v75, s53, v75
v_mul_f32 v76, s53, v76
v_mul_f32 v77, s53, v77
v_mfma_f32_16x16x32_bf16 v[156:159], a[188:191], a[156:159], v[156:159]
s_waitcnt lgkmcnt(0)
s_barrier
v_mul_f32 v78, s53, v78
v_mul_f32 v79, s53, v79
v_mul_f32 v120, s53, v120
v_mfma_f32_16x16x32_bf16 v[160:163], a[192:195], a[120:123], v[160:163]
v_mul_f32 v121, s53, v121
v_mul_f32 v122, s53, v122
v_mul_f32 v123, s53, v123
v_mfma_f32_16x16x32_bf16 v[160:163], a[196:199], a[140:143], v[160:163]
s_add_u32 m0, s48, 81920
s_xor_b32 s37, s3, 16384
v_mul_f32 v124, s53, v124
v_mul_f32 v125, s53, v125
v_mul_f32 v126, s53, v126
v_mfma_f32_16x16x32_bf16 v[164:167], a[196:199], a[144:147], v[164:167]
buffer_load_dwordx4 v220, s[20:23], s37 offen offset:0 nt lds
v_mul_f32 v127, s53, v127
v_mul_f32 v128, s53, v128
v_mul_f32 v129, s53, v129
v_mfma_f32_16x16x32_bf16 v[164:167], a[192:195], a[124:127], v[164:167]
ds_read_b128 a[200:203], v229 offset:4096
v_mul_f32 v130, s53, v130
v_mul_f32 v131, s53, v131
v_mul_f32 v132, s53, v132
v_mfma_f32_16x16x32_bf16 v[168:171], a[192:195], a[128:131], v[168:171]
ds_read_b128 a[204:207], v230 offset:4096
v_mul_f32 v133, s53, v133
v_mul_f32 v134, s53, v134
v_mul_f32 v135, s53, v135
v_mfma_f32_16x16x32_bf16 v[168:171], a[196:199], a[148:151], v[168:171]
ds_read_b128 a[208:211], v231 offset:4096
v_mul_f32 v136, s53, v136
v_mul_f32 v137, s53, v137
v_mul_f32 v138, s53, v138
v_mfma_f32_16x16x32_bf16 v[172:175], a[196:199], a[152:155], v[172:175]
ds_read_b128 a[212:215], v232 offset:4096
v_mul_f32 v139, s53, v139
v_cvt_pk_bf16_f32 v20, v60, v61
v_cvt_pk_bf16_f32 v21, v62, v63
v_mfma_f32_16x16x32_bf16 v[172:175], a[192:195], a[132:135], v[172:175]
ds_read_b128 a[184:187], v229 offset:0
v_cvt_pk_bf16_f32 v22, v120, v121
v_cvt_pk_bf16_f32 v23, v122, v123
v_cvt_pk_bf16_f32 v24, v64, v65
v_mfma_f32_16x16x32_bf16 v[176:179], a[192:195], a[136:139], v[176:179]
ds_read_b128 a[188:191], v230 offset:0
v_cvt_pk_bf16_f32 v25, v66, v67
v_cvt_pk_bf16_f32 v26, v124, v125
v_cvt_pk_bf16_f32 v27, v126, v127
v_mfma_f32_16x16x32_bf16 v[176:179], a[196:199], a[156:159], v[176:179]
v_cvt_pk_bf16_f32 v28, v68, v69
v_cvt_pk_bf16_f32 v29, v70, v71
v_cvt_pk_bf16_f32 v30, v128, v129
v_mfma_f32_16x16x32_bf16 v[180:183], a[240:243], a[120:123], v[180:183]
v_cvt_pk_bf16_f32 v31, v130, v131
v_cvt_pk_bf16_f32 v32, v72, v73
v_cvt_pk_bf16_f32 v33, v74, v75
v_mfma_f32_16x16x32_bf16 v[180:183], a[244:247], a[140:143], v[180:183]
s_add_u32 m0, s48, 81920
v_cvt_pk_bf16_f32 v34, v132, v133
v_cvt_pk_bf16_f32 v35, v134, v135
v_cvt_pk_bf16_f32 v36, v76, v77
v_mfma_f32_16x16x32_bf16 v[184:187], a[244:247], a[144:147], v[184:187]
buffer_load_dwordx4 v221, s[20:23], s37 offen offset:1024 nt lds
v_cvt_pk_bf16_f32 v37, v78, v79
v_cvt_pk_bf16_f32 v38, v136, v137
v_cvt_pk_bf16_f32 v39, v138, v139
v_mfma_f32_16x16x32_bf16 v[184:187], a[240:243], a[124:127], v[184:187]
ds_read_b128 a[192:195], v231 offset:0
v_mul_f32 v140, s53, v140
v_mul_f32 v141, s53, v141
v_mul_f32 v142, s53, v142
v_mfma_f32_16x16x32_bf16 v[188:191], a[240:243], a[128:131], v[188:191]
ds_read_b128 a[196:199], v232 offset:0
v_mul_f32 v143, s53, v143
v_mul_f32 v144, s53, v144
v_mul_f32 v145, s53, v145
v_mfma_f32_16x16x32_bf16 v[188:191], a[244:247], a[148:151], v[188:191]
ds_write_b128 v246, a[0:3] offset:0
v_mul_f32 v146, s53, v146
v_mul_f32 v147, s53, v147
v_mul_f32 v148, s53, v148
v_mfma_f32_16x16x32_bf16 v[192:195], a[244:247], a[152:155], v[192:195]
ds_write_b128 v246, a[4:7] offset:1024
v_mul_f32 v149, s53, v149
v_mul_f32 v150, s53, v150
v_mul_f32 v151, s53, v151
v_mfma_f32_16x16x32_bf16 v[192:195], a[240:243], a[132:135], v[192:195]
ds_write_b128 v246, a[8:11] offset:2048
v_mul_f32 v152, s53, v152
v_mul_f32 v153, s53, v153
v_mul_f32 v154, s53, v154
v_mfma_f32_16x16x32_bf16 v[196:199], a[240:243], a[136:139], v[196:199]
ds_write_b128 v246, a[12:15] offset:3072
v_mul_f32 v155, s53, v155
v_mul_f32 v156, s53, v156
v_mul_f32 v157, s53, v157
v_mfma_f32_16x16x32_bf16 v[196:199], a[244:247], a[156:159], v[196:199]
s_add_u32 m0, s48, 81920
v_mul_f32 v158, s53, v158
v_mul_f32 v159, s53, v159
v_mul_f32 v160, s53, v160
v_mfma_f32_16x16x32_bf16 v[200:203], a[248:251], a[120:123], v[200:203]
buffer_load_dwordx4 v222, s[20:23], s37 offen offset:2048 nt lds
v_mul_f32 v161, s53, v161
v_mul_f32 v162, s53, v162
v_mul_f32 v163, s53, v163
v_mfma_f32_16x16x32_bf16 v[200:203], a[252:255], a[140:143], v[200:203]
v_mul_f32 v164, s53, v164
v_mul_f32 v165, s53, v165
v_mul_f32 v166, s53, v166
v_mfma_f32_16x16x32_bf16 v[204:207], a[252:255], a[144:147], v[204:207]
v_mul_f32 v167, s53, v167
v_mul_f32 v168, s53, v168
v_mul_f32 v169, s53, v169
v_mfma_f32_16x16x32_bf16 v[204:207], a[248:251], a[124:127], v[204:207]
v_mul_f32 v170, s53, v170
v_mul_f32 v171, s53, v171
v_mul_f32 v172, s53, v172
v_mfma_f32_16x16x32_bf16 v[208:211], a[248:251], a[128:131], v[208:211]
v_mul_f32 v173, s53, v173
v_mul_f32 v174, s53, v174
v_mul_f32 v175, s53, v175
v_mfma_f32_16x16x32_bf16 v[208:211], a[252:255], a[148:151], v[208:211]
v_mul_f32 v176, s53, v176
v_mul_f32 v177, s53, v177
v_mul_f32 v178, s53, v178
v_mfma_f32_16x16x32_bf16 v[212:215], a[252:255], a[152:155], v[212:215]
s_add_u32 m0, s48, 81920
v_mul_f32 v179, s53, v179
v_cvt_pk_bf16_f32 v40, v140, v141
v_cvt_pk_bf16_f32 v41, v142, v143
v_mfma_f32_16x16x32_bf16 v[212:215], a[248:251], a[132:135], v[212:215]
buffer_load_dwordx4 v223, s[20:23], s37 offen offset:3072 nt lds
v_cvt_pk_bf16_f32 v42, v160, v161
v_cvt_pk_bf16_f32 v43, v162, v163
v_cvt_pk_bf16_f32 v44, v144, v145
v_mfma_f32_16x16x32_bf16 v[216:219], a[248:251], a[136:139], v[216:219]
v_cvt_pk_bf16_f32 v45, v146, v147
v_cvt_pk_bf16_f32 v46, v164, v165
v_cvt_pk_bf16_f32 v47, v166, v167
v_mfma_f32_16x16x32_bf16 v[216:219], a[252:255], a[156:159], v[216:219]
buffer_atomic_add v254, v224, s[56:59], 0 offen sc1
v_cvt_pk_bf16_f32 v48, v148, v149
v_cvt_pk_bf16_f32 v49, v150, v151
v_cvt_pk_bf16_f32 v50, v168, v169
v_cvt_pk_bf16_f32 v51, v170, v171
v_cvt_pk_bf16_f32 v52, v152, v153
s_waitcnt lgkmcnt(0)
v_mfma_f32_16x16x32_bf16 v[80:83], a[184:187], v[0:3], 0
v_cvt_pk_bf16_f32 v53, v154, v155
v_cvt_pk_bf16_f32 v54, v172, v173
v_cvt_pk_bf16_f32 v55, v174, v175
v_mfma_f32_16x16x32_bf16 v[84:87], a[184:187], v[4:7], 0
v_cvt_pk_bf16_f32 v56, v156, v157
v_cvt_pk_bf16_f32 v57, v158, v159
v_cvt_pk_bf16_f32 v58, v176, v177
v_mfma_f32_16x16x32_bf16 v[88:91], a[184:187], v[8:11], 0
v_cvt_pk_bf16_f32 v59, v178, v179
v_mul_f32 v180, s53, v180
v_mul_f32 v181, s53, v181
v_mfma_f32_16x16x32_bf16 v[92:95], a[184:187], v[12:15], 0
v_mul_f32 v182, s53, v182
v_mul_f32 v183, s53, v183
v_mul_f32 v184, s53, v184
v_mfma_f32_16x16x32_bf16 v[96:99], a[184:187], v[16:19], 0
v_mul_f32 v185, s53, v185
v_mul_f32 v186, s53, v186
v_mul_f32 v187, s53, v187
v_mfma_f32_16x16x32_bf16 v[100:103], a[200:203], v[0:3], 0
v_mul_f32 v188, s53, v188
v_mul_f32 v189, s53, v189
v_mul_f32 v190, s53, v190
v_mfma_f32_16x16x32_bf16 v[104:107], a[200:203], v[4:7], 0
v_mul_f32 v191, s53, v191
v_mul_f32 v192, s53, v192
v_mul_f32 v193, s53, v193
v_mfma_f32_16x16x32_bf16 v[108:111], a[200:203], v[8:11], 0
v_mul_f32 v194, s53, v194
v_mul_f32 v195, s53, v195
v_mul_f32 v196, s53, v196
v_mfma_f32_16x16x32_bf16 v[112:115], a[200:203], v[12:15], 0
v_mul_f32 v197, s53, v197
v_mul_f32 v198, s53, v198
v_mul_f32 v199, s53, v199
v_mfma_f32_16x16x32_bf16 v[116:119], a[200:203], v[16:19], 0
v_mul_f32 v200, s53, v200
v_mul_f32 v201, s53, v201
v_mul_f32 v202, s53, v202
v_mfma_f32_16x16x32_bf16 v[80:83], a[188:191], v[20:23], v[80:83]
v_mul_f32 v203, s53, v203
v_mul_f32 v204, s53, v204
v_mul_f32 v205, s53, v205
v_mfma_f32_16x16x32_bf16 v[84:87], a[188:191], v[24:27], v[84:87]
v_mul_f32 v206, s53, v206
v_mul_f32 v207, s53, v207
v_mul_f32 v208, s53, v208
v_mfma_f32_16x16x32_bf16 v[88:91], a[188:191], v[28:31], v[88:91]
v_mul_f32 v209, s53, v209
v_mul_f32 v210, s53, v210
v_mul_f32 v211, s53, v211
v_mfma_f32_16x16x32_bf16 v[92:95], a[188:191], v[32:35], v[92:95]
v_mul_f32 v212, s53, v212
v_mul_f32 v213, s53, v213
v_mul_f32 v214, s53, v214
v_mfma_f32_16x16x32_bf16 v[96:99], a[188:191], v[36:39], v[96:99]
v_mul_f32 v215, s53, v215
v_mul_f32 v216, s53, v216
v_mul_f32 v217, s53, v217
v_mfma_f32_16x16x32_bf16 v[100:103], a[204:207], v[20:23], v[100:103]
v_mul_f32 v218, s53, v218
v_mul_f32 v219, s53, v219
v_cvt_pk_bf16_f32 v60, v180, v181
v_mfma_f32_16x16x32_bf16 v[104:107], a[204:207], v[24:27], v[104:107]
v_cvt_pk_bf16_f32 v61, v182, v183
v_cvt_pk_bf16_f32 v62, v200, v201
v_cvt_pk_bf16_f32 v63, v202, v203
v_mfma_f32_16x16x32_bf16 v[108:111], a[204:207], v[28:31], v[108:111]
v_cvt_pk_bf16_f32 v64, v184, v185
v_cvt_pk_bf16_f32 v65, v186, v187
v_cvt_pk_bf16_f32 v66, v204, v205
v_mfma_f32_16x16x32_bf16 v[112:115], a[204:207], v[32:35], v[112:115]
v_cvt_pk_bf16_f32 v67, v206, v207
v_cvt_pk_bf16_f32 v68, v188, v189
v_cvt_pk_bf16_f32 v69, v190, v191
v_mfma_f32_16x16x32_bf16 v[116:119], a[204:207], v[36:39], v[116:119]
v_cvt_pk_bf16_f32 v70, v208, v209
v_cvt_pk_bf16_f32 v71, v210, v211
v_cvt_pk_bf16_f32 v72, v192, v193
v_mfma_f32_16x16x32_bf16 v[80:83], a[192:195], v[40:43], v[80:83]
v_cvt_pk_bf16_f32 v73, v194, v195
v_cvt_pk_bf16_f32 v74, v212, v213
v_cvt_pk_bf16_f32 v75, v214, v215
v_mfma_f32_16x16x32_bf16 v[84:87], a[192:195], v[44:47], v[84:87]
v_cvt_pk_bf16_f32 v76, v196, v197
v_cvt_pk_bf16_f32 v77, v198, v199
v_cvt_pk_bf16_f32 v78, v216, v217
v_mfma_f32_16x16x32_bf16 v[88:91], a[192:195], v[48:51], v[88:91]
v_cvt_pk_bf16_f32 v79, v218, v219
v_mfma_f32_16x16x32_bf16 v[92:95], a[192:195], v[52:55], v[92:95]
v_mfma_f32_16x16x32_bf16 v[96:99], a[192:195], v[56:59], v[96:99]
v_mfma_f32_16x16x32_bf16 v[100:103], a[208:211], v[40:43], v[100:103]
v_mfma_f32_16x16x32_bf16 v[104:107], a[208:211], v[44:47], v[104:107]
v_mfma_f32_16x16x32_bf16 v[108:111], a[208:211], v[48:51], v[108:111]
v_mfma_f32_16x16x32_bf16 v[112:115], a[208:211], v[52:55], v[112:115]
v_mfma_f32_16x16x32_bf16 v[116:119], a[208:211], v[56:59], v[116:119]
s_waitcnt vmcnt(13)
s_barrier
v_mov_b32 v204, v229
v_mov_b32 v205, v230
v_mov_b32 v206, v231
v_mov_b32 v207, v232
ds_read_b128 a[184:187], v204 offset:32768
ds_read_b128 a[188:191], v205 offset:32768
ds_read_b128 a[192:195], v206 offset:32768
ds_read_b128 a[200:203], v204 offset:36864
ds_read_b128 a[204:207], v205 offset:36864
ds_read_b128 a[208:211], v206 offset:36864
s_lshl_b32 s49, s29, 13
s_add_u32 s49, s49, 16384
v_mfma_f32_16x16x32_bf16 v[80:83], a[196:199], v[60:63], v[80:83]
v_lshrrev_b32 v229, 2, v226
v_lshrrev_b32 v232, 3, v229
v_mfma_f32_16x16x32_bf16 v[84:87], a[196:199], v[64:67], v[84:87]
v_mul_u32_u24 v232, 25, v232
v_lshlrev_b32 v231, 1, v229
v_mfma_f32_16x16x32_bf16 v[88:91], a[196:199], v[68:71], v[88:91]
v_xor_b32 v231, v231, v232
v_bfe_u32 v232, v226, 1, 1
v_mfma_f32_16x16x32_bf16 v[92:95], a[196:199], v[72:75], v[92:95]
v_xor_b32 v231, v231, v232
v_lshlrev_b32 v230, 8, v229
v_mfma_f32_16x16x32_bf16 v[96:99], a[196:199], v[76:79], v[96:99]
v_lshl_add_u32 v230, v231, 4, v230
v_and_b32 v232, 1, v226
v_mfma_f32_16x16x32_bf16 v[100:103], a[212:215], v[60:63], v[100:103]
v_lshl_add_u32 v230, v232, 3, v230
v_add_u32 v180, s49, v230
v_mfma_f32_16x16x32_bf16 v[104:107], a[212:215], v[64:67], v[104:107]
v_xor_b32 v181, 32, v180
v_xor_b32 v182, 64, v180
v_mfma_f32_16x16x32_bf16 v[108:111], a[212:215], v[68:71], v[108:111]
v_xor_b32 v183, 96, v180
v_xor_b32 v184, 128, v180
v_mfma_f32_16x16x32_bf16 v[112:115], a[212:215], v[72:75], v[112:115]
v_xor_b32 v185, 160, v180
v_xor_b32 v186, 192, v180
v_mfma_f32_16x16x32_bf16 v[116:119], a[212:215], v[76:79], v[116:119]
ds_read_b128 a[196:199], v207 offset:32768
ds_read_b128 a[212:215], v207 offset:36864
v_xor_b32 v187, 224, v180
v_add_u32 v208, 0x10000, v204
v_add_u32 v209, 0x10000, v205
v_add_u32 v210, 0x10000, v206
v_add_u32 v211, 0x10000, v207
v_mov_b32 v160, 0xff800000
v_mov_b32 v164, 0xff800000
v_mov_b32 v168, 0xff800000
v_mov_b32 v172, 0xff800000
v_mov_b32 v176, 0xff800000
s_mov_b32 s53, -1
s_getpc_b64 s[64:65]
L_pc3:
s_lshr_b32 s49, s2, 3
s_lshl_b32 s49, s49, 7
s_add_u32 s49, s49, L_afin-L_pc3
v_and_b32 v229, 15, v226
v_lshl_add_u32 v229, v229, 12, s49
v_min_u32 v229, L_end-L_pc3-4, v229
global_load_dword v230, v229, s[64:65]
L_aloop:
s_waitcnt lgkmcnt(0)
v_mfma_f32_16x16x32_bf16 v[140:143], a[184:187], v[0:3], 0
v_max3_f32 v160, v160, v80, v81
v_max3_f32 v164, v164, v84, v85
v_max3_f32 v168, v168, v88, v89
v_max3_f32 v172, v172, v92, v93
v_max3_f32 v176, v176, v96, v97
v_mfma_f32_16x16x32_bf16 v[140:143], a[188:191], v[20:23], v[140:143]
ds_read_b64_tr_b16 a[216:217], v180 offset:0
s_waitcnt vmcnt(4)
v_max3_f32 v160, v160, v82, v83
v_max3_f32 v164, v164, v86, v87
v_max3_f32 v168, v168, v90, v91
v_max3_f32 v172, v172, v94, v95
v_mfma_f32_16x16x32_bf16 v[140:143], a[192:195], v[40:43], v[140:143]
v_max3_f32 v176, v176, v98, v99
v_max3_f32 v160, v160, v100, v101
v_max3_f32 v164, v164, v104, v105
v_max3_f32 v168, v168, v108, v109
v_mfma_f32_16x16x32_bf16 v[140:143], a[196:199], v[60:63], v[140:143]
ds_read_b64_tr_b16 a[218:219], v180 offset:4096
s_add_u32 m0, s48, 131072
s_xor_b32 s36, s3, 32768
v_max3_f32 v172, v172, v112, v113
v_max3_f32 v176, v176, v116, v117
v_max3_f32 v160, v160, v102, v103
v_max3_f32 v164, v164, v106, v107
v_mfma_f32_16x16x32_bf16 v[144:147], a[196:199], v[64:67], 0
buffer_load_dwordx4 v220, s[16:19], s36 offen offset:0 nt lds
v_max3_f32 v168, v168, v110, v111
v_max3_f32 v172, v172, v114, v115
v_max3_f32 v176, v176, v118, v119
v_mov_b32 v161, v160
v_mov_b32 v165, v164
v_mfma_f32_16x16x32_bf16 v[144:147], a[192:195], v[44:47], v[144:147]
ds_read_b64_tr_b16 a[220:221], v181 offset:0
v_mov_b32 v169, v168
v_mov_b32 v173, v172
v_mov_b32 v177, v176
v_permlane32_swap_b32 v161, v160
v_mfma_f32_16x16x32_bf16 v[144:147], a[188:191], v[24:27], v[144:147]
v_permlane32_swap_b32 v165, v164
v_permlane32_swap_b32 v169, v168
v_permlane32_swap_b32 v173, v172
v_permlane32_swap_b32 v177, v176
v_mfma_f32_16x16x32_bf16 v[144:147], a[184:187], v[4:7], v[144:147]
ds_read_b64_tr_b16 a[222:223], v181 offset:4096
v_max_f32 v160, v160, v161
v_max_f32 v164, v164, v165
v_max_f32 v168, v168, v169
v_max_f32 v172, v172, v173
v_mfma_f32_16x16x32_bf16 v[148:151], a[184:187], v[8:11], 0
v_max_f32 v176, v176, v177
v_mov_b32 v161, v160
v_mov_b32 v165, v164
v_mov_b32 v169, v168
v_mov_b32 v173, v172
v_mfma_f32_16x16x32_bf16 v[148:151], a[188:191], v[28:31], v[148:151]
ds_read_b64_tr_b16 a[224:225], v182 offset:0
v_mov_b32 v177, v176
v_permlane16_swap_b32 v161, v160
v_permlane16_swap_b32 v165, v164
v_permlane16_swap_b32 v169, v168
v_mfma_f32_16x16x32_bf16 v[148:151], a[192:195], v[48:51], v[148:151]
v_permlane16_swap_b32 v173, v172
v_permlane16_swap_b32 v177, v176
v_max_f32 v160, v160, v161
v_max_f32 v164, v164, v165
v_mfma_f32_16x16x32_bf16 v[148:151], a[196:199], v[68:71], v[148:151]
ds_read_b64_tr_b16 a[226:227], v182 offset:4096
v_max_f32 v168, v168, v169
v_max_f32 v172, v172, v173
v_max_f32 v176, v176, v177
v_sub_f32 v161, 0, v160
v_mfma_f32_16x16x32_bf16 v[152:155], a[196:199], v[72:75], 0
v_sub_f32 v165, 0, v164
v_sub_f32 v169, 0, v168
v_sub_f32 v173, 0, v172
v_sub_f32 v177, 0, v176
v_sub_f32 v162, 0, v160
v_mfma_f32_16x16x32_bf16 v[152:155], a[192:195], v[52:55], v[152:155]
ds_read_b64_tr_b16 a[228:229], v183 offset:0
s_waitcnt vmcnt(4)
v_sub_f32 v166, 0, v164
v_sub_f32 v170, 0, v168
v_sub_f32 v174, 0, v172
v_sub_f32 v178, 0, v176
v_mfma_f32_16x16x32_bf16 v[152:155], a[188:191], v[32:35], v[152:155]
v_sub_f32 v163, 0, v160
v_sub_f32 v167, 0, v164
v_sub_f32 v171, 0, v168
v_sub_f32 v175, 0, v172
v_mfma_f32_16x16x32_bf16 v[152:155], a[184:187], v[12:15], v[152:155]
ds_read_b64_tr_b16 a[230:231], v183 offset:4096
s_add_u32 m0, s48, 131072
v_sub_f32 v179, 0, v176
v_sub_f32 v160, 0, v160
v_sub_f32 v164, 0, v164
v_sub_f32 v168, 0, v168
v_mfma_f32_16x16x32_bf16 v[156:159], a[184:187], v[16:19], 0
buffer_load_dwordx4 v221, s[16:19], s36 offen offset:1024 nt lds
v_sub_f32 v172, 0, v172
v_sub_f32 v176, 0, v176
v_add_f32 v80, v80, v160
v_add_f32 v81, v81, v160
v_add_f32 v82, v82, v160
v_mfma_f32_16x16x32_bf16 v[156:159], a[188:191], v[36:39], v[156:159]
ds_read_b64_tr_b16 a[232:233], v184 offset:0
v_add_f32 v83, v83, v160
v_add_f32 v84, v84, v164
v_add_f32 v85, v85, v164
v_add_f32 v86, v86, v164
v_mfma_f32_16x16x32_bf16 v[156:159], a[192:195], v[56:59], v[156:159]
v_add_f32 v87, v87, v164
v_add_f32 v88, v88, v168
v_add_f32 v89, v89, v168
v_add_f32 v90, v90, v168
v_mfma_f32_16x16x32_bf16 v[156:159], a[196:199], v[76:79], v[156:159]
ds_read_b64_tr_b16 a[234:235], v184 offset:4096
v_add_f32 v91, v91, v168
v_add_f32 v92, v92, v172
v_add_f32 v93, v93, v172
v_add_f32 v94, v94, v172
v_mfma_f32_16x16x32_bf16 v[192:195], a[200:203], v[0:3], 0
v_add_f32 v95, v95, v172
v_add_f32 v96, v96, v176
v_add_f32 v97, v97, v176
v_add_f32 v98, v98, v176
v_add_f32 v99, v99, v176
v_mfma_f32_16x16x32_bf16 v[192:195], a[204:207], v[20:23], v[192:195]
ds_read_b64_tr_b16 a[236:237], v185 offset:0
v_add_f32 v100, v100, v160
v_add_f32 v101, v101, v160
v_add_f32 v102, v102, v160
v_add_f32 v103, v103, v160
v_mfma_f32_16x16x32_bf16 v[192:195], a[208:211], v[40:43], v[192:195]
v_add_f32 v104, v104, v164
v_add_f32 v105, v105, v164
v_add_f32 v106, v106, v164
v_add_f32 v107, v107, v164
v_mfma_f32_16x16x32_bf16 v[192:195], a[212:215], v[60:63], v[192:195]
ds_read_b64_tr_b16 a[238:239], v185 offset:4096
s_waitcnt vmcnt(4)
v_add_f32 v108, v108, v168
v_add_f32 v109, v109, v168
v_add_f32 v110, v110, v168
v_add_f32 v111, v111, v168
v_mfma_f32_16x16x32_bf16 v[196:199], a[212:215], v[64:67], 0
v_add_f32 v112, v112, v172
v_add_f32 v113, v113, v172
v_add_f32 v114, v114, v172
v_add_f32 v115, v115, v172
v_add_f32 v116, v116, v176
v_mfma_f32_16x16x32_bf16 v[196:199], a[208:211], v[44:47], v[196:199]
ds_read_b64_tr_b16 a[240:241], v186 offset:0
s_add_u32 m0, s48, 131072
v_add_f32 v117, v117, v176
v_add_f32 v118, v118, v176
v_add_f32 v119, v119, v176
v_exp_f32 v80, v80
v_mfma_f32_16x16x32_bf16 v[196:199], a[204:207], v[24:27], v[196:199]
buffer_load_dwordx4 v222, s[16:19], s36 offen offset:2048 nt lds
v_exp_f32 v81, v81
v_exp_f32 v82, v82
v_exp_f32 v83, v83
v_exp_f32 v84, v84
v_mfma_f32_16x16x32_bf16 v[196:199], a[200:203], v[4:7], v[196:199]
ds_read_b64_tr_b16 a[242:243], v186 offset:4096
v_cvt_pk_bf16_f32 v120, v80, v81
v_cvt_pk_bf16_f32 v121, v82, v83
v_exp_f32 v85, v85
v_exp_f32 v86, v86
v_mfma_f32_16x16x32_bf16 v[200:203], a[200:203], v[8:11], 0
v_exp_f32 v87, v87
v_exp_f32 v88, v88
v_cvt_pk_bf16_f32 v124, v84, v85
v_cvt_pk_bf16_f32 v125, v86, v87
v_exp_f32 v89, v89
v_mfma_f32_16x16x32_bf16 v[200:203], a[204:207], v[28:31], v[200:203]
ds_read_b64_tr_b16 a[244:245], v187 offset:0
v_exp_f32 v90, v90
v_exp_f32 v91, v91
v_exp_f32 v92, v92
v_cvt_pk_bf16_f32 v128, v88, v89
v_mfma_f32_16x16x32_bf16 v[200:203], a[208:211], v[48:51], v[200:203]
v_cvt_pk_bf16_f32 v129, v90, v91
v_exp_f32 v93, v93
v_exp_f32 v94, v94
v_exp_f32 v95, v95
v_mfma_f32_16x16x32_bf16 v[200:203], a[212:215], v[68:71], v[200:203]
ds_read_b64_tr_b16 a[246:247], v187 offset:4096
v_exp_f32 v96, v96
v_cvt_pk_bf16_f32 v132, v92, v93
v_cvt_pk_bf16_f32 v133, v94, v95
v_exp_f32 v97, v97
v_mfma_f32_16x16x32_bf16 v[212:215], a[212:215], v[72:75], 0
v_exp_f32 v98, v98
v_exp_f32 v99, v99
v_cvt_pk_bf16_f32 v136, v96, v97
v_cvt_pk_bf16_f32 v137, v98, v99
v_exp_f32 v100, v100
v_mfma_f32_16x16x32_bf16 v[212:215], a[208:211], v[52:55], v[212:215]
s_waitcnt vmcnt(4)
v_exp_f32 v101, v101
v_exp_f32 v102, v102
v_exp_f32 v103, v103
v_exp_f32 v104, v104
v_mfma_f32_16x16x32_bf16 v[212:215], a[204:207], v[32:35], v[212:215]
v_cvt_pk_bf16_f32 v122, v100, v101
v_cvt_pk_bf16_f32 v123, v102, v103
v_exp_f32 v105, v105
v_exp_f32 v106, v106
v_mfma_f32_16x16x32_bf16 v[212:215], a[200:203], v[12:15], v[212:215]
s_add_u32 m0, s48, 131072
v_exp_f32 v107, v107
v_exp_f32 v108, v108
v_cvt_pk_bf16_f32 v126, v104, v105
v_cvt_pk_bf16_f32 v127, v106, v107
v_mfma_f32_16x16x32_bf16 v[216:219], a[200:203], v[16:19], 0
buffer_load_dwordx4 v223, s[16:19], s36 offen offset:3072 nt lds
v_exp_f32 v109, v109
v_exp_f32 v110, v110
v_exp_f32 v111, v111
v_exp_f32 v112, v112
v_cvt_pk_bf16_f32 v130, v108, v109
v_mfma_f32_16x16x32_bf16 v[216:219], a[204:207], v[36:39], v[216:219]
v_cvt_pk_bf16_f32 v131, v110, v111
v_exp_f32 v113, v113
v_exp_f32 v114, v114
v_exp_f32 v115, v115
v_mfma_f32_16x16x32_bf16 v[216:219], a[208:211], v[56:59], v[216:219]
v_exp_f32 v116, v116
v_cvt_pk_bf16_f32 v134, v112, v113
v_cvt_pk_bf16_f32 v135, v114, v115
v_exp_f32 v117, v117
v_mfma_f32_16x16x32_bf16 v[216:219], a[212:215], v[76:79], v[216:219]
v_exp_f32 v118, v118
v_exp_f32 v119, v119
v_cvt_pk_bf16_f32 v138, v116, v117
v_cvt_pk_bf16_f32 v139, v118, v119
v_mfma_f32_16x16x32_bf16 a[160:163], a[180:183], v[120:123], 0
v_add_f32 v140, v140, v160
v_add_f32 v141, v141, v160
v_add_f32 v142, v142, v160
v_mfma_f32_16x16x32_bf16 a[164:167], a[180:183], v[124:127], 0
v_add_f32 v143, v143, v160
v_add_f32 v144, v144, v164
v_mfma_f32_16x16x32_bf16 a[168:171], a[180:183], v[128:131], 0
v_add_f32 v145, v145, v164
v_add_f32 v146, v146, v164
v_mfma_f32_16x16x32_bf16 a[172:175], a[180:183], v[132:135], 0
s_waitcnt lgkmcnt(0)
s_barrier
v_add_f32 v147, v147, v164
v_add_f32 v148, v148, v168
v_mfma_f32_16x16x32_bf16 a[176:179], a[180:183], v[136:139], 0
s_waitcnt vmcnt(4)
v_add_f32 v149, v149, v168
v_add_f32 v150, v150, v168
v_add_f32 v151, v151, v168
v_mfma_f32_16x16x32_bf16 a[0:3], a[216:219], v[120:123], 0
ds_read_b128 a[184:187], v208 offset:0
v_add_f32 v152, v152, v172
v_add_f32 v153, v153, v172
v_mfma_f32_16x16x32_bf16 a[4:7], a[216:219], v[124:127], 0
s_add_u32 m0, s48, 114688
s_xor_b32 s37, s3, 24576
v_add_f32 v154, v154, v172
v_add_f32 v155, v155, v172
v_mfma_f32_16x16x32_bf16 a[8:11], a[216:219], v[128:131], 0
buffer_load_dwordx4 v220, s[20:23], s37 offen offset:0 nt lds
v_add_f32 v156, v156, v176
v_add_f32 v157, v157, v176
v_mfma_f32_16x16x32_bf16 a[12:15], a[216:219], v[132:135], 0
v_add_f32 v158, v158, v176
v_add_f32 v159, v159, v176
v_mfma_f32_16x16x32_bf16 a[16:19], a[216:219], v[136:139], 0
ds_read_b128 a[188:191], v209 offset:0
v_exp_f32 v140, v140
v_exp_f32 v141, v141
v_exp_f32 v142, v142
v_mfma_f32_16x16x32_bf16 a[20:23], a[220:223], v[120:123], 0
v_exp_f32 v143, v143
v_exp_f32 v144, v144
v_mfma_f32_16x16x32_bf16 a[24:27], a[220:223], v[124:127], 0
v_cvt_pk_bf16_f32 v140, v140, v141
v_cvt_pk_bf16_f32 v141, v142, v143
v_mfma_f32_16x16x32_bf16 a[28:31], a[220:223], v[128:131], 0
v_exp_f32 v145, v145
v_exp_f32 v146, v146
v_mfma_f32_16x16x32_bf16 a[32:35], a[220:223], v[132:135], 0
ds_read_b128 a[192:195], v210 offset:0
v_exp_f32 v147, v147
v_exp_f32 v148, v148
v_cvt_pk_bf16_f32 v144, v144, v145
v_mfma_f32_16x16x32_bf16 a[36:39], a[220:223], v[136:139], 0
v_cvt_pk_bf16_f32 v145, v146, v147
v_exp_f32 v149, v149
v_mfma_f32_16x16x32_bf16 a[40:43], a[224:227], v[120:123], 0
s_waitcnt vmcnt(4)
v_exp_f32 v150, v150
v_exp_f32 v151, v151
v_mfma_f32_16x16x32_bf16 a[44:47], a[224:227], v[124:127], 0
v_exp_f32 v152, v152
v_cvt_pk_bf16_f32 v148, v148, v149
v_mfma_f32_16x16x32_bf16 a[48:51], a[224:227], v[128:131], 0
ds_read_b128 a[196:199], v211 offset:0
s_add_u32 m0, s48, 114688
v_cvt_pk_bf16_f32 v149, v150, v151
v_exp_f32 v153, v153
v_mfma_f32_16x16x32_bf16 a[52:55], a[224:227], v[132:135], 0
buffer_load_dwordx4 v221, s[20:23], s37 offen offset:1024 nt lds
v_exp_f32 v154, v154
v_exp_f32 v155, v155
v_exp_f32 v156, v156
v_mfma_f32_16x16x32_bf16 a[56:59], a[224:227], v[136:139], 0
v_cvt_pk_bf16_f32 v152, v152, v153
v_cvt_pk_bf16_f32 v153, v154, v155
v_mfma_f32_16x16x32_bf16 a[60:63], a[228:231], v[120:123], 0
v_exp_f32 v157, v157
v_exp_f32 v158, v158
v_mfma_f32_16x16x32_bf16 a[64:67], a[228:231], v[124:127], 0
ds_read_b128 a[200:203], v208 offset:4096
v_exp_f32 v159, v159
v_cvt_pk_bf16_f32 v156, v156, v157
v_mfma_f32_16x16x32_bf16 a[68:71], a[228:231], v[128:131], 0
v_cvt_pk_bf16_f32 v157, v158, v159
v_add_f32 v192, v192, v160
v_add_f32 v193, v193, v160
v_mfma_f32_16x16x32_bf16 a[72:75], a[228:231], v[132:135], 0
v_add_f32 v194, v194, v160
v_add_f32 v195, v195, v160
v_mfma_f32_16x16x32_bf16 a[76:79], a[228:231], v[136:139], 0
v_add_f32 v196, v196, v164
v_add_f32 v197, v197, v164
v_mfma_f32_16x16x32_bf16 a[80:83], a[232:235], v[120:123], 0
ds_read_b128 a[204:207], v209 offset:4096
v_add_f32 v198, v198, v164
v_add_f32 v199, v199, v164
v_mfma_f32_16x16x32_bf16 a[84:87], a[232:235], v[124:127], 0
v_add_f32 v200, v200, v168
v_add_f32 v201, v201, v168
v_mfma_f32_16x16x32_bf16 a[88:91], a[232:235], v[128:131], 0
s_waitcnt vmcnt(4)
v_add_f32 v202, v202, v168
v_add_f32 v203, v203, v168
v_add_f32 v212, v212, v172
v_mfma_f32_16x16x32_bf16 a[92:95], a[232:235], v[132:135], 0
v_add_f32 v213, v213, v172
v_add_f32 v214, v214, v172
v_mfma_f32_16x16x32_bf16 a[96:99], a[232:235], v[136:139], 0
ds_read_b128 a[208:211], v210 offset:4096
s_add_u32 m0, s48, 114688
v_add_f32 v215, v215, v172
v_add_f32 v216, v216, v176
v_mfma_f32_16x16x32_bf16 a[100:103], a[236:239], v[120:123], 0
buffer_load_dwordx4 v222, s[20:23], s37 offen offset:2048 nt lds
v_add_f32 v217, v217, v176
v_add_f32 v218, v218, v176
v_mfma_f32_16x16x32_bf16 a[104:107], a[236:239], v[124:127], 0
v_add_f32 v219, v219, v176
v_exp_f32 v192, v192
v_exp_f32 v193, v193
v_mfma_f32_16x16x32_bf16 a[108:111], a[236:239], v[128:131], 0
v_exp_f32 v194, v194
v_exp_f32 v195, v195
v_mfma_f32_16x16x32_bf16 a[112:115], a[236:239], v[132:135], 0
ds_read_b128 a[212:215], v211 offset:4096
v_exp_f32 v196, v196
v_cvt_pk_bf16_f32 v142, v192, v193
v_mfma_f32_16x16x32_bf16 a[116:119], a[236:239], v[136:139], 0
v_cvt_pk_bf16_f32 v143, v194, v195
v_exp_f32 v197, v197
v_mfma_f32_16x16x32_bf16 a[120:123], a[240:243], v[120:123], 0
v_exp_f32 v198, v198
v_exp_f32 v199, v199
v_mfma_f32_16x16x32_bf16 a[124:127], a[240:243], v[124:127], 0
s_waitcnt vmcnt(4)
v_exp_f32 v200, v200
v_cvt_pk_bf16_f32 v146, v196, v197
v_cvt_pk_bf16_f32 v147, v198, v199
v_mfma_f32_16x16x32_bf16 a[128:131], a[240:243], v[128:131], 0
v_exp_f32 v201, v201
v_exp_f32 v202, v202
v_mfma_f32_16x16x32_bf16 a[132:135], a[240:243], v[132:135], 0
s_add_u32 m0, s48, 114688
v_exp_f32 v203, v203
v_exp_f32 v212, v212
v_mfma_f32_16x16x32_bf16 a[136:139], a[240:243], v[136:139], 0
buffer_load_dwordx4 v223, s[20:23], s37 offen offset:3072 nt lds
v_cvt_pk_bf16_f32 v150, v200, v201
v_cvt_pk_bf16_f32 v151, v202, v203
v_mfma_f32_16x16x32_bf16 a[140:143], a[244:247], v[120:123], 0
v_exp_f32 v213, v213
v_exp_f32 v214, v214
v_exp_f32 v215, v215
v_mfma_f32_16x16x32_bf16 a[144:147], a[244:247], v[124:127], 0
v_exp_f32 v216, v216
v_cvt_pk_bf16_f32 v154, v212, v213
v_mfma_f32_16x16x32_bf16 a[148:151], a[244:247], v[128:131], 0
v_cvt_pk_bf16_f32 v155, v214, v215
v_exp_f32 v217, v217
v_mfma_f32_16x16x32_bf16 a[152:155], a[244:247], v[132:135], 0
v_exp_f32 v218, v218
v_exp_f32 v219, v219
v_mfma_f32_16x16x32_bf16 a[156:159], a[244:247], v[136:139], 0
s_waitcnt lgkmcnt(0)
v_cvt_pk_bf16_f32 v158, v216, v217
v_cvt_pk_bf16_f32 v159, v218, v219
v_mfma_f32_16x16x32_bf16 v[80:83], a[184:187], v[0:3], v[160:163]
v_add_u32 v188, 65536, v180
v_add_u32 v189, 65536, v181
v_mfma_f32_16x16x32_bf16 v[80:83], a[188:191], v[20:23], v[80:83]
ds_read_b64_tr_b16 a[216:217], v180 offset:32768
v_add_u32 v190, 65536, v182
v_add_u32 v191, 65536, v183
v_mfma_f32_16x16x32_bf16 v[80:83], a[192:195], v[40:43], v[80:83]
v_add_u32 v192, 65536, v184
v_add_u32 v193, 65536, v185
v_mfma_f32_16x16x32_bf16 v[80:83], a[196:199], v[60:63], v[80:83]
ds_read_b64_tr_b16 a[218:219], v180 offset:36864
s_waitcnt vmcnt(4)
v_add_u32 v194, 65536, v186
v_mfma_f32_16x16x32_bf16 v[84:87], a[196:199], v[64:67], v[164:167]
v_add_u32 v195, 65536, v187
v_add_u32 v196, 131072, v180
v_mfma_f32_16x16x32_bf16 v[84:87], a[192:195], v[44:47], v[84:87]
ds_read_b64_tr_b16 a[220:221], v181 offset:32768
s_add_u32 m0, s48, 0
s_xor_b32 s36, s3, 40960
v_mfma_f32_16x16x32_bf16 v[84:87], a[188:191], v[24:27], v[84:87]
buffer_load_dwordx4 v220, s[16:19], s36 offen offset:0 nt lds
v_add_u32 v197, 131072, v181
v_add_u32 v198, 131072, v182
v_mfma_f32_16x16x32_bf16 v[84:87], a[184:187], v[4:7], v[84:87]
ds_read_b64_tr_b16 a[222:223], v181 offset:36864
v_add_u32 v199, 131072, v183
v_add_u32 v200, 131072, v184
v_mfma_f32_16x16x32_bf16 v[88:91], a[184:187], v[8:11], v[168:171]
v_add_u32 v201, 131072, v185
v_add_u32 v202, 131072, v186
v_mfma_f32_16x16x32_bf16 v[88:91], a[188:191], v[28:31], v[88:91]
ds_read_b64_tr_b16 a[224:225], v182 offset:32768
v_add_u32 v203, 131072, v187
v_add_u32 v212, 0x20000, v204
v_mfma_f32_16x16x32_bf16 v[88:91], a[192:195], v[48:51], v[88:91]
v_add_u32 v213, 0x20000, v205
v_add_u32 v214, 0x20000, v206
v_mfma_f32_16x16x32_bf16 v[88:91], a[196:199], v[68:71], v[88:91]
ds_read_b64_tr_b16 a[226:227], v182 offset:36864
v_add_u32 v215, 0x20000, v207
v_mfma_f32_16x16x32_bf16 v[92:95], a[196:199], v[72:75], v[172:175]
v_exp_f32 v80, v80
v_mfma_f32_16x16x32_bf16 v[92:95], a[192:195], v[52:55], v[92:95]
ds_read_b64_tr_b16 a[228:229], v183 offset:32768
s_waitcnt vmcnt(4)
v_mfma_f32_16x16x32_bf16 v[92:95], a[188:191], v[32:35], v[92:95]
v_exp_f32 v81, v81
v_mfma_f32_16x16x32_bf16 v[92:95], a[184:187], v[12:15], v[92:95]
ds_read_b64_tr_b16 a[230:231], v183 offset:36864
s_add_u32 m0, s48, 0
v_mfma_f32_16x16x32_bf16 v[96:99], a[184:187], v[16:19], v[176:179]
buffer_load_dwordx4 v221, s[16:19], s36 offen offset:1024 nt lds
v_exp_f32 v82, v82
v_mfma_f32_16x16x32_bf16 v[96:99], a[188:191], v[36:39], v[96:99]
ds_read_b64_tr_b16 a[232:233], v184 offset:32768
v_exp_f32 v83, v83
v_mfma_f32_16x16x32_bf16 v[96:99], a[192:195], v[56:59], v[96:99]
v_exp_f32 v84, v84
v_mfma_f32_16x16x32_bf16 v[96:99], a[196:199], v[76:79], v[96:99]
ds_read_b64_tr_b16 a[234:235], v184 offset:36864
v_cvt_pk_bf16_f32 v120, v80, v81
v_cvt_pk_bf16_f32 v121, v82, v83
v_mfma_f32_16x16x32_bf16 v[100:103], a[200:203], v[0:3], v[160:163]
v_exp_f32 v85, v85
v_mfma_f32_16x16x32_bf16 v[100:103], a[204:207], v[20:23], v[100:103]
ds_read_b64_tr_b16 a[236:237], v185 offset:32768
v_exp_f32 v86, v86
v_mfma_f32_16x16x32_bf16 v[100:103], a[208:211], v[40:43], v[100:103]
v_exp_f32 v87, v87
v_mfma_f32_16x16x32_bf16 v[100:103], a[212:215], v[60:63], v[100:103]
ds_read_b64_tr_b16 a[238:239], v185 offset:36864
v_exp_f32 v88, v88
v_mfma_f32_16x16x32_bf16 v[104:107], a[212:215], v[64:67], v[164:167]
v_cvt_pk_bf16_f32 v124, v84, v85
v_cvt_pk_bf16_f32 v125, v86, v87
v_mfma_f32_16x16x32_bf16 v[104:107], a[208:211], v[44:47], v[104:107]
ds_read_b64_tr_b16 a[240:241], v186 offset:32768
s_waitcnt vmcnt(4)
v_mfma_f32_16x16x32_bf16 v[104:107], a[204:207], v[24:27], v[104:107]
v_exp_f32 v89, v89
v_mfma_f32_16x16x32_bf16 v[104:107], a[200:203], v[4:7], v[104:107]
ds_read_b64_tr_b16 a[242:243], v186 offset:36864
s_add_u32 m0, s48, 0
v_mfma_f32_16x16x32_bf16 v[108:111], a[200:203], v[8:11], v[168:171]
buffer_load_dwordx4 v222, s[16:19], s36 offen offset:2048 nt lds
v_exp_f32 v90, v90
v_mfma_f32_16x16x32_bf16 v[108:111], a[204:207], v[28:31], v[108:111]
ds_read_b64_tr_b16 a[244:245], v187 offset:32768
v_exp_f32 v91, v91
v_mfma_f32_16x16x32_bf16 v[108:111], a[208:211], v[48:51], v[108:111]
v_exp_f32 v92, v92
v_mfma_f32_16x16x32_bf16 v[108:111], a[212:215], v[68:71], v[108:111]
ds_read_b64_tr_b16 a[246:247], v187 offset:36864
v_cvt_pk_bf16_f32 v128, v88, v89
v_cvt_pk_bf16_f32 v129, v90, v91
v_mfma_f32_16x16x32_bf16 v[112:115], a[212:215], v[72:75], v[172:175]
v_exp_f32 v93, v93
v_mfma_f32_16x16x32_bf16 v[112:115], a[208:211], v[52:55], v[112:115]
v_exp_f32 v94, v94
v_mfma_f32_16x16x32_bf16 v[112:115], a[204:207], v[32:35], v[112:115]
s_waitcnt vmcnt(4)
v_exp_f32 v95, v95
v_mfma_f32_16x16x32_bf16 v[112:115], a[200:203], v[12:15], v[112:115]
v_exp_f32 v96, v96
v_mfma_f32_16x16x32_bf16 v[116:119], a[200:203], v[16:19], v[176:179]
s_add_u32 m0, s48, 0
v_cvt_pk_bf16_f32 v132, v92, v93
v_cvt_pk_bf16_f32 v133, v94, v95
v_mfma_f32_16x16x32_bf16 v[116:119], a[204:207], v[36:39], v[116:119]
buffer_load_dwordx4 v223, s[16:19], s36 offen offset:3072 nt lds
v_exp_f32 v97, v97
v_mfma_f32_16x16x32_bf16 v[116:119], a[208:211], v[56:59], v[116:119]
v_exp_f32 v98, v98
v_mfma_f32_16x16x32_bf16 v[116:119], a[212:215], v[76:79], v[116:119]
v_exp_f32 v99, v99
v_mfma_f32_16x16x32_bf16 a[160:163], a[180:183], v[140:143], a[160:163]
v_cvt_pk_bf16_f32 v136, v96, v97
v_cvt_pk_bf16_f32 v137, v98, v99
v_mfma_f32_16x16x32_bf16 a[164:167], a[180:183], v[144:147], a[164:167]
v_exp_f32 v100, v100
v_mfma_f32_16x16x32_bf16 a[168:171], a[180:183], v[148:151], a[168:171]
v_exp_f32 v101, v101
v_mfma_f32_16x16x32_bf16 a[172:175], a[180:183], v[152:155], a[172:175]
s_waitcnt lgkmcnt(0)
s_barrier
v_mfma_f32_16x16x32_bf16 a[176:179], a[180:183], v[156:159], a[176:179]
v_exp_f32 v102, v102
v_mfma_f32_16x16x32_bf16 a[0:3], a[216:219], v[140:143], a[0:3]
ds_read_b128 a[184:187], v208 offset:32768
s_waitcnt vmcnt(4)
v_mfma_f32_16x16x32_bf16 a[4:7], a[216:219], v[144:147], a[4:7]
v_exp_f32 v103, v103
v_mfma_f32_16x16x32_bf16 a[8:11], a[216:219], v[148:151], a[8:11]
s_add_u32 m0, s48, 147456
s_xor_b32 s37, s3, 32768
v_mfma_f32_16x16x32_bf16 a[12:15], a[216:219], v[152:155], a[12:15]
buffer_load_dwordx4 v220, s[20:23], s37 offen offset:0 nt lds
v_exp_f32 v104, v104
v_mfma_f32_16x16x32_bf16 a[16:19], a[216:219], v[156:159], a[16:19]
ds_read_b128 a[188:191], v209 offset:32768
v_cvt_pk_bf16_f32 v122, v100, v101
v_cvt_pk_bf16_f32 v123, v102, v103
v_mfma_f32_16x16x32_bf16 a[20:23], a[220:223], v[140:143], a[20:23]
v_exp_f32 v105, v105
v_mfma_f32_16x16x32_bf16 a[24:27], a[220:223], v[144:147], a[24:27]
v_exp_f32 v106, v106
v_mfma_f32_16x16x32_bf16 a[28:31], a[220:223], v[148:151], a[28:31]
v_exp_f32 v107, v107
v_mfma_f32_16x16x32_bf16 a[32:35], a[220:223], v[152:155], a[32:35]
ds_read_b128 a[192:195], v210 offset:32768
v_exp_f32 v108, v108
v_mfma_f32_16x16x32_bf16 a[36:39], a[220:223], v[156:159], a[36:39]
v_cvt_pk_bf16_f32 v126, v104, v105
v_cvt_pk_bf16_f32 v127, v106, v107
v_mfma_f32_16x16x32_bf16 a[40:43], a[224:227], v[140:143], a[40:43]
v_exp_f32 v109, v109
v_mfma_f32_16x16x32_bf16 a[44:47], a[224:227], v[144:147], a[44:47]
s_waitcnt vmcnt(4)
v_exp_f32 v110, v110
v_mfma_f32_16x16x32_bf16 a[48:51], a[224:227], v[148:151], a[48:51]
ds_read_b128 a[196:199], v211 offset:32768
v_exp_f32 v111, v111
v_mfma_f32_16x16x32_bf16 a[52:55], a[224:227], v[152:155], a[52:55]
s_add_u32 m0, s48, 147456
v_exp_f32 v112, v112
v_mfma_f32_16x16x32_bf16 a[56:59], a[224:227], v[156:159], a[56:59]
buffer_load_dwordx4 v221, s[20:23], s37 offen offset:1024 nt lds
v_cvt_pk_bf16_f32 v130, v108, v109
v_cvt_pk_bf16_f32 v131, v110, v111
v_mfma_f32_16x16x32_bf16 a[60:63], a[228:231], v[140:143], a[60:63]
v_exp_f32 v113, v113
v_mfma_f32_16x16x32_bf16 a[64:67], a[228:231], v[144:147], a[64:67]
ds_read_b128 a[200:203], v208 offset:36864
v_exp_f32 v114, v114
v_mfma_f32_16x16x32_bf16 a[68:71], a[228:231], v[148:151], a[68:71]
v_exp_f32 v115, v115
v_mfma_f32_16x16x32_bf16 a[72:75], a[228:231], v[152:155], a[72:75]
v_exp_f32 v116, v116
v_mfma_f32_16x16x32_bf16 a[76:79], a[228:231], v[156:159], a[76:79]
v_cvt_pk_bf16_f32 v134, v112, v113
v_cvt_pk_bf16_f32 v135, v114, v115
v_mfma_f32_16x16x32_bf16 a[80:83], a[232:235], v[140:143], a[80:83]
ds_read_b128 a[204:207], v209 offset:36864
v_exp_f32 v117, v117
v_mfma_f32_16x16x32_bf16 a[84:87], a[232:235], v[144:147], a[84:87]
v_exp_f32 v118, v118
v_mfma_f32_16x16x32_bf16 a[88:91], a[232:235], v[148:151], a[88:91]
s_waitcnt vmcnt(4)
v_exp_f32 v119, v119
v_mfma_f32_16x16x32_bf16 a[92:95], a[232:235], v[152:155], a[92:95]
v_cvt_pk_bf16_f32 v138, v116, v117
v_cvt_pk_bf16_f32 v139, v118, v119
v_mfma_f32_16x16x32_bf16 a[96:99], a[232:235], v[156:159], a[96:99]
ds_read_b128 a[208:211], v210 offset:36864
s_add_u32 m0, s48, 147456
v_mfma_f32_16x16x32_bf16 a[100:103], a[236:239], v[140:143], a[100:103]
buffer_load_dwordx4 v222, s[20:23], s37 offen offset:2048 nt lds
v_mfma_f32_16x16x32_bf16 a[104:107], a[236:239], v[144:147], a[104:107]
v_mfma_f32_16x16x32_bf16 a[108:111], a[236:239], v[148:151], a[108:111]
v_mfma_f32_16x16x32_bf16 a[112:115], a[236:239], v[152:155], a[112:115]
ds_read_b128 a[212:215], v211 offset:36864
v_mfma_f32_16x16x32_bf16 a[116:119], a[236:239], v[156:159], a[116:119]
v_mfma_f32_16x16x32_bf16 a[120:123], a[240:243], v[140:143], a[120:123]
v_mfma_f32_16x16x32_bf16 a[124:127], a[240:243], v[144:147], a[124:127]
v_mfma_f32_16x16x32_bf16 a[128:131], a[240:243], v[148:151], a[128:131]
s_waitcnt vmcnt(4)
v_mfma_f32_16x16x32_bf16 a[132:135], a[240:243], v[152:155], a[132:135]
v_mfma_f32_16x16x32_bf16 a[136:139], a[240:243], v[156:159], a[136:139]
s_add_u32 m0, s48, 147456
v_mfma_f32_16x16x32_bf16 a[140:143], a[244:247], v[140:143], a[140:143]
buffer_load_dwordx4 v223, s[20:23], s37 offen offset:3072 nt lds
v_mfma_f32_16x16x32_bf16 a[144:147], a[244:247], v[144:147], a[144:147]
v_mfma_f32_16x16x32_bf16 a[148:151], a[244:247], v[148:151], a[148:151]
v_mfma_f32_16x16x32_bf16 a[152:155], a[244:247], v[152:155], a[152:155]
v_mfma_f32_16x16x32_bf16 a[156:159], a[244:247], v[156:159], a[156:159]
s_waitcnt lgkmcnt(0)
v_mfma_f32_16x16x32_bf16 v[80:83], a[184:187], v[0:3], v[160:163]
v_mfma_f32_16x16x32_bf16 v[80:83], a[188:191], v[20:23], v[80:83]
ds_read_b64_tr_b16 a[216:217], v188 offset:0
v_mfma_f32_16x16x32_bf16 v[80:83], a[192:195], v[40:43], v[80:83]
v_mfma_f32_16x16x32_bf16 v[80:83], a[196:199], v[60:63], v[80:83]
ds_read_b64_tr_b16 a[218:219], v188 offset:4096
s_waitcnt vmcnt(4)
v_mfma_f32_16x16x32_bf16 v[84:87], a[196:199], v[64:67], v[164:167]
v_mfma_f32_16x16x32_bf16 v[84:87], a[192:195], v[44:47], v[84:87]
ds_read_b64_tr_b16 a[220:221], v189 offset:0
s_add_u32 m0, s48, 32768
s_xor_b32 s36, s3, 49152
v_mfma_f32_16x16x32_bf16 v[84:87], a[188:191], v[24:27], v[84:87]
buffer_load_dwordx4 v220, s[16:19], s36 offen offset:0 nt lds
v_mfma_f32_16x16x32_bf16 v[84:87], a[184:187], v[4:7], v[84:87]
ds_read_b64_tr_b16 a[222:223], v189 offset:4096
v_mfma_f32_16x16x32_bf16 v[88:91], a[184:187], v[8:11], v[168:171]
v_mfma_f32_16x16x32_bf16 v[88:91], a[188:191], v[28:31], v[88:91]
ds_read_b64_tr_b16 a[224:225], v190 offset:0
v_mfma_f32_16x16x32_bf16 v[88:91], a[192:195], v[48:51], v[88:91]
v_mfma_f32_16x16x32_bf16 v[88:91], a[196:199], v[68:71], v[88:91]
ds_read_b64_tr_b16 a[226:227], v190 offset:4096
v_mfma_f32_16x16x32_bf16 v[92:95], a[196:199], v[72:75], v[172:175]
v_exp_f32 v80, v80
v_mfma_f32_16x16x32_bf16 v[92:95], a[192:195], v[52:55], v[92:95]
ds_read_b64_tr_b16 a[228:229], v191 offset:0
v_exp_f32 v81, v81
v_mfma_f32_16x16x32_bf16 v[92:95], a[188:191], v[32:35], v[92:95]
v_exp_f32 v82, v82
v_mfma_f32_16x16x32_bf16 v[92:95], a[184:187], v[12:15], v[92:95]
ds_read_b64_tr_b16 a[230:231], v191 offset:4096
s_waitcnt vmcnt(4)
v_mfma_f32_16x16x32_bf16 v[96:99], a[184:187], v[16:19], v[176:179]
v_exp_f32 v83, v83
v_mfma_f32_16x16x32_bf16 v[96:99], a[188:191], v[36:39], v[96:99]
ds_read_b64_tr_b16 a[232:233], v192 offset:0
s_add_u32 m0, s48, 32768
v_mfma_f32_16x16x32_bf16 v[96:99], a[192:195], v[56:59], v[96:99]
buffer_load_dwordx4 v221, s[16:19], s36 offen offset:1024 nt lds
v_exp_f32 v84, v84
v_mfma_f32_16x16x32_bf16 v[96:99], a[196:199], v[76:79], v[96:99]
ds_read_b64_tr_b16 a[234:235], v192 offset:4096
v_cvt_pk_bf16_f32 v140, v80, v81
v_cvt_pk_bf16_f32 v141, v82, v83
v_mfma_f32_16x16x32_bf16 v[100:103], a[200:203], v[0:3], v[160:163]
v_exp_f32 v85, v85
v_mfma_f32_16x16x32_bf16 v[100:103], a[204:207], v[20:23], v[100:103]
ds_read_b64_tr_b16 a[236:237], v193 offset:0
v_exp_f32 v86, v86
v_mfma_f32_16x16x32_bf16 v[100:103], a[208:211], v[40:43], v[100:103]
v_exp_f32 v87, v87
v_mfma_f32_16x16x32_bf16 v[100:103], a[212:215], v[60:63], v[100:103]
ds_read_b64_tr_b16 a[238:239], v193 offset:4096
v_exp_f32 v88, v88
v_mfma_f32_16x16x32_bf16 v[104:107], a[212:215], v[64:67], v[164:167]
v_cvt_pk_bf16_f32 v144, v84, v85
v_cvt_pk_bf16_f32 v145, v86, v87
v_mfma_f32_16x16x32_bf16 v[104:107], a[208:211], v[44:47], v[104:107]
ds_read_b64_tr_b16 a[240:241], v194 offset:0
s_waitcnt vmcnt(4)
v_mfma_f32_16x16x32_bf16 v[104:107], a[204:207], v[24:27], v[104:107]
v_exp_f32 v89, v89
v_mfma_f32_16x16x32_bf16 v[104:107], a[200:203], v[4:7], v[104:107]
ds_read_b64_tr_b16 a[242:243], v194 offset:4096
s_add_u32 m0, s48, 32768
v_mfma_f32_16x16x32_bf16 v[108:111], a[200:203], v[8:11], v[168:171]
buffer_load_dwordx4 v222, s[16:19], s36 offen offset:2048 nt lds
v_exp_f32 v90, v90
v_mfma_f32_16x16x32_bf16 v[108:111], a[204:207], v[28:31], v[108:111]
ds_read_b64_tr_b16 a[244:245], v195 offset:0
v_exp_f32 v91, v91
v_mfma_f32_16x16x32_bf16 v[108:111], a[208:211], v[48:51], v[108:111]
v_exp_f32 v92, v92
v_mfma_f32_16x16x32_bf16 v[108:111], a[212:215], v[68:71], v[108:111]
ds_read_b64_tr_b16 a[246:247], v195 offset:4096
v_cvt_pk_bf16_f32 v148, v88, v89
v_cvt_pk_bf16_f32 v149, v90, v91
v_mfma_f32_16x16x32_bf16 v[112:115], a[212:215], v[72:75], v[172:175]
v_exp_f32 v93, v93
v_mfma_f32_16x16x32_bf16 v[112:115], a[208:211], v[52:55], v[112:115]
v_exp_f32 v94, v94
v_mfma_f32_16x16x32_bf16 v[112:115], a[204:207], v[32:35], v[112:115]
v_exp_f32 v95, v95
v_mfma_f32_16x16x32_bf16 v[112:115], a[200:203], v[12:15], v[112:115]
s_waitcnt vmcnt(4)
v_exp_f32 v96, v96
v_mfma_f32_16x16x32_bf16 v[116:119], a[200:203], v[16:19], v[176:179]
v_cvt_pk_bf16_f32 v152, v92, v93
v_cvt_pk_bf16_f32 v153, v94, v95
v_mfma_f32_16x16x32_bf16 v[116:119], a[204:207], v[36:39], v[116:119]
s_add_u32 m0, s48, 32768
v_exp_f32 v97, v97
v_mfma_f32_16x16x32_bf16 v[116:119], a[208:211], v[56:59], v[116:119]
buffer_load_dwordx4 v223, s[16:19], s36 offen offset:3072 nt lds
v_exp_f32 v98, v98
v_mfma_f32_16x16x32_bf16 v[116:119], a[212:215], v[76:79], v[116:119]
v_exp_f32 v99, v99
v_mfma_f32_16x16x32_bf16 a[160:163], a[180:183], v[120:123], a[160:163]
v_cvt_pk_bf16_f32 v156, v96, v97
v_cvt_pk_bf16_f32 v157, v98, v99
v_mfma_f32_16x16x32_bf16 a[164:167], a[180:183], v[124:127], a[164:167]
v_exp_f32 v100, v100
v_mfma_f32_16x16x32_bf16 a[168:171], a[180:183], v[128:131], a[168:171]
v_exp_f32 v101, v101
v_mfma_f32_16x16x32_bf16 a[172:175], a[180:183], v[132:135], a[172:175]
s_waitcnt lgkmcnt(0)
s_barrier
v_mfma_f32_16x16x32_bf16 a[176:179], a[180:183], v[136:139], a[176:179]
v_exp_f32 v102, v102
v_mfma_f32_16x16x32_bf16 a[0:3], a[216:219], v[120:123], a[0:3]
ds_read_b128 a[184:187], v212 offset:0
v_exp_f32 v103, v103
v_mfma_f32_16x16x32_bf16 a[4:7], a[216:219], v[124:127], a[4:7]
v_exp_f32 v104, v104
v_mfma_f32_16x16x32_bf16 a[8:11], a[216:219], v[128:131], a[8:11]
s_waitcnt vmcnt(4)
v_cvt_pk_bf16_f32 v142, v100, v101
v_cvt_pk_bf16_f32 v143, v102, v103
v_mfma_f32_16x16x32_bf16 a[12:15], a[216:219], v[132:135], a[12:15]
v_exp_f32 v105, v105
v_mfma_f32_16x16x32_bf16 a[16:19], a[216:219], v[136:139], a[16:19]
ds_read_b128 a[188:191], v213 offset:0
s_add_u32 m0, s48, 16384
s_xor_b32 s37, s3, 40960
v_mfma_f32_16x16x32_bf16 a[20:23], a[220:223], v[120:123], a[20:23]
buffer_load_dwordx4 v220, s[20:23], s37 offen offset:0 nt lds
v_exp_f32 v106, v106
v_mfma_f32_16x16x32_bf16 a[24:27], a[220:223], v[124:127], a[24:27]
v_exp_f32 v107, v107
v_mfma_f32_16x16x32_bf16 a[28:31], a[220:223], v[128:131], a[28:31]
v_exp_f32 v108, v108
v_mfma_f32_16x16x32_bf16 a[32:35], a[220:223], v[132:135], a[32:35]
ds_read_b128 a[192:195], v214 offset:0
v_cvt_pk_bf16_f32 v146, v104, v105
v_cvt_pk_bf16_f32 v147, v106, v107
v_mfma_f32_16x16x32_bf16 a[36:39], a[220:223], v[136:139], a[36:39]
v_exp_f32 v109, v109
v_mfma_f32_16x16x32_bf16 a[40:43], a[224:227], v[120:123], a[40:43]
v_exp_f32 v110, v110
v_mfma_f32_16x16x32_bf16 a[44:47], a[224:227], v[124:127], a[44:47]
v_exp_f32 v111, v111
v_mfma_f32_16x16x32_bf16 a[48:51], a[224:227], v[128:131], a[48:51]
ds_read_b128 a[196:199], v215 offset:0
s_waitcnt vmcnt(4)
v_mfma_f32_16x16x32_bf16 a[52:55], a[224:227], v[132:135], a[52:55]
v_exp_f32 v112, v112
v_mfma_f32_16x16x32_bf16 a[56:59], a[224:227], v[136:139], a[56:59]
s_add_u32 m0, s48, 16384
v_cvt_pk_bf16_f32 v150, v108, v109
v_cvt_pk_bf16_f32 v151, v110, v111
v_mfma_f32_16x16x32_bf16 a[60:63], a[228:231], v[120:123], a[60:63]
buffer_load_dwordx4 v221, s[20:23], s37 offen offset:1024 nt lds
v_exp_f32 v113, v113
v_mfma_f32_16x16x32_bf16 a[64:67], a[228:231], v[124:127], a[64:67]
ds_read_b128 a[200:203], v212 offset:4096
v_exp_f32 v114, v114
v_mfma_f32_16x16x32_bf16 a[68:71], a[228:231], v[128:131], a[68:71]
v_exp_f32 v115, v115
v_mfma_f32_16x16x32_bf16 a[72:75], a[228:231], v[132:135], a[72:75]
v_exp_f32 v116, v116
v_mfma_f32_16x16x32_bf16 a[76:79], a[228:231], v[136:139], a[76:79]
v_cvt_pk_bf16_f32 v154, v112, v113
v_cvt_pk_bf16_f32 v155, v114, v115
v_mfma_f32_16x16x32_bf16 a[80:83], a[232:235], v[120:123], a[80:83]
ds_read_b128 a[204:207], v213 offset:4096
v_exp_f32 v117, v117
v_mfma_f32_16x16x32_bf16 a[84:87], a[232:235], v[124:127], a[84:87]
v_exp_f32 v118, v118
v_mfma_f32_16x16x32_bf16 a[88:91], a[232:235], v[128:131], a[88:91]
v_exp_f32 v119, v119
v_mfma_f32_16x16x32_bf16 a[92:95], a[232:235], v[132:135], a[92:95]
s_waitcnt vmcnt(4)
v_cvt_pk_bf16_f32 v158, v116, v117
v_cvt_pk_bf16_f32 v159, v118, v119
v_mfma_f32_16x16x32_bf16 a[96:99], a[232:235], v[136:139], a[96:99]
ds_read_b128 a[208:211], v214 offset:4096
v_mfma_f32_16x16x32_bf16 a[100:103], a[236:239], v[120:123], a[100:103]
s_add_u32 m0, s48, 16384
v_mfma_f32_16x16x32_bf16 a[104:107], a[236:239], v[124:127], a[104:107]
buffer_load_dwordx4 v222, s[20:23], s37 offen offset:2048 nt lds
v_mfma_f32_16x16x32_bf16 a[108:111], a[236:239], v[128:131], a[108:111]
v_mfma_f32_16x16x32_bf16 a[112:115], a[236:239], v[132:135], a[112:115]
ds_read_b128 a[212:215], v215 offset:4096
v_mfma_f32_16x16x32_bf16 a[116:119], a[236:239], v[136:139], a[116:119]
v_mfma_f32_16x16x32_bf16 a[120:123], a[240:243], v[120:123], a[120:123]
v_mfma_f32_16x16x32_bf16 a[124:127], a[240:243], v[124:127], a[124:127]
v_mfma_f32_16x16x32_bf16 a[128:131], a[240:243], v[128:131], a[128:131]
v_mfma_f32_16x16x32_bf16 a[132:135], a[240:243], v[132:135], a[132:135]
s_waitcnt vmcnt(4)
v_mfma_f32_16x16x32_bf16 a[136:139], a[240:243], v[136:139], a[136:139]
v_mfma_f32_16x16x32_bf16 a[140:143], a[244:247], v[120:123], a[140:143]
s_add_u32 m0, s48, 16384
v_mfma_f32_16x16x32_bf16 a[144:147], a[244:247], v[124:127], a[144:147]
buffer_load_dwordx4 v223, s[20:23], s37 offen offset:3072 nt lds
v_mfma_f32_16x16x32_bf16 a[148:151], a[244:247], v[128:131], a[148:151]
v_mfma_f32_16x16x32_bf16 a[152:155], a[244:247], v[132:135], a[152:155]
v_mfma_f32_16x16x32_bf16 a[156:159], a[244:247], v[136:139], a[156:159]
s_waitcnt lgkmcnt(0)
v_mfma_f32_16x16x32_bf16 v[80:83], a[184:187], v[0:3], v[160:163]
v_mfma_f32_16x16x32_bf16 v[80:83], a[188:191], v[20:23], v[80:83]
ds_read_b64_tr_b16 a[216:217], v188 offset:32768
v_mfma_f32_16x16x32_bf16 v[80:83], a[192:195], v[40:43], v[80:83]
v_mfma_f32_16x16x32_bf16 v[80:83], a[196:199], v[60:63], v[80:83]
ds_read_b64_tr_b16 a[218:219], v188 offset:36864
v_mfma_f32_16x16x32_bf16 v[84:87], a[196:199], v[64:67], v[164:167]
v_mfma_f32_16x16x32_bf16 v[84:87], a[192:195], v[44:47], v[84:87]
ds_read_b64_tr_b16 a[220:221], v189 offset:32768
s_waitcnt vmcnt(4)
v_mfma_f32_16x16x32_bf16 v[84:87], a[188:191], v[24:27], v[84:87]
v_mfma_f32_16x16x32_bf16 v[84:87], a[184:187], v[4:7], v[84:87]
ds_read_b64_tr_b16 a[222:223], v189 offset:36864
s_add_u32 m0, s48, 65536
s_xor_b32 s36, s3, 57344
v_mfma_f32_16x16x32_bf16 v[88:91], a[184:187], v[8:11], v[168:171]
buffer_load_dwordx4 v220, s[16:19], s36 offen offset:0 nt lds
v_mfma_f32_16x16x32_bf16 v[88:91], a[188:191], v[28:31], v[88:91]
ds_read_b64_tr_b16 a[224:225], v190 offset:32768
v_mfma_f32_16x16x32_bf16 v[88:91], a[192:195], v[48:51], v[88:91]
v_mfma_f32_16x16x32_bf16 v[88:91], a[196:199], v[68:71], v[88:91]
ds_read_b64_tr_b16 a[226:227], v190 offset:36864
v_mfma_f32_16x16x32_bf16 v[92:95], a[196:199], v[72:75], v[172:175]
v_exp_f32 v80, v80
v_mfma_f32_16x16x32_bf16 v[92:95], a[192:195], v[52:55], v[92:95]
ds_read_b64_tr_b16 a[228:229], v191 offset:32768
v_exp_f32 v81, v81
v_mfma_f32_16x16x32_bf16 v[92:95], a[188:191], v[32:35], v[92:95]
v_exp_f32 v82, v82
v_mfma_f32_16x16x32_bf16 v[92:95], a[184:187], v[12:15], v[92:95]
ds_read_b64_tr_b16 a[230:231], v191 offset:36864
s_waitcnt vmcnt(4)
v_mfma_f32_16x16x32_bf16 v[96:99], a[184:187], v[16:19], v[176:179]
v_exp_f32 v83, v83
v_mfma_f32_16x16x32_bf16 v[96:99], a[188:191], v[36:39], v[96:99]
ds_read_b64_tr_b16 a[232:233], v192 offset:32768
s_add_u32 m0, s48, 65536
v_mfma_f32_16x16x32_bf16 v[96:99], a[192:195], v[56:59], v[96:99]
buffer_load_dwordx4 v221, s[16:19], s36 offen offset:1024 nt lds
v_exp_f32 v84, v84
v_mfma_f32_16x16x32_bf16 v[96:99], a[196:199], v[76:79], v[96:99]
ds_read_b64_tr_b16 a[234:235], v192 offset:36864
v_cvt_pk_bf16_f32 v120, v80, v81
v_cvt_pk_bf16_f32 v121, v82, v83
v_mfma_f32_16x16x32_bf16 v[100:103], a[200:203], v[0:3], v[160:163]
v_exp_f32 v85, v85
v_mfma_f32_16x16x32_bf16 v[100:103], a[204:207], v[20:23], v[100:103]
ds_read_b64_tr_b16 a[236:237], v193 offset:32768
v_exp_f32 v86, v86
v_mfma_f32_16x16x32_bf16 v[100:103], a[208:211], v[40:43], v[100:103]
v_exp_f32 v87, v87
v_mfma_f32_16x16x32_bf16 v[100:103], a[212:215], v[60:63], v[100:103]
ds_read_b64_tr_b16 a[238:239], v193 offset:36864
v_exp_f32 v88, v88
v_mfma_f32_16x16x32_bf16 v[104:107], a[212:215], v[64:67], v[164:167]
v_cvt_pk_bf16_f32 v124, v84, v85
v_cvt_pk_bf16_f32 v125, v86, v87
v_mfma_f32_16x16x32_bf16 v[104:107], a[208:211], v[44:47], v[104:107]
ds_read_b64_tr_b16 a[240:241], v194 offset:32768
v_exp_f32 v89, v89
v_mfma_f32_16x16x32_bf16 v[104:107], a[204:207], v[24:27], v[104:107]
v_exp_f32 v90, v90
v_mfma_f32_16x16x32_bf16 v[104:107], a[200:203], v[4:7], v[104:107]
ds_read_b64_tr_b16 a[242:243], v194 offset:36864
s_waitcnt vmcnt(4)
v_mfma_f32_16x16x32_bf16 v[108:111], a[200:203], v[8:11], v[168:171]
v_exp_f32 v91, v91
v_mfma_f32_16x16x32_bf16 v[108:111], a[204:207], v[28:31], v[108:111]
ds_read_b64_tr_b16 a[244:245], v195 offset:32768
s_add_u32 m0, s48, 65536
v_mfma_f32_16x16x32_bf16 v[108:111], a[208:211], v[48:51], v[108:111]
buffer_load_dwordx4 v222, s[16:19], s36 offen offset:2048 nt lds
v_exp_f32 v92, v92
v_mfma_f32_16x16x32_bf16 v[108:111], a[212:215], v[68:71], v[108:111]
ds_read_b64_tr_b16 a[246:247], v195 offset:36864
v_cvt_pk_bf16_f32 v128, v88, v89
v_cvt_pk_bf16_f32 v129, v90, v91
v_mfma_f32_16x16x32_bf16 v[112:115], a[212:215], v[72:75], v[172:175]
v_exp_f32 v93, v93
v_mfma_f32_16x16x32_bf16 v[112:115], a[208:211], v[52:55], v[112:115]
v_exp_f32 v94, v94
v_mfma_f32_16x16x32_bf16 v[112:115], a[204:207], v[32:35], v[112:115]
v_exp_f32 v95, v95
v_mfma_f32_16x16x32_bf16 v[112:115], a[200:203], v[12:15], v[112:115]
v_exp_f32 v96, v96
v_mfma_f32_16x16x32_bf16 v[116:119], a[200:203], v[16:19], v[176:179]
s_waitcnt vmcnt(4)
v_cvt_pk_bf16_f32 v132, v92, v93
v_cvt_pk_bf16_f32 v133, v94, v95
v_mfma_f32_16x16x32_bf16 v[116:119], a[204:207], v[36:39], v[116:119]
v_exp_f32 v97, v97
v_mfma_f32_16x16x32_bf16 v[116:119], a[208:211], v[56:59], v[116:119]
s_add_u32 m0, s48, 65536
v_exp_f32 v98, v98
v_mfma_f32_16x16x32_bf16 v[116:119], a[212:215], v[76:79], v[116:119]
buffer_load_dwordx4 v223, s[16:19], s36 offen offset:3072 nt lds
v_exp_f32 v99, v99
v_mfma_f32_16x16x32_bf16 a[160:163], a[180:183], v[140:143], a[160:163]
v_cvt_pk_bf16_f32 v136, v96, v97
v_cvt_pk_bf16_f32 v137, v98, v99
v_mfma_f32_16x16x32_bf16 a[164:167], a[180:183], v[144:147], a[164:167]
v_exp_f32 v100, v100
v_mfma_f32_16x16x32_bf16 a[168:171], a[180:183], v[148:151], a[168:171]
v_exp_f32 v101, v101
v_mfma_f32_16x16x32_bf16 a[172:175], a[180:183], v[152:155], a[172:175]
s_waitcnt lgkmcnt(0)
s_barrier
v_mfma_f32_16x16x32_bf16 a[176:179], a[180:183], v[156:159], a[176:179]
v_exp_f32 v102, v102
v_mfma_f32_16x16x32_bf16 a[0:3], a[216:219], v[140:143], a[0:3]
ds_read_b128 a[184:187], v204 offset:0
v_exp_f32 v103, v103
v_mfma_f32_16x16x32_bf16 a[4:7], a[216:219], v[144:147], a[4:7]
v_exp_f32 v104, v104
v_mfma_f32_16x16x32_bf16 a[8:11], a[216:219], v[148:151], a[8:11]
s_waitcnt vmcnt(4)
v_cvt_pk_bf16_f32 v122, v100, v101
v_cvt_pk_bf16_f32 v123, v102, v103
v_mfma_f32_16x16x32_bf16 a[12:15], a[216:219], v[152:155], a[12:15]
v_exp_f32 v105, v105
v_mfma_f32_16x16x32_bf16 a[16:19], a[216:219], v[156:159], a[16:19]
ds_read_b128 a[188:191], v205 offset:0
s_add_u32 m0, s48, 49152
s_xor_b32 s37, s3, 49152
v_mfma_f32_16x16x32_bf16 a[20:23], a[220:223], v[140:143], a[20:23]
buffer_load_dwordx4 v220, s[20:23], s37 offen offset:0 nt lds
v_exp_f32 v106, v106
v_mfma_f32_16x16x32_bf16 a[24:27], a[220:223], v[144:147], a[24:27]
v_exp_f32 v107, v107
v_mfma_f32_16x16x32_bf16 a[28:31], a[220:223], v[148:151], a[28:31]
v_exp_f32 v108, v108
v_mfma_f32_16x16x32_bf16 a[32:35], a[220:223], v[152:155], a[32:35]
ds_read_b128 a[192:195], v206 offset:0
v_cvt_pk_bf16_f32 v126, v104, v105
v_cvt_pk_bf16_f32 v127, v106, v107
v_mfma_f32_16x16x32_bf16 a[36:39], a[220:223], v[156:159], a[36:39]
v_exp_f32 v109, v109
v_mfma_f32_16x16x32_bf16 a[40:43], a[224:227], v[140:143], a[40:43]
v_exp_f32 v110, v110
v_mfma_f32_16x16x32_bf16 a[44:47], a[224:227], v[144:147], a[44:47]
v_exp_f32 v111, v111
v_mfma_f32_16x16x32_bf16 a[48:51], a[224:227], v[148:151], a[48:51]
ds_read_b128 a[196:199], v207 offset:0
v_exp_f32 v112, v112
v_mfma_f32_16x16x32_bf16 a[52:55], a[224:227], v[152:155], a[52:55]
v_cvt_pk_bf16_f32 v130, v108, v109
v_cvt_pk_bf16_f32 v131, v110, v111
v_mfma_f32_16x16x32_bf16 a[56:59], a[224:227], v[156:159], a[56:59]
s_waitcnt vmcnt(4)
v_exp_f32 v113, v113
v_mfma_f32_16x16x32_bf16 a[60:63], a[228:231], v[140:143], a[60:63]
v_exp_f32 v114, v114
v_mfma_f32_16x16x32_bf16 a[64:67], a[228:231], v[144:147], a[64:67]
ds_read_b128 a[200:203], v204 offset:4096
s_add_u32 m0, s48, 49152
v_mfma_f32_16x16x32_bf16 a[68:71], a[228:231], v[148:151], a[68:71]
buffer_load_dwordx4 v221, s[20:23], s37 offen offset:1024 nt lds
v_exp_f32 v115, v115
v_mfma_f32_16x16x32_bf16 a[72:75], a[228:231], v[152:155], a[72:75]
v_exp_f32 v116, v116
v_mfma_f32_16x16x32_bf16 a[76:79], a[228:231], v[156:159], a[76:79]
v_cvt_pk_bf16_f32 v134, v112, v113
v_cvt_pk_bf16_f32 v135, v114, v115
v_mfma_f32_16x16x32_bf16 a[80:83], a[232:235], v[140:143], a[80:83]
ds_read_b128 a[204:207], v205 offset:4096
v_exp_f32 v117, v117
v_mfma_f32_16x16x32_bf16 a[84:87], a[232:235], v[144:147], a[84:87]
v_exp_f32 v118, v118
v_mfma_f32_16x16x32_bf16 a[88:91], a[232:235], v[148:151], a[88:91]
v_exp_f32 v119, v119
v_mfma_f32_16x16x32_bf16 a[92:95], a[232:235], v[152:155], a[92:95]
v_cvt_pk_bf16_f32 v138, v116, v117
v_cvt_pk_bf16_f32 v139, v118, v119
v_mfma_f32_16x16x32_bf16 a[96:99], a[232:235], v[156:159], a[96:99]
ds_read_b128 a[208:211], v206 offset:4096
s_waitcnt vmcnt(4)
v_mfma_f32_16x16x32_bf16 a[100:103], a[236:239], v[140:143], a[100:103]
v_mfma_f32_16x16x32_bf16 a[104:107], a[236:239], v[144:147], a[104:107]
s_add_u32 m0, s48, 49152
v_mfma_f32_16x16x32_bf16 a[108:111], a[236:239], v[148:151], a[108:111]
buffer_load_dwordx4 v222, s[20:23], s37 offen offset:2048 nt lds
v_mfma_f32_16x16x32_bf16 a[112:115], a[236:239], v[152:155], a[112:115]
ds_read_b128 a[212:215], v207 offset:4096
v_mfma_f32_16x16x32_bf16 a[116:119], a[236:239], v[156:159], a[116:119]
v_mfma_f32_16x16x32_bf16 a[120:123], a[240:243], v[140:143], a[120:123]
v_mfma_f32_16x16x32_bf16 a[124:127], a[240:243], v[144:147], a[124:127]
v_mfma_f32_16x16x32_bf16 a[128:131], a[240:243], v[148:151], a[128:131]
v_mfma_f32_16x16x32_bf16 a[132:135], a[240:243], v[152:155], a[132:135]
v_mfma_f32_16x16x32_bf16 a[136:139], a[240:243], v[156:159], a[136:139]
s_waitcnt vmcnt(4)
v_mfma_f32_16x16x32_bf16 a[140:143], a[244:247], v[140:143], a[140:143]
v_mfma_f32_16x16x32_bf16 a[144:147], a[244:247], v[144:147], a[144:147]
s_add_u32 m0, s48, 49152
v_mfma_f32_16x16x32_bf16 a[148:151], a[244:247], v[148:151], a[148:151]
buffer_load_dwordx4 v223, s[20:23], s37 offen offset:3072 nt lds
v_mfma_f32_16x16x32_bf16 a[152:155], a[244:247], v[152:155], a[152:155]
v_mfma_f32_16x16x32_bf16 a[156:159], a[244:247], v[156:159], a[156:159]
s_waitcnt lgkmcnt(0)
v_mfma_f32_16x16x32_bf16 v[80:83], a[184:187], v[0:3], v[160:163]
v_bfe_u32 v229, v226, 2, 2
v_lshl_add_u32 v230, v227, 3, v229
v_mfma_f32_16x16x32_bf16 v[80:83], a[188:191], v[20:23], v[80:83]
ds_read_b64_tr_b16 a[216:217], v196 offset:0
v_lshlrev_b32 v230, 8, v230
s_lshl_b32 s49, s29, 13
v_mfma_f32_16x16x32_bf16 v[80:83], a[192:195], v[40:43], v[80:83]
s_add_u32 s49, s49, 81920
v_add_u32 v230, s49, v230
v_bfe_u32 v231, v226, 2, 3
v_mfma_f32_16x16x32_bf16 v[80:83], a[196:199], v[60:63], v[80:83]
ds_read_b64_tr_b16 a[218:219], v196 offset:4096
v_xor_b32 v231, s100, v231
v_lshlrev_b32 v231, 1, v231
v_mfma_f32_16x16x32_bf16 v[84:87], a[196:199], v[64:67], v[164:167]
v_and_b32 v229, 3, v226
v_xor_b32 v231, v231, v229
v_mfma_f32_16x16x32_bf16 v[84:87], a[192:195], v[44:47], v[84:87]
ds_read_b64_tr_b16 a[220:221], v197 offset:0
s_waitcnt vmcnt(4)
v_lshl_add_u32 v233, v231, 4, v230
v_mfma_f32_16x16x32_bf16 v[84:87], a[188:191], v[24:27], v[84:87]
v_xor_b32 v234, 64, v233
v_xor_b32 v235, 128, v233
v_mfma_f32_16x16x32_bf16 v[84:87], a[184:187], v[4:7], v[84:87]
ds_read_b64_tr_b16 a[222:223], v197 offset:4096
s_add_u32 m0, s48, 98304
s_xor_b32 s36, s3, 65536
v_mfma_f32_16x16x32_bf16 v[88:91], a[184:187], v[8:11], v[168:171]
buffer_load_dwordx4 v220, s[16:19], s36 offen offset:0 nt lds
v_xor_b32 v236, 192, v233
v_add_u32 v237, 49152, v233
v_mfma_f32_16x16x32_bf16 v[88:91], a[188:191], v[28:31], v[88:91]
ds_read_b64_tr_b16 a[224:225], v198 offset:0
v_add_u32 v238, 49152, v234
v_add_u32 v239, 49152, v235
v_mfma_f32_16x16x32_bf16 v[88:91], a[192:195], v[48:51], v[88:91]
v_add_u32 v240, 49152, v236
v_and_b32 v241, 0xfffffbff, v244
v_mfma_f32_16x16x32_bf16 v[88:91], a[196:199], v[68:71], v[88:91]
ds_read_b64_tr_b16 a[226:227], v198 offset:4096
v_and_b32 v242, 0xfffffbff, v245
v_mfma_f32_16x16x32_bf16 v[92:95], a[196:199], v[72:75], v[172:175]
v_exp_f32 v80, v80
v_mfma_f32_16x16x32_bf16 v[92:95], a[192:195], v[52:55], v[92:95]
ds_read_b64_tr_b16 a[228:229], v199 offset:0
v_exp_f32 v81, v81
v_mfma_f32_16x16x32_bf16 v[92:95], a[188:191], v[32:35], v[92:95]
v_exp_f32 v82, v82
v_mfma_f32_16x16x32_bf16 v[92:95], a[184:187], v[12:15], v[92:95]
ds_read_b64_tr_b16 a[230:231], v199 offset:4096
v_exp_f32 v83, v83
v_mfma_f32_16x16x32_bf16 v[96:99], a[184:187], v[16:19], v[176:179]
v_exp_f32 v84, v84
v_mfma_f32_16x16x32_bf16 v[96:99], a[188:191], v[36:39], v[96:99]
ds_read_b64_tr_b16 a[232:233], v200 offset:0
s_waitcnt vmcnt(4)
v_cvt_pk_bf16_f32 v140, v80, v81
v_mfma_f32_16x16x32_bf16 v[96:99], a[192:195], v[56:59], v[96:99]
v_cvt_pk_bf16_f32 v141, v82, v83
v_mfma_f32_16x16x32_bf16 v[96:99], a[196:199], v[76:79], v[96:99]
ds_read_b64_tr_b16 a[234:235], v200 offset:4096
s_add_u32 m0, s48, 98304
v_mfma_f32_16x16x32_bf16 v[100:103], a[200:203], v[0:3], v[160:163]
buffer_load_dwordx4 v221, s[16:19], s36 offen offset:1024 nt lds
v_exp_f32 v85, v85
v_mfma_f32_16x16x32_bf16 v[100:103], a[204:207], v[20:23], v[100:103]
ds_read_b64_tr_b16 a[236:237], v201 offset:0
v_exp_f32 v86, v86
v_mfma_f32_16x16x32_bf16 v[100:103], a[208:211], v[40:43], v[100:103]
v_exp_f32 v87, v87
v_mfma_f32_16x16x32_bf16 v[100:103], a[212:215], v[60:63], v[100:103]
ds_read_b64_tr_b16 a[238:239], v201 offset:4096
v_exp_f32 v88, v88
v_mfma_f32_16x16x32_bf16 v[104:107], a[212:215], v[64:67], v[164:167]
v_cvt_pk_bf16_f32 v144, v84, v85
v_cvt_pk_bf16_f32 v145, v86, v87
v_mfma_f32_16x16x32_bf16 v[104:107], a[208:211], v[44:47], v[104:107]
ds_read_b64_tr_b16 a[240:241], v202 offset:0
v_exp_f32 v89, v89
v_mfma_f32_16x16x32_bf16 v[104:107], a[204:207], v[24:27], v[104:107]
v_exp_f32 v90, v90
v_mfma_f32_16x16x32_bf16 v[104:107], a[200:203], v[4:7], v[104:107]
ds_read_b64_tr_b16 a[242:243], v202 offset:4096
s_waitcnt vmcnt(4)
v_mfma_f32_16x16x32_bf16 v[108:111], a[200:203], v[8:11], v[168:171]
v_exp_f32 v91, v91
v_mfma_f32_16x16x32_bf16 v[108:111], a[204:207], v[28:31], v[108:111]
ds_read_b64_tr_b16 a[244:245], v203 offset:0
s_add_u32 m0, s48, 98304
v_mfma_f32_16x16x32_bf16 v[108:111], a[208:211], v[48:51], v[108:111]
buffer_load_dwordx4 v222, s[16:19], s36 offen offset:2048 nt lds
v_exp_f32 v92, v92
v_mfma_f32_16x16x32_bf16 v[108:111], a[212:215], v[68:71], v[108:111]
ds_read_b64_tr_b16 a[246:247], v203 offset:4096
v_cvt_pk_bf16_f32 v148, v88, v89
v_cvt_pk_bf16_f32 v149, v90, v91
v_mfma_f32_16x16x32_bf16 v[112:115], a[212:215], v[72:75], v[172:175]
v_exp_f32 v93, v93
v_mfma_f32_16x16x32_bf16 v[112:115], a[208:211], v[52:55], v[112:115]
v_exp_f32 v94, v94
v_mfma_f32_16x16x32_bf16 v[112:115], a[204:207], v[32:35], v[112:115]
v_exp_f32 v95, v95
v_mfma_f32_16x16x32_bf16 v[112:115], a[200:203], v[12:15], v[112:115]
v_exp_f32 v96, v96
v_mfma_f32_16x16x32_bf16 v[116:119], a[200:203], v[16:19], v[176:179]
v_cvt_pk_bf16_f32 v152, v92, v93
v_cvt_pk_bf16_f32 v153, v94, v95
v_mfma_f32_16x16x32_bf16 v[116:119], a[204:207], v[36:39], v[116:119]
s_waitcnt vmcnt(4)
v_exp_f32 v97, v97
v_mfma_f32_16x16x32_bf16 v[116:119], a[208:211], v[56:59], v[116:119]
v_exp_f32 v98, v98
v_mfma_f32_16x16x32_bf16 v[116:119], a[212:215], v[76:79], v[116:119]
s_add_u32 m0, s48, 98304
v_exp_f32 v99, v99
v_mfma_f32_16x16x32_bf16 a[160:163], a[180:183], v[120:123], a[160:163]
buffer_load_dwordx4 v223, s[16:19], s36 offen offset:3072 nt lds
v_cvt_pk_bf16_f32 v156, v96, v97
v_cvt_pk_bf16_f32 v157, v98, v99
v_mfma_f32_16x16x32_bf16 a[164:167], a[180:183], v[124:127], a[164:167]
v_exp_f32 v100, v100
v_mfma_f32_16x16x32_bf16 a[168:171], a[180:183], v[128:131], a[168:171]
v_exp_f32 v101, v101
v_mfma_f32_16x16x32_bf16 a[172:175], a[180:183], v[132:135], a[172:175]
s_waitcnt lgkmcnt(0)
s_barrier
v_mfma_f32_16x16x32_bf16 a[176:179], a[180:183], v[136:139], a[176:179]
v_exp_f32 v102, v102
v_mfma_f32_16x16x32_bf16 a[0:3], a[216:219], v[120:123], a[0:3]
ds_read_b128 a[184:187], v204 offset:32768
v_exp_f32 v103, v103
v_mfma_f32_16x16x32_bf16 a[4:7], a[216:219], v[124:127], a[4:7]
v_exp_f32 v104, v104
v_mfma_f32_16x16x32_bf16 a[8:11], a[216:219], v[128:131], a[8:11]
v_cvt_pk_bf16_f32 v142, v100, v101
v_cvt_pk_bf16_f32 v143, v102, v103
v_mfma_f32_16x16x32_bf16 a[12:15], a[216:219], v[132:135], a[12:15]
s_waitcnt vmcnt(4)
v_exp_f32 v105, v105
v_mfma_f32_16x16x32_bf16 a[16:19], a[216:219], v[136:139], a[16:19]
ds_read_b128 a[188:191], v205 offset:32768
v_exp_f32 v106, v106
v_mfma_f32_16x16x32_bf16 a[20:23], a[220:223], v[120:123], a[20:23]
s_add_u32 m0, s48, 81920
s_xor_b32 s37, s3, 57344
v_mfma_f32_16x16x32_bf16 a[24:27], a[220:223], v[124:127], a[24:27]
buffer_load_dwordx4 v220, s[20:23], s37 offen offset:0 nt lds
v_exp_f32 v107, v107
v_mfma_f32_16x16x32_bf16 a[28:31], a[220:223], v[128:131], a[28:31]
v_exp_f32 v108, v108
v_mfma_f32_16x16x32_bf16 a[32:35], a[220:223], v[132:135], a[32:35]
ds_read_b128 a[192:195], v206 offset:32768
v_cvt_pk_bf16_f32 v146, v104, v105
v_cvt_pk_bf16_f32 v147, v106, v107
v_mfma_f32_16x16x32_bf16 a[36:39], a[220:223], v[136:139], a[36:39]
v_exp_f32 v109, v109
v_mfma_f32_16x16x32_bf16 a[40:43], a[224:227], v[120:123], a[40:43]
v_exp_f32 v110, v110
v_mfma_f32_16x16x32_bf16 a[44:47], a[224:227], v[124:127], a[44:47]
v_exp_f32 v111, v111
v_mfma_f32_16x16x32_bf16 a[48:51], a[224:227], v[128:131], a[48:51]
ds_read_b128 a[196:199], v207 offset:32768
v_exp_f32 v112, v112
v_mfma_f32_16x16x32_bf16 a[52:55], a[224:227], v[132:135], a[52:55]
v_cvt_pk_bf16_f32 v150, v108, v109
v_cvt_pk_bf16_f32 v151, v110, v111
v_mfma_f32_16x16x32_bf16 a[56:59], a[224:227], v[136:139], a[56:59]
s_waitcnt vmcnt(4)
v_exp_f32 v113, v113
v_mfma_f32_16x16x32_bf16 a[60:63], a[228:231], v[120:123], a[60:63]
v_exp_f32 v114, v114
v_mfma_f32_16x16x32_bf16 a[64:67], a[228:231], v[124:127], a[64:67]
ds_read_b128 a[200:203], v204 offset:36864
s_add_u32 m0, s48, 81920
v_mfma_f32_16x16x32_bf16 a[68:71], a[228:231], v[128:131], a[68:71]
buffer_load_dwordx4 v221, s[20:23], s37 offen offset:1024 nt lds
v_exp_f32 v115, v115
v_mfma_f32_16x16x32_bf16 a[72:75], a[228:231], v[132:135], a[72:75]
v_exp_f32 v116, v116
v_mfma_f32_16x16x32_bf16 a[76:79], a[228:231], v[136:139], a[76:79]
v_cvt_pk_bf16_f32 v154, v112, v113
v_cvt_pk_bf16_f32 v155, v114, v115
v_mfma_f32_16x16x32_bf16 a[80:83], a[232:235], v[120:123], a[80:83]
ds_read_b128 a[204:207], v205 offset:36864
v_exp_f32 v117, v117
v_mfma_f32_16x16x32_bf16 a[84:87], a[232:235], v[124:127], a[84:87]
v_exp_f32 v118, v118
v_mfma_f32_16x16x32_bf16 a[88:91], a[232:235], v[128:131], a[88:91]
v_exp_f32 v119, v119
v_mfma_f32_16x16x32_bf16 a[92:95], a[232:235], v[132:135], a[92:95]
v_cvt_pk_bf16_f32 v158, v116, v117
v_cvt_pk_bf16_f32 v159, v118, v119
v_mfma_f32_16x16x32_bf16 a[96:99], a[232:235], v[136:139], a[96:99]
ds_read_b128 a[208:211], v206 offset:36864
v_mfma_f32_16x16x32_bf16 a[100:103], a[236:239], v[120:123], a[100:103]
v_mfma_f32_16x16x32_bf16 a[104:107], a[236:239], v[124:127], a[104:107]
s_waitcnt vmcnt(4)
v_mfma_f32_16x16x32_bf16 a[108:111], a[236:239], v[128:131], a[108:111]
v_mfma_f32_16x16x32_bf16 a[112:115], a[236:239], v[132:135], a[112:115]
ds_read_b128 a[212:215], v207 offset:36864
s_add_u32 m0, s48, 81920
v_mfma_f32_16x16x32_bf16 a[116:119], a[236:239], v[136:139], a[116:119]
buffer_load_dwordx4 v222, s[20:23], s37 offen offset:2048 nt lds
v_mfma_f32_16x16x32_bf16 a[120:123], a[240:243], v[120:123], a[120:123]
v_mfma_f32_16x16x32_bf16 a[124:127], a[240:243], v[124:127], a[124:127]
v_mfma_f32_16x16x32_bf16 a[128:131], a[240:243], v[128:131], a[128:131]
v_mfma_f32_16x16x32_bf16 a[132:135], a[240:243], v[132:135], a[132:135]
v_mfma_f32_16x16x32_bf16 a[136:139], a[240:243], v[136:139], a[136:139]
s_waitcnt vmcnt(4)
v_mfma_f32_16x16x32_bf16 a[140:143], a[244:247], v[120:123], a[140:143]
v_mfma_f32_16x16x32_bf16 a[144:147], a[244:247], v[124:127], a[144:147]
s_add_u32 m0, s48, 81920
v_mfma_f32_16x16x32_bf16 a[148:151], a[244:247], v[128:131], a[148:151]
buffer_load_dwordx4 v223, s[20:23], s37 offen offset:3072 nt lds
v_mfma_f32_16x16x32_bf16 a[152:155], a[244:247], v[132:135], a[152:155]
v_mfma_f32_16x16x32_bf16 a[156:159], a[244:247], v[136:139], a[156:159]
s_waitcnt lgkmcnt(0)
v_mfma_f32_16x16x32_bf16 v[80:83], a[184:187], v[0:3], v[160:163]
v_mfma_f32_16x16x32_bf16 v[80:83], a[188:191], v[20:23], v[80:83]
ds_read_b64_tr_b16 a[216:217], v180 offset:0
v_mfma_f32_16x16x32_bf16 v[80:83], a[192:195], v[40:43], v[80:83]
v_mfma_f32_16x16x32_bf16 v[80:83], a[196:199], v[60:63], v[80:83]
ds_read_b64_tr_b16 a[218:219], v180 offset:4096
v_mfma_f32_16x16x32_bf16 v[84:87], a[196:199], v[64:67], v[164:167]
v_mfma_f32_16x16x32_bf16 v[84:87], a[192:195], v[44:47], v[84:87]
ds_read_b64_tr_b16 a[220:221], v181 offset:0
v_mfma_f32_16x16x32_bf16 v[84:87], a[188:191], v[24:27], v[84:87]
v_mfma_f32_16x16x32_bf16 v[84:87], a[184:187], v[4:7], v[84:87]
ds_read_b64_tr_b16 a[222:223], v181 offset:4096
s_waitcnt vmcnt(4)
v_mfma_f32_16x16x32_bf16 v[88:91], a[184:187], v[8:11], v[168:171]
v_mfma_f32_16x16x32_bf16 v[88:91], a[188:191], v[28:31], v[88:91]
ds_read_b64_tr_b16 a[224:225], v182 offset:0
s_add_u32 m0, s48, 131072
s_xor_b32 s36, s3, 73728
v_mfma_f32_16x16x32_bf16 v[88:91], a[192:195], v[48:51], v[88:91]
buffer_load_dwordx4 v220, s[16:19], s36 offen offset:0 nt lds
v_mfma_f32_16x16x32_bf16 v[88:91], a[196:199], v[68:71], v[88:91]
ds_read_b64_tr_b16 a[226:227], v182 offset:4096
v_mfma_f32_16x16x32_bf16 v[92:95], a[196:199], v[72:75], v[172:175]
v_exp_f32 v80, v80
v_mfma_f32_16x16x32_bf16 v[92:95], a[192:195], v[52:55], v[92:95]
ds_read_b64_tr_b16 a[228:229], v183 offset:0
v_exp_f32 v81, v81
v_mfma_f32_16x16x32_bf16 v[92:95], a[188:191], v[32:35], v[92:95]
v_exp_f32 v82, v82
v_mfma_f32_16x16x32_bf16 v[92:95], a[184:187], v[12:15], v[92:95]
ds_read_b64_tr_b16 a[230:231], v183 offset:4096
v_exp_f32 v83, v83
v_mfma_f32_16x16x32_bf16 v[96:99], a[184:187], v[16:19], v[176:179]
v_exp_f32 v84, v84
v_mfma_f32_16x16x32_bf16 v[96:99], a[188:191], v[36:39], v[96:99]
ds_read_b64_tr_b16 a[232:233], v184 offset:0
s_waitcnt vmcnt(4)
v_cvt_pk_bf16_f32 v120, v80, v81
v_mfma_f32_16x16x32_bf16 v[96:99], a[192:195], v[56:59], v[96:99]
v_cvt_pk_bf16_f32 v121, v82, v83
v_mfma_f32_16x16x32_bf16 v[96:99], a[196:199], v[76:79], v[96:99]
ds_read_b64_tr_b16 a[234:235], v184 offset:4096
s_add_u32 m0, s48, 131072
v_mfma_f32_16x16x32_bf16 v[100:103], a[200:203], v[0:3], v[160:163]
buffer_load_dwordx4 v221, s[16:19], s36 offen offset:1024 nt lds
v_exp_f32 v85, v85
v_mfma_f32_16x16x32_bf16 v[100:103], a[204:207], v[20:23], v[100:103]
ds_read_b64_tr_b16 a[236:237], v185 offset:0
v_exp_f32 v86, v86
v_mfma_f32_16x16x32_bf16 v[100:103], a[208:211], v[40:43], v[100:103]
v_exp_f32 v87, v87
v_mfma_f32_16x16x32_bf16 v[100:103], a[212:215], v[60:63], v[100:103]
ds_read_b64_tr_b16 a[238:239], v185 offset:4096
v_exp_f32 v88, v88
v_mfma_f32_16x16x32_bf16 v[104:107], a[212:215], v[64:67], v[164:167]
v_cvt_pk_bf16_f32 v124, v84, v85
v_cvt_pk_bf16_f32 v125, v86, v87
v_mfma_f32_16x16x32_bf16 v[104:107], a[208:211], v[44:47], v[104:107]
ds_read_b64_tr_b16 a[240:241], v186 offset:0
v_exp_f32 v89, v89
v_mfma_f32_16x16x32_bf16 v[104:107], a[204:207], v[24:27], v[104:107]
v_exp_f32 v90, v90
v_mfma_f32_16x16x32_bf16 v[104:107], a[200:203], v[4:7], v[104:107]
ds_read_b64_tr_b16 a[242:243], v186 offset:4096
v_exp_f32 v91, v91
v_mfma_f32_16x16x32_bf16 v[108:111], a[200:203], v[8:11], v[168:171]
v_exp_f32 v92, v92
v_mfma_f32_16x16x32_bf16 v[108:111], a[204:207], v[28:31], v[108:111]
ds_read_b64_tr_b16 a[244:245], v187 offset:0
s_waitcnt vmcnt(4)
v_cvt_pk_bf16_f32 v128, v88, v89
v_mfma_f32_16x16x32_bf16 v[108:111], a[208:211], v[48:51], v[108:111]
v_cvt_pk_bf16_f32 v129, v90, v91
v_mfma_f32_16x16x32_bf16 v[108:111], a[212:215], v[68:71], v[108:111]
ds_read_b64_tr_b16 a[246:247], v187 offset:4096
s_add_u32 m0, s48, 131072
v_mfma_f32_16x16x32_bf16 v[112:115], a[212:215], v[72:75], v[172:175]
buffer_load_dwordx4 v222, s[16:19], s36 offen offset:2048 nt lds
v_exp_f32 v93, v93
v_mfma_f32_16x16x32_bf16 v[112:115], a[208:211], v[52:55], v[112:115]
v_exp_f32 v94, v94
v_mfma_f32_16x16x32_bf16 v[112:115], a[204:207], v[32:35], v[112:115]
v_exp_f32 v95, v95
v_mfma_f32_16x16x32_bf16 v[112:115], a[200:203], v[12:15], v[112:115]
v_exp_f32 v96, v96
v_mfma_f32_16x16x32_bf16 v[116:119], a[200:203], v[16:19], v[176:179]
v_cvt_pk_bf16_f32 v132, v92, v93
v_cvt_pk_bf16_f32 v133, v94, v95
v_mfma_f32_16x16x32_bf16 v[116:119], a[204:207], v[36:39], v[116:119]
v_exp_f32 v97, v97
v_mfma_f32_16x16x32_bf16 v[116:119], a[208:211], v[56:59], v[116:119]
s_waitcnt vmcnt(4)
v_exp_f32 v98, v98
v_mfma_f32_16x16x32_bf16 v[116:119], a[212:215], v[76:79], v[116:119]
v_exp_f32 v99, v99
v_mfma_f32_16x16x32_bf16 a[160:163], a[180:183], v[140:143], a[160:163]
s_add_u32 m0, s48, 131072
v_cvt_pk_bf16_f32 v136, v96, v97
v_cvt_pk_bf16_f32 v137, v98, v99
v_mfma_f32_16x16x32_bf16 a[164:167], a[180:183], v[144:147], a[164:167]
buffer_load_dwordx4 v223, s[16:19], s36 offen offset:3072 nt lds
v_exp_f32 v100, v100
v_mfma_f32_16x16x32_bf16 a[168:171], a[180:183], v[148:151], a[168:171]
v_exp_f32 v101, v101
v_mfma_f32_16x16x32_bf16 a[172:175], a[180:183], v[152:155], a[172:175]
s_waitcnt lgkmcnt(0)
s_barrier
v_mfma_f32_16x16x32_bf16 a[176:179], a[180:183], v[156:159], a[176:179]
v_exp_f32 v102, v102
v_mfma_f32_16x16x32_bf16 a[0:3], a[216:219], v[140:143], a[0:3]
ds_read_b128 a[184:187], v208 offset:0
v_exp_f32 v103, v103
v_mfma_f32_16x16x32_bf16 a[4:7], a[216:219], v[144:147], a[4:7]
v_exp_f32 v104, v104
v_mfma_f32_16x16x32_bf16 a[8:11], a[216:219], v[148:151], a[8:11]
v_cvt_pk_bf16_f32 v122, v100, v101
v_cvt_pk_bf16_f32 v123, v102, v103
v_mfma_f32_16x16x32_bf16 a[12:15], a[216:219], v[152:155], a[12:15]
v_exp_f32 v105, v105
v_mfma_f32_16x16x32_bf16 a[16:19], a[216:219], v[156:159], a[16:19]
ds_read_b128 a[188:191], v209 offset:0
s_waitcnt vmcnt(4)
v_mfma_f32_16x16x32_bf16 a[20:23], a[220:223], v[140:143], a[20:23]
v_exp_f32 v106, v106
v_mfma_f32_16x16x32_bf16 a[24:27], a[220:223], v[144:147], a[24:27]
s_add_u32 m0, s48, 114688
s_xor_b32 s37, s3, 65536
v_mfma_f32_16x16x32_bf16 a[28:31], a[220:223], v[148:151], a[28:31]
buffer_load_dwordx4 v220, s[20:23], s37 offen offset:0 nt lds
v_exp_f32 v107, v107
v_mfma_f32_16x16x32_bf16 a[32:35], a[220:223], v[152:155], a[32:35]
ds_read_b128 a[192:195], v210 offset:0
v_exp_f32 v108, v108
v_mfma_f32_16x16x32_bf16 a[36:39], a[220:223], v[156:159], a[36:39]
v_cvt_pk_bf16_f32 v126, v104, v105
v_cvt_pk_bf16_f32 v127, v106, v107
v_mfma_f32_16x16x32_bf16 a[40:43], a[224:227], v[140:143], a[40:43]
v_exp_f32 v109, v109
v_mfma_f32_16x16x32_bf16 a[44:47], a[224:227], v[144:147], a[44:47]
v_exp_f32 v110, v110
v_mfma_f32_16x16x32_bf16 a[48:51], a[224:227], v[148:151], a[48:51]
ds_read_b128 a[196:199], v211 offset:0
v_exp_f32 v111, v111
v_mfma_f32_16x16x32_bf16 a[52:55], a[224:227], v[152:155], a[52:55]
v_exp_f32 v112, v112
v_mfma_f32_16x16x32_bf16 a[56:59], a[224:227], v[156:159], a[56:59]
v_cvt_pk_bf16_f32 v130, v108, v109
v_cvt_pk_bf16_f32 v131, v110, v111
v_mfma_f32_16x16x32_bf16 a[60:63], a[228:231], v[140:143], a[60:63]
s_waitcnt vmcnt(4)
v_exp_f32 v113, v113
v_mfma_f32_16x16x32_bf16 a[64:67], a[228:231], v[144:147], a[64:67]
ds_read_b128 a[200:203], v208 offset:4096
v_exp_f32 v114, v114
v_mfma_f32_16x16x32_bf16 a[68:71], a[228:231], v[148:151], a[68:71]
s_add_u32 m0, s48, 114688
v_exp_f32 v115, v115
v_mfma_f32_16x16x32_bf16 a[72:75], a[228:231], v[152:155], a[72:75]
buffer_load_dwordx4 v221, s[20:23], s37 offen offset:1024 nt lds
v_exp_f32 v116, v116
v_mfma_f32_16x16x32_bf16 a[76:79], a[228:231], v[156:159], a[76:79]
v_cvt_pk_bf16_f32 v134, v112, v113
v_cvt_pk_bf16_f32 v135, v114, v115
v_mfma_f32_16x16x32_bf16 a[80:83], a[232:235], v[140:143], a[80:83]
ds_read_b128 a[204:207], v209 offset:4096
v_exp_f32 v117, v117
v_mfma_f32_16x16x32_bf16 a[84:87], a[232:235], v[144:147], a[84:87]
v_exp_f32 v118, v118
v_mfma_f32_16x16x32_bf16 a[88:91], a[232:235], v[148:151], a[88:91]
v_exp_f32 v119, v119
v_mfma_f32_16x16x32_bf16 a[92:95], a[232:235], v[152:155], a[92:95]
v_cvt_pk_bf16_f32 v138, v116, v117
v_cvt_pk_bf16_f32 v139, v118, v119
v_mfma_f32_16x16x32_bf16 a[96:99], a[232:235], v[156:159], a[96:99]
ds_read_b128 a[208:211], v210 offset:4096
v_mfma_f32_16x16x32_bf16 a[100:103], a[236:239], v[140:143], a[100:103]
v_mfma_f32_16x16x32_bf16 a[104:107], a[236:239], v[144:147], a[104:107]
s_waitcnt vmcnt(4)
v_mfma_f32_16x16x32_bf16 a[108:111], a[236:239], v[148:151], a[108:111]
v_mfma_f32_16x16x32_bf16 a[112:115], a[236:239], v[152:155], a[112:115]
ds_read_b128 a[212:215], v211 offset:4096
s_add_u32 m0, s48, 114688
v_mfma_f32_16x16x32_bf16 a[116:119], a[236:239], v[156:159], a[116:119]
buffer_load_dwordx4 v222, s[20:23], s37 offen offset:2048 nt lds
v_mfma_f32_16x16x32_bf16 a[120:123], a[240:243], v[140:143], a[120:123]
v_mfma_f32_16x16x32_bf16 a[124:127], a[240:243], v[144:147], a[124:127]
v_mfma_f32_16x16x32_bf16 a[128:131], a[240:243], v[148:151], a[128:131]
v_mfma_f32_16x16x32_bf16 a[132:135], a[240:243], v[152:155], a[132:135]
v_mfma_f32_16x16x32_bf16 a[136:139], a[240:243], v[156:159], a[136:139]
s_waitcnt vmcnt(4)
v_mfma_f32_16x16x32_bf16 a[140:143], a[244:247], v[140:143], a[140:143]
v_mfma_f32_16x16x32_bf16 a[144:147], a[244:247], v[144:147], a[144:147]
s_add_u32 m0, s48, 114688
v_mfma_f32_16x16x32_bf16 a[148:151], a[244:247], v[148:151], a[148:151]
buffer_load_dwordx4 v223, s[20:23], s37 offen offset:3072 nt lds
v_mfma_f32_16x16x32_bf16 a[152:155], a[244:247], v[152:155], a[152:155]
v_mfma_f32_16x16x32_bf16 a[156:159], a[244:247], v[156:159], a[156:159]
s_waitcnt lgkmcnt(0)
v_mfma_f32_16x16x32_bf16 v[80:83], a[184:187], v[0:3], v[160:163]
s_lshl_b32 s50, s28, 2
s_add_u32 s50, s50, 65536
v_and_b32 v217, 1, v226
v_mfma_f32_16x16x32_bf16 v[80:83], a[188:191], v[20:23], v[80:83]
ds_read_b64_tr_b16 a[216:217], v180 offset:32768
v_mul_u32_u24 v217, 10240, v217
v_bfe_u32 v216, v226, 1, 1
v_mfma_f32_16x16x32_bf16 v[80:83], a[192:195], v[40:43], v[80:83]
v_lshl_add_u32 v216, v216, 10, v217
v_add_u32 v216, s50, v216
v_mfma_f32_16x16x32_bf16 v[80:83], a[196:199], v[60:63], v[80:83]
ds_read_b64_tr_b16 a[218:219], v180 offset:36864
v_and_b32 v217, 0xfffffc00, v244
v_and_b32 v218, 3, v226
v_mfma_f32_16x16x32_bf16 v[84:87], a[196:199], v[64:67], v[164:167]
v_lshl_add_u32 v217, v218, 2, v217
v_add_u32 v217, 0x10000, v217
v_mfma_f32_16x16x32_bf16 v[84:87], a[192:195], v[44:47], v[84:87]
ds_read_b64_tr_b16 a[220:221], v181 offset:32768
v_mov_b32 v218, 0
v_mfma_f32_16x16x32_bf16 v[84:87], a[188:191], v[24:27], v[84:87]
v_mfma_f32_16x16x32_bf16 v[84:87], a[184:187], v[4:7], v[84:87]
ds_read_b64_tr_b16 a[222:223], v181 offset:36864
s_waitcnt vmcnt(4)
v_mfma_f32_16x16x32_bf16 v[88:91], a[184:187], v[8:11], v[168:171]
v_mfma_f32_16x16x32_bf16 v[88:91], a[188:191], v[28:31], v[88:91]
ds_read_b64_tr_b16 a[224:225], v182 offset:32768
s_add_u32 m0, s48, 0
s_xor_b32 s36, s3, 81920
v_mfma_f32_16x16x32_bf16 v[88:91], a[192:195], v[48:51], v[88:91]
buffer_load_dwordx4 v220, s[16:19], s36 offen offset:0 nt lds
v_mfma_f32_16x16x32_bf16 v[88:91], a[196:199], v[68:71], v[88:91]
ds_read_b64_tr_b16 a[226:227], v182 offset:36864
v_mfma_f32_16x16x32_bf16 v[92:95], a[196:199], v[72:75], v[172:175]
v_exp_f32 v80, v80
v_mfma_f32_16x16x32_bf16 v[92:95], a[192:195], v[52:55], v[92:95]
ds_read_b64_tr_b16 a[228:229], v183 offset:32768
v_exp_f32 v81, v81
v_mfma_f32_16x16x32_bf16 v[92:95], a[188:191], v[32:35], v[92:95]
v_exp_f32 v82, v82
v_mfma_f32_16x16x32_bf16 v[92:95], a[184:187], v[12:15], v[92:95]
ds_read_b64_tr_b16 a[230:231], v183 offset:36864
v_exp_f32 v83, v83
v_mfma_f32_16x16x32_bf16 v[96:99], a[184:187], v[16:19], v[176:179]
v_exp_f32 v84, v84
v_mfma_f32_16x16x32_bf16 v[96:99], a[188:191], v[36:39], v[96:99]
ds_read_b64_tr_b16 a[232:233], v184 offset:32768
v_cvt_pk_bf16_f32 v140, v80, v81
v_cvt_pk_bf16_f32 v141, v82, v83
v_mfma_f32_16x16x32_bf16 v[96:99], a[192:195], v[56:59], v[96:99]
v_exp_f32 v85, v85
v_mfma_f32_16x16x32_bf16 v[96:99], a[196:199], v[76:79], v[96:99]
ds_read_b64_tr_b16 a[234:235], v184 offset:36864
s_waitcnt vmcnt(4)
v_mfma_f32_16x16x32_bf16 v[100:103], a[200:203], v[0:3], v[160:163]
v_exp_f32 v86, v86
v_mfma_f32_16x16x32_bf16 v[100:103], a[204:207], v[20:23], v[100:103]
ds_read_b64_tr_b16 a[236:237], v185 offset:32768
s_add_u32 m0, s48, 0
v_mfma_f32_16x16x32_bf16 v[100:103], a[208:211], v[40:43], v[100:103]
buffer_load_dwordx4 v221, s[16:19], s36 offen offset:1024 nt lds
v_exp_f32 v87, v87
v_mfma_f32_16x16x32_bf16 v[100:103], a[212:215], v[60:63], v[100:103]
ds_read_b64_tr_b16 a[238:239], v185 offset:36864
v_exp_f32 v88, v88
v_mfma_f32_16x16x32_bf16 v[104:107], a[212:215], v[64:67], v[164:167]
v_cvt_pk_bf16_f32 v144, v84, v85
v_cvt_pk_bf16_f32 v145, v86, v87
v_mfma_f32_16x16x32_bf16 v[104:107], a[208:211], v[44:47], v[104:107]
ds_read_b64_tr_b16 a[240:241], v186 offset:32768
v_exp_f32 v89, v89
v_mfma_f32_16x16x32_bf16 v[104:107], a[204:207], v[24:27], v[104:107]
v_exp_f32 v90, v90
v_mfma_f32_16x16x32_bf16 v[104:107], a[200:203], v[4:7], v[104:107]
ds_read_b64_tr_b16 a[242:243], v186 offset:36864
v_exp_f32 v91, v91
v_mfma_f32_16x16x32_bf16 v[108:111], a[200:203], v[8:11], v[168:171]
v_exp_f32 v92, v92
v_mfma_f32_16x16x32_bf16 v[108:111], a[204:207], v[28:31], v[108:111]
ds_read_b64_tr_b16 a[244:245], v187 offset:32768
s_waitcnt vmcnt(4)
v_cvt_pk_bf16_f32 v148, v88, v89
v_mfma_f32_16x16x32_bf16 v[108:111], a[208:211], v[48:51], v[108:111]
v_cvt_pk_bf16_f32 v149, v90, v91
v_mfma_f32_16x16x32_bf16 v[108:111], a[212:215], v[68:71], v[108:111]
ds_read_b64_tr_b16 a[246:247], v187 offset:36864
s_add_u32 m0, s48, 0
v_mfma_f32_16x16x32_bf16 v[112:115], a[212:215], v[72:75], v[172:175]
buffer_load_dwordx4 v222, s[16:19], s36 offen offset:2048 nt lds
v_exp_f32 v93, v93
v_mfma_f32_16x16x32_bf16 v[112:115], a[208:211], v[52:55], v[112:115]
v_exp_f32 v94, v94
v_mfma_f32_16x16x32_bf16 v[112:115], a[204:207], v[32:35], v[112:115]
v_exp_f32 v95, v95
v_mfma_f32_16x16x32_bf16 v[112:115], a[200:203], v[12:15], v[112:115]
v_exp_f32 v96, v96
v_mfma_f32_16x16x32_bf16 v[116:119], a[200:203], v[16:19], v[176:179]
v_cvt_pk_bf16_f32 v152, v92, v93
v_cvt_pk_bf16_f32 v153, v94, v95
v_mfma_f32_16x16x32_bf16 v[116:119], a[204:207], v[36:39], v[116:119]
s_waitcnt vmcnt(4)
v_exp_f32 v97, v97
v_mfma_f32_16x16x32_bf16 v[116:119], a[208:211], v[56:59], v[116:119]
v_exp_f32 v98, v98
v_mfma_f32_16x16x32_bf16 v[116:119], a[212:215], v[76:79], v[116:119]
s_add_u32 m0, s48, 0
v_exp_f32 v99, v99
v_mfma_f32_16x16x32_bf16 a[160:163], a[180:183], v[120:123], a[160:163]
buffer_load_dwordx4 v223, s[16:19], s36 offen offset:3072 nt lds
v_cvt_pk_bf16_f32 v156, v96, v97
v_cvt_pk_bf16_f32 v157, v98, v99
v_mfma_f32_16x16x32_bf16 a[164:167], a[180:183], v[124:127], a[164:167]
v_exp_f32 v100, v100
v_mfma_f32_16x16x32_bf16 a[168:171], a[180:183], v[128:131], a[168:171]
v_exp_f32 v101, v101
v_mfma_f32_16x16x32_bf16 a[172:175], a[180:183], v[132:135], a[172:175]
s_waitcnt lgkmcnt(0)
s_barrier
v_mfma_f32_16x16x32_bf16 a[176:179], a[180:183], v[136:139], a[176:179]
v_exp_f32 v102, v102
v_mfma_f32_16x16x32_bf16 a[0:3], a[216:219], v[120:123], a[0:3]
ds_read_b128 a[184:187], v208 offset:32768
v_exp_f32 v103, v103
v_mfma_f32_16x16x32_bf16 a[4:7], a[216:219], v[124:127], a[4:7]
v_exp_f32 v104, v104
v_mfma_f32_16x16x32_bf16 a[8:11], a[216:219], v[128:131], a[8:11]
v_cvt_pk_bf16_f32 v142, v100, v101
v_cvt_pk_bf16_f32 v143, v102, v103
v_mfma_f32_16x16x32_bf16 a[12:15], a[216:219], v[132:135], a[12:15]
v_exp_f32 v105, v105
v_mfma_f32_16x16x32_bf16 a[16:19], a[216:219], v[136:139], a[16:19]
ds_read_b128 a[188:191], v209 offset:32768
v_exp_f32 v106, v106
v_mfma_f32_16x16x32_bf16 a[20:23], a[220:223], v[120:123], a[20:23]
v_exp_f32 v107, v107
v_mfma_f32_16x16x32_bf16 a[24:27], a[220:223], v[124:127], a[24:27]
s_waitcnt vmcnt(4)
v_exp_f32 v108, v108
v_mfma_f32_16x16x32_bf16 a[28:31], a[220:223], v[128:131], a[28:31]
v_cvt_pk_bf16_f32 v146, v104, v105
v_cvt_pk_bf16_f32 v147, v106, v107
v_mfma_f32_16x16x32_bf16 a[32:35], a[220:223], v[132:135], a[32:35]
ds_read_b128 a[192:195], v210 offset:32768
s_add_u32 m0, s48, 147456
s_xor_b32 s37, s3, 73728
v_mfma_f32_16x16x32_bf16 a[36:39], a[220:223], v[136:139], a[36:39]
buffer_load_dwordx4 v220, s[20:23], s37 offen offset:0 nt lds
v_exp_f32 v109, v109
v_mfma_f32_16x16x32_bf16 a[40:43], a[224:227], v[120:123], a[40:43]
v_exp_f32 v110, v110
v_mfma_f32_16x16x32_bf16 a[44:47], a[224:227], v[124:127], a[44:47]
v_exp_f32 v111, v111
v_mfma_f32_16x16x32_bf16 a[48:51], a[224:227], v[128:131], a[48:51]
ds_read_b128 a[196:199], v211 offset:32768
v_exp_f32 v112, v112
v_mfma_f32_16x16x32_bf16 a[52:55], a[224:227], v[132:135], a[52:55]
v_cvt_pk_bf16_f32 v150, v108, v109
v_cvt_pk_bf16_f32 v151, v110, v111
v_mfma_f32_16x16x32_bf16 a[56:59], a[224:227], v[136:139], a[56:59]
v_exp_f32 v113, v113
v_mfma_f32_16x16x32_bf16 a[60:63], a[228:231], v[120:123], a[60:63]
v_exp_f32 v114, v114
v_mfma_f32_16x16x32_bf16 a[64:67], a[228:231], v[124:127], a[64:67]
ds_read_b128 a[200:203], v208 offset:36864
s_waitcnt vmcnt(4)
v_mfma_f32_16x16x32_bf16 a[68:71], a[228:231], v[128:131], a[68:71]
v_exp_f32 v115, v115
v_mfma_f32_16x16x32_bf16 a[72:75], a[228:231], v[132:135], a[72:75]
s_add_u32 m0, s48, 147456
v_exp_f32 v116, v116
v_mfma_f32_16x16x32_bf16 a[76:79], a[228:231], v[136:139], a[76:79]
buffer_load_dwordx4 v221, s[20:23], s37 offen offset:1024 nt lds
v_cvt_pk_bf16_f32 v154, v112, v113
v_cvt_pk_bf16_f32 v155, v114, v115
v_mfma_f32_16x16x32_bf16 a[80:83], a[232:235], v[120:123], a[80:83]
ds_read_b128 a[204:207], v209 offset:36864
v_exp_f32 v117, v117
v_mfma_f32_16x16x32_bf16 a[84:87], a[232:235], v[124:127], a[84:87]
v_exp_f32 v118, v118
v_mfma_f32_16x16x32_bf16 a[88:91], a[232:235], v[128:131], a[88:91]
v_exp_f32 v119, v119
v_mfma_f32_16x16x32_bf16 a[92:95], a[232:235], v[132:135], a[92:95]
v_cvt_pk_bf16_f32 v158, v116, v117
v_cvt_pk_bf16_f32 v159, v118, v119
v_mfma_f32_16x16x32_bf16 a[96:99], a[232:235], v[136:139], a[96:99]
ds_read_b128 a[208:211], v210 offset:36864
v_mfma_f32_16x16x32_bf16 a[100:103], a[236:239], v[120:123], a[100:103]
v_mfma_f32_16x16x32_bf16 a[104:107], a[236:239], v[124:127], a[104:107]
v_mfma_f32_16x16x32_bf16 a[108:111], a[236:239], v[128:131], a[108:111]
s_waitcnt vmcnt(4)
v_mfma_f32_16x16x32_bf16 a[112:115], a[236:239], v[132:135], a[112:115]
ds_read_b128 a[212:215], v211 offset:36864
v_mfma_f32_16x16x32_bf16 a[116:119], a[236:239], v[136:139], a[116:119]
s_add_u32 m0, s48, 147456
v_mfma_f32_16x16x32_bf16 a[120:123], a[240:243], v[120:123], a[120:123]
buffer_load_dwordx4 v222, s[20:23], s37 offen offset:2048 nt lds
v_mfma_f32_16x16x32_bf16 a[124:127], a[240:243], v[124:127], a[124:127]
v_mfma_f32_16x16x32_bf16 a[128:131], a[240:243], v[128:131], a[128:131]
v_mfma_f32_16x16x32_bf16 a[132:135], a[240:243], v[132:135], a[132:135]
v_mfma_f32_16x16x32_bf16 a[136:139], a[240:243], v[136:139], a[136:139]
v_mfma_f32_16x16x32_bf16 a[140:143], a[244:247], v[120:123], a[140:143]
v_mfma_f32_16x16x32_bf16 a[144:147], a[244:247], v[124:127], a[144:147]
v_mfma_f32_16x16x32_bf16 a[148:151], a[244:247], v[128:131], a[148:151]
v_mfma_f32_16x16x32_bf16 a[152:155], a[244:247], v[132:135], a[152:155]
v_mfma_f32_16x16x32_bf16 a[156:159], a[244:247], v[136:139], a[156:159]
s_waitcnt lgkmcnt(0)
v_mfma_f32_16x16x32_bf16 v[80:83], a[184:187], v[0:3], v[160:163]
s_waitcnt vmcnt(4)
v_mfma_f32_16x16x32_bf16 v[80:83], a[188:191], v[20:23], v[80:83]
ds_read_b64_tr_b16 a[216:217], v188 offset:0
s_add_u32 m0, s48, 147456
v_mfma_f32_16x16x32_bf16 v[80:83], a[192:195], v[40:43], v[80:83]
buffer_load_dwordx4 v223, s[20:23], s37 offen offset:3072 nt lds
v_mfma_f32_16x16x32_bf16 v[80:83], a[196:199], v[60:63], v[80:83]
ds_read_b64_tr_b16 a[218:219], v188 offset:4096
v_mfma_f32_16x16x32_bf16 v[84:87], a[196:199], v[64:67], v[164:167]
v_mfma_f32_16x16x32_bf16 v[84:87], a[192:195], v[44:47], v[84:87]
ds_read_b64_tr_b16 a[220:221], v189 offset:0
v_mfma_f32_16x16x32_bf16 v[84:87], a[188:191], v[24:27], v[84:87]
v_mfma_f32_16x16x32_bf16 v[84:87], a[184:187], v[4:7], v[84:87]
ds_read_b64_tr_b16 a[222:223], v189 offset:4096
v_mfma_f32_16x16x32_bf16 v[88:91], a[184:187], v[8:11], v[168:171]
v_mfma_f32_16x16x32_bf16 v[88:91], a[188:191], v[28:31], v[88:91]
ds_read_b64_tr_b16 a[224:225], v190 offset:0
s_waitcnt vmcnt(4)
v_mfma_f32_16x16x32_bf16 v[88:91], a[192:195], v[48:51], v[88:91]
v_mfma_f32_16x16x32_bf16 v[88:91], a[196:199], v[68:71], v[88:91]
ds_read_b64_tr_b16 a[226:227], v190 offset:4096
s_add_u32 m0, s48, 32768
s_xor_b32 s36, s3, 90112
v_mfma_f32_16x16x32_bf16 v[92:95], a[196:199], v[72:75], v[172:175]
buffer_load_dwordx4 v220, s[16:19], s36 offen offset:0 nt lds
v_exp_f32 v80, v80
v_mfma_f32_16x16x32_bf16 v[92:95], a[192:195], v[52:55], v[92:95]
ds_read_b64_tr_b16 a[228:229], v191 offset:0
v_exp_f32 v81, v81
v_mfma_f32_16x16x32_bf16 v[92:95], a[188:191], v[32:35], v[92:95]
v_exp_f32 v82, v82
v_mfma_f32_16x16x32_bf16 v[92:95], a[184:187], v[12:15], v[92:95]
ds_read_b64_tr_b16 a[230:231], v191 offset:4096
v_exp_f32 v83, v83
v_mfma_f32_16x16x32_bf16 v[96:99], a[184:187], v[16:19], v[176:179]
v_exp_f32 v84, v84
v_mfma_f32_16x16x32_bf16 v[96:99], a[188:191], v[36:39], v[96:99]
ds_read_b64_tr_b16 a[232:233], v192 offset:0
v_cvt_pk_bf16_f32 v120, v80, v81
v_cvt_pk_bf16_f32 v121, v82, v83
v_mfma_f32_16x16x32_bf16 v[96:99], a[192:195], v[56:59], v[96:99]
v_exp_f32 v85, v85
v_mfma_f32_16x16x32_bf16 v[96:99], a[196:199], v[76:79], v[96:99]
ds_read_b64_tr_b16 a[234:235], v192 offset:4096
s_waitcnt vmcnt(4)
v_mfma_f32_16x16x32_bf16 v[100:103], a[200:203], v[0:3], v[160:163]
v_exp_f32 v86, v86
v_mfma_f32_16x16x32_bf16 v[100:103], a[204:207], v[20:23], v[100:103]
ds_read_b64_tr_b16 a[236:237], v193 offset:0
s_add_u32 m0, s48, 32768
v_mfma_f32_16x16x32_bf16 v[100:103], a[208:211], v[40:43], v[100:103]
buffer_load_dwordx4 v221, s[16:19], s36 offen offset:1024 nt lds
v_exp_f32 v87, v87
v_mfma_f32_16x16x32_bf16 v[100:103], a[212:215], v[60:63], v[100:103]
ds_read_b64_tr_b16 a[238:239], v193 offset:4096
v_exp_f32 v88, v88
v_mfma_f32_16x16x32_bf16 v[104:107], a[212:215], v[64:67], v[164:167]
v_cvt_pk_bf16_f32 v124, v84, v85
v_cvt_pk_bf16_f32 v125, v86, v87
v_mfma_f32_16x16x32_bf16 v[104:107], a[208:211], v[44:47], v[104:107]
ds_read_b64_tr_b16 a[240:241], v194 offset:0
v_exp_f32 v89, v89
v_mfma_f32_16x16x32_bf16 v[104:107], a[204:207], v[24:27], v[104:107]
v_exp_f32 v90, v90
v_mfma_f32_16x16x32_bf16 v[104:107], a[200:203], v[4:7], v[104:107]
ds_read_b64_tr_b16 a[242:243], v194 offset:4096
v_exp_f32 v91, v91
v_mfma_f32_16x16x32_bf16 v[108:111], a[200:203], v[8:11], v[168:171]
v_exp_f32 v92, v92
v_mfma_f32_16x16x32_bf16 v[108:111], a[204:207], v[28:31], v[108:111]
ds_read_b64_tr_b16 a[244:245], v195 offset:0
v_cvt_pk_bf16_f32 v128, v88, v89
v_cvt_pk_bf16_f32 v129, v90, v91
v_mfma_f32_16x16x32_bf16 v[108:111], a[208:211], v[48:51], v[108:111]
s_waitcnt vmcnt(4)
v_exp_f32 v93, v93
v_mfma_f32_16x16x32_bf16 v[108:111], a[212:215], v[68:71], v[108:111]
ds_read_b64_tr_b16 a[246:247], v195 offset:4096
v_exp_f32 v94, v94
v_mfma_f32_16x16x32_bf16 v[112:115], a[212:215], v[72:75], v[172:175]
s_add_u32 m0, s48, 32768
v_exp_f32 v95, v95
v_mfma_f32_16x16x32_bf16 v[112:115], a[208:211], v[52:55], v[112:115]
buffer_load_dwordx4 v222, s[16:19], s36 offen offset:2048 nt lds
v_exp_f32 v96, v96
v_mfma_f32_16x16x32_bf16 v[112:115], a[204:207], v[32:35], v[112:115]
v_cvt_pk_bf16_f32 v132, v92, v93
v_cvt_pk_bf16_f32 v133, v94, v95
v_mfma_f32_16x16x32_bf16 v[112:115], a[200:203], v[12:15], v[112:115]
v_exp_f32 v97, v97
v_mfma_f32_16x16x32_bf16 v[116:119], a[200:203], v[16:19], v[176:179]
v_exp_f32 v98, v98
v_mfma_f32_16x16x32_bf16 v[116:119], a[204:207], v[36:39], v[116:119]
v_exp_f32 v99, v99
v_mfma_f32_16x16x32_bf16 v[116:119], a[208:211], v[56:59], v[116:119]
v_cvt_pk_bf16_f32 v136, v96, v97
v_cvt_pk_bf16_f32 v137, v98, v99
v_mfma_f32_16x16x32_bf16 v[116:119], a[212:215], v[76:79], v[116:119]
v_exp_f32 v100, v100
v_mfma_f32_16x16x32_bf16 a[160:163], a[180:183], v[140:143], a[160:163]
v_exp_f32 v101, v101
v_mfma_f32_16x16x32_bf16 a[164:167], a[180:183], v[144:147], a[164:167]
v_exp_f32 v102, v102
v_mfma_f32_16x16x32_bf16 a[168:171], a[180:183], v[148:151], a[168:171]
v_exp_f32 v103, v103
v_mfma_f32_16x16x32_bf16 a[172:175], a[180:183], v[152:155], a[172:175]
s_waitcnt lgkmcnt(0)
s_barrier
s_waitcnt vmcnt(4)
v_mfma_f32_16x16x32_bf16 a[176:179], a[180:183], v[156:159], a[176:179]
v_exp_f32 v104, v104
v_mfma_f32_16x16x32_bf16 a[0:3], a[216:219], v[140:143], a[0:3]
ds_read_b128 a[184:187], v212 offset:0
s_add_u32 m0, s48, 32768
v_cvt_pk_bf16_f32 v122, v100, v101
v_mfma_f32_16x16x32_bf16 a[4:7], a[216:219], v[144:147], a[4:7]
buffer_load_dwordx4 v223, s[16:19], s36 offen offset:3072 nt lds
v_cvt_pk_bf16_f32 v123, v102, v103
v_mfma_f32_16x16x32_bf16 a[8:11], a[216:219], v[148:151], a[8:11]
v_exp_f32 v105, v105
v_mfma_f32_16x16x32_bf16 a[12:15], a[216:219], v[152:155], a[12:15]
v_exp_f32 v106, v106
v_mfma_f32_16x16x32_bf16 a[16:19], a[216:219], v[156:159], a[16:19]
ds_read_b128 a[188:191], v213 offset:0
v_exp_f32 v107, v107
v_mfma_f32_16x16x32_bf16 a[20:23], a[220:223], v[140:143], a[20:23]
v_exp_f32 v108, v108
v_mfma_f32_16x16x32_bf16 a[24:27], a[220:223], v[144:147], a[24:27]
s_waitcnt vmcnt(4)
v_cvt_pk_bf16_f32 v126, v104, v105
v_cvt_pk_bf16_f32 v127, v106, v107
v_mfma_f32_16x16x32_bf16 a[28:31], a[220:223], v[148:151], a[28:31]
v_exp_f32 v109, v109
v_mfma_f32_16x16x32_bf16 a[32:35], a[220:223], v[152:155], a[32:35]
ds_read_b128 a[192:195], v214 offset:0
s_add_u32 m0, s48, 16384
s_xor_b32 s37, s3, 81920
v_mfma_f32_16x16x32_bf16 a[36:39], a[220:223], v[156:159], a[36:39]
buffer_load_dwordx4 v220, s[20:23], s37 offen offset:0 nt lds
v_exp_f32 v110, v110
v_mfma_f32_16x16x32_bf16 a[40:43], a[224:227], v[140:143], a[40:43]
v_exp_f32 v111, v111
v_mfma_f32_16x16x32_bf16 a[44:47], a[224:227], v[144:147], a[44:47]
v_exp_f32 v112, v112
v_mfma_f32_16x16x32_bf16 a[48:51], a[224:227], v[148:151], a[48:51]
ds_read_b128 a[196:199], v215 offset:0
v_cvt_pk_bf16_f32 v130, v108, v109
v_cvt_pk_bf16_f32 v131, v110, v111
v_mfma_f32_16x16x32_bf16 a[52:55], a[224:227], v[152:155], a[52:55]
v_exp_f32 v113, v113
v_mfma_f32_16x16x32_bf16 a[56:59], a[224:227], v[156:159], a[56:59]
v_exp_f32 v114, v114
v_mfma_f32_16x16x32_bf16 a[60:63], a[228:231], v[140:143], a[60:63]
v_exp_f32 v115, v115
v_mfma_f32_16x16x32_bf16 a[64:67], a[228:231], v[144:147], a[64:67]
ds_read_b128 a[200:203], v212 offset:4096
v_exp_f32 v116, v116
v_mfma_f32_16x16x32_bf16 a[68:71], a[228:231], v[148:151], a[68:71]
v_cvt_pk_bf16_f32 v134, v112, v113
v_cvt_pk_bf16_f32 v135, v114, v115
v_mfma_f32_16x16x32_bf16 a[72:75], a[228:231], v[152:155], a[72:75]
s_waitcnt vmcnt(4)
v_exp_f32 v117, v117
v_mfma_f32_16x16x32_bf16 a[76:79], a[228:231], v[156:159], a[76:79]
v_exp_f32 v118, v118
v_mfma_f32_16x16x32_bf16 a[80:83], a[232:235], v[140:143], a[80:83]
ds_read_b128 a[204:207], v213 offset:4096
s_add_u32 m0, s48, 16384
v_mfma_f32_16x16x32_bf16 a[84:87], a[232:235], v[144:147], a[84:87]
buffer_load_dwordx4 v221, s[20:23], s37 offen offset:1024 nt lds
v_exp_f32 v119, v119
v_mfma_f32_16x16x32_bf16 a[88:91], a[232:235], v[148:151], a[88:91]
v_cvt_pk_bf16_f32 v138, v116, v117
v_cvt_pk_bf16_f32 v139, v118, v119
v_mfma_f32_16x16x32_bf16 a[92:95], a[232:235], v[152:155], a[92:95]
v_mfma_f32_16x16x32_bf16 a[96:99], a[232:235], v[156:159], a[96:99]
ds_read_b128 a[208:211], v214 offset:4096
v_mfma_f32_16x16x32_bf16 a[100:103], a[236:239], v[140:143], a[100:103]
v_mfma_f32_16x16x32_bf16 a[104:107], a[236:239], v[144:147], a[104:107]
v_mfma_f32_16x16x32_bf16 a[108:111], a[236:239], v[148:151], a[108:111]
v_mfma_f32_16x16x32_bf16 a[112:115], a[236:239], v[152:155], a[112:115]
ds_read_b128 a[212:215], v215 offset:4096
s_waitcnt vmcnt(4)
v_mfma_f32_16x16x32_bf16 a[116:119], a[236:239], v[156:159], a[116:119]
v_mfma_f32_16x16x32_bf16 a[120:123], a[240:243], v[140:143], a[120:123]
s_add_u32 m0, s48, 16384
v_mfma_f32_16x16x32_bf16 a[124:127], a[240:243], v[144:147], a[124:127]
buffer_load_dwordx4 v222, s[20:23], s37 offen offset:2048 nt lds
v_mfma_f32_16x16x32_bf16 a[128:131], a[240:243], v[148:151], a[128:131]
v_mfma_f32_16x16x32_bf16 a[132:135], a[240:243], v[152:155], a[132:135]
v_mfma_f32_16x16x32_bf16 a[136:139], a[240:243], v[156:159], a[136:139]
v_mfma_f32_16x16x32_bf16 a[140:143], a[244:247], v[140:143], a[140:143]
v_mfma_f32_16x16x32_bf16 a[144:147], a[244:247], v[144:147], a[144:147]
v_mfma_f32_16x16x32_bf16 a[148:151], a[244:247], v[148:151], a[148:151]
v_mfma_f32_16x16x32_bf16 a[152:155], a[244:247], v[152:155], a[152:155]
v_mfma_f32_16x16x32_bf16 a[156:159], a[244:247], v[156:159], a[156:159]
s_waitcnt lgkmcnt(0)
v_mfma_f32_16x16x32_bf16 v[80:83], a[184:187], v[0:3], v[160:163]
s_waitcnt vmcnt(4)
v_mfma_f32_16x16x32_bf16 v[80:83], a[188:191], v[20:23], v[80:83]
ds_read_b64_tr_b16 a[216:217], v188 offset:32768
s_add_u32 m0, s48, 16384
v_mfma_f32_16x16x32_bf16 v[80:83], a[192:195], v[40:43], v[80:83]
buffer_load_dwordx4 v223, s[20:23], s37 offen offset:3072 nt lds
v_mfma_f32_16x16x32_bf16 v[80:83], a[196:199], v[60:63], v[80:83]
ds_read_b64_tr_b16 a[218:219], v188 offset:36864
v_mfma_f32_16x16x32_bf16 v[84:87], a[196:199], v[64:67], v[164:167]
v_mfma_f32_16x16x32_bf16 v[84:87], a[192:195], v[44:47], v[84:87]
ds_read_b64_tr_b16 a[220:221], v189 offset:32768
v_mfma_f32_16x16x32_bf16 v[84:87], a[188:191], v[24:27], v[84:87]
v_mfma_f32_16x16x32_bf16 v[84:87], a[184:187], v[4:7], v[84:87]
ds_read_b64_tr_b16 a[222:223], v189 offset:36864
v_mfma_f32_16x16x32_bf16 v[88:91], a[184:187], v[8:11], v[168:171]
v_mfma_f32_16x16x32_bf16 v[88:91], a[188:191], v[28:31], v[88:91]
ds_read_b64_tr_b16 a[224:225], v190 offset:32768
s_waitcnt vmcnt(4)
v_mfma_f32_16x16x32_bf16 v[88:91], a[192:195], v[48:51], v[88:91]
v_mfma_f32_16x16x32_bf16 v[88:91], a[196:199], v[68:71], v[88:91]
ds_read_b64_tr_b16 a[226:227], v190 offset:36864
s_add_u32 m0, s48, 65536
s_xor_b32 s36, s3, 98304
v_mfma_f32_16x16x32_bf16 v[92:95], a[196:199], v[72:75], v[172:175]
buffer_load_dwordx4 v220, s[16:19], s36 offen offset:0 nt lds
v_exp_f32 v80, v80
v_mfma_f32_16x16x32_bf16 v[92:95], a[192:195], v[52:55], v[92:95]
ds_read_b64_tr_b16 a[228:229], v191 offset:32768
v_exp_f32 v81, v81
v_mfma_f32_16x16x32_bf16 v[92:95], a[188:191], v[32:35], v[92:95]
v_exp_f32 v82, v82
v_mfma_f32_16x16x32_bf16 v[92:95], a[184:187], v[12:15], v[92:95]
ds_read_b64_tr_b16 a[230:231], v191 offset:36864
v_exp_f32 v83, v83
v_mfma_f32_16x16x32_bf16 v[96:99], a[184:187], v[16:19], v[176:179]
v_exp_f32 v84, v84
v_mfma_f32_16x16x32_bf16 v[96:99], a[188:191], v[36:39], v[96:99]
ds_read_b64_tr_b16 a[232:233], v192 offset:32768
v_cvt_pk_bf16_f32 v140, v80, v81
v_cvt_pk_bf16_f32 v141, v82, v83
v_mfma_f32_16x16x32_bf16 v[96:99], a[192:195], v[56:59], v[96:99]
v_exp_f32 v85, v85
v_mfma_f32_16x16x32_bf16 v[96:99], a[196:199], v[76:79], v[96:99]
ds_read_b64_tr_b16 a[234:235], v192 offset:36864
v_exp_f32 v86, v86
v_mfma_f32_16x16x32_bf16 v[100:103], a[200:203], v[0:3], v[160:163]
v_exp_f32 v87, v87
v_mfma_f32_16x16x32_bf16 v[100:103], a[204:207], v[20:23], v[100:103]
ds_read_b64_tr_b16 a[236:237], v193 offset:32768
s_waitcnt vmcnt(4)
v_mfma_f32_16x16x32_bf16 v[100:103], a[208:211], v[40:43], v[100:103]
v_exp_f32 v88, v88
v_mfma_f32_16x16x32_bf16 v[100:103], a[212:215], v[60:63], v[100:103]
ds_read_b64_tr_b16 a[238:239], v193 offset:36864
s_add_u32 m0, s48, 65536
v_cvt_pk_bf16_f32 v144, v84, v85
v_mfma_f32_16x16x32_bf16 v[104:107], a[212:215], v[64:67], v[164:167]
buffer_load_dwordx4 v221, s[16:19], s36 offen offset:1024 nt lds
v_cvt_pk_bf16_f32 v145, v86, v87
v_mfma_f32_16x16x32_bf16 v[104:107], a[208:211], v[44:47], v[104:107]
ds_read_b64_tr_b16 a[240:241], v194 offset:32768
v_exp_f32 v89, v89
v_mfma_f32_16x16x32_bf16 v[104:107], a[204:207], v[24:27], v[104:107]
v_exp_f32 v90, v90
v_mfma_f32_16x16x32_bf16 v[104:107], a[200:203], v[4:7], v[104:107]
ds_read_b64_tr_b16 a[242:243], v194 offset:36864
v_exp_f32 v91, v91
v_mfma_f32_16x16x32_bf16 v[108:111], a[200:203], v[8:11], v[168:171]
v_exp_f32 v92, v92
v_mfma_f32_16x16x32_bf16 v[108:111], a[204:207], v[28:31], v[108:111]
ds_read_b64_tr_b16 a[244:245], v195 offset:32768
v_cvt_pk_bf16_f32 v148, v88, v89
v_cvt_pk_bf16_f32 v149, v90, v91
v_mfma_f32_16x16x32_bf16 v[108:111], a[208:211], v[48:51], v[108:111]
v_exp_f32 v93, v93
v_mfma_f32_16x16x32_bf16 v[108:111], a[212:215], v[68:71], v[108:111]
ds_read_b64_tr_b16 a[246:247], v195 offset:36864
s_waitcnt vmcnt(4)
v_mfma_f32_16x16x32_bf16 v[112:115], a[212:215], v[72:75], v[172:175]
v_exp_f32 v94, v94
v_mfma_f32_16x16x32_bf16 v[112:115], a[208:211], v[52:55], v[112:115]
s_add_u32 m0, s48, 65536
v_exp_f32 v95, v95
v_mfma_f32_16x16x32_bf16 v[112:115], a[204:207], v[32:35], v[112:115]
buffer_load_dwordx4 v222, s[16:19], s36 offen offset:2048 nt lds
v_exp_f32 v96, v96
v_mfma_f32_16x16x32_bf16 v[112:115], a[200:203], v[12:15], v[112:115]
v_cvt_pk_bf16_f32 v152, v92, v93
v_cvt_pk_bf16_f32 v153, v94, v95
v_mfma_f32_16x16x32_bf16 v[116:119], a[200:203], v[16:19], v[176:179]
v_exp_f32 v97, v97
v_mfma_f32_16x16x32_bf16 v[116:119], a[204:207], v[36:39], v[116:119]
v_exp_f32 v98, v98
v_mfma_f32_16x16x32_bf16 v[116:119], a[208:211], v[56:59], v[116:119]
v_exp_f32 v99, v99
v_mfma_f32_16x16x32_bf16 v[116:119], a[212:215], v[76:79], v[116:119]
v_cvt_pk_bf16_f32 v156, v96, v97
v_cvt_pk_bf16_f32 v157, v98, v99
v_mfma_f32_16x16x32_bf16 a[160:163], a[180:183], v[120:123], a[160:163]
v_exp_f32 v100, v100
v_mfma_f32_16x16x32_bf16 a[164:167], a[180:183], v[124:127], a[164:167]
v_exp_f32 v101, v101
v_mfma_f32_16x16x32_bf16 a[168:171], a[180:183], v[128:131], a[168:171]
v_exp_f32 v102, v102
v_mfma_f32_16x16x32_bf16 a[172:175], a[180:183], v[132:135], a[172:175]
s_waitcnt lgkmcnt(0)
s_barrier
s_waitcnt vmcnt(4)
v_mfma_f32_16x16x32_bf16 a[176:179], a[180:183], v[136:139], a[176:179]
v_exp_f32 v103, v103
v_mfma_f32_16x16x32_bf16 a[0:3], a[216:219], v[120:123], a[0:3]
ds_read_b128 a[184:187], v204 offset:0
s_add_u32 m0, s48, 65536
v_mfma_f32_16x16x32_bf16 a[4:7], a[216:219], v[124:127], a[4:7]
buffer_load_dwordx4 v223, s[16:19], s36 offen offset:3072 nt lds
v_exp_f32 v104, v104
v_mfma_f32_16x16x32_bf16 a[8:11], a[216:219], v[128:131], a[8:11]
v_cvt_pk_bf16_f32 v142, v100, v101
v_cvt_pk_bf16_f32 v143, v102, v103
v_mfma_f32_16x16x32_bf16 a[12:15], a[216:219], v[132:135], a[12:15]
v_exp_f32 v105, v105
v_mfma_f32_16x16x32_bf16 a[16:19], a[216:219], v[136:139], a[16:19]
ds_read_b128 a[188:191], v205 offset:0
v_exp_f32 v106, v106
v_mfma_f32_16x16x32_bf16 a[20:23], a[220:223], v[120:123], a[20:23]
v_exp_f32 v107, v107
v_mfma_f32_16x16x32_bf16 a[24:27], a[220:223], v[124:127], a[24:27]
v_exp_f32 v108, v108
v_mfma_f32_16x16x32_bf16 a[28:31], a[220:223], v[128:131], a[28:31]
s_waitcnt vmcnt(4)
v_cvt_pk_bf16_f32 v146, v104, v105
v_cvt_pk_bf16_f32 v147, v106, v107
v_mfma_f32_16x16x32_bf16 a[32:35], a[220:223], v[132:135], a[32:35]
ds_read_b128 a[192:195], v206 offset:0
v_exp_f32 v109, v109
v_mfma_f32_16x16x32_bf16 a[36:39], a[220:223], v[136:139], a[36:39]
s_add_u32 m0, s48, 49152
s_xor_b32 s37, s3, 90112
v_mfma_f32_16x16x32_bf16 a[40:43], a[224:227], v[120:123], a[40:43]
buffer_load_dwordx4 v220, s[20:23], s37 offen offset:0 nt lds
v_exp_f32 v110, v110
v_mfma_f32_16x16x32_bf16 a[44:47], a[224:227], v[124:127], a[44:47]
v_exp_f32 v111, v111
v_mfma_f32_16x16x32_bf16 a[48:51], a[224:227], v[128:131], a[48:51]
ds_read_b128 a[196:199], v207 offset:0
v_exp_f32 v112, v112
v_mfma_f32_16x16x32_bf16 a[52:55], a[224:227], v[132:135], a[52:55]
v_cvt_pk_bf16_f32 v150, v108, v109
v_cvt_pk_bf16_f32 v151, v110, v111
v_mfma_f32_16x16x32_bf16 a[56:59], a[224:227], v[136:139], a[56:59]
v_exp_f32 v113, v113
v_mfma_f32_16x16x32_bf16 a[60:63], a[228:231], v[120:123], a[60:63]
v_exp_f32 v114, v114
v_mfma_f32_16x16x32_bf16 a[64:67], a[228:231], v[124:127], a[64:67]
ds_read_b128 a[200:203], v204 offset:4096
v_exp_f32 v115, v115
v_mfma_f32_16x16x32_bf16 a[68:71], a[228:231], v[128:131], a[68:71]
v_exp_f32 v116, v116
v_mfma_f32_16x16x32_bf16 a[72:75], a[228:231], v[132:135], a[72:75]
s_waitcnt vmcnt(4)
v_cvt_pk_bf16_f32 v154, v112, v113
v_cvt_pk_bf16_f32 v155, v114, v115
v_mfma_f32_16x16x32_bf16 a[76:79], a[228:231], v[136:139], a[76:79]
v_exp_f32 v117, v117
v_mfma_f32_16x16x32_bf16 a[80:83], a[232:235], v[120:123], a[80:83]
ds_read_b128 a[204:207], v205 offset:4096
s_add_u32 m0, s48, 49152
v_mfma_f32_16x16x32_bf16 a[84:87], a[232:235], v[124:127], a[84:87]
buffer_load_dwordx4 v221, s[20:23], s37 offen offset:1024 nt lds
v_exp_f32 v118, v118
v_mfma_f32_16x16x32_bf16 a[88:91], a[232:235], v[128:131], a[88:91]
v_exp_f32 v119, v119
v_mfma_f32_16x16x32_bf16 a[92:95], a[232:235], v[132:135], a[92:95]
v_cvt_pk_bf16_f32 v158, v116, v117
v_cvt_pk_bf16_f32 v159, v118, v119
v_mfma_f32_16x16x32_bf16 a[96:99], a[232:235], v[136:139], a[96:99]
ds_read_b128 a[208:211], v206 offset:4096
v_mfma_f32_16x16x32_bf16 a[100:103], a[236:239], v[120:123], a[100:103]
v_mfma_f32_16x16x32_bf16 a[104:107], a[236:239], v[124:127], a[104:107]
v_mfma_f32_16x16x32_bf16 a[108:111], a[236:239], v[128:131], a[108:111]
v_mfma_f32_16x16x32_bf16 a[112:115], a[236:239], v[132:135], a[112:115]
ds_read_b128 a[212:215], v207 offset:4096
v_mfma_f32_16x16x32_bf16 a[116:119], a[236:239], v[136:139], a[116:119]
s_waitcnt vmcnt(4)
v_mfma_f32_16x16x32_bf16 a[120:123], a[240:243], v[120:123], a[120:123]
v_mfma_f32_16x16x32_bf16 a[124:127], a[240:243], v[124:127], a[124:127]
s_add_u32 m0, s48, 49152
v_mfma_f32_16x16x32_bf16 a[128:131], a[240:243], v[128:131], a[128:131]
buffer_load_dwordx4 v222, s[20:23], s37 offen offset:2048 nt lds
v_mfma_f32_16x16x32_bf16 a[132:135], a[240:243], v[132:135], a[132:135]
v_mfma_f32_16x16x32_bf16 a[136:139], a[240:243], v[136:139], a[136:139]
v_mfma_f32_16x16x32_bf16 a[140:143], a[244:247], v[120:123], a[140:143]
v_mfma_f32_16x16x32_bf16 a[144:147], a[244:247], v[124:127], a[144:147]
v_mfma_f32_16x16x32_bf16 a[148:151], a[244:247], v[128:131], a[148:151]
v_mfma_f32_16x16x32_bf16 a[152:155], a[244:247], v[132:135], a[152:155]
v_mfma_f32_16x16x32_bf16 a[156:159], a[244:247], v[136:139], a[156:159]
s_waitcnt lgkmcnt(0)
v_mfma_f32_16x16x32_bf16 v[80:83], a[184:187], v[0:3], v[160:163]
s_waitcnt vmcnt(4)
v_mfma_f32_16x16x32_bf16 v[80:83], a[188:191], v[20:23], v[80:83]
ds_read_b64_tr_b16 a[216:217], v196 offset:0
s_add_u32 m0, s48, 49152
v_mfma_f32_16x16x32_bf16 v[80:83], a[192:195], v[40:43], v[80:83]
buffer_load_dwordx4 v223, s[20:23], s37 offen offset:3072 nt lds
v_mfma_f32_16x16x32_bf16 v[80:83], a[196:199], v[60:63], v[80:83]
ds_read_b64_tr_b16 a[218:219], v196 offset:4096
v_mfma_f32_16x16x32_bf16 v[84:87], a[196:199], v[64:67], v[164:167]
v_mfma_f32_16x16x32_bf16 v[84:87], a[192:195], v[44:47], v[84:87]
ds_read_b64_tr_b16 a[220:221], v197 offset:0
v_mfma_f32_16x16x32_bf16 v[84:87], a[188:191], v[24:27], v[84:87]
v_mfma_f32_16x16x32_bf16 v[84:87], a[184:187], v[4:7], v[84:87]
ds_read_b64_tr_b16 a[222:223], v197 offset:4096
v_mfma_f32_16x16x32_bf16 v[88:91], a[184:187], v[8:11], v[168:171]
v_mfma_f32_16x16x32_bf16 v[88:91], a[188:191], v[28:31], v[88:91]
ds_read_b64_tr_b16 a[224:225], v198 offset:0
v_mfma_f32_16x16x32_bf16 v[88:91], a[192:195], v[48:51], v[88:91]
v_mfma_f32_16x16x32_bf16 v[88:91], a[196:199], v[68:71], v[88:91]
ds_read_b64_tr_b16 a[226:227], v198 offset:4096
s_waitcnt vmcnt(4)
v_mfma_f32_16x16x32_bf16 v[92:95], a[196:199], v[72:75], v[172:175]
v_exp_f32 v80, v80
v_mfma_f32_16x16x32_bf16 v[92:95], a[192:195], v[52:55], v[92:95]
ds_read_b64_tr_b16 a[228:229], v199 offset:0
s_add_u32 m0, s48, 98304
s_xor_b32 s36, s3, 106496
v_mfma_f32_16x16x32_bf16 v[92:95], a[188:191], v[32:35], v[92:95]
buffer_load_dwordx4 v220, s[16:19], s36 offen offset:0 nt lds
v_exp_f32 v81, v81
v_mfma_f32_16x16x32_bf16 v[92:95], a[184:187], v[12:15], v[92:95]
ds_read_b64_tr_b16 a[230:231], v199 offset:4096
v_exp_f32 v82, v82
v_mfma_f32_16x16x32_bf16 v[96:99], a[184:187], v[16:19], v[176:179]
v_exp_f32 v83, v83
v_mfma_f32_16x16x32_bf16 v[96:99], a[188:191], v[36:39], v[96:99]
ds_read_b64_tr_b16 a[232:233], v200 offset:0
v_exp_f32 v84, v84
v_mfma_f32_16x16x32_bf16 v[96:99], a[192:195], v[56:59], v[96:99]
v_cvt_pk_bf16_f32 v120, v80, v81
v_cvt_pk_bf16_f32 v121, v82, v83
v_mfma_f32_16x16x32_bf16 v[96:99], a[196:199], v[76:79], v[96:99]
ds_read_b64_tr_b16 a[234:235], v200 offset:4096
v_exp_f32 v85, v85
v_mfma_f32_16x16x32_bf16 v[100:103], a[200:203], v[0:3], v[160:163]
v_exp_f32 v86, v86
v_mfma_f32_16x16x32_bf16 v[100:103], a[204:207], v[20:23], v[100:103]
ds_read_b64_tr_b16 a[236:237], v201 offset:0
s_waitcnt vmcnt(4)
v_mfma_f32_16x16x32_bf16 v[100:103], a[208:211], v[40:43], v[100:103]
v_exp_f32 v87, v87
v_mfma_f32_16x16x32_bf16 v[100:103], a[212:215], v[60:63], v[100:103]
ds_read_b64_tr_b16 a[238:239], v201 offset:4096
s_add_u32 m0, s48, 98304
v_mfma_f32_16x16x32_bf16 v[104:107], a[212:215], v[64:67], v[164:167]
buffer_load_dwordx4 v221, s[16:19], s36 offen offset:1024 nt lds
v_exp_f32 v88, v88
v_mfma_f32_16x16x32_bf16 v[104:107], a[208:211], v[44:47], v[104:107]
ds_read_b64_tr_b16 a[240:241], v202 offset:0
v_cvt_pk_bf16_f32 v124, v84, v85
v_cvt_pk_bf16_f32 v125, v86, v87
v_mfma_f32_16x16x32_bf16 v[104:107], a[204:207], v[24:27], v[104:107]
v_exp_f32 v89, v89
v_mfma_f32_16x16x32_bf16 v[104:107], a[200:203], v[4:7], v[104:107]
ds_read_b64_tr_b16 a[242:243], v202 offset:4096
v_exp_f32 v90, v90
v_mfma_f32_16x16x32_bf16 v[108:111], a[200:203], v[8:11], v[168:171]
v_exp_f32 v91, v91
v_mfma_f32_16x16x32_bf16 v[108:111], a[204:207], v[28:31], v[108:111]
ds_read_b64_tr_b16 a[244:245], v203 offset:0
v_exp_f32 v92, v92
v_mfma_f32_16x16x32_bf16 v[108:111], a[208:211], v[48:51], v[108:111]
v_cvt_pk_bf16_f32 v128, v88, v89
v_cvt_pk_bf16_f32 v129, v90, v91
v_mfma_f32_16x16x32_bf16 v[108:111], a[212:215], v[68:71], v[108:111]
ds_read_b64_tr_b16 a[246:247], v203 offset:4096
v_exp_f32 v93, v93
v_mfma_f32_16x16x32_bf16 v[112:115], a[212:215], v[72:75], v[172:175]
s_waitcnt vmcnt(4)
v_exp_f32 v94, v94
v_mfma_f32_16x16x32_bf16 v[112:115], a[208:211], v[52:55], v[112:115]
v_exp_f32 v95, v95
v_mfma_f32_16x16x32_bf16 v[112:115], a[204:207], v[32:35], v[112:115]
s_add_u32 m0, s48, 98304
v_exp_f32 v96, v96
v_mfma_f32_16x16x32_bf16 v[112:115], a[200:203], v[12:15], v[112:115]
buffer_load_dwordx4 v222, s[16:19], s36 offen offset:2048 nt lds
v_cvt_pk_bf16_f32 v132, v92, v93
v_cvt_pk_bf16_f32 v133, v94, v95
v_mfma_f32_16x16x32_bf16 v[116:119], a[200:203], v[16:19], v[176:179]
v_exp_f32 v97, v97
v_mfma_f32_16x16x32_bf16 v[116:119], a[204:207], v[36:39], v[116:119]
v_exp_f32 v98, v98
v_mfma_f32_16x16x32_bf16 v[116:119], a[208:211], v[56:59], v[116:119]
v_exp_f32 v99, v99
v_mfma_f32_16x16x32_bf16 v[116:119], a[212:215], v[76:79], v[116:119]
v_cvt_pk_bf16_f32 v136, v96, v97
v_cvt_pk_bf16_f32 v137, v98, v99
v_mfma_f32_16x16x32_bf16 a[160:163], a[180:183], v[140:143], a[160:163]
v_exp_f32 v100, v100
v_mfma_f32_16x16x32_bf16 a[164:167], a[180:183], v[144:147], a[164:167]
v_exp_f32 v101, v101
v_mfma_f32_16x16x32_bf16 a[168:171], a[180:183], v[148:151], a[168:171]
v_exp_f32 v102, v102
v_mfma_f32_16x16x32_bf16 a[172:175], a[180:183], v[152:155], a[172:175]
s_waitcnt lgkmcnt(0)
s_barrier
s_waitcnt vmcnt(4)
v_mfma_f32_16x16x32_bf16 a[176:179], a[180:183], v[156:159], a[176:179]
v_exp_f32 v103, v103
v_mfma_f32_16x16x32_bf16 a[0:3], a[216:219], v[140:143], a[0:3]
ds_read_b128 a[184:187], v204 offset:32768
s_add_u32 m0, s48, 98304
v_mfma_f32_16x16x32_bf16 a[4:7], a[216:219], v[144:147], a[4:7]
buffer_load_dwordx4 v223, s[16:19], s36 offen offset:3072 nt lds
v_exp_f32 v104, v104
v_mfma_f32_16x16x32_bf16 a[8:11], a[216:219], v[148:151], a[8:11]
v_cvt_pk_bf16_f32 v122, v100, v101
v_cvt_pk_bf16_f32 v123, v102, v103
v_mfma_f32_16x16x32_bf16 a[12:15], a[216:219], v[152:155], a[12:15]
v_exp_f32 v105, v105
v_mfma_f32_16x16x32_bf16 a[16:19], a[216:219], v[156:159], a[16:19]
ds_read_b128 a[188:191], v205 offset:32768
v_exp_f32 v106, v106
v_mfma_f32_16x16x32_bf16 a[20:23], a[220:223], v[140:143], a[20:23]
v_exp_f32 v107, v107
v_mfma_f32_16x16x32_bf16 a[24:27], a[220:223], v[144:147], a[24:27]
v_exp_f32 v108, v108
v_mfma_f32_16x16x32_bf16 a[28:31], a[220:223], v[148:151], a[28:31]
v_cvt_pk_bf16_f32 v126, v104, v105
v_cvt_pk_bf16_f32 v127, v106, v107
v_mfma_f32_16x16x32_bf16 a[32:35], a[220:223], v[152:155], a[32:35]
ds_read_b128 a[192:195], v206 offset:32768
s_waitcnt vmcnt(4)
v_mfma_f32_16x16x32_bf16 a[36:39], a[220:223], v[156:159], a[36:39]
v_exp_f32 v109, v109
v_mfma_f32_16x16x32_bf16 a[40:43], a[224:227], v[140:143], a[40:43]
s_add_u32 m0, s48, 81920
s_xor_b32 s37, s3, 98304
v_mfma_f32_16x16x32_bf16 a[44:47], a[224:227], v[144:147], a[44:47]
buffer_load_dwordx4 v220, s[20:23], s37 offen offset:0 nt lds
v_exp_f32 v110, v110
v_mfma_f32_16x16x32_bf16 a[48:51], a[224:227], v[148:151], a[48:51]
ds_read_b128 a[196:199], v207 offset:32768
v_exp_f32 v111, v111
v_mfma_f32_16x16x32_bf16 a[52:55], a[224:227], v[152:155], a[52:55]
v_exp_f32 v112, v112
v_mfma_f32_16x16x32_bf16 a[56:59], a[224:227], v[156:159], a[56:59]
v_cvt_pk_bf16_f32 v130, v108, v109
v_cvt_pk_bf16_f32 v131, v110, v111
v_mfma_f32_16x16x32_bf16 a[60:63], a[228:231], v[140:143], a[60:63]
v_exp_f32 v113, v113
v_mfma_f32_16x16x32_bf16 a[64:67], a[228:231], v[144:147], a[64:67]
ds_read_b128 a[200:203], v204 offset:36864
v_exp_f32 v114, v114
v_mfma_f32_16x16x32_bf16 a[68:71], a[228:231], v[148:151], a[68:71]
v_exp_f32 v115, v115
v_mfma_f32_16x16x32_bf16 a[72:75], a[228:231], v[152:155], a[72:75]
v_exp_f32 v116, v116
v_mfma_f32_16x16x32_bf16 a[76:79], a[228:231], v[156:159], a[76:79]
s_waitcnt vmcnt(4)
v_cvt_pk_bf16_f32 v134, v112, v113
v_cvt_pk_bf16_f32 v135, v114, v115
v_mfma_f32_16x16x32_bf16 a[80:83], a[232:235], v[140:143], a[80:83]
ds_read_b128 a[204:207], v205 offset:36864
v_exp_f32 v117, v117
v_mfma_f32_16x16x32_bf16 a[84:87], a[232:235], v[144:147], a[84:87]
s_add_u32 m0, s48, 81920
v_exp_f32 v118, v118
v_mfma_f32_16x16x32_bf16 a[88:91], a[232:235], v[148:151], a[88:91]
buffer_load_dwordx4 v221, s[20:23], s37 offen offset:1024 nt lds
v_exp_f32 v119, v119
v_mfma_f32_16x16x32_bf16 a[92:95], a[232:235], v[152:155], a[92:95]
v_cvt_pk_bf16_f32 v138, v116, v117
v_cvt_pk_bf16_f32 v139, v118, v119
v_mfma_f32_16x16x32_bf16 a[96:99], a[232:235], v[156:159], a[96:99]
ds_read_b128 a[208:211], v206 offset:36864
v_mfma_f32_16x16x32_bf16 a[100:103], a[236:239], v[140:143], a[100:103]
v_mfma_f32_16x16x32_bf16 a[104:107], a[236:239], v[144:147], a[104:107]
v_mfma_f32_16x16x32_bf16 a[108:111], a[236:239], v[148:151], a[108:111]
v_mfma_f32_16x16x32_bf16 a[112:115], a[236:239], v[152:155], a[112:115]
ds_read_b128 a[212:215], v207 offset:36864
v_mfma_f32_16x16x32_bf16 a[116:119], a[236:239], v[156:159], a[116:119]
v_mfma_f32_16x16x32_bf16 a[120:123], a[240:243], v[140:143], a[120:123]
s_waitcnt vmcnt(4)
v_mfma_f32_16x16x32_bf16 a[124:127], a[240:243], v[144:147], a[124:127]
v_mfma_f32_16x16x32_bf16 a[128:131], a[240:243], v[148:151], a[128:131]
s_add_u32 m0, s48, 81920
v_mfma_f32_16x16x32_bf16 a[132:135], a[240:243], v[152:155], a[132:135]
buffer_load_dwordx4 v222, s[20:23], s37 offen offset:2048 nt lds
v_mfma_f32_16x16x32_bf16 a[136:139], a[240:243], v[156:159], a[136:139]
v_mfma_f32_16x16x32_bf16 a[140:143], a[244:247], v[140:143], a[140:143]
v_mfma_f32_16x16x32_bf16 a[144:147], a[244:247], v[144:147], a[144:147]
v_mfma_f32_16x16x32_bf16 a[148:151], a[244:247], v[148:151], a[148:151]
v_mfma_f32_16x16x32_bf16 a[152:155], a[244:247], v[152:155], a[152:155]
v_mfma_f32_16x16x32_bf16 a[156:159], a[244:247], v[156:159], a[156:159]
s_waitcnt lgkmcnt(0)
v_mfma_f32_16x16x32_bf16 v[80:83], a[184:187], v[0:3], v[160:163]
v_mfma_f32_16x16x32_bf16 v[80:83], a[188:191], v[20:23], v[80:83]
ds_read_b64_tr_b16 a[216:217], v180 offset:0
s_waitcnt vmcnt(4)
v_mfma_f32_16x16x32_bf16 v[80:83], a[192:195], v[40:43], v[80:83]
v_mfma_f32_16x16x32_bf16 v[80:83], a[196:199], v[60:63], v[80:83]
ds_read_b64_tr_b16 a[218:219], v180 offset:4096
s_add_u32 m0, s48, 81920
v_mfma_f32_16x16x32_bf16 v[84:87], a[196:199], v[64:67], v[164:167]
buffer_load_dwordx4 v223, s[20:23], s37 offen offset:3072 nt lds
v_mfma_f32_16x16x32_bf16 v[84:87], a[192:195], v[44:47], v[84:87]
ds_read_b64_tr_b16 a[220:221], v181 offset:0
v_mfma_f32_16x16x32_bf16 v[84:87], a[188:191], v[24:27], v[84:87]
v_mfma_f32_16x16x32_bf16 v[84:87], a[184:187], v[4:7], v[84:87]
ds_read_b64_tr_b16 a[222:223], v181 offset:4096
v_mfma_f32_16x16x32_bf16 v[88:91], a[184:187], v[8:11], v[168:171]
v_mfma_f32_16x16x32_bf16 v[88:91], a[188:191], v[28:31], v[88:91]
ds_read_b64_tr_b16 a[224:225], v182 offset:0
v_mfma_f32_16x16x32_bf16 v[88:91], a[192:195], v[48:51], v[88:91]
v_mfma_f32_16x16x32_bf16 v[88:91], a[196:199], v[68:71], v[88:91]
ds_read_b64_tr_b16 a[226:227], v182 offset:4096
s_waitcnt vmcnt(4)
v_mfma_f32_16x16x32_bf16 v[92:95], a[196:199], v[72:75], v[172:175]
v_exp_f32 v80, v80
v_mfma_f32_16x16x32_bf16 v[92:95], a[192:195], v[52:55], v[92:95]
ds_read_b64_tr_b16 a[228:229], v183 offset:0
s_add_u32 m0, s48, 131072
s_xor_b32 s36, s3, 114688
v_mfma_f32_16x16x32_bf16 v[92:95], a[188:191], v[32:35], v[92:95]
buffer_load_dwordx4 v220, s[16:19], s36 offen offset:0 nt lds
v_exp_f32 v81, v81
v_mfma_f32_16x16x32_bf16 v[92:95], a[184:187], v[12:15], v[92:95]
ds_read_b64_tr_b16 a[230:231], v183 offset:4096
v_exp_f32 v82, v82
v_mfma_f32_16x16x32_bf16 v[96:99], a[184:187], v[16:19], v[176:179]
v_exp_f32 v83, v83
v_mfma_f32_16x16x32_bf16 v[96:99], a[188:191], v[36:39], v[96:99]
ds_read_b64_tr_b16 a[232:233], v184 offset:0
v_exp_f32 v84, v84
v_mfma_f32_16x16x32_bf16 v[96:99], a[192:195], v[56:59], v[96:99]
v_cvt_pk_bf16_f32 v140, v80, v81
v_cvt_pk_bf16_f32 v141, v82, v83
v_mfma_f32_16x16x32_bf16 v[96:99], a[196:199], v[76:79], v[96:99]
ds_read_b64_tr_b16 a[234:235], v184 offset:4096
v_exp_f32 v85, v85
v_mfma_f32_16x16x32_bf16 v[100:103], a[200:203], v[0:3], v[160:163]
v_exp_f32 v86, v86
v_mfma_f32_16x16x32_bf16 v[100:103], a[204:207], v[20:23], v[100:103]
ds_read_b64_tr_b16 a[236:237], v185 offset:0
v_exp_f32 v87, v87
v_mfma_f32_16x16x32_bf16 v[100:103], a[208:211], v[40:43], v[100:103]
v_exp_f32 v88, v88
v_mfma_f32_16x16x32_bf16 v[100:103], a[212:215], v[60:63], v[100:103]
ds_read_b64_tr_b16 a[238:239], v185 offset:4096
s_waitcnt vmcnt(4)
v_cvt_pk_bf16_f32 v144, v84, v85
v_mfma_f32_16x16x32_bf16 v[104:107], a[212:215], v[64:67], v[164:167]
v_cvt_pk_bf16_f32 v145, v86, v87
v_mfma_f32_16x16x32_bf16 v[104:107], a[208:211], v[44:47], v[104:107]
ds_read_b64_tr_b16 a[240:241], v186 offset:0
s_add_u32 m0, s48, 131072
v_mfma_f32_16x16x32_bf16 v[104:107], a[204:207], v[24:27], v[104:107]
buffer_load_dwordx4 v221, s[16:19], s36 offen offset:1024 nt lds
v_exp_f32 v89, v89
v_mfma_f32_16x16x32_bf16 v[104:107], a[200:203], v[4:7], v[104:107]
ds_read_b64_tr_b16 a[242:243], v186 offset:4096
v_exp_f32 v90, v90
v_mfma_f32_16x16x32_bf16 v[108:111], a[200:203], v[8:11], v[168:171]
v_exp_f32 v91, v91
v_mfma_f32_16x16x32_bf16 v[108:111], a[204:207], v[28:31], v[108:111]
ds_read_b64_tr_b16 a[244:245], v187 offset:0
v_exp_f32 v92, v92
v_mfma_f32_16x16x32_bf16 v[108:111], a[208:211], v[48:51], v[108:111]
v_cvt_pk_bf16_f32 v148, v88, v89
v_cvt_pk_bf16_f32 v149, v90, v91
v_mfma_f32_16x16x32_bf16 v[108:111], a[212:215], v[68:71], v[108:111]
ds_read_b64_tr_b16 a[246:247], v187 offset:4096
v_exp_f32 v93, v93
v_mfma_f32_16x16x32_bf16 v[112:115], a[212:215], v[72:75], v[172:175]
v_exp_f32 v94, v94
v_mfma_f32_16x16x32_bf16 v[112:115], a[208:211], v[52:55], v[112:115]
s_waitcnt vmcnt(4)
v_exp_f32 v95, v95
v_mfma_f32_16x16x32_bf16 v[112:115], a[204:207], v[32:35], v[112:115]
v_exp_f32 v96, v96
v_mfma_f32_16x16x32_bf16 v[112:115], a[200:203], v[12:15], v[112:115]
s_add_u32 m0, s48, 131072
v_cvt_pk_bf16_f32 v152, v92, v93
v_cvt_pk_bf16_f32 v153, v94, v95
v_mfma_f32_16x16x32_bf16 v[116:119], a[200:203], v[16:19], v[176:179]
buffer_load_dwordx4 v222, s[16:19], s36 offen offset:2048 nt lds
v_exp_f32 v97, v97
v_mfma_f32_16x16x32_bf16 v[116:119], a[204:207], v[36:39], v[116:119]
v_exp_f32 v98, v98
v_mfma_f32_16x16x32_bf16 v[116:119], a[208:211], v[56:59], v[116:119]
v_exp_f32 v99, v99
v_mfma_f32_16x16x32_bf16 v[116:119], a[212:215], v[76:79], v[116:119]
v_cvt_pk_bf16_f32 v156, v96, v97
v_cvt_pk_bf16_f32 v157, v98, v99
v_mfma_f32_16x16x32_bf16 a[160:163], a[180:183], v[120:123], a[160:163]
v_exp_f32 v100, v100
v_mfma_f32_16x16x32_bf16 a[164:167], a[180:183], v[124:127], a[164:167]
v_exp_f32 v101, v101
v_mfma_f32_16x16x32_bf16 a[168:171], a[180:183], v[128:131], a[168:171]
v_exp_f32 v102, v102
v_mfma_f32_16x16x32_bf16 a[172:175], a[180:183], v[132:135], a[172:175]
s_waitcnt lgkmcnt(0)
s_barrier
v_mfma_f32_16x16x32_bf16 a[176:179], a[180:183], v[136:139], a[176:179]
s_waitcnt vmcnt(4)
v_exp_f32 v103, v103
v_mfma_f32_16x16x32_bf16 a[0:3], a[216:219], v[120:123], a[0:3]
ds_read_b128 a[184:187], v208 offset:0
v_exp_f32 v104, v104
v_mfma_f32_16x16x32_bf16 a[4:7], a[216:219], v[124:127], a[4:7]
s_add_u32 m0, s48, 131072
v_cvt_pk_bf16_f32 v142, v100, v101
v_cvt_pk_bf16_f32 v143, v102, v103
v_mfma_f32_16x16x32_bf16 a[8:11], a[216:219], v[128:131], a[8:11]
buffer_load_dwordx4 v223, s[16:19], s36 offen offset:3072 nt lds
v_exp_f32 v105, v105
v_mfma_f32_16x16x32_bf16 a[12:15], a[216:219], v[132:135], a[12:15]
v_exp_f32 v106, v106
v_mfma_f32_16x16x32_bf16 a[16:19], a[216:219], v[136:139], a[16:19]
ds_read_b128 a[188:191], v209 offset:0
v_exp_f32 v107, v107
v_mfma_f32_16x16x32_bf16 a[20:23], a[220:223], v[120:123], a[20:23]
v_exp_f32 v108, v108
v_mfma_f32_16x16x32_bf16 a[24:27], a[220:223], v[124:127], a[24:27]
v_cvt_pk_bf16_f32 v146, v104, v105
v_cvt_pk_bf16_f32 v147, v106, v107
v_mfma_f32_16x16x32_bf16 a[28:31], a[220:223], v[128:131], a[28:31]
v_exp_f32 v109, v109
v_mfma_f32_16x16x32_bf16 a[32:35], a[220:223], v[132:135], a[32:35]
ds_read_b128 a[192:195], v210 offset:0
v_exp_f32 v110, v110
v_mfma_f32_16x16x32_bf16 a[36:39], a[220:223], v[136:139], a[36:39]
v_exp_f32 v111, v111
v_mfma_f32_16x16x32_bf16 a[40:43], a[224:227], v[120:123], a[40:43]
s_waitcnt vmcnt(4)
v_exp_f32 v112, v112
v_mfma_f32_16x16x32_bf16 a[44:47], a[224:227], v[124:127], a[44:47]
v_cvt_pk_bf16_f32 v150, v108, v109
v_cvt_pk_bf16_f32 v151, v110, v111
v_mfma_f32_16x16x32_bf16 a[48:51], a[224:227], v[128:131], a[48:51]
ds_read_b128 a[196:199], v211 offset:0
s_add_u32 m0, s48, 114688
s_xor_b32 s37, s3, 106496
v_mfma_f32_16x16x32_bf16 a[52:55], a[224:227], v[132:135], a[52:55]
buffer_load_dwordx4 v220, s[20:23], s37 offen offset:0 nt lds
v_exp_f32 v113, v113
v_mfma_f32_16x16x32_bf16 a[56:59], a[224:227], v[136:139], a[56:59]
v_exp_f32 v114, v114
v_mfma_f32_16x16x32_bf16 a[60:63], a[228:231], v[120:123], a[60:63]
v_exp_f32 v115, v115
v_mfma_f32_16x16x32_bf16 a[64:67], a[228:231], v[124:127], a[64:67]
ds_read_b128 a[200:203], v208 offset:4096
v_exp_f32 v116, v116
v_mfma_f32_16x16x32_bf16 a[68:71], a[228:231], v[128:131], a[68:71]
v_cvt_pk_bf16_f32 v154, v112, v113
v_cvt_pk_bf16_f32 v155, v114, v115
v_mfma_f32_16x16x32_bf16 a[72:75], a[228:231], v[132:135], a[72:75]
v_exp_f32 v117, v117
v_mfma_f32_16x16x32_bf16 a[76:79], a[228:231], v[136:139], a[76:79]
v_exp_f32 v118, v118
v_mfma_f32_16x16x32_bf16 a[80:83], a[232:235], v[120:123], a[80:83]
ds_read_b128 a[204:207], v209 offset:4096
s_waitcnt vmcnt(4)
v_mfma_f32_16x16x32_bf16 a[84:87], a[232:235], v[124:127], a[84:87]
v_exp_f32 v119, v119
v_mfma_f32_16x16x32_bf16 a[88:91], a[232:235], v[128:131], a[88:91]
s_add_u32 m0, s48, 114688
v_cvt_pk_bf16_f32 v158, v116, v117
v_cvt_pk_bf16_f32 v159, v118, v119
v_mfma_f32_16x16x32_bf16 a[92:95], a[232:235], v[132:135], a[92:95]
buffer_load_dwordx4 v221, s[20:23], s37 offen offset:1024 nt lds
v_mfma_f32_16x16x32_bf16 a[96:99], a[232:235], v[136:139], a[96:99]
ds_read_b128 a[208:211], v210 offset:4096
v_mfma_f32_16x16x32_bf16 a[100:103], a[236:239], v[120:123], a[100:103]
v_mfma_f32_16x16x32_bf16 a[104:107], a[236:239], v[124:127], a[104:107]
v_mfma_f32_16x16x32_bf16 a[108:111], a[236:239], v[128:131], a[108:111]
v_mfma_f32_16x16x32_bf16 a[112:115], a[236:239], v[132:135], a[112:115]
ds_read_b128 a[212:215], v211 offset:4096
v_mfma_f32_16x16x32_bf16 a[116:119], a[236:239], v[136:139], a[116:119]
v_mfma_f32_16x16x32_bf16 a[120:123], a[240:243], v[120:123], a[120:123]
v_mfma_f32_16x16x32_bf16 a[124:127], a[240:243], v[124:127], a[124:127]
s_waitcnt vmcnt(4)
v_mfma_f32_16x16x32_bf16 a[128:131], a[240:243], v[128:131], a[128:131]
v_mfma_f32_16x16x32_bf16 a[132:135], a[240:243], v[132:135], a[132:135]
s_add_u32 m0, s48, 114688
v_mfma_f32_16x16x32_bf16 a[136:139], a[240:243], v[136:139], a[136:139]
buffer_load_dwordx4 v222, s[20:23], s37 offen offset:2048 nt lds
v_mfma_f32_16x16x32_bf16 a[140:143], a[244:247], v[120:123], a[140:143]
v_mfma_f32_16x16x32_bf16 a[144:147], a[244:247], v[124:127], a[144:147]
v_mfma_f32_16x16x32_bf16 a[148:151], a[244:247], v[128:131], a[148:151]
v_mfma_f32_16x16x32_bf16 a[152:155], a[244:247], v[132:135], a[152:155]
v_mfma_f32_16x16x32_bf16 a[156:159], a[244:247], v[136:139], a[156:159]
s_waitcnt lgkmcnt(0)
v_mfma_f32_16x16x32_bf16 v[80:83], a[184:187], v[0:3], v[160:163]
v_mfma_f32_16x16x32_bf16 v[80:83], a[188:191], v[20:23], v[80:83]
ds_read_b64_tr_b16 a[216:217], v180 offset:32768
v_mfma_f32_16x16x32_bf16 v[80:83], a[192:195], v[40:43], v[80:83]
v_mfma_f32_16x16x32_bf16 v[80:83], a[196:199], v[60:63], v[80:83]
ds_read_b64_tr_b16 a[218:219], v180 offset:36864
s_waitcnt vmcnt(4)
v_mfma_f32_16x16x32_bf16 v[84:87], a[196:199], v[64:67], v[164:167]
v_mfma_f32_16x16x32_bf16 v[84:87], a[192:195], v[44:47], v[84:87]
ds_read_b64_tr_b16 a[220:221], v181 offset:32768
s_add_u32 m0, s48, 114688
v_mfma_f32_16x16x32_bf16 v[84:87], a[188:191], v[24:27], v[84:87]
buffer_load_dwordx4 v223, s[20:23], s37 offen offset:3072 nt lds
v_mfma_f32_16x16x32_bf16 v[84:87], a[184:187], v[4:7], v[84:87]
ds_read_b64_tr_b16 a[222:223], v181 offset:36864
v_mfma_f32_16x16x32_bf16 v[88:91], a[184:187], v[8:11], v[168:171]
v_mfma_f32_16x16x32_bf16 v[88:91], a[188:191], v[28:31], v[88:91]
ds_read_b64_tr_b16 a[224:225], v182 offset:32768
v_mfma_f32_16x16x32_bf16 v[88:91], a[192:195], v[48:51], v[88:91]
v_mfma_f32_16x16x32_bf16 v[88:91], a[196:199], v[68:71], v[88:91]
ds_read_b64_tr_b16 a[226:227], v182 offset:36864
v_mfma_f32_16x16x32_bf16 v[92:95], a[196:199], v[72:75], v[172:175]
v_exp_f32 v80, v80
v_mfma_f32_16x16x32_bf16 v[92:95], a[192:195], v[52:55], v[92:95]
ds_read_b64_tr_b16 a[228:229], v183 offset:32768
s_waitcnt vmcnt(4)
v_mfma_f32_16x16x32_bf16 v[92:95], a[188:191], v[32:35], v[92:95]
v_exp_f32 v81, v81
v_mfma_f32_16x16x32_bf16 v[92:95], a[184:187], v[12:15], v[92:95]
ds_read_b64_tr_b16 a[230:231], v183 offset:36864
s_add_u32 m0, s48, 0
s_xor_b32 s36, s3, 122880
v_mfma_f32_16x16x32_bf16 v[96:99], a[184:187], v[16:19], v[176:179]
buffer_load_dwordx4 v220, s[16:19], s36 offen offset:0 nt lds
v_exp_f32 v82, v82
v_mfma_f32_16x16x32_bf16 v[96:99], a[188:191], v[36:39], v[96:99]
ds_read_b64_tr_b16 a[232:233], v184 offset:32768
v_exp_f32 v83, v83
v_mfma_f32_16x16x32_bf16 v[96:99], a[192:195], v[56:59], v[96:99]
v_exp_f32 v84, v84
v_mfma_f32_16x16x32_bf16 v[96:99], a[196:199], v[76:79], v[96:99]
ds_read_b64_tr_b16 a[234:235], v184 offset:36864
v_cvt_pk_bf16_f32 v120, v80, v81
v_cvt_pk_bf16_f32 v121, v82, v83
v_mfma_f32_16x16x32_bf16 v[100:103], a[200:203], v[0:3], v[160:163]
v_exp_f32 v85, v85
v_mfma_f32_16x16x32_bf16 v[100:103], a[204:207], v[20:23], v[100:103]
ds_read_b64_tr_b16 a[236:237], v185 offset:32768
v_exp_f32 v86, v86
v_mfma_f32_16x16x32_bf16 v[100:103], a[208:211], v[40:43], v[100:103]
v_exp_f32 v87, v87
v_mfma_f32_16x16x32_bf16 v[100:103], a[212:215], v[60:63], v[100:103]
ds_read_b64_tr_b16 a[238:239], v185 offset:36864
s_waitcnt vmcnt(4)
v_mfma_f32_16x16x32_bf16 v[104:107], a[212:215], v[64:67], v[164:167]
v_exp_f32 v88, v88
v_mfma_f32_16x16x32_bf16 v[104:107], a[208:211], v[44:47], v[104:107]
ds_read_b64_tr_b16 a[240:241], v186 offset:32768
s_add_u32 m0, s48, 0
v_cvt_pk_bf16_f32 v124, v84, v85
v_mfma_f32_16x16x32_bf16 v[104:107], a[204:207], v[24:27], v[104:107]
buffer_load_dwordx4 v221, s[16:19], s36 offen offset:1024 nt lds
v_cvt_pk_bf16_f32 v125, v86, v87
v_mfma_f32_16x16x32_bf16 v[104:107], a[200:203], v[4:7], v[104:107]
ds_read_b64_tr_b16 a[242:243], v186 offset:36864
v_exp_f32 v89, v89
v_mfma_f32_16x16x32_bf16 v[108:111], a[200:203], v[8:11], v[168:171]
v_exp_f32 v90, v90
v_mfma_f32_16x16x32_bf16 v[108:111], a[204:207], v[28:31], v[108:111]
ds_read_b64_tr_b16 a[244:245], v187 offset:32768
v_exp_f32 v91, v91
v_mfma_f32_16x16x32_bf16 v[108:111], a[208:211], v[48:51], v[108:111]
v_exp_f32 v92, v92
v_mfma_f32_16x16x32_bf16 v[108:111], a[212:215], v[68:71], v[108:111]
ds_read_b64_tr_b16 a[246:247], v187 offset:36864
v_cvt_pk_bf16_f32 v128, v88, v89
v_cvt_pk_bf16_f32 v129, v90, v91
v_mfma_f32_16x16x32_bf16 v[112:115], a[212:215], v[72:75], v[172:175]
v_exp_f32 v93, v93
v_mfma_f32_16x16x32_bf16 v[112:115], a[208:211], v[52:55], v[112:115]
v_exp_f32 v94, v94
v_mfma_f32_16x16x32_bf16 v[112:115], a[204:207], v[32:35], v[112:115]
s_waitcnt vmcnt(4)
v_exp_f32 v95, v95
v_mfma_f32_16x16x32_bf16 v[112:115], a[200:203], v[12:15], v[112:115]
v_exp_f32 v96, v96
v_mfma_f32_16x16x32_bf16 v[116:119], a[200:203], v[16:19], v[176:179]
s_add_u32 m0, s48, 0
v_cvt_pk_bf16_f32 v132, v92, v93
v_cvt_pk_bf16_f32 v133, v94, v95
v_mfma_f32_16x16x32_bf16 v[116:119], a[204:207], v[36:39], v[116:119]
buffer_load_dwordx4 v222, s[16:19], s36 offen offset:2048 nt lds
v_exp_f32 v97, v97
v_mfma_f32_16x16x32_bf16 v[116:119], a[208:211], v[56:59], v[116:119]
v_exp_f32 v98, v98
v_mfma_f32_16x16x32_bf16 v[116:119], a[212:215], v[76:79], v[116:119]
v_exp_f32 v99, v99
v_mfma_f32_16x16x32_bf16 a[160:163], a[180:183], v[140:143], a[160:163]
v_cvt_pk_bf16_f32 v136, v96, v97
v_cvt_pk_bf16_f32 v137, v98, v99
v_mfma_f32_16x16x32_bf16 a[164:167], a[180:183], v[144:147], a[164:167]
v_exp_f32 v100, v100
v_mfma_f32_16x16x32_bf16 a[168:171], a[180:183], v[148:151], a[168:171]
v_exp_f32 v101, v101
v_mfma_f32_16x16x32_bf16 a[172:175], a[180:183], v[152:155], a[172:175]
s_waitcnt lgkmcnt(0)
s_barrier
v_mfma_f32_16x16x32_bf16 a[176:179], a[180:183], v[156:159], a[176:179]
v_exp_f32 v102, v102
v_mfma_f32_16x16x32_bf16 a[0:3], a[216:219], v[140:143], a[0:3]
ds_read_b128 a[184:187], v208 offset:32768
s_waitcnt vmcnt(4)
v_mfma_f32_16x16x32_bf16 a[4:7], a[216:219], v[144:147], a[4:7]
v_exp_f32 v103, v103
v_mfma_f32_16x16x32_bf16 a[8:11], a[216:219], v[148:151], a[8:11]
s_add_u32 m0, s48, 0
v_exp_f32 v104, v104
v_mfma_f32_16x16x32_bf16 a[12:15], a[216:219], v[152:155], a[12:15]
buffer_load_dwordx4 v223, s[16:19], s36 offen offset:3072 nt lds
v_cvt_pk_bf16_f32 v122, v100, v101
v_cvt_pk_bf16_f32 v123, v102, v103
v_mfma_f32_16x16x32_bf16 a[16:19], a[216:219], v[156:159], a[16:19]
ds_read_b128 a[188:191], v209 offset:32768
v_exp_f32 v105, v105
v_mfma_f32_16x16x32_bf16 a[20:23], a[220:223], v[140:143], a[20:23]
v_exp_f32 v106, v106
v_mfma_f32_16x16x32_bf16 a[24:27], a[220:223], v[144:147], a[24:27]
v_exp_f32 v107, v107
v_mfma_f32_16x16x32_bf16 a[28:31], a[220:223], v[148:151], a[28:31]
v_exp_f32 v108, v108
v_mfma_f32_16x16x32_bf16 a[32:35], a[220:223], v[152:155], a[32:35]
ds_read_b128 a[192:195], v210 offset:32768
v_cvt_pk_bf16_f32 v126, v104, v105
v_cvt_pk_bf16_f32 v127, v106, v107
v_mfma_f32_16x16x32_bf16 a[36:39], a[220:223], v[156:159], a[36:39]
v_exp_f32 v109, v109
v_mfma_f32_16x16x32_bf16 a[40:43], a[224:227], v[140:143], a[40:43]
s_waitcnt vmcnt(4)
v_exp_f32 v110, v110
v_mfma_f32_16x16x32_bf16 a[44:47], a[224:227], v[144:147], a[44:47]
v_exp_f32 v111, v111
v_mfma_f32_16x16x32_bf16 a[48:51], a[224:227], v[148:151], a[48:51]
ds_read_b128 a[196:199], v211 offset:32768
s_add_u32 m0, s48, 147456
s_xor_b32 s37, s3, 114688
v_mfma_f32_16x16x32_bf16 a[52:55], a[224:227], v[152:155], a[52:55]
buffer_load_dwordx4 v220, s[20:23], s37 offen offset:0 nt lds
v_exp_f32 v112, v112
v_mfma_f32_16x16x32_bf16 a[56:59], a[224:227], v[156:159], a[56:59]
v_cvt_pk_bf16_f32 v130, v108, v109
v_cvt_pk_bf16_f32 v131, v110, v111
v_mfma_f32_16x16x32_bf16 a[60:63], a[228:231], v[140:143], a[60:63]
v_exp_f32 v113, v113
v_mfma_f32_16x16x32_bf16 a[64:67], a[228:231], v[144:147], a[64:67]
ds_read_b128 a[200:203], v208 offset:36864
v_exp_f32 v114, v114
v_mfma_f32_16x16x32_bf16 a[68:71], a[228:231], v[148:151], a[68:71]
v_exp_f32 v115, v115
v_mfma_f32_16x16x32_bf16 a[72:75], a[228:231], v[152:155], a[72:75]
v_exp_f32 v116, v116
v_mfma_f32_16x16x32_bf16 a[76:79], a[228:231], v[156:159], a[76:79]
v_cvt_pk_bf16_f32 v134, v112, v113
v_cvt_pk_bf16_f32 v135, v114, v115
v_mfma_f32_16x16x32_bf16 a[80:83], a[232:235], v[140:143], a[80:83]
ds_read_b128 a[204:207], v209 offset:36864
v_exp_f32 v117, v117
v_mfma_f32_16x16x32_bf16 a[84:87], a[232:235], v[144:147], a[84:87]
v_exp_f32 v118, v118
v_mfma_f32_16x16x32_bf16 a[88:91], a[232:235], v[148:151], a[88:91]
s_waitcnt vmcnt(4)
v_exp_f32 v119, v119
v_mfma_f32_16x16x32_bf16 a[92:95], a[232:235], v[152:155], a[92:95]
v_cvt_pk_bf16_f32 v138, v116, v117
v_cvt_pk_bf16_f32 v139, v118, v119
v_mfma_f32_16x16x32_bf16 a[96:99], a[232:235], v[156:159], a[96:99]
ds_read_b128 a[208:211], v210 offset:36864
s_add_u32 m0, s48, 147456
v_mfma_f32_16x16x32_bf16 a[100:103], a[236:239], v[140:143], a[100:103]
buffer_load_dwordx4 v221, s[20:23], s37 offen offset:1024 nt lds
v_mfma_f32_16x16x32_bf16 a[104:107], a[236:239], v[144:147], a[104:107]
v_mfma_f32_16x16x32_bf16 a[108:111], a[236:239], v[148:151], a[108:111]
v_mfma_f32_16x16x32_bf16 a[112:115], a[236:239], v[152:155], a[112:115]
ds_read_b128 a[212:215], v211 offset:36864
v_mfma_f32_16x16x32_bf16 a[116:119], a[236:239], v[156:159], a[116:119]
v_mfma_f32_16x16x32_bf16 a[120:123], a[240:243], v[140:143], a[120:123]
v_mfma_f32_16x16x32_bf16 a[124:127], a[240:243], v[144:147], a[124:127]
v_mfma_f32_16x16x32_bf16 a[128:131], a[240:243], v[148:151], a[128:131]
s_waitcnt vmcnt(4)
v_mfma_f32_16x16x32_bf16 a[132:135], a[240:243], v[152:155], a[132:135]
v_mfma_f32_16x16x32_bf16 a[136:139], a[240:243], v[156:159], a[136:139]
s_add_u32 m0, s48, 147456
v_mfma_f32_16x16x32_bf16 a[140:143], a[244:247], v[140:143], a[140:143]
buffer_load_dwordx4 v222, s[20:23], s37 offen offset:2048 nt lds
v_mfma_f32_16x16x32_bf16 a[144:147], a[244:247], v[144:147], a[144:147]
v_mfma_f32_16x16x32_bf16 a[148:151], a[244:247], v[148:151], a[148:151]
v_mfma_f32_16x16x32_bf16 a[152:155], a[244:247], v[152:155], a[152:155]
v_mfma_f32_16x16x32_bf16 a[156:159], a[244:247], v[156:159], a[156:159]
s_waitcnt lgkmcnt(0)
v_mfma_f32_16x16x32_bf16 v[80:83], a[184:187], v[0:3], v[160:163]
v_mfma_f32_16x16x32_bf16 v[80:83], a[188:191], v[20:23], v[80:83]
ds_read_b64_tr_b16 a[216:217], v188 offset:0
v_mfma_f32_16x16x32_bf16 v[80:83], a[192:195], v[40:43], v[80:83]
v_mfma_f32_16x16x32_bf16 v[80:83], a[196:199], v[60:63], v[80:83]
ds_read_b64_tr_b16 a[218:219], v188 offset:4096
s_waitcnt vmcnt(4)
v_mfma_f32_16x16x32_bf16 v[84:87], a[196:199], v[64:67], v[164:167]
v_mfma_f32_16x16x32_bf16 v[84:87], a[192:195], v[44:47], v[84:87]
ds_read_b64_tr_b16 a[220:221], v189 offset:0
s_add_u32 m0, s48, 147456
v_mfma_f32_16x16x32_bf16 v[84:87], a[188:191], v[24:27], v[84:87]
buffer_load_dwordx4 v223, s[20:23], s37 offen offset:3072 nt lds
v_mfma_f32_16x16x32_bf16 v[84:87], a[184:187], v[4:7], v[84:87]
ds_read_b64_tr_b16 a[222:223], v189 offset:4096
v_mfma_f32_16x16x32_bf16 v[88:91], a[184:187], v[8:11], v[168:171]
v_mfma_f32_16x16x32_bf16 v[88:91], a[188:191], v[28:31], v[88:91]
ds_read_b64_tr_b16 a[224:225], v190 offset:0
v_mfma_f32_16x16x32_bf16 v[88:91], a[192:195], v[48:51], v[88:91]
v_mfma_f32_16x16x32_bf16 v[88:91], a[196:199], v[68:71], v[88:91]
ds_read_b64_tr_b16 a[226:227], v190 offset:4096
v_mfma_f32_16x16x32_bf16 v[92:95], a[196:199], v[72:75], v[172:175]
v_exp_f32 v80, v80
v_mfma_f32_16x16x32_bf16 v[92:95], a[192:195], v[52:55], v[92:95]
ds_read_b64_tr_b16 a[228:229], v191 offset:0
s_waitcnt vmcnt(4)
v_mfma_f32_16x16x32_bf16 v[92:95], a[188:191], v[32:35], v[92:95]
v_exp_f32 v81, v81
v_mfma_f32_16x16x32_bf16 v[92:95], a[184:187], v[12:15], v[92:95]
ds_read_b64_tr_b16 a[230:231], v191 offset:4096
s_add_u32 m0, s48, 32768
s_xor_b32 s36, s3, 131072
v_mfma_f32_16x16x32_bf16 v[96:99], a[184:187], v[16:19], v[176:179]
buffer_load_dwordx4 v220, s[16:19], s36 offen offset:0 nt lds
v_exp_f32 v82, v82
v_mfma_f32_16x16x32_bf16 v[96:99], a[188:191], v[36:39], v[96:99]
ds_read_b64_tr_b16 a[232:233], v192 offset:0
v_exp_f32 v83, v83
v_mfma_f32_16x16x32_bf16 v[96:99], a[192:195], v[56:59], v[96:99]
v_exp_f32 v84, v84
v_mfma_f32_16x16x32_bf16 v[96:99], a[196:199], v[76:79], v[96:99]
ds_read_b64_tr_b16 a[234:235], v192 offset:4096
v_cvt_pk_bf16_f32 v140, v80, v81
v_cvt_pk_bf16_f32 v141, v82, v83
v_mfma_f32_16x16x32_bf16 v[100:103], a[200:203], v[0:3], v[160:163]
v_exp_f32 v85, v85
v_mfma_f32_16x16x32_bf16 v[100:103], a[204:207], v[20:23], v[100:103]
ds_read_b64_tr_b16 a[236:237], v193 offset:0
v_exp_f32 v86, v86
v_mfma_f32_16x16x32_bf16 v[100:103], a[208:211], v[40:43], v[100:103]
v_exp_f32 v87, v87
v_mfma_f32_16x16x32_bf16 v[100:103], a[212:215], v[60:63], v[100:103]
ds_read_b64_tr_b16 a[238:239], v193 offset:4096
v_exp_f32 v88, v88
v_mfma_f32_16x16x32_bf16 v[104:107], a[212:215], v[64:67], v[164:167]
v_cvt_pk_bf16_f32 v144, v84, v85
v_cvt_pk_bf16_f32 v145, v86, v87
v_mfma_f32_16x16x32_bf16 v[104:107], a[208:211], v[44:47], v[104:107]
ds_read_b64_tr_b16 a[240:241], v194 offset:0
s_waitcnt vmcnt(4)
v_mfma_f32_16x16x32_bf16 v[104:107], a[204:207], v[24:27], v[104:107]
v_exp_f32 v89, v89
v_mfma_f32_16x16x32_bf16 v[104:107], a[200:203], v[4:7], v[104:107]
ds_read_b64_tr_b16 a[242:243], v194 offset:4096
s_add_u32 m0, s48, 32768
v_mfma_f32_16x16x32_bf16 v[108:111], a[200:203], v[8:11], v[168:171]
buffer_load_dwordx4 v221, s[16:19], s36 offen offset:1024 nt lds
v_exp_f32 v90, v90
v_mfma_f32_16x16x32_bf16 v[108:111], a[204:207], v[28:31], v[108:111]
ds_read_b64_tr_b16 a[244:245], v195 offset:0
v_exp_f32 v91, v91
v_mfma_f32_16x16x32_bf16 v[108:111], a[208:211], v[48:51], v[108:111]
v_exp_f32 v92, v92
v_mfma_f32_16x16x32_bf16 v[108:111], a[212:215], v[68:71], v[108:111]
ds_read_b64_tr_b16 a[246:247], v195 offset:4096
v_cvt_pk_bf16_f32 v148, v88, v89
v_cvt_pk_bf16_f32 v149, v90, v91
v_mfma_f32_16x16x32_bf16 v[112:115], a[212:215], v[72:75], v[172:175]
v_exp_f32 v93, v93
v_mfma_f32_16x16x32_bf16 v[112:115], a[208:211], v[52:55], v[112:115]
v_exp_f32 v94, v94
v_mfma_f32_16x16x32_bf16 v[112:115], a[204:207], v[32:35], v[112:115]
v_exp_f32 v95, v95
v_mfma_f32_16x16x32_bf16 v[112:115], a[200:203], v[12:15], v[112:115]
s_waitcnt vmcnt(4)
v_exp_f32 v96, v96
v_mfma_f32_16x16x32_bf16 v[116:119], a[200:203], v[16:19], v[176:179]
v_cvt_pk_bf16_f32 v152, v92, v93
v_cvt_pk_bf16_f32 v153, v94, v95
v_mfma_f32_16x16x32_bf16 v[116:119], a[204:207], v[36:39], v[116:119]
s_add_u32 m0, s48, 32768
v_exp_f32 v97, v97
v_mfma_f32_16x16x32_bf16 v[116:119], a[208:211], v[56:59], v[116:119]
buffer_load_dwordx4 v222, s[16:19], s36 offen offset:2048 nt lds
v_exp_f32 v98, v98
v_mfma_f32_16x16x32_bf16 v[116:119], a[212:215], v[76:79], v[116:119]
v_exp_f32 v99, v99
v_mfma_f32_16x16x32_bf16 a[160:163], a[180:183], v[120:123], a[160:163]
v_cvt_pk_bf16_f32 v156, v96, v97
v_cvt_pk_bf16_f32 v157, v98, v99
v_mfma_f32_16x16x32_bf16 a[164:167], a[180:183], v[124:127], a[164:167]
v_exp_f32 v100, v100
v_mfma_f32_16x16x32_bf16 a[168:171], a[180:183], v[128:131], a[168:171]
v_exp_f32 v101, v101
v_mfma_f32_16x16x32_bf16 a[172:175], a[180:183], v[132:135], a[172:175]
s_waitcnt lgkmcnt(0)
s_barrier
v_mfma_f32_16x16x32_bf16 a[176:179], a[180:183], v[136:139], a[176:179]
v_exp_f32 v102, v102
v_mfma_f32_16x16x32_bf16 a[0:3], a[216:219], v[120:123], a[0:3]
ds_read_b128 a[184:187], v212 offset:0
v_exp_f32 v103, v103
v_mfma_f32_16x16x32_bf16 a[4:7], a[216:219], v[124:127], a[4:7]
v_exp_f32 v104, v104
v_mfma_f32_16x16x32_bf16 a[8:11], a[216:219], v[128:131], a[8:11]
s_waitcnt vmcnt(4)
v_cvt_pk_bf16_f32 v142, v100, v101
v_cvt_pk_bf16_f32 v143, v102, v103
v_mfma_f32_16x16x32_bf16 a[12:15], a[216:219], v[132:135], a[12:15]
v_exp_f32 v105, v105
v_mfma_f32_16x16x32_bf16 a[16:19], a[216:219], v[136:139], a[16:19]
ds_read_b128 a[188:191], v213 offset:0
s_add_u32 m0, s48, 32768
v_mfma_f32_16x16x32_bf16 a[20:23], a[220:223], v[120:123], a[20:23]
buffer_load_dwordx4 v223, s[16:19], s36 offen offset:3072 nt lds
v_exp_f32 v106, v106
v_mfma_f32_16x16x32_bf16 a[24:27], a[220:223], v[124:127], a[24:27]
v_exp_f32 v107, v107
v_mfma_f32_16x16x32_bf16 a[28:31], a[220:223], v[128:131], a[28:31]
v_exp_f32 v108, v108
v_mfma_f32_16x16x32_bf16 a[32:35], a[220:223], v[132:135], a[32:35]
ds_read_b128 a[192:195], v214 offset:0
v_cvt_pk_bf16_f32 v146, v104, v105
v_cvt_pk_bf16_f32 v147, v106, v107
v_mfma_f32_16x16x32_bf16 a[36:39], a[220:223], v[136:139], a[36:39]
v_exp_f32 v109, v109
v_mfma_f32_16x16x32_bf16 a[40:43], a[224:227], v[120:123], a[40:43]
v_exp_f32 v110, v110
v_mfma_f32_16x16x32_bf16 a[44:47], a[224:227], v[124:127], a[44:47]
s_waitcnt vmcnt(4)
v_exp_f32 v111, v111
v_mfma_f32_16x16x32_bf16 a[48:51], a[224:227], v[128:131], a[48:51]
ds_read_b128 a[196:199], v215 offset:0
v_exp_f32 v112, v112
v_mfma_f32_16x16x32_bf16 a[52:55], a[224:227], v[132:135], a[52:55]
s_add_u32 m0, s48, 16384
s_xor_b32 s37, s3, 122880
v_cvt_pk_bf16_f32 v150, v108, v109
v_mfma_f32_16x16x32_bf16 a[56:59], a[224:227], v[136:139], a[56:59]
buffer_load_dwordx4 v220, s[20:23], s37 offen offset:0 nt lds
v_cvt_pk_bf16_f32 v151, v110, v111
v_mfma_f32_16x16x32_bf16 a[60:63], a[228:231], v[120:123], a[60:63]
v_exp_f32 v113, v113
v_mfma_f32_16x16x32_bf16 a[64:67], a[228:231], v[124:127], a[64:67]
ds_read_b128 a[200:203], v212 offset:4096
v_exp_f32 v114, v114
v_mfma_f32_16x16x32_bf16 a[68:71], a[228:231], v[128:131], a[68:71]
v_exp_f32 v115, v115
v_mfma_f32_16x16x32_bf16 a[72:75], a[228:231], v[132:135], a[72:75]
v_exp_f32 v116, v116
v_mfma_f32_16x16x32_bf16 a[76:79], a[228:231], v[136:139], a[76:79]
v_cvt_pk_bf16_f32 v154, v112, v113
v_cvt_pk_bf16_f32 v155, v114, v115
v_mfma_f32_16x16x32_bf16 a[80:83], a[232:235], v[120:123], a[80:83]
ds_read_b128 a[204:207], v213 offset:4096
v_exp_f32 v117, v117
v_mfma_f32_16x16x32_bf16 a[84:87], a[232:235], v[124:127], a[84:87]
v_exp_f32 v118, v118
v_mfma_f32_16x16x32_bf16 a[88:91], a[232:235], v[128:131], a[88:91]
s_waitcnt vmcnt(4)
v_exp_f32 v119, v119
v_mfma_f32_16x16x32_bf16 a[92:95], a[232:235], v[132:135], a[92:95]
v_cvt_pk_bf16_f32 v158, v116, v117
v_cvt_pk_bf16_f32 v159, v118, v119
v_mfma_f32_16x16x32_bf16 a[96:99], a[232:235], v[136:139], a[96:99]
ds_read_b128 a[208:211], v214 offset:4096
s_add_u32 m0, s48, 16384
v_mfma_f32_16x16x32_bf16 a[100:103], a[236:239], v[120:123], a[100:103]
buffer_load_dwordx4 v221, s[20:23], s37 offen offset:1024 nt lds
v_mfma_f32_16x16x32_bf16 a[104:107], a[236:239], v[124:127], a[104:107]
v_mfma_f32_16x16x32_bf16 a[108:111], a[236:239], v[128:131], a[108:111]
v_mfma_f32_16x16x32_bf16 a[112:115], a[236:239], v[132:135], a[112:115]
ds_read_b128 a[212:215], v215 offset:4096
v_mfma_f32_16x16x32_bf16 a[116:119], a[236:239], v[136:139], a[116:119]
v_mfma_f32_16x16x32_bf16 a[120:123], a[240:243], v[120:123], a[120:123]
v_mfma_f32_16x16x32_bf16 a[124:127], a[240:243], v[124:127], a[124:127]
v_mfma_f32_16x16x32_bf16 a[128:131], a[240:243], v[128:131], a[128:131]
v_mfma_f32_16x16x32_bf16 a[132:135], a[240:243], v[132:135], a[132:135]
s_waitcnt vmcnt(4)
v_mfma_f32_16x16x32_bf16 a[136:139], a[240:243], v[136:139], a[136:139]
v_mfma_f32_16x16x32_bf16 a[140:143], a[244:247], v[120:123], a[140:143]
s_add_u32 m0, s48, 16384
v_mfma_f32_16x16x32_bf16 a[144:147], a[244:247], v[124:127], a[144:147]
buffer_load_dwordx4 v222, s[20:23], s37 offen offset:2048 nt lds
v_mfma_f32_16x16x32_bf16 a[148:151], a[244:247], v[128:131], a[148:151]
v_mfma_f32_16x16x32_bf16 a[152:155], a[244:247], v[132:135], a[152:155]
v_mfma_f32_16x16x32_bf16 a[156:159], a[244:247], v[136:139], a[156:159]
s_waitcnt lgkmcnt(0)
v_mfma_f32_16x16x32_bf16 v[80:83], a[184:187], v[0:3], v[160:163]
v_mfma_f32_16x16x32_bf16 v[80:83], a[188:191], v[20:23], v[80:83]
ds_read_b64_tr_b16 a[216:217], v188 offset:32768
v_mfma_f32_16x16x32_bf16 v[80:83], a[192:195], v[40:43], v[80:83]
v_mfma_f32_16x16x32_bf16 v[80:83], a[196:199], v[60:63], v[80:83]
ds_read_b64_tr_b16 a[218:219], v188 offset:36864
v_mfma_f32_16x16x32_bf16 v[84:87], a[196:199], v[64:67], v[164:167]
v_mfma_f32_16x16x32_bf16 v[84:87], a[192:195], v[44:47], v[84:87]
ds_read_b64_tr_b16 a[220:221], v189 offset:32768
s_waitcnt vmcnt(4)
v_mfma_f32_16x16x32_bf16 v[84:87], a[188:191], v[24:27], v[84:87]
v_mfma_f32_16x16x32_bf16 v[84:87], a[184:187], v[4:7], v[84:87]
ds_read_b64_tr_b16 a[222:223], v189 offset:36864
s_add_u32 m0, s48, 16384
v_mfma_f32_16x16x32_bf16 v[88:91], a[184:187], v[8:11], v[168:171]
buffer_load_dwordx4 v223, s[20:23], s37 offen offset:3072 nt lds
v_mfma_f32_16x16x32_bf16 v[88:91], a[188:191], v[28:31], v[88:91]
ds_read_b64_tr_b16 a[224:225], v190 offset:32768
v_mfma_f32_16x16x32_bf16 v[88:91], a[192:195], v[48:51], v[88:91]
v_mfma_f32_16x16x32_bf16 v[88:91], a[196:199], v[68:71], v[88:91]
ds_read_b64_tr_b16 a[226:227], v190 offset:36864
v_mfma_f32_16x16x32_bf16 v[92:95], a[196:199], v[72:75], v[172:175]
v_exp_f32 v80, v80
v_mfma_f32_16x16x32_bf16 v[92:95], a[192:195], v[52:55], v[92:95]
ds_read_b64_tr_b16 a[228:229], v191 offset:32768
v_exp_f32 v81, v81
v_mfma_f32_16x16x32_bf16 v[92:95], a[188:191], v[32:35], v[92:95]
v_exp_f32 v82, v82
v_mfma_f32_16x16x32_bf16 v[92:95], a[184:187], v[12:15], v[92:95]
ds_read_b64_tr_b16 a[230:231], v191 offset:36864
s_waitcnt vmcnt(4)
v_mfma_f32_16x16x32_bf16 v[96:99], a[184:187], v[16:19], v[176:179]
v_exp_f32 v83, v83
v_mfma_f32_16x16x32_bf16 v[96:99], a[188:191], v[36:39], v[96:99]
ds_read_b64_tr_b16 a[232:233], v192 offset:32768
s_add_u32 m0, s48, 65536
s_xor_b32 s36, s3, 139264
v_mfma_f32_16x16x32_bf16 v[96:99], a[192:195], v[56:59], v[96:99]
buffer_load_dwordx4 v220, s[16:19], s36 offen offset:0 nt lds
v_exp_f32 v84, v84
v_mfma_f32_16x16x32_bf16 v[96:99], a[196:199], v[76:79], v[96:99]
ds_read_b64_tr_b16 a[234:235], v192 offset:36864
v_cvt_pk_bf16_f32 v120, v80, v81
v_cvt_pk_bf16_f32 v121, v82, v83
v_mfma_f32_16x16x32_bf16 v[100:103], a[200:203], v[0:3], v[160:163]
v_exp_f32 v85, v85
v_mfma_f32_16x16x32_bf16 v[100:103], a[204:207], v[20:23], v[100:103]
ds_read_b64_tr_b16 a[236:237], v193 offset:32768
v_exp_f32 v86, v86
v_mfma_f32_16x16x32_bf16 v[100:103], a[208:211], v[40:43], v[100:103]
v_exp_f32 v87, v87
v_mfma_f32_16x16x32_bf16 v[100:103], a[212:215], v[60:63], v[100:103]
ds_read_b64_tr_b16 a[238:239], v193 offset:36864
v_exp_f32 v88, v88
v_mfma_f32_16x16x32_bf16 v[104:107], a[212:215], v[64:67], v[164:167]
v_cvt_pk_bf16_f32 v124, v84, v85
v_cvt_pk_bf16_f32 v125, v86, v87
v_mfma_f32_16x16x32_bf16 v[104:107], a[208:211], v[44:47], v[104:107]
ds_read_b64_tr_b16 a[240:241], v194 offset:32768
s_waitcnt vmcnt(4)
v_mfma_f32_16x16x32_bf16 v[104:107], a[204:207], v[24:27], v[104:107]
v_exp_f32 v89, v89
v_mfma_f32_16x16x32_bf16 v[104:107], a[200:203], v[4:7], v[104:107]
ds_read_b64_tr_b16 a[242:243], v194 offset:36864
s_add_u32 m0, s48, 65536
v_mfma_f32_16x16x32_bf16 v[108:111], a[200:203], v[8:11], v[168:171]
buffer_load_dwordx4 v221, s[16:19], s36 offen offset:1024 nt lds
v_exp_f32 v90, v90
v_mfma_f32_16x16x32_bf16 v[108:111], a[204:207], v[28:31], v[108:111]
ds_read_b64_tr_b16 a[244:245], v195 offset:32768
v_exp_f32 v91, v91
v_mfma_f32_16x16x32_bf16 v[108:111], a[208:211], v[48:51], v[108:111]
v_exp_f32 v92, v92
v_mfma_f32_16x16x32_bf16 v[108:111], a[212:215], v[68:71], v[108:111]
ds_read_b64_tr_b16 a[246:247], v195 offset:36864
v_cvt_pk_bf16_f32 v128, v88, v89
v_cvt_pk_bf16_f32 v129, v90, v91
v_mfma_f32_16x16x32_bf16 v[112:115], a[212:215], v[72:75], v[172:175]
v_exp_f32 v93, v93
v_mfma_f32_16x16x32_bf16 v[112:115], a[208:211], v[52:55], v[112:115]
v_exp_f32 v94, v94
v_mfma_f32_16x16x32_bf16 v[112:115], a[204:207], v[32:35], v[112:115]
v_exp_f32 v95, v95
v_mfma_f32_16x16x32_bf16 v[112:115], a[200:203], v[12:15], v[112:115]
v_exp_f32 v96, v96
v_mfma_f32_16x16x32_bf16 v[116:119], a[200:203], v[16:19], v[176:179]
s_waitcnt vmcnt(4)
v_cvt_pk_bf16_f32 v132, v92, v93
v_cvt_pk_bf16_f32 v133, v94, v95
v_mfma_f32_16x16x32_bf16 v[116:119], a[204:207], v[36:39], v[116:119]
v_exp_f32 v97, v97
v_mfma_f32_16x16x32_bf16 v[116:119], a[208:211], v[56:59], v[116:119]
s_add_u32 m0, s48, 65536
v_exp_f32 v98, v98
v_mfma_f32_16x16x32_bf16 v[116:119], a[212:215], v[76:79], v[116:119]
buffer_load_dwordx4 v222, s[16:19], s36 offen offset:2048 nt lds
v_exp_f32 v99, v99
v_mfma_f32_16x16x32_bf16 a[160:163], a[180:183], v[140:143], a[160:163]
v_cvt_pk_bf16_f32 v136, v96, v97
v_cvt_pk_bf16_f32 v137, v98, v99
v_mfma_f32_16x16x32_bf16 a[164:167], a[180:183], v[144:147], a[164:167]
v_exp_f32 v100, v100
v_mfma_f32_16x16x32_bf16 a[168:171], a[180:183], v[148:151], a[168:171]
v_exp_f32 v101, v101
v_mfma_f32_16x16x32_bf16 a[172:175], a[180:183], v[152:155], a[172:175]
s_waitcnt lgkmcnt(0)
s_barrier
v_mfma_f32_16x16x32_bf16 a[176:179], a[180:183], v[156:159], a[176:179]
v_exp_f32 v102, v102
v_mfma_f32_16x16x32_bf16 a[0:3], a[216:219], v[140:143], a[0:3]
ds_read_b128 a[184:187], v204 offset:0
v_exp_f32 v103, v103
v_mfma_f32_16x16x32_bf16 a[4:7], a[216:219], v[144:147], a[4:7]
v_exp_f32 v104, v104
v_mfma_f32_16x16x32_bf16 a[8:11], a[216:219], v[148:151], a[8:11]
s_waitcnt vmcnt(4)
v_cvt_pk_bf16_f32 v122, v100, v101
v_cvt_pk_bf16_f32 v123, v102, v103
v_mfma_f32_16x16x32_bf16 a[12:15], a[216:219], v[152:155], a[12:15]
v_exp_f32 v105, v105
v_mfma_f32_16x16x32_bf16 a[16:19], a[216:219], v[156:159], a[16:19]
ds_read_b128 a[188:191], v205 offset:0
s_add_u32 m0, s48, 65536
v_mfma_f32_16x16x32_bf16 a[20:23], a[220:223], v[140:143], a[20:23]
buffer_load_dwordx4 v223, s[16:19], s36 offen offset:3072 nt lds
v_exp_f32 v106, v106
v_mfma_f32_16x16x32_bf16 a[24:27], a[220:223], v[144:147], a[24:27]
v_exp_f32 v107, v107
v_mfma_f32_16x16x32_bf16 a[28:31], a[220:223], v[148:151], a[28:31]
v_exp_f32 v108, v108
v_mfma_f32_16x16x32_bf16 a[32:35], a[220:223], v[152:155], a[32:35]
ds_read_b128 a[192:195], v206 offset:0
v_cvt_pk_bf16_f32 v126, v104, v105
v_cvt_pk_bf16_f32 v127, v106, v107
v_mfma_f32_16x16x32_bf16 a[36:39], a[220:223], v[156:159], a[36:39]
v_exp_f32 v109, v109
v_mfma_f32_16x16x32_bf16 a[40:43], a[224:227], v[140:143], a[40:43]
v_exp_f32 v110, v110
v_mfma_f32_16x16x32_bf16 a[44:47], a[224:227], v[144:147], a[44:47]
v_exp_f32 v111, v111
v_mfma_f32_16x16x32_bf16 a[48:51], a[224:227], v[148:151], a[48:51]
ds_read_b128 a[196:199], v207 offset:0
s_waitcnt vmcnt(4)
v_mfma_f32_16x16x32_bf16 a[52:55], a[224:227], v[152:155], a[52:55]
v_exp_f32 v112, v112
v_mfma_f32_16x16x32_bf16 a[56:59], a[224:227], v[156:159], a[56:59]
s_add_u32 m0, s48, 49152
s_xor_b32 s37, s3, 131072
v_cvt_pk_bf16_f32 v130, v108, v109
v_mfma_f32_16x16x32_bf16 a[60:63], a[228:231], v[140:143], a[60:63]
buffer_load_dwordx4 v220, s[20:23], s37 offen offset:0 nt lds
v_cvt_pk_bf16_f32 v131, v110, v111
v_mfma_f32_16x16x32_bf16 a[64:67], a[228:231], v[144:147], a[64:67]
ds_read_b128 a[200:203], v204 offset:4096
v_exp_f32 v113, v113
v_mfma_f32_16x16x32_bf16 a[68:71], a[228:231], v[148:151], a[68:71]
v_exp_f32 v114, v114
v_mfma_f32_16x16x32_bf16 a[72:75], a[228:231], v[152:155], a[72:75]
v_exp_f32 v115, v115
v_mfma_f32_16x16x32_bf16 a[76:79], a[228:231], v[156:159], a[76:79]
v_exp_f32 v116, v116
v_mfma_f32_16x16x32_bf16 a[80:83], a[232:235], v[140:143], a[80:83]
ds_read_b128 a[204:207], v205 offset:4096
v_cvt_pk_bf16_f32 v134, v112, v113
v_cvt_pk_bf16_f32 v135, v114, v115
v_mfma_f32_16x16x32_bf16 a[84:87], a[232:235], v[144:147], a[84:87]
v_exp_f32 v117, v117
v_mfma_f32_16x16x32_bf16 a[88:91], a[232:235], v[148:151], a[88:91]
v_exp_f32 v118, v118
v_mfma_f32_16x16x32_bf16 a[92:95], a[232:235], v[152:155], a[92:95]
s_waitcnt vmcnt(4)
v_exp_f32 v119, v119
v_mfma_f32_16x16x32_bf16 a[96:99], a[232:235], v[156:159], a[96:99]
ds_read_b128 a[208:211], v206 offset:4096
v_cvt_pk_bf16_f32 v138, v116, v117
v_cvt_pk_bf16_f32 v139, v118, v119
v_mfma_f32_16x16x32_bf16 a[100:103], a[236:239], v[140:143], a[100:103]
s_add_u32 m0, s48, 49152
v_mfma_f32_16x16x32_bf16 a[104:107], a[236:239], v[144:147], a[104:107]
buffer_load_dwordx4 v221, s[20:23], s37 offen offset:1024 nt lds
v_mfma_f32_16x16x32_bf16 a[108:111], a[236:239], v[148:151], a[108:111]
v_mfma_f32_16x16x32_bf16 a[112:115], a[236:239], v[152:155], a[112:115]
ds_read_b128 a[212:215], v207 offset:4096
v_mfma_f32_16x16x32_bf16 a[116:119], a[236:239], v[156:159], a[116:119]
v_mfma_f32_16x16x32_bf16 a[120:123], a[240:243], v[140:143], a[120:123]
v_mfma_f32_16x16x32_bf16 a[124:127], a[240:243], v[144:147], a[124:127]
v_mfma_f32_16x16x32_bf16 a[128:131], a[240:243], v[148:151], a[128:131]
v_mfma_f32_16x16x32_bf16 a[132:135], a[240:243], v[152:155], a[132:135]
v_mfma_f32_16x16x32_bf16 a[136:139], a[240:243], v[156:159], a[136:139]
s_waitcnt vmcnt(4)
v_mfma_f32_16x16x32_bf16 a[140:143], a[244:247], v[140:143], a[140:143]
v_mfma_f32_16x16x32_bf16 a[144:147], a[244:247], v[144:147], a[144:147]
s_add_u32 m0, s48, 49152
v_mfma_f32_16x16x32_bf16 a[148:151], a[244:247], v[148:151], a[148:151]
buffer_load_dwordx4 v222, s[20:23], s37 offen offset:2048 nt lds
v_mfma_f32_16x16x32_bf16 a[152:155], a[244:247], v[152:155], a[152:155]
v_mfma_f32_16x16x32_bf16 a[156:159], a[244:247], v[156:159], a[156:159]
s_waitcnt lgkmcnt(0)
v_mfma_f32_16x16x32_bf16 v[80:83], a[184:187], v[0:3], v[160:163]
v_mfma_f32_16x16x32_bf16 v[80:83], a[188:191], v[20:23], v[80:83]
ds_read_b64_tr_b16 a[216:217], v196 offset:0
v_mfma_f32_16x16x32_bf16 v[80:83], a[192:195], v[40:43], v[80:83]
v_mfma_f32_16x16x32_bf16 v[80:83], a[196:199], v[60:63], v[80:83]
ds_read_b64_tr_b16 a[218:219], v196 offset:4096
v_mfma_f32_16x16x32_bf16 v[84:87], a[196:199], v[64:67], v[164:167]
v_mfma_f32_16x16x32_bf16 v[84:87], a[192:195], v[44:47], v[84:87]
ds_read_b64_tr_b16 a[220:221], v197 offset:0
s_waitcnt vmcnt(4)
v_mfma_f32_16x16x32_bf16 v[84:87], a[188:191], v[24:27], v[84:87]
v_mfma_f32_16x16x32_bf16 v[84:87], a[184:187], v[4:7], v[84:87]
ds_read_b64_tr_b16 a[222:223], v197 offset:4096
s_add_u32 m0, s48, 49152
v_mfma_f32_16x16x32_bf16 v[88:91], a[184:187], v[8:11], v[168:171]
buffer_load_dwordx4 v223, s[20:23], s37 offen offset:3072 nt lds
v_mfma_f32_16x16x32_bf16 v[88:91], a[188:191], v[28:31], v[88:91]
ds_read_b64_tr_b16 a[224:225], v198 offset:0
v_mfma_f32_16x16x32_bf16 v[88:91], a[192:195], v[48:51], v[88:91]
v_mfma_f32_16x16x32_bf16 v[88:91], a[196:199], v[68:71], v[88:91]
ds_read_b64_tr_b16 a[226:227], v198 offset:4096
v_mfma_f32_16x16x32_bf16 v[92:95], a[196:199], v[72:75], v[172:175]
v_exp_f32 v80, v80
v_mfma_f32_16x16x32_bf16 v[92:95], a[192:195], v[52:55], v[92:95]
ds_read_b64_tr_b16 a[228:229], v199 offset:0
v_exp_f32 v81, v81
v_mfma_f32_16x16x32_bf16 v[92:95], a[188:191], v[32:35], v[92:95]
v_exp_f32 v82, v82
v_mfma_f32_16x16x32_bf16 v[92:95], a[184:187], v[12:15], v[92:95]
ds_read_b64_tr_b16 a[230:231], v199 offset:4096
s_waitcnt vmcnt(4)
v_mfma_f32_16x16x32_bf16 v[96:99], a[184:187], v[16:19], v[176:179]
v_exp_f32 v83, v83
v_mfma_f32_16x16x32_bf16 v[96:99], a[188:191], v[36:39], v[96:99]
ds_read_b64_tr_b16 a[232:233], v200 offset:0
s_add_u32 m0, s48, 98304
s_xor_b32 s36, s3, 147456
v_mfma_f32_16x16x32_bf16 v[96:99], a[192:195], v[56:59], v[96:99]
buffer_load_dwordx4 v220, s[16:19], s36 offen offset:0 nt lds
v_exp_f32 v84, v84
v_mfma_f32_16x16x32_bf16 v[96:99], a[196:199], v[76:79], v[96:99]
ds_read_b64_tr_b16 a[234:235], v200 offset:4096
v_cvt_pk_bf16_f32 v140, v80, v81
v_cvt_pk_bf16_f32 v141, v82, v83
v_mfma_f32_16x16x32_bf16 v[100:103], a[200:203], v[0:3], v[160:163]
v_exp_f32 v85, v85
v_mfma_f32_16x16x32_bf16 v[100:103], a[204:207], v[20:23], v[100:103]
ds_read_b64_tr_b16 a[236:237], v201 offset:0
v_exp_f32 v86, v86
v_mfma_f32_16x16x32_bf16 v[100:103], a[208:211], v[40:43], v[100:103]
v_exp_f32 v87, v87
v_mfma_f32_16x16x32_bf16 v[100:103], a[212:215], v[60:63], v[100:103]
ds_read_b64_tr_b16 a[238:239], v201 offset:4096
v_exp_f32 v88, v88
v_mfma_f32_16x16x32_bf16 v[104:107], a[212:215], v[64:67], v[164:167]
v_cvt_pk_bf16_f32 v144, v84, v85
v_cvt_pk_bf16_f32 v145, v86, v87
v_mfma_f32_16x16x32_bf16 v[104:107], a[208:211], v[44:47], v[104:107]
ds_read_b64_tr_b16 a[240:241], v202 offset:0
v_exp_f32 v89, v89
v_mfma_f32_16x16x32_bf16 v[104:107], a[204:207], v[24:27], v[104:107]
v_exp_f32 v90, v90
v_mfma_f32_16x16x32_bf16 v[104:107], a[200:203], v[4:7], v[104:107]
ds_read_b64_tr_b16 a[242:243], v202 offset:4096
s_waitcnt vmcnt(4)
v_mfma_f32_16x16x32_bf16 v[108:111], a[200:203], v[8:11], v[168:171]
v_exp_f32 v91, v91
v_mfma_f32_16x16x32_bf16 v[108:111], a[204:207], v[28:31], v[108:111]
ds_read_b64_tr_b16 a[244:245], v203 offset:0
s_add_u32 m0, s48, 98304
v_mfma_f32_16x16x32_bf16 v[108:111], a[208:211], v[48:51], v[108:111]
buffer_load_dwordx4 v221, s[16:19], s36 offen offset:1024 nt lds
v_exp_f32 v92, v92
v_mfma_f32_16x16x32_bf16 v[108:111], a[212:215], v[68:71], v[108:111]
ds_read_b64_tr_b16 a[246:247], v203 offset:4096
v_cvt_pk_bf16_f32 v148, v88, v89
v_cvt_pk_bf16_f32 v149, v90, v91
v_mfma_f32_16x16x32_bf16 v[112:115], a[212:215], v[72:75], v[172:175]
v_exp_f32 v93, v93
v_mfma_f32_16x16x32_bf16 v[112:115], a[208:211], v[52:55], v[112:115]
v_exp_f32 v94, v94
v_mfma_f32_16x16x32_bf16 v[112:115], a[204:207], v[32:35], v[112:115]
v_exp_f32 v95, v95
v_mfma_f32_16x16x32_bf16 v[112:115], a[200:203], v[12:15], v[112:115]
v_exp_f32 v96, v96
v_mfma_f32_16x16x32_bf16 v[116:119], a[200:203], v[16:19], v[176:179]
v_cvt_pk_bf16_f32 v152, v92, v93
v_cvt_pk_bf16_f32 v153, v94, v95
v_mfma_f32_16x16x32_bf16 v[116:119], a[204:207], v[36:39], v[116:119]
s_waitcnt vmcnt(4)
v_exp_f32 v97, v97
v_mfma_f32_16x16x32_bf16 v[116:119], a[208:211], v[56:59], v[116:119]
v_exp_f32 v98, v98
v_mfma_f32_16x16x32_bf16 v[116:119], a[212:215], v[76:79], v[116:119]
s_add_u32 m0, s48, 98304
v_exp_f32 v99, v99
v_mfma_f32_16x16x32_bf16 a[160:163], a[180:183], v[120:123], a[160:163]
buffer_load_dwordx4 v222, s[16:19], s36 offen offset:2048 nt lds
v_cvt_pk_bf16_f32 v156, v96, v97
v_cvt_pk_bf16_f32 v157, v98, v99
v_mfma_f32_16x16x32_bf16 a[164:167], a[180:183], v[124:127], a[164:167]
v_exp_f32 v100, v100
v_mfma_f32_16x16x32_bf16 a[168:171], a[180:183], v[128:131], a[168:171]
v_exp_f32 v101, v101
v_mfma_f32_16x16x32_bf16 a[172:175], a[180:183], v[132:135], a[172:175]
s_waitcnt lgkmcnt(0)
s_barrier
v_mfma_f32_16x16x32_bf16 a[176:179], a[180:183], v[136:139], a[176:179]
v_exp_f32 v102, v102
v_mfma_f32_16x16x32_bf16 a[0:3], a[216:219], v[120:123], a[0:3]
ds_read_b128 a[184:187], v204 offset:32768
v_exp_f32 v103, v103
v_mfma_f32_16x16x32_bf16 a[4:7], a[216:219], v[124:127], a[4:7]
v_exp_f32 v104, v104
v_mfma_f32_16x16x32_bf16 a[8:11], a[216:219], v[128:131], a[8:11]
v_cvt_pk_bf16_f32 v142, v100, v101
v_cvt_pk_bf16_f32 v143, v102, v103
v_mfma_f32_16x16x32_bf16 a[12:15], a[216:219], v[132:135], a[12:15]
s_waitcnt vmcnt(4)
v_exp_f32 v105, v105
v_mfma_f32_16x16x32_bf16 a[16:19], a[216:219], v[136:139], a[16:19]
ds_read_b128 a[188:191], v205 offset:32768
v_exp_f32 v106, v106
v_mfma_f32_16x16x32_bf16 a[20:23], a[220:223], v[120:123], a[20:23]
s_add_u32 m0, s48, 98304
v_exp_f32 v107, v107
v_mfma_f32_16x16x32_bf16 a[24:27], a[220:223], v[124:127], a[24:27]
buffer_load_dwordx4 v223, s[16:19], s36 offen offset:3072 nt lds
v_exp_f32 v108, v108
v_mfma_f32_16x16x32_bf16 a[28:31], a[220:223], v[128:131], a[28:31]
v_cvt_pk_bf16_f32 v146, v104, v105
v_cvt_pk_bf16_f32 v147, v106, v107
v_mfma_f32_16x16x32_bf16 a[32:35], a[220:223], v[132:135], a[32:35]
ds_read_b128 a[192:195], v206 offset:32768
v_exp_f32 v109, v109
v_mfma_f32_16x16x32_bf16 a[36:39], a[220:223], v[136:139], a[36:39]
v_exp_f32 v110, v110
v_mfma_f32_16x16x32_bf16 a[40:43], a[224:227], v[120:123], a[40:43]
v_exp_f32 v111, v111
v_mfma_f32_16x16x32_bf16 a[44:47], a[224:227], v[124:127], a[44:47]
v_exp_f32 v112, v112
v_mfma_f32_16x16x32_bf16 a[48:51], a[224:227], v[128:131], a[48:51]
ds_read_b128 a[196:199], v207 offset:32768
v_cvt_pk_bf16_f32 v150, v108, v109
v_cvt_pk_bf16_f32 v151, v110, v111
v_mfma_f32_16x16x32_bf16 a[52:55], a[224:227], v[132:135], a[52:55]
v_exp_f32 v113, v113
v_mfma_f32_16x16x32_bf16 a[56:59], a[224:227], v[136:139], a[56:59]
s_waitcnt vmcnt(4)
v_exp_f32 v114, v114
v_mfma_f32_16x16x32_bf16 a[60:63], a[228:231], v[120:123], a[60:63]
v_exp_f32 v115, v115
v_mfma_f32_16x16x32_bf16 a[64:67], a[228:231], v[124:127], a[64:67]
ds_read_b128 a[200:203], v204 offset:36864
s_add_u32 m0, s48, 81920
s_xor_b32 s37, s3, 139264
v_mfma_f32_16x16x32_bf16 a[68:71], a[228:231], v[128:131], a[68:71]
buffer_load_dwordx4 v220, s[20:23], s37 offen offset:0 nt lds
v_exp_f32 v116, v116
v_mfma_f32_16x16x32_bf16 a[72:75], a[228:231], v[132:135], a[72:75]
v_cvt_pk_bf16_f32 v154, v112, v113
v_cvt_pk_bf16_f32 v155, v114, v115
v_mfma_f32_16x16x32_bf16 a[76:79], a[228:231], v[136:139], a[76:79]
v_exp_f32 v117, v117
v_mfma_f32_16x16x32_bf16 a[80:83], a[232:235], v[120:123], a[80:83]
ds_read_b128 a[204:207], v205 offset:36864
v_exp_f32 v118, v118
v_mfma_f32_16x16x32_bf16 a[84:87], a[232:235], v[124:127], a[84:87]
v_exp_f32 v119, v119
v_mfma_f32_16x16x32_bf16 a[88:91], a[232:235], v[128:131], a[88:91]
v_cvt_pk_bf16_f32 v158, v116, v117
v_cvt_pk_bf16_f32 v159, v118, v119
v_mfma_f32_16x16x32_bf16 a[92:95], a[232:235], v[132:135], a[92:95]
v_mfma_f32_16x16x32_bf16 a[96:99], a[232:235], v[136:139], a[96:99]
ds_read_b128 a[208:211], v206 offset:36864
s_waitcnt vmcnt(4)
v_mfma_f32_16x16x32_bf16 a[100:103], a[236:239], v[120:123], a[100:103]
v_mfma_f32_16x16x32_bf16 a[104:107], a[236:239], v[124:127], a[104:107]
s_add_u32 m0, s48, 81920
v_mfma_f32_16x16x32_bf16 a[108:111], a[236:239], v[128:131], a[108:111]
buffer_load_dwordx4 v221, s[20:23], s37 offen offset:1024 nt lds
v_mfma_f32_16x16x32_bf16 a[112:115], a[236:239], v[132:135], a[112:115]
ds_read_b128 a[212:215], v207 offset:36864
v_mfma_f32_16x16x32_bf16 a[116:119], a[236:239], v[136:139], a[116:119]
v_mfma_f32_16x16x32_bf16 a[120:123], a[240:243], v[120:123], a[120:123]
v_mfma_f32_16x16x32_bf16 a[124:127], a[240:243], v[124:127], a[124:127]
v_mfma_f32_16x16x32_bf16 a[128:131], a[240:243], v[128:131], a[128:131]
v_mfma_f32_16x16x32_bf16 a[132:135], a[240:243], v[132:135], a[132:135]
v_mfma_f32_16x16x32_bf16 a[136:139], a[240:243], v[136:139], a[136:139]
s_waitcnt vmcnt(4)
v_mfma_f32_16x16x32_bf16 a[140:143], a[244:247], v[120:123], a[140:143]
v_mfma_f32_16x16x32_bf16 a[144:147], a[244:247], v[124:127], a[144:147]
s_add_u32 m0, s48, 81920
v_mfma_f32_16x16x32_bf16 a[148:151], a[244:247], v[128:131], a[148:151]
buffer_load_dwordx4 v222, s[20:23], s37 offen offset:2048 nt lds
v_mfma_f32_16x16x32_bf16 a[152:155], a[244:247], v[132:135], a[152:155]
v_mfma_f32_16x16x32_bf16 a[156:159], a[244:247], v[136:139], a[156:159]
s_waitcnt lgkmcnt(0)
v_mfma_f32_16x16x32_bf16 v[80:83], a[184:187], v[0:3], v[160:163]
v_mfma_f32_16x16x32_bf16 v[80:83], a[188:191], v[20:23], v[80:83]
ds_read_b64_tr_b16 a[216:217], v180 offset:0
v_mfma_f32_16x16x32_bf16 v[80:83], a[192:195], v[40:43], v[80:83]
v_mfma_f32_16x16x32_bf16 v[80:83], a[196:199], v[60:63], v[80:83]
ds_read_b64_tr_b16 a[218:219], v180 offset:4096
v_mfma_f32_16x16x32_bf16 v[84:87], a[196:199], v[64:67], v[164:167]
v_mfma_f32_16x16x32_bf16 v[84:87], a[192:195], v[44:47], v[84:87]
ds_read_b64_tr_b16 a[220:221], v181 offset:0
v_mfma_f32_16x16x32_bf16 v[84:87], a[188:191], v[24:27], v[84:87]
v_mfma_f32_16x16x32_bf16 v[84:87], a[184:187], v[4:7], v[84:87]
ds_read_b64_tr_b16 a[222:223], v181 offset:4096
s_waitcnt vmcnt(4)
v_mfma_f32_16x16x32_bf16 v[88:91], a[184:187], v[8:11], v[168:171]
v_mfma_f32_16x16x32_bf16 v[88:91], a[188:191], v[28:31], v[88:91]
ds_read_b64_tr_b16 a[224:225], v182 offset:0
s_add_u32 m0, s48, 81920
v_mfma_f32_16x16x32_bf16 v[88:91], a[192:195], v[48:51], v[88:91]
buffer_load_dwordx4 v223, s[20:23], s37 offen offset:3072 nt lds
v_mfma_f32_16x16x32_bf16 v[88:91], a[196:199], v[68:71], v[88:91]
ds_read_b64_tr_b16 a[226:227], v182 offset:4096
v_mfma_f32_16x16x32_bf16 v[92:95], a[196:199], v[72:75], v[172:175]
v_exp_f32 v80, v80
v_mfma_f32_16x16x32_bf16 v[92:95], a[192:195], v[52:55], v[92:95]
ds_read_b64_tr_b16 a[228:229], v183 offset:0
v_exp_f32 v81, v81
v_mfma_f32_16x16x32_bf16 v[92:95], a[188:191], v[32:35], v[92:95]
v_exp_f32 v82, v82
v_mfma_f32_16x16x32_bf16 v[92:95], a[184:187], v[12:15], v[92:95]
ds_read_b64_tr_b16 a[230:231], v183 offset:4096
v_exp_f32 v83, v83
v_mfma_f32_16x16x32_bf16 v[96:99], a[184:187], v[16:19], v[176:179]
v_exp_f32 v84, v84
v_mfma_f32_16x16x32_bf16 v[96:99], a[188:191], v[36:39], v[96:99]
ds_read_b64_tr_b16 a[232:233], v184 offset:0
s_waitcnt vmcnt(4)
v_cvt_pk_bf16_f32 v120, v80, v81
v_mfma_f32_16x16x32_bf16 v[96:99], a[192:195], v[56:59], v[96:99]
v_cvt_pk_bf16_f32 v121, v82, v83
v_mfma_f32_16x16x32_bf16 v[96:99], a[196:199], v[76:79], v[96:99]
ds_read_b64_tr_b16 a[234:235], v184 offset:4096
s_add_u32 m0, s48, 131072
s_xor_b32 s36, s3, 155648
v_mfma_f32_16x16x32_bf16 v[100:103], a[200:203], v[0:3], v[160:163]
buffer_load_dwordx4 v220, s[16:19], s36 offen offset:0 nt lds
v_exp_f32 v85, v85
v_mfma_f32_16x16x32_bf16 v[100:103], a[204:207], v[20:23], v[100:103]
ds_read_b64_tr_b16 a[236:237], v185 offset:0
v_exp_f32 v86, v86
v_mfma_f32_16x16x32_bf16 v[100:103], a[208:211], v[40:43], v[100:103]
v_exp_f32 v87, v87
v_mfma_f32_16x16x32_bf16 v[100:103], a[212:215], v[60:63], v[100:103]
ds_read_b64_tr_b16 a[238:239], v185 offset:4096
v_exp_f32 v88, v88
v_mfma_f32_16x16x32_bf16 v[104:107], a[212:215], v[64:67], v[164:167]
v_cvt_pk_bf16_f32 v124, v84, v85
v_cvt_pk_bf16_f32 v125, v86, v87
v_mfma_f32_16x16x32_bf16 v[104:107], a[208:211], v[44:47], v[104:107]
ds_read_b64_tr_b16 a[240:241], v186 offset:0
v_exp_f32 v89, v89
v_mfma_f32_16x16x32_bf16 v[104:107], a[204:207], v[24:27], v[104:107]
v_exp_f32 v90, v90
v_mfma_f32_16x16x32_bf16 v[104:107], a[200:203], v[4:7], v[104:107]
ds_read_b64_tr_b16 a[242:243], v186 offset:4096
s_waitcnt vmcnt(4)
v_mfma_f32_16x16x32_bf16 v[108:111], a[200:203], v[8:11], v[168:171]
v_exp_f32 v91, v91
v_mfma_f32_16x16x32_bf16 v[108:111], a[204:207], v[28:31], v[108:111]
ds_read_b64_tr_b16 a[244:245], v187 offset:0
s_add_u32 m0, s48, 131072
v_mfma_f32_16x16x32_bf16 v[108:111], a[208:211], v[48:51], v[108:111]
buffer_load_dwordx4 v221, s[16:19], s36 offen offset:1024 nt lds
v_exp_f32 v92, v92
v_mfma_f32_16x16x32_bf16 v[108:111], a[212:215], v[68:71], v[108:111]
ds_read_b64_tr_b16 a[246:247], v187 offset:4096
v_cvt_pk_bf16_f32 v128, v88, v89
v_cvt_pk_bf16_f32 v129, v90, v91
v_mfma_f32_16x16x32_bf16 v[112:115], a[212:215], v[72:75], v[172:175]
v_exp_f32 v93, v93
v_mfma_f32_16x16x32_bf16 v[112:115], a[208:211], v[52:55], v[112:115]
v_exp_f32 v94, v94
v_mfma_f32_16x16x32_bf16 v[112:115], a[204:207], v[32:35], v[112:115]
v_exp_f32 v95, v95
v_mfma_f32_16x16x32_bf16 v[112:115], a[200:203], v[12:15], v[112:115]
v_exp_f32 v96, v96
v_mfma_f32_16x16x32_bf16 v[116:119], a[200:203], v[16:19], v[176:179]
v_cvt_pk_bf16_f32 v132, v92, v93
v_cvt_pk_bf16_f32 v133, v94, v95
v_mfma_f32_16x16x32_bf16 v[116:119], a[204:207], v[36:39], v[116:119]
v_exp_f32 v97, v97
v_mfma_f32_16x16x32_bf16 v[116:119], a[208:211], v[56:59], v[116:119]
s_waitcnt vmcnt(4)
v_exp_f32 v98, v98
v_mfma_f32_16x16x32_bf16 v[116:119], a[212:215], v[76:79], v[116:119]
v_exp_f32 v99, v99
v_mfma_f32_16x16x32_bf16 a[160:163], a[180:183], v[140:143], a[160:163]
s_add_u32 m0, s48, 131072
v_cvt_pk_bf16_f32 v136, v96, v97
v_cvt_pk_bf16_f32 v137, v98, v99
v_mfma_f32_16x16x32_bf16 a[164:167], a[180:183], v[144:147], a[164:167]
buffer_load_dwordx4 v222, s[16:19], s36 offen offset:2048 nt lds
v_exp_f32 v100, v100
v_mfma_f32_16x16x32_bf16 a[168:171], a[180:183], v[148:151], a[168:171]
v_exp_f32 v101, v101
v_mfma_f32_16x16x32_bf16 a[172:175], a[180:183], v[152:155], a[172:175]
s_waitcnt lgkmcnt(0)
s_barrier
v_mfma_f32_16x16x32_bf16 a[176:179], a[180:183], v[156:159], a[176:179]
v_exp_f32 v102, v102
v_mfma_f32_16x16x32_bf16 a[0:3], a[216:219], v[140:143], a[0:3]
ds_read_b128 a[184:187], v208 offset:0
v_exp_f32 v103, v103
v_mfma_f32_16x16x32_bf16 a[4:7], a[216:219], v[144:147], a[4:7]
v_exp_f32 v104, v104
v_mfma_f32_16x16x32_bf16 a[8:11], a[216:219], v[148:151], a[8:11]
v_cvt_pk_bf16_f32 v122, v100, v101
v_cvt_pk_bf16_f32 v123, v102, v103
v_mfma_f32_16x16x32_bf16 a[12:15], a[216:219], v[152:155], a[12:15]
v_exp_f32 v105, v105
v_mfma_f32_16x16x32_bf16 a[16:19], a[216:219], v[156:159], a[16:19]
ds_read_b128 a[188:191], v209 offset:0
s_waitcnt vmcnt(4)
v_mfma_f32_16x16x32_bf16 a[20:23], a[220:223], v[140:143], a[20:23]
v_exp_f32 v106, v106
v_mfma_f32_16x16x32_bf16 a[24:27], a[220:223], v[144:147], a[24:27]
s_add_u32 m0, s48, 131072
v_exp_f32 v107, v107
v_mfma_f32_16x16x32_bf16 a[28:31], a[220:223], v[148:151], a[28:31]
buffer_load_dwordx4 v223, s[16:19], s36 offen offset:3072 nt lds
v_exp_f32 v108, v108
v_mfma_f32_16x16x32_bf16 a[32:35], a[220:223], v[152:155], a[32:35]
ds_read_b128 a[192:195], v210 offset:0
v_cvt_pk_bf16_f32 v126, v104, v105
v_cvt_pk_bf16_f32 v127, v106, v107
v_mfma_f32_16x16x32_bf16 a[36:39], a[220:223], v[156:159], a[36:39]
v_exp_f32 v109, v109
v_mfma_f32_16x16x32_bf16 a[40:43], a[224:227], v[140:143], a[40:43]
v_exp_f32 v110, v110
v_mfma_f32_16x16x32_bf16 a[44:47], a[224:227], v[144:147], a[44:47]
v_exp_f32 v111, v111
v_mfma_f32_16x16x32_bf16 a[48:51], a[224:227], v[148:151], a[48:51]
ds_read_b128 a[196:199], v211 offset:0
v_exp_f32 v112, v112
v_mfma_f32_16x16x32_bf16 a[52:55], a[224:227], v[152:155], a[52:55]
v_cvt_pk_bf16_f32 v130, v108, v109
v_cvt_pk_bf16_f32 v131, v110, v111
v_mfma_f32_16x16x32_bf16 a[56:59], a[224:227], v[156:159], a[56:59]
s_waitcnt vmcnt(4)
v_exp_f32 v113, v113
v_mfma_f32_16x16x32_bf16 a[60:63], a[228:231], v[140:143], a[60:63]
v_exp_f32 v114, v114
v_mfma_f32_16x16x32_bf16 a[64:67], a[228:231], v[144:147], a[64:67]
ds_read_b128 a[200:203], v208 offset:4096
s_add_u32 m0, s48, 114688
s_xor_b32 s37, s3, 147456
v_mfma_f32_16x16x32_bf16 a[68:71], a[228:231], v[148:151], a[68:71]
buffer_load_dwordx4 v220, s[20:23], s37 offen offset:0 nt lds
v_exp_f32 v115, v115
v_mfma_f32_16x16x32_bf16 a[72:75], a[228:231], v[152:155], a[72:75]
v_exp_f32 v116, v116
v_mfma_f32_16x16x32_bf16 a[76:79], a[228:231], v[156:159], a[76:79]
v_cvt_pk_bf16_f32 v134, v112, v113
v_cvt_pk_bf16_f32 v135, v114, v115
v_mfma_f32_16x16x32_bf16 a[80:83], a[232:235], v[140:143], a[80:83]
ds_read_b128 a[204:207], v209 offset:4096
v_exp_f32 v117, v117
v_mfma_f32_16x16x32_bf16 a[84:87], a[232:235], v[144:147], a[84:87]
v_exp_f32 v118, v118
v_mfma_f32_16x16x32_bf16 a[88:91], a[232:235], v[148:151], a[88:91]
v_exp_f32 v119, v119
v_mfma_f32_16x16x32_bf16 a[92:95], a[232:235], v[152:155], a[92:95]
v_cvt_pk_bf16_f32 v138, v116, v117
v_cvt_pk_bf16_f32 v139, v118, v119
v_mfma_f32_16x16x32_bf16 a[96:99], a[232:235], v[156:159], a[96:99]
ds_read_b128 a[208:211], v210 offset:4096
v_mfma_f32_16x16x32_bf16 a[100:103], a[236:239], v[140:143], a[100:103]
v_mfma_f32_16x16x32_bf16 a[104:107], a[236:239], v[144:147], a[104:107]
s_waitcnt vmcnt(4)
v_mfma_f32_16x16x32_bf16 a[108:111], a[236:239], v[148:151], a[108:111]
v_mfma_f32_16x16x32_bf16 a[112:115], a[236:239], v[152:155], a[112:115]
ds_read_b128 a[212:215], v211 offset:4096
s_add_u32 m0, s48, 114688
v_mfma_f32_16x16x32_bf16 a[116:119], a[236:239], v[156:159], a[116:119]
buffer_load_dwordx4 v221, s[20:23], s37 offen offset:1024 nt lds
v_mfma_f32_16x16x32_bf16 a[120:123], a[240:243], v[140:143], a[120:123]
v_mfma_f32_16x16x32_bf16 a[124:127], a[240:243], v[144:147], a[124:127]
v_mfma_f32_16x16x32_bf16 a[128:131], a[240:243], v[148:151], a[128:131]
v_mfma_f32_16x16x32_bf16 a[132:135], a[240:243], v[152:155], a[132:135]
v_mfma_f32_16x16x32_bf16 a[136:139], a[240:243], v[156:159], a[136:139]
s_waitcnt vmcnt(4)
v_mfma_f32_16x16x32_bf16 a[140:143], a[244:247], v[140:143], a[140:143]
v_mfma_f32_16x16x32_bf16 a[144:147], a[244:247], v[144:147], a[144:147]
s_add_u32 m0, s48, 114688
v_mfma_f32_16x16x32_bf16 a[148:151], a[244:247], v[148:151], a[148:151]
buffer_load_dwordx4 v222, s[20:23], s37 offen offset:2048 nt lds
v_mfma_f32_16x16x32_bf16 a[152:155], a[244:247], v[152:155], a[152:155]
v_mfma_f32_16x16x32_bf16 a[156:159], a[244:247], v[156:159], a[156:159]
s_waitcnt lgkmcnt(0)
v_mfma_f32_16x16x32_bf16 v[80:83], a[184:187], v[0:3], v[160:163]
v_mfma_f32_16x16x32_bf16 v[80:83], a[188:191], v[20:23], v[80:83]
ds_read_b64_tr_b16 a[216:217], v180 offset:32768
v_mfma_f32_16x16x32_bf16 v[80:83], a[192:195], v[40:43], v[80:83]
v_mfma_f32_16x16x32_bf16 v[80:83], a[196:199], v[60:63], v[80:83]
ds_read_b64_tr_b16 a[218:219], v180 offset:36864
v_mfma_f32_16x16x32_bf16 v[84:87], a[196:199], v[64:67], v[164:167]
v_mfma_f32_16x16x32_bf16 v[84:87], a[192:195], v[44:47], v[84:87]
ds_read_b64_tr_b16 a[220:221], v181 offset:32768
v_mfma_f32_16x16x32_bf16 v[84:87], a[188:191], v[24:27], v[84:87]
v_mfma_f32_16x16x32_bf16 v[84:87], a[184:187], v[4:7], v[84:87]
ds_read_b64_tr_b16 a[222:223], v181 offset:36864
s_waitcnt vmcnt(4)
v_mfma_f32_16x16x32_bf16 v[88:91], a[184:187], v[8:11], v[168:171]
v_mfma_f32_16x16x32_bf16 v[88:91], a[188:191], v[28:31], v[88:91]
ds_read_b64_tr_b16 a[224:225], v182 offset:32768
s_add_u32 m0, s48, 114688
v_mfma_f32_16x16x32_bf16 v[88:91], a[192:195], v[48:51], v[88:91]
buffer_load_dwordx4 v223, s[20:23], s37 offen offset:3072 nt lds
v_mfma_f32_16x16x32_bf16 v[88:91], a[196:199], v[68:71], v[88:91]
ds_read_b64_tr_b16 a[226:227], v182 offset:36864
v_mfma_f32_16x16x32_bf16 v[92:95], a[196:199], v[72:75], v[172:175]
v_exp_f32 v80, v80
v_mfma_f32_16x16x32_bf16 v[92:95], a[192:195], v[52:55], v[92:95]
ds_read_b64_tr_b16 a[228:229], v183 offset:32768
v_exp_f32 v81, v81
v_mfma_f32_16x16x32_bf16 v[92:95], a[188:191], v[32:35], v[92:95]
v_exp_f32 v82, v82
v_mfma_f32_16x16x32_bf16 v[92:95], a[184:187], v[12:15], v[92:95]
ds_read_b64_tr_b16 a[230:231], v183 offset:36864
v_exp_f32 v83, v83
v_mfma_f32_16x16x32_bf16 v[96:99], a[184:187], v[16:19], v[176:179]
v_exp_f32 v84, v84
v_mfma_f32_16x16x32_bf16 v[96:99], a[188:191], v[36:39], v[96:99]
ds_read_b64_tr_b16 a[232:233], v184 offset:32768
s_waitcnt vmcnt(4)
v_cvt_pk_bf16_f32 v140, v80, v81
v_mfma_f32_16x16x32_bf16 v[96:99], a[192:195], v[56:59], v[96:99]
v_cvt_pk_bf16_f32 v141, v82, v83
v_mfma_f32_16x16x32_bf16 v[96:99], a[196:199], v[76:79], v[96:99]
ds_read_b64_tr_b16 a[234:235], v184 offset:36864
s_add_u32 m0, s48, 0
s_xor_b32 s36, s3, 163840
v_mfma_f32_16x16x32_bf16 v[100:103], a[200:203], v[0:3], v[160:163]
buffer_load_dwordx4 v220, s[16:19], s36 offen offset:0 nt lds
v_exp_f32 v85, v85
v_mfma_f32_16x16x32_bf16 v[100:103], a[204:207], v[20:23], v[100:103]
ds_read_b64_tr_b16 a[236:237], v185 offset:32768
v_exp_f32 v86, v86
v_mfma_f32_16x16x32_bf16 v[100:103], a[208:211], v[40:43], v[100:103]
v_exp_f32 v87, v87
v_mfma_f32_16x16x32_bf16 v[100:103], a[212:215], v[60:63], v[100:103]
ds_read_b64_tr_b16 a[238:239], v185 offset:36864
v_exp_f32 v88, v88
v_mfma_f32_16x16x32_bf16 v[104:107], a[212:215], v[64:67], v[164:167]
v_cvt_pk_bf16_f32 v144, v84, v85
v_cvt_pk_bf16_f32 v145, v86, v87
v_mfma_f32_16x16x32_bf16 v[104:107], a[208:211], v[44:47], v[104:107]
ds_read_b64_tr_b16 a[240:241], v186 offset:32768
v_exp_f32 v89, v89
v_mfma_f32_16x16x32_bf16 v[104:107], a[204:207], v[24:27], v[104:107]
v_exp_f32 v90, v90
v_mfma_f32_16x16x32_bf16 v[104:107], a[200:203], v[4:7], v[104:107]
ds_read_b64_tr_b16 a[242:243], v186 offset:36864
v_exp_f32 v91, v91
v_mfma_f32_16x16x32_bf16 v[108:111], a[200:203], v[8:11], v[168:171]
v_exp_f32 v92, v92
v_mfma_f32_16x16x32_bf16 v[108:111], a[204:207], v[28:31], v[108:111]
ds_read_b64_tr_b16 a[244:245], v187 offset:32768
s_waitcnt vmcnt(4)
v_cvt_pk_bf16_f32 v148, v88, v89
v_mfma_f32_16x16x32_bf16 v[108:111], a[208:211], v[48:51], v[108:111]
v_cvt_pk_bf16_f32 v149, v90, v91
v_mfma_f32_16x16x32_bf16 v[108:111], a[212:215], v[68:71], v[108:111]
ds_read_b64_tr_b16 a[246:247], v187 offset:36864
s_add_u32 m0, s48, 0
v_mfma_f32_16x16x32_bf16 v[112:115], a[212:215], v[72:75], v[172:175]
buffer_load_dwordx4 v221, s[16:19], s36 offen offset:1024 nt lds
v_exp_f32 v93, v93
v_mfma_f32_16x16x32_bf16 v[112:115], a[208:211], v[52:55], v[112:115]
v_exp_f32 v94, v94
v_mfma_f32_16x16x32_bf16 v[112:115], a[204:207], v[32:35], v[112:115]
v_exp_f32 v95, v95
v_mfma_f32_16x16x32_bf16 v[112:115], a[200:203], v[12:15], v[112:115]
v_exp_f32 v96, v96
v_mfma_f32_16x16x32_bf16 v[116:119], a[200:203], v[16:19], v[176:179]
v_cvt_pk_bf16_f32 v152, v92, v93
v_cvt_pk_bf16_f32 v153, v94, v95
v_mfma_f32_16x16x32_bf16 v[116:119], a[204:207], v[36:39], v[116:119]
s_waitcnt vmcnt(4)
v_exp_f32 v97, v97
v_mfma_f32_16x16x32_bf16 v[116:119], a[208:211], v[56:59], v[116:119]
v_exp_f32 v98, v98
v_mfma_f32_16x16x32_bf16 v[116:119], a[212:215], v[76:79], v[116:119]
s_add_u32 m0, s48, 0
v_exp_f32 v99, v99
v_mfma_f32_16x16x32_bf16 a[160:163], a[180:183], v[120:123], a[160:163]
buffer_load_dwordx4 v222, s[16:19], s36 offen offset:2048 nt lds
v_cvt_pk_bf16_f32 v156, v96, v97
v_cvt_pk_bf16_f32 v157, v98, v99
v_mfma_f32_16x16x32_bf16 a[164:167], a[180:183], v[124:127], a[164:167]
v_exp_f32 v100, v100
v_mfma_f32_16x16x32_bf16 a[168:171], a[180:183], v[128:131], a[168:171]
v_exp_f32 v101, v101
v_mfma_f32_16x16x32_bf16 a[172:175], a[180:183], v[132:135], a[172:175]
s_waitcnt lgkmcnt(0)
s_barrier
v_mfma_f32_16x16x32_bf16 a[176:179], a[180:183], v[136:139], a[176:179]
v_exp_f32 v102, v102
v_mfma_f32_16x16x32_bf16 a[0:3], a[216:219], v[120:123], a[0:3]
ds_read_b128 a[184:187], v208 offset:32768
v_exp_f32 v103, v103
v_mfma_f32_16x16x32_bf16 a[4:7], a[216:219], v[124:127], a[4:7]
v_exp_f32 v104, v104
v_mfma_f32_16x16x32_bf16 a[8:11], a[216:219], v[128:131], a[8:11]
v_cvt_pk_bf16_f32 v142, v100, v101
v_cvt_pk_bf16_f32 v143, v102, v103
v_mfma_f32_16x16x32_bf16 a[12:15], a[216:219], v[132:135], a[12:15]
v_exp_f32 v105, v105
v_mfma_f32_16x16x32_bf16 a[16:19], a[216:219], v[136:139], a[16:19]
ds_read_b128 a[188:191], v209 offset:32768
v_exp_f32 v106, v106
v_mfma_f32_16x16x32_bf16 a[20:23], a[220:223], v[120:123], a[20:23]
v_exp_f32 v107, v107
v_mfma_f32_16x16x32_bf16 a[24:27], a[220:223], v[124:127], a[24:27]
s_waitcnt vmcnt(4)
v_exp_f32 v108, v108
v_mfma_f32_16x16x32_bf16 a[28:31], a[220:223], v[128:131], a[28:31]
v_cvt_pk_bf16_f32 v146, v104, v105
v_cvt_pk_bf16_f32 v147, v106, v107
v_mfma_f32_16x16x32_bf16 a[32:35], a[220:223], v[132:135], a[32:35]
ds_read_b128 a[192:195], v210 offset:32768
s_add_u32 m0, s48, 0
v_mfma_f32_16x16x32_bf16 a[36:39], a[220:223], v[136:139], a[36:39]
buffer_load_dwordx4 v223, s[16:19], s36 offen offset:3072 nt lds
v_exp_f32 v109, v109
v_mfma_f32_16x16x32_bf16 a[40:43], a[224:227], v[120:123], a[40:43]
v_exp_f32 v110, v110
v_mfma_f32_16x16x32_bf16 a[44:47], a[224:227], v[124:127], a[44:47]
v_exp_f32 v111, v111
v_mfma_f32_16x16x32_bf16 a[48:51], a[224:227], v[128:131], a[48:51]
ds_read_b128 a[196:199], v211 offset:32768
v_exp_f32 v112, v112
v_mfma_f32_16x16x32_bf16 a[52:55], a[224:227], v[132:135], a[52:55]
v_cvt_pk_bf16_f32 v150, v108, v109
v_cvt_pk_bf16_f32 v151, v110, v111
v_mfma_f32_16x16x32_bf16 a[56:59], a[224:227], v[136:139], a[56:59]
v_exp_f32 v113, v113
v_mfma_f32_16x16x32_bf16 a[60:63], a[228:231], v[120:123], a[60:63]
s_waitcnt vmcnt(4)
v_exp_f32 v114, v114
v_mfma_f32_16x16x32_bf16 a[64:67], a[228:231], v[124:127], a[64:67]
ds_read_b128 a[200:203], v208 offset:36864
v_exp_f32 v115, v115
v_mfma_f32_16x16x32_bf16 a[68:71], a[228:231], v[128:131], a[68:71]
s_add_u32 m0, s48, 147456
s_xor_b32 s37, s3, 155648
v_mfma_f32_16x16x32_bf16 a[72:75], a[228:231], v[132:135], a[72:75]
buffer_load_dwordx4 v220, s[20:23], s37 offen offset:0 nt lds
v_exp_f32 v116, v116
v_mfma_f32_16x16x32_bf16 a[76:79], a[228:231], v[136:139], a[76:79]
v_cvt_pk_bf16_f32 v154, v112, v113
v_cvt_pk_bf16_f32 v155, v114, v115
v_mfma_f32_16x16x32_bf16 a[80:83], a[232:235], v[120:123], a[80:83]
ds_read_b128 a[204:207], v209 offset:36864
v_exp_f32 v117, v117
v_mfma_f32_16x16x32_bf16 a[84:87], a[232:235], v[124:127], a[84:87]
v_exp_f32 v118, v118
v_mfma_f32_16x16x32_bf16 a[88:91], a[232:235], v[128:131], a[88:91]
v_exp_f32 v119, v119
v_mfma_f32_16x16x32_bf16 a[92:95], a[232:235], v[132:135], a[92:95]
v_cvt_pk_bf16_f32 v158, v116, v117
v_cvt_pk_bf16_f32 v159, v118, v119
v_mfma_f32_16x16x32_bf16 a[96:99], a[232:235], v[136:139], a[96:99]
ds_read_b128 a[208:211], v210 offset:36864
v_mfma_f32_16x16x32_bf16 a[100:103], a[236:239], v[120:123], a[100:103]
v_mfma_f32_16x16x32_bf16 a[104:107], a[236:239], v[124:127], a[104:107]
s_waitcnt vmcnt(4)
v_mfma_f32_16x16x32_bf16 a[108:111], a[236:239], v[128:131], a[108:111]
v_mfma_f32_16x16x32_bf16 a[112:115], a[236:239], v[132:135], a[112:115]
ds_read_b128 a[212:215], v211 offset:36864
s_add_u32 m0, s48, 147456
v_mfma_f32_16x16x32_bf16 a[116:119], a[236:239], v[136:139], a[116:119]
buffer_load_dwordx4 v221, s[20:23], s37 offen offset:1024 nt lds
v_mfma_f32_16x16x32_bf16 a[120:123], a[240:243], v[120:123], a[120:123]
v_mfma_f32_16x16x32_bf16 a[124:127], a[240:243], v[124:127], a[124:127]
v_mfma_f32_16x16x32_bf16 a[128:131], a[240:243], v[128:131], a[128:131]
v_mfma_f32_16x16x32_bf16 a[132:135], a[240:243], v[132:135], a[132:135]
v_mfma_f32_16x16x32_bf16 a[136:139], a[240:243], v[136:139], a[136:139]
v_mfma_f32_16x16x32_bf16 a[140:143], a[244:247], v[120:123], a[140:143]
v_mfma_f32_16x16x32_bf16 a[144:147], a[244:247], v[124:127], a[144:147]
v_mfma_f32_16x16x32_bf16 a[148:151], a[244:247], v[128:131], a[148:151]
v_mfma_f32_16x16x32_bf16 a[152:155], a[244:247], v[132:135], a[152:155]
v_mfma_f32_16x16x32_bf16 a[156:159], a[244:247], v[136:139], a[156:159]
s_waitcnt lgkmcnt(0)
v_mfma_f32_16x16x32_bf16 v[80:83], a[184:187], v[0:3], v[160:163]
s_waitcnt vmcnt(4)
v_mfma_f32_16x16x32_bf16 v[80:83], a[188:191], v[20:23], v[80:83]
ds_read_b64_tr_b16 a[216:217], v188 offset:0
s_add_u32 m0, s48, 147456
v_mfma_f32_16x16x32_bf16 v[80:83], a[192:195], v[40:43], v[80:83]
buffer_load_dwordx4 v222, s[20:23], s37 offen offset:2048 nt lds
v_mfma_f32_16x16x32_bf16 v[80:83], a[196:199], v[60:63], v[80:83]
ds_read_b64_tr_b16 a[218:219], v188 offset:4096
v_mfma_f32_16x16x32_bf16 v[84:87], a[196:199], v[64:67], v[164:167]
v_mfma_f32_16x16x32_bf16 v[84:87], a[192:195], v[44:47], v[84:87]
ds_read_b64_tr_b16 a[220:221], v189 offset:0
v_mfma_f32_16x16x32_bf16 v[84:87], a[188:191], v[24:27], v[84:87]
v_mfma_f32_16x16x32_bf16 v[84:87], a[184:187], v[4:7], v[84:87]
ds_read_b64_tr_b16 a[222:223], v189 offset:4096
v_mfma_f32_16x16x32_bf16 v[88:91], a[184:187], v[8:11], v[168:171]
v_mfma_f32_16x16x32_bf16 v[88:91], a[188:191], v[28:31], v[88:91]
ds_read_b64_tr_b16 a[224:225], v190 offset:0
s_waitcnt vmcnt(4)
v_mfma_f32_16x16x32_bf16 v[88:91], a[192:195], v[48:51], v[88:91]
v_mfma_f32_16x16x32_bf16 v[88:91], a[196:199], v[68:71], v[88:91]
ds_read_b64_tr_b16 a[226:227], v190 offset:4096
s_add_u32 m0, s48, 147456
v_mfma_f32_16x16x32_bf16 v[92:95], a[196:199], v[72:75], v[172:175]
buffer_load_dwordx4 v223, s[20:23], s37 offen offset:3072 nt lds
v_exp_f32 v80, v80
v_mfma_f32_16x16x32_bf16 v[92:95], a[192:195], v[52:55], v[92:95]
ds_read_b64_tr_b16 a[228:229], v191 offset:0
v_exp_f32 v81, v81
v_mfma_f32_16x16x32_bf16 v[92:95], a[188:191], v[32:35], v[92:95]
v_exp_f32 v82, v82
v_mfma_f32_16x16x32_bf16 v[92:95], a[184:187], v[12:15], v[92:95]
ds_read_b64_tr_b16 a[230:231], v191 offset:4096
v_exp_f32 v83, v83
v_mfma_f32_16x16x32_bf16 v[96:99], a[184:187], v[16:19], v[176:179]
v_exp_f32 v84, v84
v_mfma_f32_16x16x32_bf16 v[96:99], a[188:191], v[36:39], v[96:99]
ds_read_b64_tr_b16 a[232:233], v192 offset:0
v_cvt_pk_bf16_f32 v120, v80, v81
v_cvt_pk_bf16_f32 v121, v82, v83
v_mfma_f32_16x16x32_bf16 v[96:99], a[192:195], v[56:59], v[96:99]
v_exp_f32 v85, v85
v_mfma_f32_16x16x32_bf16 v[96:99], a[196:199], v[76:79], v[96:99]
ds_read_b64_tr_b16 a[234:235], v192 offset:4096
s_waitcnt vmcnt(4)
v_mfma_f32_16x16x32_bf16 v[100:103], a[200:203], v[0:3], v[160:163]
v_exp_f32 v86, v86
v_mfma_f32_16x16x32_bf16 v[100:103], a[204:207], v[20:23], v[100:103]
ds_read_b64_tr_b16 a[236:237], v193 offset:0
s_add_u32 m0, s48, 32768
s_xor_b32 s36, s3, 172032
v_mfma_f32_16x16x32_bf16 v[100:103], a[208:211], v[40:43], v[100:103]
buffer_load_dwordx4 v220, s[16:19], s36 offen offset:0 nt lds
v_exp_f32 v87, v87
v_mfma_f32_16x16x32_bf16 v[100:103], a[212:215], v[60:63], v[100:103]
ds_read_b64_tr_b16 a[238:239], v193 offset:4096
v_exp_f32 v88, v88
v_mfma_f32_16x16x32_bf16 v[104:107], a[212:215], v[64:67], v[164:167]
v_cvt_pk_bf16_f32 v124, v84, v85
v_cvt_pk_bf16_f32 v125, v86, v87
v_mfma_f32_16x16x32_bf16 v[104:107], a[208:211], v[44:47], v[104:107]
ds_read_b64_tr_b16 a[240:241], v194 offset:0
v_exp_f32 v89, v89
v_mfma_f32_16x16x32_bf16 v[104:107], a[204:207], v[24:27], v[104:107]
v_exp_f32 v90, v90
v_mfma_f32_16x16x32_bf16 v[104:107], a[200:203], v[4:7], v[104:107]
ds_read_b64_tr_b16 a[242:243], v194 offset:4096
v_exp_f32 v91, v91
v_mfma_f32_16x16x32_bf16 v[108:111], a[200:203], v[8:11], v[168:171]
v_exp_f32 v92, v92
v_mfma_f32_16x16x32_bf16 v[108:111], a[204:207], v[28:31], v[108:111]
ds_read_b64_tr_b16 a[244:245], v195 offset:0
s_waitcnt vmcnt(4)
v_cvt_pk_bf16_f32 v128, v88, v89
v_mfma_f32_16x16x32_bf16 v[108:111], a[208:211], v[48:51], v[108:111]
v_cvt_pk_bf16_f32 v129, v90, v91
v_mfma_f32_16x16x32_bf16 v[108:111], a[212:215], v[68:71], v[108:111]
ds_read_b64_tr_b16 a[246:247], v195 offset:4096
s_add_u32 m0, s48, 32768
v_mfma_f32_16x16x32_bf16 v[112:115], a[212:215], v[72:75], v[172:175]
buffer_load_dwordx4 v221, s[16:19], s36 offen offset:1024 nt lds
v_exp_f32 v93, v93
v_mfma_f32_16x16x32_bf16 v[112:115], a[208:211], v[52:55], v[112:115]
v_exp_f32 v94, v94
v_mfma_f32_16x16x32_bf16 v[112:115], a[204:207], v[32:35], v[112:115]
v_exp_f32 v95, v95
v_mfma_f32_16x16x32_bf16 v[112:115], a[200:203], v[12:15], v[112:115]
v_exp_f32 v96, v96
v_mfma_f32_16x16x32_bf16 v[116:119], a[200:203], v[16:19], v[176:179]
v_cvt_pk_bf16_f32 v132, v92, v93
v_cvt_pk_bf16_f32 v133, v94, v95
v_mfma_f32_16x16x32_bf16 v[116:119], a[204:207], v[36:39], v[116:119]
v_exp_f32 v97, v97
v_mfma_f32_16x16x32_bf16 v[116:119], a[208:211], v[56:59], v[116:119]
v_exp_f32 v98, v98
v_mfma_f32_16x16x32_bf16 v[116:119], a[212:215], v[76:79], v[116:119]
v_exp_f32 v99, v99
v_mfma_f32_16x16x32_bf16 a[160:163], a[180:183], v[140:143], a[160:163]
v_cvt_pk_bf16_f32 v136, v96, v97
v_cvt_pk_bf16_f32 v137, v98, v99
v_mfma_f32_16x16x32_bf16 a[164:167], a[180:183], v[144:147], a[164:167]
v_exp_f32 v100, v100
v_mfma_f32_16x16x32_bf16 a[168:171], a[180:183], v[148:151], a[168:171]
v_exp_f32 v101, v101
v_mfma_f32_16x16x32_bf16 a[172:175], a[180:183], v[152:155], a[172:175]
s_waitcnt lgkmcnt(0)
s_barrier
s_waitcnt vmcnt(4)
v_mfma_f32_16x16x32_bf16 a[176:179], a[180:183], v[156:159], a[176:179]
v_exp_f32 v102, v102
v_mfma_f32_16x16x32_bf16 a[0:3], a[216:219], v[140:143], a[0:3]
ds_read_b128 a[184:187], v212 offset:0
s_add_u32 m0, s48, 32768
v_mfma_f32_16x16x32_bf16 a[4:7], a[216:219], v[144:147], a[4:7]
buffer_load_dwordx4 v222, s[16:19], s36 offen offset:2048 nt lds
v_exp_f32 v103, v103
v_mfma_f32_16x16x32_bf16 a[8:11], a[216:219], v[148:151], a[8:11]
v_exp_f32 v104, v104
v_mfma_f32_16x16x32_bf16 a[12:15], a[216:219], v[152:155], a[12:15]
v_cvt_pk_bf16_f32 v122, v100, v101
v_cvt_pk_bf16_f32 v123, v102, v103
v_mfma_f32_16x16x32_bf16 a[16:19], a[216:219], v[156:159], a[16:19]
ds_read_b128 a[188:191], v213 offset:0
v_exp_f32 v105, v105
v_mfma_f32_16x16x32_bf16 a[20:23], a[220:223], v[140:143], a[20:23]
v_exp_f32 v106, v106
v_mfma_f32_16x16x32_bf16 a[24:27], a[220:223], v[144:147], a[24:27]
s_waitcnt vmcnt(4)
v_exp_f32 v107, v107
v_mfma_f32_16x16x32_bf16 a[28:31], a[220:223], v[148:151], a[28:31]
v_exp_f32 v108, v108
v_mfma_f32_16x16x32_bf16 a[32:35], a[220:223], v[152:155], a[32:35]
ds_read_b128 a[192:195], v214 offset:0
s_add_u32 m0, s48, 32768
v_cvt_pk_bf16_f32 v126, v104, v105
v_mfma_f32_16x16x32_bf16 a[36:39], a[220:223], v[156:159], a[36:39]
buffer_load_dwordx4 v223, s[16:19], s36 offen offset:3072 nt lds
v_cvt_pk_bf16_f32 v127, v106, v107
v_mfma_f32_16x16x32_bf16 a[40:43], a[224:227], v[140:143], a[40:43]
v_exp_f32 v109, v109
v_mfma_f32_16x16x32_bf16 a[44:47], a[224:227], v[144:147], a[44:47]
v_exp_f32 v110, v110
v_mfma_f32_16x16x32_bf16 a[48:51], a[224:227], v[148:151], a[48:51]
ds_read_b128 a[196:199], v215 offset:0
v_exp_f32 v111, v111
v_mfma_f32_16x16x32_bf16 a[52:55], a[224:227], v[152:155], a[52:55]
v_exp_f32 v112, v112
v_mfma_f32_16x16x32_bf16 a[56:59], a[224:227], v[156:159], a[56:59]
v_cvt_pk_bf16_f32 v130, v108, v109
v_cvt_pk_bf16_f32 v131, v110, v111
v_mfma_f32_16x16x32_bf16 a[60:63], a[228:231], v[140:143], a[60:63]
v_exp_f32 v113, v113
v_mfma_f32_16x16x32_bf16 a[64:67], a[228:231], v[144:147], a[64:67]
ds_read_b128 a[200:203], v212 offset:4096
s_waitcnt vmcnt(4)
v_mfma_f32_16x16x32_bf16 a[68:71], a[228:231], v[148:151], a[68:71]
v_exp_f32 v114, v114
v_mfma_f32_16x16x32_bf16 a[72:75], a[228:231], v[152:155], a[72:75]
s_add_u32 m0, s48, 16384
s_xor_b32 s37, s3, 163840
v_mfma_f32_16x16x32_bf16 a[76:79], a[228:231], v[156:159], a[76:79]
buffer_load_dwordx4 v220, s[20:23], s37 offen offset:0 nt lds
v_exp_f32 v115, v115
v_mfma_f32_16x16x32_bf16 a[80:83], a[232:235], v[140:143], a[80:83]
ds_read_b128 a[204:207], v213 offset:4096
v_exp_f32 v116, v116
v_mfma_f32_16x16x32_bf16 a[84:87], a[232:235], v[144:147], a[84:87]
v_cvt_pk_bf16_f32 v134, v112, v113
v_cvt_pk_bf16_f32 v135, v114, v115
v_mfma_f32_16x16x32_bf16 a[88:91], a[232:235], v[148:151], a[88:91]
v_exp_f32 v117, v117
v_mfma_f32_16x16x32_bf16 a[92:95], a[232:235], v[152:155], a[92:95]
v_exp_f32 v118, v118
v_mfma_f32_16x16x32_bf16 a[96:99], a[232:235], v[156:159], a[96:99]
ds_read_b128 a[208:211], v214 offset:4096
v_exp_f32 v119, v119
v_mfma_f32_16x16x32_bf16 a[100:103], a[236:239], v[140:143], a[100:103]
v_cvt_pk_bf16_f32 v138, v116, v117
v_cvt_pk_bf16_f32 v139, v118, v119
v_mfma_f32_16x16x32_bf16 a[104:107], a[236:239], v[144:147], a[104:107]
v_mfma_f32_16x16x32_bf16 a[108:111], a[236:239], v[148:151], a[108:111]
s_waitcnt vmcnt(4)
v_mfma_f32_16x16x32_bf16 a[112:115], a[236:239], v[152:155], a[112:115]
ds_read_b128 a[212:215], v215 offset:4096
v_mfma_f32_16x16x32_bf16 a[116:119], a[236:239], v[156:159], a[116:119]
s_add_u32 m0, s48, 16384
v_mfma_f32_16x16x32_bf16 a[120:123], a[240:243], v[140:143], a[120:123]
buffer_load_dwordx4 v221, s[20:23], s37 offen offset:1024 nt lds
v_mfma_f32_16x16x32_bf16 a[124:127], a[240:243], v[144:147], a[124:127]
v_mfma_f32_16x16x32_bf16 a[128:131], a[240:243], v[148:151], a[128:131]
v_mfma_f32_16x16x32_bf16 a[132:135], a[240:243], v[152:155], a[132:135]
v_mfma_f32_16x16x32_bf16 a[136:139], a[240:243], v[156:159], a[136:139]
v_mfma_f32_16x16x32_bf16 a[140:143], a[244:247], v[140:143], a[140:143]
v_mfma_f32_16x16x32_bf16 a[144:147], a[244:247], v[144:147], a[144:147]
v_mfma_f32_16x16x32_bf16 a[148:151], a[244:247], v[148:151], a[148:151]
v_mfma_f32_16x16x32_bf16 a[152:155], a[244:247], v[152:155], a[152:155]
v_mfma_f32_16x16x32_bf16 a[156:159], a[244:247], v[156:159], a[156:159]
s_waitcnt lgkmcnt(0)
v_mfma_f32_16x16x32_bf16 v[80:83], a[184:187], v[0:3], v[160:163]
s_waitcnt vmcnt(4)
v_mfma_f32_16x16x32_bf16 v[80:83], a[188:191], v[20:23], v[80:83]
ds_read_b64_tr_b16 a[216:217], v188 offset:32768
s_add_u32 m0, s48, 16384
v_mfma_f32_16x16x32_bf16 v[80:83], a[192:195], v[40:43], v[80:83]
buffer_load_dwordx4 v222, s[20:23], s37 offen offset:2048 nt lds
v_mfma_f32_16x16x32_bf16 v[80:83], a[196:199], v[60:63], v[80:83]
ds_read_b64_tr_b16 a[218:219], v188 offset:36864
v_mfma_f32_16x16x32_bf16 v[84:87], a[196:199], v[64:67], v[164:167]
v_mfma_f32_16x16x32_bf16 v[84:87], a[192:195], v[44:47], v[84:87]
ds_read_b64_tr_b16 a[220:221], v189 offset:32768
v_mfma_f32_16x16x32_bf16 v[84:87], a[188:191], v[24:27], v[84:87]
v_mfma_f32_16x16x32_bf16 v[84:87], a[184:187], v[4:7], v[84:87]
ds_read_b64_tr_b16 a[222:223], v189 offset:36864
v_mfma_f32_16x16x32_bf16 v[88:91], a[184:187], v[8:11], v[168:171]
v_mfma_f32_16x16x32_bf16 v[88:91], a[188:191], v[28:31], v[88:91]
ds_read_b64_tr_b16 a[224:225], v190 offset:32768
s_waitcnt vmcnt(4)
v_mfma_f32_16x16x32_bf16 v[88:91], a[192:195], v[48:51], v[88:91]
v_mfma_f32_16x16x32_bf16 v[88:91], a[196:199], v[68:71], v[88:91]
ds_read_b64_tr_b16 a[226:227], v190 offset:36864
s_add_u32 m0, s48, 16384
v_mfma_f32_16x16x32_bf16 v[92:95], a[196:199], v[72:75], v[172:175]
buffer_load_dwordx4 v223, s[20:23], s37 offen offset:3072 nt lds
v_exp_f32 v80, v80
v_mfma_f32_16x16x32_bf16 v[92:95], a[192:195], v[52:55], v[92:95]
ds_read_b64_tr_b16 a[228:229], v191 offset:32768
v_exp_f32 v81, v81
v_mfma_f32_16x16x32_bf16 v[92:95], a[188:191], v[32:35], v[92:95]
v_exp_f32 v82, v82
v_mfma_f32_16x16x32_bf16 v[92:95], a[184:187], v[12:15], v[92:95]
ds_read_b64_tr_b16 a[230:231], v191 offset:36864
v_exp_f32 v83, v83
v_mfma_f32_16x16x32_bf16 v[96:99], a[184:187], v[16:19], v[176:179]
v_exp_f32 v84, v84
v_mfma_f32_16x16x32_bf16 v[96:99], a[188:191], v[36:39], v[96:99]
ds_read_b64_tr_b16 a[232:233], v192 offset:32768
v_cvt_pk_bf16_f32 v140, v80, v81
v_cvt_pk_bf16_f32 v141, v82, v83
v_mfma_f32_16x16x32_bf16 v[96:99], a[192:195], v[56:59], v[96:99]
v_exp_f32 v85, v85
v_mfma_f32_16x16x32_bf16 v[96:99], a[196:199], v[76:79], v[96:99]
ds_read_b64_tr_b16 a[234:235], v192 offset:36864
s_waitcnt vmcnt(4)
v_mfma_f32_16x16x32_bf16 v[100:103], a[200:203], v[0:3], v[160:163]
v_exp_f32 v86, v86
v_mfma_f32_16x16x32_bf16 v[100:103], a[204:207], v[20:23], v[100:103]
ds_read_b64_tr_b16 a[236:237], v193 offset:32768
s_add_u32 m0, s48, 65536
s_xor_b32 s36, s3, 180224
v_mfma_f32_16x16x32_bf16 v[100:103], a[208:211], v[40:43], v[100:103]
buffer_load_dwordx4 v220, s[16:19], s36 offen offset:0 nt lds
v_exp_f32 v87, v87
v_mfma_f32_16x16x32_bf16 v[100:103], a[212:215], v[60:63], v[100:103]
ds_read_b64_tr_b16 a[238:239], v193 offset:36864
v_exp_f32 v88, v88
v_mfma_f32_16x16x32_bf16 v[104:107], a[212:215], v[64:67], v[164:167]
v_cvt_pk_bf16_f32 v144, v84, v85
v_cvt_pk_bf16_f32 v145, v86, v87
v_mfma_f32_16x16x32_bf16 v[104:107], a[208:211], v[44:47], v[104:107]
ds_read_b64_tr_b16 a[240:241], v194 offset:32768
v_exp_f32 v89, v89
v_mfma_f32_16x16x32_bf16 v[104:107], a[204:207], v[24:27], v[104:107]
v_exp_f32 v90, v90
v_mfma_f32_16x16x32_bf16 v[104:107], a[200:203], v[4:7], v[104:107]
ds_read_b64_tr_b16 a[242:243], v194 offset:36864
v_exp_f32 v91, v91
v_mfma_f32_16x16x32_bf16 v[108:111], a[200:203], v[8:11], v[168:171]
v_exp_f32 v92, v92
v_mfma_f32_16x16x32_bf16 v[108:111], a[204:207], v[28:31], v[108:111]
ds_read_b64_tr_b16 a[244:245], v195 offset:32768
v_cvt_pk_bf16_f32 v148, v88, v89
v_cvt_pk_bf16_f32 v149, v90, v91
v_mfma_f32_16x16x32_bf16 v[108:111], a[208:211], v[48:51], v[108:111]
s_waitcnt vmcnt(4)
v_exp_f32 v93, v93
v_mfma_f32_16x16x32_bf16 v[108:111], a[212:215], v[68:71], v[108:111]
ds_read_b64_tr_b16 a[246:247], v195 offset:36864
v_exp_f32 v94, v94
v_mfma_f32_16x16x32_bf16 v[112:115], a[212:215], v[72:75], v[172:175]
s_add_u32 m0, s48, 65536
v_exp_f32 v95, v95
v_mfma_f32_16x16x32_bf16 v[112:115], a[208:211], v[52:55], v[112:115]
buffer_load_dwordx4 v221, s[16:19], s36 offen offset:1024 nt lds
v_exp_f32 v96, v96
v_mfma_f32_16x16x32_bf16 v[112:115], a[204:207], v[32:35], v[112:115]
v_cvt_pk_bf16_f32 v152, v92, v93
v_cvt_pk_bf16_f32 v153, v94, v95
v_mfma_f32_16x16x32_bf16 v[112:115], a[200:203], v[12:15], v[112:115]
v_exp_f32 v97, v97
v_mfma_f32_16x16x32_bf16 v[116:119], a[200:203], v[16:19], v[176:179]
v_exp_f32 v98, v98
v_mfma_f32_16x16x32_bf16 v[116:119], a[204:207], v[36:39], v[116:119]
v_exp_f32 v99, v99
v_mfma_f32_16x16x32_bf16 v[116:119], a[208:211], v[56:59], v[116:119]
v_cvt_pk_bf16_f32 v156, v96, v97
v_cvt_pk_bf16_f32 v157, v98, v99
v_mfma_f32_16x16x32_bf16 v[116:119], a[212:215], v[76:79], v[116:119]
v_exp_f32 v100, v100
v_mfma_f32_16x16x32_bf16 a[160:163], a[180:183], v[120:123], a[160:163]
v_exp_f32 v101, v101
v_mfma_f32_16x16x32_bf16 a[164:167], a[180:183], v[124:127], a[164:167]
v_exp_f32 v102, v102
v_mfma_f32_16x16x32_bf16 a[168:171], a[180:183], v[128:131], a[168:171]
v_exp_f32 v103, v103
v_mfma_f32_16x16x32_bf16 a[172:175], a[180:183], v[132:135], a[172:175]
s_waitcnt lgkmcnt(0)
s_barrier
s_waitcnt vmcnt(4)
v_mfma_f32_16x16x32_bf16 a[176:179], a[180:183], v[136:139], a[176:179]
v_exp_f32 v104, v104
v_mfma_f32_16x16x32_bf16 a[0:3], a[216:219], v[120:123], a[0:3]
ds_read_b128 a[184:187], v204 offset:0
s_add_u32 m0, s48, 65536
v_cvt_pk_bf16_f32 v142, v100, v101
v_mfma_f32_16x16x32_bf16 a[4:7], a[216:219], v[124:127], a[4:7]
buffer_load_dwordx4 v222, s[16:19], s36 offen offset:2048 nt lds
v_cvt_pk_bf16_f32 v143, v102, v103
v_mfma_f32_16x16x32_bf16 a[8:11], a[216:219], v[128:131], a[8:11]
v_exp_f32 v105, v105
v_mfma_f32_16x16x32_bf16 a[12:15], a[216:219], v[132:135], a[12:15]
v_exp_f32 v106, v106
v_mfma_f32_16x16x32_bf16 a[16:19], a[216:219], v[136:139], a[16:19]
ds_read_b128 a[188:191], v205 offset:0
v_exp_f32 v107, v107
v_mfma_f32_16x16x32_bf16 a[20:23], a[220:223], v[120:123], a[20:23]
v_exp_f32 v108, v108
v_mfma_f32_16x16x32_bf16 a[24:27], a[220:223], v[124:127], a[24:27]
v_cvt_pk_bf16_f32 v146, v104, v105
v_cvt_pk_bf16_f32 v147, v106, v107
v_mfma_f32_16x16x32_bf16 a[28:31], a[220:223], v[128:131], a[28:31]
s_waitcnt vmcnt(4)
v_exp_f32 v109, v109
v_mfma_f32_16x16x32_bf16 a[32:35], a[220:223], v[132:135], a[32:35]
ds_read_b128 a[192:195], v206 offset:0
v_exp_f32 v110, v110
v_mfma_f32_16x16x32_bf16 a[36:39], a[220:223], v[136:139], a[36:39]
s_add_u32 m0, s48, 65536
v_exp_f32 v111, v111
v_mfma_f32_16x16x32_bf16 a[40:43], a[224:227], v[120:123], a[40:43]
buffer_load_dwordx4 v223, s[16:19], s36 offen offset:3072 nt lds
v_exp_f32 v112, v112
v_mfma_f32_16x16x32_bf16 a[44:47], a[224:227], v[124:127], a[44:47]
v_cvt_pk_bf16_f32 v150, v108, v109
v_cvt_pk_bf16_f32 v151, v110, v111
v_mfma_f32_16x16x32_bf16 a[48:51], a[224:227], v[128:131], a[48:51]
ds_read_b128 a[196:199], v207 offset:0
v_exp_f32 v113, v113
v_mfma_f32_16x16x32_bf16 a[52:55], a[224:227], v[132:135], a[52:55]
v_exp_f32 v114, v114
v_mfma_f32_16x16x32_bf16 a[56:59], a[224:227], v[136:139], a[56:59]
v_exp_f32 v115, v115
v_mfma_f32_16x16x32_bf16 a[60:63], a[228:231], v[120:123], a[60:63]
v_exp_f32 v116, v116
v_mfma_f32_16x16x32_bf16 a[64:67], a[228:231], v[124:127], a[64:67]
ds_read_b128 a[200:203], v204 offset:4096
v_cvt_pk_bf16_f32 v154, v112, v113
v_cvt_pk_bf16_f32 v155, v114, v115
v_mfma_f32_16x16x32_bf16 a[68:71], a[228:231], v[128:131], a[68:71]
v_exp_f32 v117, v117
v_mfma_f32_16x16x32_bf16 a[72:75], a[228:231], v[132:135], a[72:75]
s_waitcnt vmcnt(4)
v_exp_f32 v118, v118
v_mfma_f32_16x16x32_bf16 a[76:79], a[228:231], v[136:139], a[76:79]
v_exp_f32 v119, v119
v_mfma_f32_16x16x32_bf16 a[80:83], a[232:235], v[120:123], a[80:83]
ds_read_b128 a[204:207], v205 offset:4096
s_add_u32 m0, s48, 49152
s_xor_b32 s37, s3, 172032
v_mfma_f32_16x16x32_bf16 a[84:87], a[232:235], v[124:127], a[84:87]
buffer_load_dwordx4 v220, s[20:23], s37 offen offset:0 nt lds
v_cvt_pk_bf16_f32 v158, v116, v117
v_cvt_pk_bf16_f32 v159, v118, v119
v_mfma_f32_16x16x32_bf16 a[88:91], a[232:235], v[128:131], a[88:91]
v_mfma_f32_16x16x32_bf16 a[92:95], a[232:235], v[132:135], a[92:95]
v_mfma_f32_16x16x32_bf16 a[96:99], a[232:235], v[136:139], a[96:99]
ds_read_b128 a[208:211], v206 offset:4096
v_mfma_f32_16x16x32_bf16 a[100:103], a[236:239], v[120:123], a[100:103]
v_mfma_f32_16x16x32_bf16 a[104:107], a[236:239], v[124:127], a[104:107]
v_mfma_f32_16x16x32_bf16 a[108:111], a[236:239], v[128:131], a[108:111]
v_mfma_f32_16x16x32_bf16 a[112:115], a[236:239], v[132:135], a[112:115]
ds_read_b128 a[212:215], v207 offset:4096
s_waitcnt vmcnt(4)
v_mfma_f32_16x16x32_bf16 a[116:119], a[236:239], v[136:139], a[116:119]
v_mfma_f32_16x16x32_bf16 a[120:123], a[240:243], v[120:123], a[120:123]
s_add_u32 m0, s48, 49152
v_mfma_f32_16x16x32_bf16 a[124:127], a[240:243], v[124:127], a[124:127]
buffer_load_dwordx4 v221, s[20:23], s37 offen offset:1024 nt lds
v_mfma_f32_16x16x32_bf16 a[128:131], a[240:243], v[128:131], a[128:131]
v_mfma_f32_16x16x32_bf16 a[132:135], a[240:243], v[132:135], a[132:135]
v_mfma_f32_16x16x32_bf16 a[136:139], a[240:243], v[136:139], a[136:139]
v_mfma_f32_16x16x32_bf16 a[140:143], a[244:247], v[120:123], a[140:143]
v_mfma_f32_16x16x32_bf16 a[144:147], a[244:247], v[124:127], a[144:147]
v_mfma_f32_16x16x32_bf16 a[148:151], a[244:247], v[128:131], a[148:151]
v_mfma_f32_16x16x32_bf16 a[152:155], a[244:247], v[132:135], a[152:155]
v_mfma_f32_16x16x32_bf16 a[156:159], a[244:247], v[136:139], a[156:159]
s_waitcnt lgkmcnt(0)
v_mfma_f32_16x16x32_bf16 v[80:83], a[184:187], v[0:3], v[160:163]
s_waitcnt vmcnt(4)
v_mfma_f32_16x16x32_bf16 v[80:83], a[188:191], v[20:23], v[80:83]
ds_read_b64_tr_b16 a[216:217], v196 offset:0
s_add_u32 m0, s48, 49152
v_mfma_f32_16x16x32_bf16 v[80:83], a[192:195], v[40:43], v[80:83]
buffer_load_dwordx4 v222, s[20:23], s37 offen offset:2048 nt lds
v_mfma_f32_16x16x32_bf16 v[80:83], a[196:199], v[60:63], v[80:83]
ds_read_b64_tr_b16 a[218:219], v196 offset:4096
v_mfma_f32_16x16x32_bf16 v[84:87], a[196:199], v[64:67], v[164:167]
v_mfma_f32_16x16x32_bf16 v[84:87], a[192:195], v[44:47], v[84:87]
ds_read_b64_tr_b16 a[220:221], v197 offset:0
v_mfma_f32_16x16x32_bf16 v[84:87], a[188:191], v[24:27], v[84:87]
v_mfma_f32_16x16x32_bf16 v[84:87], a[184:187], v[4:7], v[84:87]
ds_read_b64_tr_b16 a[222:223], v197 offset:4096
v_mfma_f32_16x16x32_bf16 v[88:91], a[184:187], v[8:11], v[168:171]
v_mfma_f32_16x16x32_bf16 v[88:91], a[188:191], v[28:31], v[88:91]
ds_read_b64_tr_b16 a[224:225], v198 offset:0
v_mfma_f32_16x16x32_bf16 v[88:91], a[192:195], v[48:51], v[88:91]
v_mfma_f32_16x16x32_bf16 v[88:91], a[196:199], v[68:71], v[88:91]
ds_read_b64_tr_b16 a[226:227], v198 offset:4096
s_waitcnt vmcnt(4)
v_mfma_f32_16x16x32_bf16 v[92:95], a[196:199], v[72:75], v[172:175]
v_exp_f32 v80, v80
v_mfma_f32_16x16x32_bf16 v[92:95], a[192:195], v[52:55], v[92:95]
ds_read_b64_tr_b16 a[228:229], v199 offset:0
s_add_u32 m0, s48, 49152
v_mfma_f32_16x16x32_bf16 v[92:95], a[188:191], v[32:35], v[92:95]
buffer_load_dwordx4 v223, s[20:23], s37 offen offset:3072 nt lds
v_exp_f32 v81, v81
v_mfma_f32_16x16x32_bf16 v[92:95], a[184:187], v[12:15], v[92:95]
ds_read_b64_tr_b16 a[230:231], v199 offset:4096
v_exp_f32 v82, v82
v_mfma_f32_16x16x32_bf16 v[96:99], a[184:187], v[16:19], v[176:179]
v_exp_f32 v83, v83
v_mfma_f32_16x16x32_bf16 v[96:99], a[188:191], v[36:39], v[96:99]
ds_read_b64_tr_b16 a[232:233], v200 offset:0
v_exp_f32 v84, v84
v_mfma_f32_16x16x32_bf16 v[96:99], a[192:195], v[56:59], v[96:99]
v_cvt_pk_bf16_f32 v120, v80, v81
v_cvt_pk_bf16_f32 v121, v82, v83
v_mfma_f32_16x16x32_bf16 v[96:99], a[196:199], v[76:79], v[96:99]
ds_read_b64_tr_b16 a[234:235], v200 offset:4096
v_exp_f32 v85, v85
v_mfma_f32_16x16x32_bf16 v[100:103], a[200:203], v[0:3], v[160:163]
v_exp_f32 v86, v86
v_mfma_f32_16x16x32_bf16 v[100:103], a[204:207], v[20:23], v[100:103]
ds_read_b64_tr_b16 a[236:237], v201 offset:0
s_waitcnt vmcnt(4)
v_mfma_f32_16x16x32_bf16 v[100:103], a[208:211], v[40:43], v[100:103]
v_exp_f32 v87, v87
v_mfma_f32_16x16x32_bf16 v[100:103], a[212:215], v[60:63], v[100:103]
ds_read_b64_tr_b16 a[238:239], v201 offset:4096
s_add_u32 m0, s48, 98304
s_xor_b32 s36, s3, 188416
v_mfma_f32_16x16x32_bf16 v[104:107], a[212:215], v[64:67], v[164:167]
buffer_load_dwordx4 v220, s[16:19], s36 offen offset:0 nt lds
v_exp_f32 v88, v88
v_mfma_f32_16x16x32_bf16 v[104:107], a[208:211], v[44:47], v[104:107]
ds_read_b64_tr_b16 a[240:241], v202 offset:0
v_cvt_pk_bf16_f32 v124, v84, v85
v_cvt_pk_bf16_f32 v125, v86, v87
v_mfma_f32_16x16x32_bf16 v[104:107], a[204:207], v[24:27], v[104:107]
v_exp_f32 v89, v89
v_mfma_f32_16x16x32_bf16 v[104:107], a[200:203], v[4:7], v[104:107]
ds_read_b64_tr_b16 a[242:243], v202 offset:4096
v_exp_f32 v90, v90
v_mfma_f32_16x16x32_bf16 v[108:111], a[200:203], v[8:11], v[168:171]
v_exp_f32 v91, v91
v_mfma_f32_16x16x32_bf16 v[108:111], a[204:207], v[28:31], v[108:111]
ds_read_b64_tr_b16 a[244:245], v203 offset:0
v_exp_f32 v92, v92
v_mfma_f32_16x16x32_bf16 v[108:111], a[208:211], v[48:51], v[108:111]
v_cvt_pk_bf16_f32 v128, v88, v89
v_cvt_pk_bf16_f32 v129, v90, v91
v_mfma_f32_16x16x32_bf16 v[108:111], a[212:215], v[68:71], v[108:111]
ds_read_b64_tr_b16 a[246:247], v203 offset:4096
s_waitcnt vmcnt(4)
v_mfma_f32_16x16x32_bf16 v[112:115], a[212:215], v[72:75], v[172:175]
v_exp_f32 v93, v93
v_mfma_f32_16x16x32_bf16 v[112:115], a[208:211], v[52:55], v[112:115]
s_add_u32 m0, s48, 98304
v_exp_f32 v94, v94
v_mfma_f32_16x16x32_bf16 v[112:115], a[204:207], v[32:35], v[112:115]
buffer_load_dwordx4 v221, s[16:19], s36 offen offset:1024 nt lds
v_exp_f32 v95, v95
v_mfma_f32_16x16x32_bf16 v[112:115], a[200:203], v[12:15], v[112:115]
v_exp_f32 v96, v96
v_mfma_f32_16x16x32_bf16 v[116:119], a[200:203], v[16:19], v[176:179]
v_cvt_pk_bf16_f32 v132, v92, v93
v_cvt_pk_bf16_f32 v133, v94, v95
v_mfma_f32_16x16x32_bf16 v[116:119], a[204:207], v[36:39], v[116:119]
v_exp_f32 v97, v97
v_mfma_f32_16x16x32_bf16 v[116:119], a[208:211], v[56:59], v[116:119]
v_exp_f32 v98, v98
v_mfma_f32_16x16x32_bf16 v[116:119], a[212:215], v[76:79], v[116:119]
v_exp_f32 v99, v99
v_mfma_f32_16x16x32_bf16 a[160:163], a[180:183], v[140:143], a[160:163]
v_cvt_pk_bf16_f32 v136, v96, v97
v_cvt_pk_bf16_f32 v137, v98, v99
v_mfma_f32_16x16x32_bf16 a[164:167], a[180:183], v[144:147], a[164:167]
v_exp_f32 v100, v100
v_mfma_f32_16x16x32_bf16 a[168:171], a[180:183], v[148:151], a[168:171]
v_exp_f32 v101, v101
v_mfma_f32_16x16x32_bf16 a[172:175], a[180:183], v[152:155], a[172:175]
s_waitcnt lgkmcnt(0)
s_barrier
s_waitcnt vmcnt(4)
v_mfma_f32_16x16x32_bf16 a[176:179], a[180:183], v[156:159], a[176:179]
v_exp_f32 v102, v102
v_mfma_f32_16x16x32_bf16 a[0:3], a[216:219], v[140:143], a[0:3]
ds_read_b128 a[184:187], v204 offset:32768
s_add_u32 m0, s48, 98304
v_mfma_f32_16x16x32_bf16 a[4:7], a[216:219], v[144:147], a[4:7]
buffer_load_dwordx4 v222, s[16:19], s36 offen offset:2048 nt lds
v_exp_f32 v103, v103
v_mfma_f32_16x16x32_bf16 a[8:11], a[216:219], v[148:151], a[8:11]
v_exp_f32 v104, v104
v_mfma_f32_16x16x32_bf16 a[12:15], a[216:219], v[152:155], a[12:15]
v_cvt_pk_bf16_f32 v122, v100, v101
v_cvt_pk_bf16_f32 v123, v102, v103
v_mfma_f32_16x16x32_bf16 a[16:19], a[216:219], v[156:159], a[16:19]
ds_read_b128 a[188:191], v205 offset:32768
v_exp_f32 v105, v105
v_mfma_f32_16x16x32_bf16 a[20:23], a[220:223], v[140:143], a[20:23]
v_exp_f32 v106, v106
v_mfma_f32_16x16x32_bf16 a[24:27], a[220:223], v[144:147], a[24:27]
v_exp_f32 v107, v107
v_mfma_f32_16x16x32_bf16 a[28:31], a[220:223], v[148:151], a[28:31]
v_exp_f32 v108, v108
v_mfma_f32_16x16x32_bf16 a[32:35], a[220:223], v[152:155], a[32:35]
ds_read_b128 a[192:195], v206 offset:32768
s_waitcnt vmcnt(4)
v_cvt_pk_bf16_f32 v126, v104, v105
v_mfma_f32_16x16x32_bf16 a[36:39], a[220:223], v[156:159], a[36:39]
v_cvt_pk_bf16_f32 v127, v106, v107
v_mfma_f32_16x16x32_bf16 a[40:43], a[224:227], v[140:143], a[40:43]
s_add_u32 m0, s48, 98304
v_exp_f32 v109, v109
v_mfma_f32_16x16x32_bf16 a[44:47], a[224:227], v[144:147], a[44:47]
buffer_load_dwordx4 v223, s[16:19], s36 offen offset:3072 nt lds
v_exp_f32 v110, v110
v_mfma_f32_16x16x32_bf16 a[48:51], a[224:227], v[148:151], a[48:51]
ds_read_b128 a[196:199], v207 offset:32768
v_exp_f32 v111, v111
v_mfma_f32_16x16x32_bf16 a[52:55], a[224:227], v[152:155], a[52:55]
v_exp_f32 v112, v112
v_mfma_f32_16x16x32_bf16 a[56:59], a[224:227], v[156:159], a[56:59]
v_cvt_pk_bf16_f32 v130, v108, v109
v_cvt_pk_bf16_f32 v131, v110, v111
v_mfma_f32_16x16x32_bf16 a[60:63], a[228:231], v[140:143], a[60:63]
v_exp_f32 v113, v113
v_mfma_f32_16x16x32_bf16 a[64:67], a[228:231], v[144:147], a[64:67]
ds_read_b128 a[200:203], v204 offset:36864
v_exp_f32 v114, v114
v_mfma_f32_16x16x32_bf16 a[68:71], a[228:231], v[148:151], a[68:71]
v_exp_f32 v115, v115
v_mfma_f32_16x16x32_bf16 a[72:75], a[228:231], v[152:155], a[72:75]
v_exp_f32 v116, v116
v_mfma_f32_16x16x32_bf16 a[76:79], a[228:231], v[156:159], a[76:79]
s_waitcnt vmcnt(4)
v_cvt_pk_bf16_f32 v134, v112, v113
v_cvt_pk_bf16_f32 v135, v114, v115
v_mfma_f32_16x16x32_bf16 a[80:83], a[232:235], v[140:143], a[80:83]
ds_read_b128 a[204:207], v205 offset:36864
v_exp_f32 v117, v117
v_mfma_f32_16x16x32_bf16 a[84:87], a[232:235], v[144:147], a[84:87]
s_add_u32 m0, s48, 81920
s_xor_b32 s37, s3, 180224
v_mfma_f32_16x16x32_bf16 a[88:91], a[232:235], v[148:151], a[88:91]
buffer_load_dwordx4 v220, s[20:23], s37 offen offset:0 nt lds
v_exp_f32 v118, v118
v_mfma_f32_16x16x32_bf16 a[92:95], a[232:235], v[152:155], a[92:95]
v_exp_f32 v119, v119
v_mfma_f32_16x16x32_bf16 a[96:99], a[232:235], v[156:159], a[96:99]
ds_read_b128 a[208:211], v206 offset:36864
v_cvt_pk_bf16_f32 v138, v116, v117
v_cvt_pk_bf16_f32 v139, v118, v119
v_mfma_f32_16x16x32_bf16 a[100:103], a[236:239], v[140:143], a[100:103]
v_mfma_f32_16x16x32_bf16 a[104:107], a[236:239], v[144:147], a[104:107]
v_mfma_f32_16x16x32_bf16 a[108:111], a[236:239], v[148:151], a[108:111]
v_mfma_f32_16x16x32_bf16 a[112:115], a[236:239], v[152:155], a[112:115]
ds_read_b128 a[212:215], v207 offset:36864
v_mfma_f32_16x16x32_bf16 a[116:119], a[236:239], v[156:159], a[116:119]
s_waitcnt vmcnt(4)
v_mfma_f32_16x16x32_bf16 a[120:123], a[240:243], v[140:143], a[120:123]
v_mfma_f32_16x16x32_bf16 a[124:127], a[240:243], v[144:147], a[124:127]
s_add_u32 m0, s48, 81920
v_mfma_f32_16x16x32_bf16 a[128:131], a[240:243], v[148:151], a[128:131]
buffer_load_dwordx4 v221, s[20:23], s37 offen offset:1024 nt lds
v_mfma_f32_16x16x32_bf16 a[132:135], a[240:243], v[152:155], a[132:135]
v_mfma_f32_16x16x32_bf16 a[136:139], a[240:243], v[156:159], a[136:139]
v_mfma_f32_16x16x32_bf16 a[140:143], a[244:247], v[140:143], a[140:143]
v_mfma_f32_16x16x32_bf16 a[144:147], a[244:247], v[144:147], a[144:147]
v_mfma_f32_16x16x32_bf16 a[148:151], a[244:247], v[148:151], a[148:151]
v_mfma_f32_16x16x32_bf16 a[152:155], a[244:247], v[152:155], a[152:155]
v_mfma_f32_16x16x32_bf16 a[156:159], a[244:247], v[156:159], a[156:159]
s_waitcnt lgkmcnt(0)
v_mfma_f32_16x16x32_bf16 v[80:83], a[184:187], v[0:3], v[160:163]
v_mfma_f32_16x16x32_bf16 v[80:83], a[188:191], v[20:23], v[80:83]
ds_read_b64_tr_b16 a[216:217], v180 offset:0
s_waitcnt vmcnt(4)
v_mfma_f32_16x16x32_bf16 v[80:83], a[192:195], v[40:43], v[80:83]
v_mfma_f32_16x16x32_bf16 v[80:83], a[196:199], v[60:63], v[80:83]
ds_read_b64_tr_b16 a[218:219], v180 offset:4096
s_add_u32 m0, s48, 81920
v_mfma_f32_16x16x32_bf16 v[84:87], a[196:199], v[64:67], v[164:167]
buffer_load_dwordx4 v222, s[20:23], s37 offen offset:2048 nt lds
v_mfma_f32_16x16x32_bf16 v[84:87], a[192:195], v[44:47], v[84:87]
ds_read_b64_tr_b16 a[220:221], v181 offset:0
v_mfma_f32_16x16x32_bf16 v[84:87], a[188:191], v[24:27], v[84:87]
v_mfma_f32_16x16x32_bf16 v[84:87], a[184:187], v[4:7], v[84:87]
ds_read_b64_tr_b16 a[222:223], v181 offset:4096
v_mfma_f32_16x16x32_bf16 v[88:91], a[184:187], v[8:11], v[168:171]
v_mfma_f32_16x16x32_bf16 v[88:91], a[188:191], v[28:31], v[88:91]
ds_read_b64_tr_b16 a[224:225], v182 offset:0
v_mfma_f32_16x16x32_bf16 v[88:91], a[192:195], v[48:51], v[88:91]
v_mfma_f32_16x16x32_bf16 v[88:91], a[196:199], v[68:71], v[88:91]
ds_read_b64_tr_b16 a[226:227], v182 offset:4096
s_waitcnt vmcnt(4)
v_mfma_f32_16x16x32_bf16 v[92:95], a[196:199], v[72:75], v[172:175]
v_exp_f32 v80, v80
v_mfma_f32_16x16x32_bf16 v[92:95], a[192:195], v[52:55], v[92:95]
ds_read_b64_tr_b16 a[228:229], v183 offset:0
s_add_u32 m0, s48, 81920
v_mfma_f32_16x16x32_bf16 v[92:95], a[188:191], v[32:35], v[92:95]
buffer_load_dwordx4 v223, s[20:23], s37 offen offset:3072 nt lds
v_exp_f32 v81, v81
v_mfma_f32_16x16x32_bf16 v[92:95], a[184:187], v[12:15], v[92:95]
ds_read_b64_tr_b16 a[230:231], v183 offset:4096
v_exp_f32 v82, v82
v_mfma_f32_16x16x32_bf16 v[96:99], a[184:187], v[16:19], v[176:179]
v_exp_f32 v83, v83
v_mfma_f32_16x16x32_bf16 v[96:99], a[188:191], v[36:39], v[96:99]
ds_read_b64_tr_b16 a[232:233], v184 offset:0
v_exp_f32 v84, v84
v_mfma_f32_16x16x32_bf16 v[96:99], a[192:195], v[56:59], v[96:99]
v_cvt_pk_bf16_f32 v140, v80, v81
v_cvt_pk_bf16_f32 v141, v82, v83
v_mfma_f32_16x16x32_bf16 v[96:99], a[196:199], v[76:79], v[96:99]
ds_read_b64_tr_b16 a[234:235], v184 offset:4096
v_exp_f32 v85, v85
v_mfma_f32_16x16x32_bf16 v[100:103], a[200:203], v[0:3], v[160:163]
v_exp_f32 v86, v86
v_mfma_f32_16x16x32_bf16 v[100:103], a[204:207], v[20:23], v[100:103]
ds_read_b64_tr_b16 a[236:237], v185 offset:0
v_exp_f32 v87, v87
v_mfma_f32_16x16x32_bf16 v[100:103], a[208:211], v[40:43], v[100:103]
v_exp_f32 v88, v88
v_mfma_f32_16x16x32_bf16 v[100:103], a[212:215], v[60:63], v[100:103]
ds_read_b64_tr_b16 a[238:239], v185 offset:4096
s_waitcnt vmcnt(4)
v_cvt_pk_bf16_f32 v144, v84, v85
v_mfma_f32_16x16x32_bf16 v[104:107], a[212:215], v[64:67], v[164:167]
v_cvt_pk_bf16_f32 v145, v86, v87
v_mfma_f32_16x16x32_bf16 v[104:107], a[208:211], v[44:47], v[104:107]
ds_read_b64_tr_b16 a[240:241], v186 offset:0
s_add_u32 m0, s48, 131072
s_xor_b32 s36, s3, 196608
v_mfma_f32_16x16x32_bf16 v[104:107], a[204:207], v[24:27], v[104:107]
buffer_load_dwordx4 v220, s[16:19], s36 offen offset:0 nt lds
v_exp_f32 v89, v89
v_mfma_f32_16x16x32_bf16 v[104:107], a[200:203], v[4:7], v[104:107]
ds_read_b64_tr_b16 a[242:243], v186 offset:4096
v_exp_f32 v90, v90
v_mfma_f32_16x16x32_bf16 v[108:111], a[200:203], v[8:11], v[168:171]
v_exp_f32 v91, v91
v_mfma_f32_16x16x32_bf16 v[108:111], a[204:207], v[28:31], v[108:111]
ds_read_b64_tr_b16 a[244:245], v187 offset:0
v_exp_f32 v92, v92
v_mfma_f32_16x16x32_bf16 v[108:111], a[208:211], v[48:51], v[108:111]
v_cvt_pk_bf16_f32 v148, v88, v89
v_cvt_pk_bf16_f32 v149, v90, v91
v_mfma_f32_16x16x32_bf16 v[108:111], a[212:215], v[68:71], v[108:111]
ds_read_b64_tr_b16 a[246:247], v187 offset:4096
v_exp_f32 v93, v93
v_mfma_f32_16x16x32_bf16 v[112:115], a[212:215], v[72:75], v[172:175]
s_waitcnt vmcnt(4)
v_exp_f32 v94, v94
v_mfma_f32_16x16x32_bf16 v[112:115], a[208:211], v[52:55], v[112:115]
v_exp_f32 v95, v95
v_mfma_f32_16x16x32_bf16 v[112:115], a[204:207], v[32:35], v[112:115]
s_add_u32 m0, s48, 131072
v_exp_f32 v96, v96
v_mfma_f32_16x16x32_bf16 v[112:115], a[200:203], v[12:15], v[112:115]
buffer_load_dwordx4 v221, s[16:19], s36 offen offset:1024 nt lds
v_cvt_pk_bf16_f32 v152, v92, v93
v_cvt_pk_bf16_f32 v153, v94, v95
v_mfma_f32_16x16x32_bf16 v[116:119], a[200:203], v[16:19], v[176:179]
v_exp_f32 v97, v97
v_mfma_f32_16x16x32_bf16 v[116:119], a[204:207], v[36:39], v[116:119]
v_exp_f32 v98, v98
v_mfma_f32_16x16x32_bf16 v[116:119], a[208:211], v[56:59], v[116:119]
v_exp_f32 v99, v99
v_mfma_f32_16x16x32_bf16 v[116:119], a[212:215], v[76:79], v[116:119]
v_cvt_pk_bf16_f32 v156, v96, v97
v_cvt_pk_bf16_f32 v157, v98, v99
v_mfma_f32_16x16x32_bf16 a[160:163], a[180:183], v[120:123], a[160:163]
v_exp_f32 v100, v100
v_mfma_f32_16x16x32_bf16 a[164:167], a[180:183], v[124:127], a[164:167]
v_exp_f32 v101, v101
v_mfma_f32_16x16x32_bf16 a[168:171], a[180:183], v[128:131], a[168:171]
v_exp_f32 v102, v102
v_mfma_f32_16x16x32_bf16 a[172:175], a[180:183], v[132:135], a[172:175]
s_waitcnt lgkmcnt(0)
s_barrier
s_waitcnt vmcnt(4)
v_mfma_f32_16x16x32_bf16 a[176:179], a[180:183], v[136:139], a[176:179]
v_exp_f32 v103, v103
v_mfma_f32_16x16x32_bf16 a[0:3], a[216:219], v[120:123], a[0:3]
ds_read_b128 a[184:187], v208 offset:0
s_add_u32 m0, s48, 131072
v_mfma_f32_16x16x32_bf16 a[4:7], a[216:219], v[124:127], a[4:7]
buffer_load_dwordx4 v222, s[16:19], s36 offen offset:2048 nt lds
v_exp_f32 v104, v104
v_mfma_f32_16x16x32_bf16 a[8:11], a[216:219], v[128:131], a[8:11]
v_cvt_pk_bf16_f32 v142, v100, v101
v_cvt_pk_bf16_f32 v143, v102, v103
v_mfma_f32_16x16x32_bf16 a[12:15], a[216:219], v[132:135], a[12:15]
v_exp_f32 v105, v105
v_mfma_f32_16x16x32_bf16 a[16:19], a[216:219], v[136:139], a[16:19]
ds_read_b128 a[188:191], v209 offset:0
v_exp_f32 v106, v106
v_mfma_f32_16x16x32_bf16 a[20:23], a[220:223], v[120:123], a[20:23]
v_exp_f32 v107, v107
v_mfma_f32_16x16x32_bf16 a[24:27], a[220:223], v[124:127], a[24:27]
v_exp_f32 v108, v108
v_mfma_f32_16x16x32_bf16 a[28:31], a[220:223], v[128:131], a[28:31]
v_cvt_pk_bf16_f32 v146, v104, v105
v_cvt_pk_bf16_f32 v147, v106, v107
v_mfma_f32_16x16x32_bf16 a[32:35], a[220:223], v[132:135], a[32:35]
ds_read_b128 a[192:195], v210 offset:0
v_exp_f32 v109, v109
v_mfma_f32_16x16x32_bf16 a[36:39], a[220:223], v[136:139], a[36:39]
v_exp_f32 v110, v110
v_mfma_f32_16x16x32_bf16 a[40:43], a[224:227], v[120:123], a[40:43]
s_waitcnt vmcnt(4)
v_exp_f32 v111, v111
v_mfma_f32_16x16x32_bf16 a[44:47], a[224:227], v[124:127], a[44:47]
v_exp_f32 v112, v112
v_mfma_f32_16x16x32_bf16 a[48:51], a[224:227], v[128:131], a[48:51]
ds_read_b128 a[196:199], v211 offset:0
s_add_u32 m0, s48, 131072
v_cvt_pk_bf16_f32 v150, v108, v109
v_mfma_f32_16x16x32_bf16 a[52:55], a[224:227], v[132:135], a[52:55]
buffer_load_dwordx4 v223, s[16:19], s36 offen offset:3072 nt lds
v_cvt_pk_bf16_f32 v151, v110, v111
v_mfma_f32_16x16x32_bf16 a[56:59], a[224:227], v[136:139], a[56:59]
v_exp_f32 v113, v113
v_mfma_f32_16x16x32_bf16 a[60:63], a[228:231], v[120:123], a[60:63]
v_exp_f32 v114, v114
v_mfma_f32_16x16x32_bf16 a[64:67], a[228:231], v[124:127], a[64:67]
ds_read_b128 a[200:203], v208 offset:4096
v_exp_f32 v115, v115
v_mfma_f32_16x16x32_bf16 a[68:71], a[228:231], v[128:131], a[68:71]
v_exp_f32 v116, v116
v_mfma_f32_16x16x32_bf16 a[72:75], a[228:231], v[132:135], a[72:75]
v_cvt_pk_bf16_f32 v154, v112, v113
v_cvt_pk_bf16_f32 v155, v114, v115
v_mfma_f32_16x16x32_bf16 a[76:79], a[228:231], v[136:139], a[76:79]
v_exp_f32 v117, v117
v_mfma_f32_16x16x32_bf16 a[80:83], a[232:235], v[120:123], a[80:83]
ds_read_b128 a[204:207], v209 offset:4096
s_waitcnt vmcnt(4)
v_mfma_f32_16x16x32_bf16 a[84:87], a[232:235], v[124:127], a[84:87]
v_exp_f32 v118, v118
v_mfma_f32_16x16x32_bf16 a[88:91], a[232:235], v[128:131], a[88:91]
s_add_u32 m0, s48, 114688
s_xor_b32 s37, s3, 188416
v_mfma_f32_16x16x32_bf16 a[92:95], a[232:235], v[132:135], a[92:95]
buffer_load_dwordx4 v220, s[20:23], s37 offen offset:0 nt lds
v_exp_f32 v119, v119
v_mfma_f32_16x16x32_bf16 a[96:99], a[232:235], v[136:139], a[96:99]
ds_read_b128 a[208:211], v210 offset:4096
v_cvt_pk_bf16_f32 v158, v116, v117
v_cvt_pk_bf16_f32 v159, v118, v119
v_mfma_f32_16x16x32_bf16 a[100:103], a[236:239], v[120:123], a[100:103]
v_mfma_f32_16x16x32_bf16 a[104:107], a[236:239], v[124:127], a[104:107]
v_mfma_f32_16x16x32_bf16 a[108:111], a[236:239], v[128:131], a[108:111]
v_mfma_f32_16x16x32_bf16 a[112:115], a[236:239], v[132:135], a[112:115]
ds_read_b128 a[212:215], v211 offset:4096
v_mfma_f32_16x16x32_bf16 a[116:119], a[236:239], v[136:139], a[116:119]
v_mfma_f32_16x16x32_bf16 a[120:123], a[240:243], v[120:123], a[120:123]
s_waitcnt vmcnt(4)
v_mfma_f32_16x16x32_bf16 a[124:127], a[240:243], v[124:127], a[124:127]
v_mfma_f32_16x16x32_bf16 a[128:131], a[240:243], v[128:131], a[128:131]
s_add_u32 m0, s48, 114688
v_mfma_f32_16x16x32_bf16 a[132:135], a[240:243], v[132:135], a[132:135]
buffer_load_dwordx4 v221, s[20:23], s37 offen offset:1024 nt lds
v_mfma_f32_16x16x32_bf16 a[136:139], a[240:243], v[136:139], a[136:139]
v_mfma_f32_16x16x32_bf16 a[140:143], a[244:247], v[120:123], a[140:143]
v_mfma_f32_16x16x32_bf16 a[144:147], a[244:247], v[124:127], a[144:147]
v_mfma_f32_16x16x32_bf16 a[148:151], a[244:247], v[128:131], a[148:151]
v_mfma_f32_16x16x32_bf16 a[152:155], a[244:247], v[132:135], a[152:155]
v_mfma_f32_16x16x32_bf16 a[156:159], a[244:247], v[136:139], a[156:159]
s_waitcnt lgkmcnt(0)
v_mfma_f32_16x16x32_bf16 v[80:83], a[184:187], v[0:3], v[160:163]
v_mfma_f32_16x16x32_bf16 v[80:83], a[188:191], v[20:23], v[80:83]
ds_read_b64_tr_b16 a[216:217], v180 offset:32768
s_waitcnt vmcnt(4)
v_mfma_f32_16x16x32_bf16 v[80:83], a[192:195], v[40:43], v[80:83]
v_mfma_f32_16x16x32_bf16 v[80:83], a[196:199], v[60:63], v[80:83]
ds_read_b64_tr_b16 a[218:219], v180 offset:36864
s_add_u32 m0, s48, 114688
v_mfma_f32_16x16x32_bf16 v[84:87], a[196:199], v[64:67], v[164:167]
buffer_load_dwordx4 v222, s[20:23], s37 offen offset:2048 nt lds
v_mfma_f32_16x16x32_bf16 v[84:87], a[192:195], v[44:47], v[84:87]
ds_read_b64_tr_b16 a[220:221], v181 offset:32768
v_mfma_f32_16x16x32_bf16 v[84:87], a[188:191], v[24:27], v[84:87]
v_mfma_f32_16x16x32_bf16 v[84:87], a[184:187], v[4:7], v[84:87]
ds_read_b64_tr_b16 a[222:223], v181 offset:36864
v_mfma_f32_16x16x32_bf16 v[88:91], a[184:187], v[8:11], v[168:171]
v_mfma_f32_16x16x32_bf16 v[88:91], a[188:191], v[28:31], v[88:91]
ds_read_b64_tr_b16 a[224:225], v182 offset:32768
v_mfma_f32_16x16x32_bf16 v[88:91], a[192:195], v[48:51], v[88:91]
v_mfma_f32_16x16x32_bf16 v[88:91], a[196:199], v[68:71], v[88:91]
ds_read_b64_tr_b16 a[226:227], v182 offset:36864
v_mfma_f32_16x16x32_bf16 v[92:95], a[196:199], v[72:75], v[172:175]
v_exp_f32 v80, v80
v_mfma_f32_16x16x32_bf16 v[92:95], a[192:195], v[52:55], v[92:95]
ds_read_b64_tr_b16 a[228:229], v183 offset:32768
s_waitcnt vmcnt(4)
v_mfma_f32_16x16x32_bf16 v[92:95], a[188:191], v[32:35], v[92:95]
v_exp_f32 v81, v81
v_mfma_f32_16x16x32_bf16 v[92:95], a[184:187], v[12:15], v[92:95]
ds_read_b64_tr_b16 a[230:231], v183 offset:36864
s_add_u32 m0, s48, 114688
v_mfma_f32_16x16x32_bf16 v[96:99], a[184:187], v[16:19], v[176:179]
buffer_load_dwordx4 v223, s[20:23], s37 offen offset:3072 nt lds
v_exp_f32 v82, v82
v_mfma_f32_16x16x32_bf16 v[96:99], a[188:191], v[36:39], v[96:99]
ds_read_b64_tr_b16 a[232:233], v184 offset:32768
v_exp_f32 v83, v83
v_mfma_f32_16x16x32_bf16 v[96:99], a[192:195], v[56:59], v[96:99]
v_exp_f32 v84, v84
v_mfma_f32_16x16x32_bf16 v[96:99], a[196:199], v[76:79], v[96:99]
ds_read_b64_tr_b16 a[234:235], v184 offset:36864
v_cvt_pk_bf16_f32 v120, v80, v81
v_cvt_pk_bf16_f32 v121, v82, v83
v_mfma_f32_16x16x32_bf16 v[100:103], a[200:203], v[0:3], v[160:163]
v_exp_f32 v85, v85
v_mfma_f32_16x16x32_bf16 v[100:103], a[204:207], v[20:23], v[100:103]
ds_read_b64_tr_b16 a[236:237], v185 offset:32768
v_exp_f32 v86, v86
v_mfma_f32_16x16x32_bf16 v[100:103], a[208:211], v[40:43], v[100:103]
v_exp_f32 v87, v87
v_mfma_f32_16x16x32_bf16 v[100:103], a[212:215], v[60:63], v[100:103]
ds_read_b64_tr_b16 a[238:239], v185 offset:36864
s_waitcnt vmcnt(4)
v_mfma_f32_16x16x32_bf16 v[104:107], a[212:215], v[64:67], v[164:167]
v_exp_f32 v88, v88
v_mfma_f32_16x16x32_bf16 v[104:107], a[208:211], v[44:47], v[104:107]
ds_read_b64_tr_b16 a[240:241], v186 offset:32768
s_add_u32 m0, s48, 0
s_xor_b32 s36, s3, 204800
v_mfma_f32_16x16x32_bf16 v[104:107], a[204:207], v[24:27], v[104:107]
buffer_load_dwordx4 v220, s[16:19], s36 offen offset:0 nt lds
v_cvt_pk_bf16_f32 v124, v84, v85
v_cvt_pk_bf16_f32 v125, v86, v87
v_mfma_f32_16x16x32_bf16 v[104:107], a[200:203], v[4:7], v[104:107]
ds_read_b64_tr_b16 a[242:243], v186 offset:36864
v_exp_f32 v89, v89
v_mfma_f32_16x16x32_bf16 v[108:111], a[200:203], v[8:11], v[168:171]
v_exp_f32 v90, v90
v_mfma_f32_16x16x32_bf16 v[108:111], a[204:207], v[28:31], v[108:111]
ds_read_b64_tr_b16 a[244:245], v187 offset:32768
v_exp_f32 v91, v91
v_mfma_f32_16x16x32_bf16 v[108:111], a[208:211], v[48:51], v[108:111]
v_exp_f32 v92, v92
v_mfma_f32_16x16x32_bf16 v[108:111], a[212:215], v[68:71], v[108:111]
ds_read_b64_tr_b16 a[246:247], v187 offset:36864
v_cvt_pk_bf16_f32 v128, v88, v89
v_cvt_pk_bf16_f32 v129, v90, v91
v_mfma_f32_16x16x32_bf16 v[112:115], a[212:215], v[72:75], v[172:175]
v_exp_f32 v93, v93
v_mfma_f32_16x16x32_bf16 v[112:115], a[208:211], v[52:55], v[112:115]
s_waitcnt vmcnt(4)
v_exp_f32 v94, v94
v_mfma_f32_16x16x32_bf16 v[112:115], a[204:207], v[32:35], v[112:115]
v_exp_f32 v95, v95
v_mfma_f32_16x16x32_bf16 v[112:115], a[200:203], v[12:15], v[112:115]
s_add_u32 m0, s48, 0
v_exp_f32 v96, v96
v_mfma_f32_16x16x32_bf16 v[116:119], a[200:203], v[16:19], v[176:179]
buffer_load_dwordx4 v221, s[16:19], s36 offen offset:1024 nt lds
v_cvt_pk_bf16_f32 v132, v92, v93
v_cvt_pk_bf16_f32 v133, v94, v95
v_mfma_f32_16x16x32_bf16 v[116:119], a[204:207], v[36:39], v[116:119]
v_exp_f32 v97, v97
v_mfma_f32_16x16x32_bf16 v[116:119], a[208:211], v[56:59], v[116:119]
v_exp_f32 v98, v98
v_mfma_f32_16x16x32_bf16 v[116:119], a[212:215], v[76:79], v[116:119]
v_exp_f32 v99, v99
v_mfma_f32_16x16x32_bf16 a[160:163], a[180:183], v[140:143], a[160:163]
v_cvt_pk_bf16_f32 v136, v96, v97
v_cvt_pk_bf16_f32 v137, v98, v99
v_mfma_f32_16x16x32_bf16 a[164:167], a[180:183], v[144:147], a[164:167]
v_exp_f32 v100, v100
v_mfma_f32_16x16x32_bf16 a[168:171], a[180:183], v[148:151], a[168:171]
v_exp_f32 v101, v101
v_mfma_f32_16x16x32_bf16 a[172:175], a[180:183], v[152:155], a[172:175]
s_waitcnt lgkmcnt(0)
s_barrier
v_mfma_f32_16x16x32_bf16 a[176:179], a[180:183], v[156:159], a[176:179]
s_waitcnt vmcnt(4)
v_exp_f32 v102, v102
v_mfma_f32_16x16x32_bf16 a[0:3], a[216:219], v[140:143], a[0:3]
ds_read_b128 a[184:187], v208 offset:32768
v_exp_f32 v103, v103
v_mfma_f32_16x16x32_bf16 a[4:7], a[216:219], v[144:147], a[4:7]
s_add_u32 m0, s48, 0
v_exp_f32 v104, v104
v_mfma_f32_16x16x32_bf16 a[8:11], a[216:219], v[148:151], a[8:11]
buffer_load_dwordx4 v222, s[16:19], s36 offen offset:2048 nt lds
v_cvt_pk_bf16_f32 v122, v100, v101
v_cvt_pk_bf16_f32 v123, v102, v103
v_mfma_f32_16x16x32_bf16 a[12:15], a[216:219], v[152:155], a[12:15]
v_exp_f32 v105, v105
v_mfma_f32_16x16x32_bf16 a[16:19], a[216:219], v[156:159], a[16:19]
ds_read_b128 a[188:191], v209 offset:32768
v_exp_f32 v106, v106
v_mfma_f32_16x16x32_bf16 a[20:23], a[220:223], v[140:143], a[20:23]
v_exp_f32 v107, v107
v_mfma_f32_16x16x32_bf16 a[24:27], a[220:223], v[144:147], a[24:27]
v_exp_f32 v108, v108
v_mfma_f32_16x16x32_bf16 a[28:31], a[220:223], v[148:151], a[28:31]
v_cvt_pk_bf16_f32 v126, v104, v105
v_cvt_pk_bf16_f32 v127, v106, v107
v_mfma_f32_16x16x32_bf16 a[32:35], a[220:223], v[152:155], a[32:35]
ds_read_b128 a[192:195], v210 offset:32768
v_exp_f32 v109, v109
v_mfma_f32_16x16x32_bf16 a[36:39], a[220:223], v[156:159], a[36:39]
v_exp_f32 v110, v110
v_mfma_f32_16x16x32_bf16 a[40:43], a[224:227], v[140:143], a[40:43]
s_waitcnt vmcnt(4)
v_exp_f32 v111, v111
v_mfma_f32_16x16x32_bf16 a[44:47], a[224:227], v[144:147], a[44:47]
v_exp_f32 v112, v112
v_mfma_f32_16x16x32_bf16 a[48:51], a[224:227], v[148:151], a[48:51]
ds_read_b128 a[196:199], v211 offset:32768
s_add_u32 m0, s48, 0
v_cvt_pk_bf16_f32 v130, v108, v109
v_mfma_f32_16x16x32_bf16 a[52:55], a[224:227], v[152:155], a[52:55]
buffer_load_dwordx4 v223, s[16:19], s36 offen offset:3072 nt lds
v_cvt_pk_bf16_f32 v131, v110, v111
v_mfma_f32_16x16x32_bf16 a[56:59], a[224:227], v[156:159], a[56:59]
v_exp_f32 v113, v113
v_mfma_f32_16x16x32_bf16 a[60:63], a[228:231], v[140:143], a[60:63]
v_exp_f32 v114, v114
v_mfma_f32_16x16x32_bf16 a[64:67], a[228:231], v[144:147], a[64:67]
ds_read_b128 a[200:203], v208 offset:36864
v_exp_f32 v115, v115
v_mfma_f32_16x16x32_bf16 a[68:71], a[228:231], v[148:151], a[68:71]
v_exp_f32 v116, v116
v_mfma_f32_16x16x32_bf16 a[72:75], a[228:231], v[152:155], a[72:75]
v_cvt_pk_bf16_f32 v134, v112, v113
v_cvt_pk_bf16_f32 v135, v114, v115
v_mfma_f32_16x16x32_bf16 a[76:79], a[228:231], v[156:159], a[76:79]
v_exp_f32 v117, v117
v_mfma_f32_16x16x32_bf16 a[80:83], a[232:235], v[140:143], a[80:83]
ds_read_b128 a[204:207], v209 offset:36864
v_exp_f32 v118, v118
v_mfma_f32_16x16x32_bf16 a[84:87], a[232:235], v[144:147], a[84:87]
v_exp_f32 v119, v119
v_mfma_f32_16x16x32_bf16 a[88:91], a[232:235], v[148:151], a[88:91]
s_waitcnt vmcnt(4)
v_cvt_pk_bf16_f32 v138, v116, v117
v_cvt_pk_bf16_f32 v139, v118, v119
v_mfma_f32_16x16x32_bf16 a[92:95], a[232:235], v[152:155], a[92:95]
v_mfma_f32_16x16x32_bf16 a[96:99], a[232:235], v[156:159], a[96:99]
ds_read_b128 a[208:211], v210 offset:36864
s_add_u32 m0, s48, 147456
s_xor_b32 s37, s3, 196608
v_mfma_f32_16x16x32_bf16 a[100:103], a[236:239], v[140:143], a[100:103]
buffer_load_dwordx4 v220, s[20:23], s37 offen offset:0 nt lds
v_mfma_f32_16x16x32_bf16 a[104:107], a[236:239], v[144:147], a[104:107]
v_mfma_f32_16x16x32_bf16 a[108:111], a[236:239], v[148:151], a[108:111]
v_mfma_f32_16x16x32_bf16 a[112:115], a[236:239], v[152:155], a[112:115]
ds_read_b128 a[212:215], v211 offset:36864
v_mfma_f32_16x16x32_bf16 a[116:119], a[236:239], v[156:159], a[116:119]
v_mfma_f32_16x16x32_bf16 a[120:123], a[240:243], v[140:143], a[120:123]
v_mfma_f32_16x16x32_bf16 a[124:127], a[240:243], v[144:147], a[124:127]
s_waitcnt vmcnt(4)
v_mfma_f32_16x16x32_bf16 a[128:131], a[240:243], v[148:151], a[128:131]
v_mfma_f32_16x16x32_bf16 a[132:135], a[240:243], v[152:155], a[132:135]
s_add_u32 m0, s48, 147456
v_mfma_f32_16x16x32_bf16 a[136:139], a[240:243], v[156:159], a[136:139]
buffer_load_dwordx4 v221, s[20:23], s37 offen offset:1024 nt lds
v_mfma_f32_16x16x32_bf16 a[140:143], a[244:247], v[140:143], a[140:143]
v_mfma_f32_16x16x32_bf16 a[144:147], a[244:247], v[144:147], a[144:147]
v_mfma_f32_16x16x32_bf16 a[148:151], a[244:247], v[148:151], a[148:151]
v_mfma_f32_16x16x32_bf16 a[152:155], a[244:247], v[152:155], a[152:155]
v_mfma_f32_16x16x32_bf16 a[156:159], a[244:247], v[156:159], a[156:159]
s_waitcnt lgkmcnt(0)
v_mfma_f32_16x16x32_bf16 v[80:83], a[184:187], v[0:3], v[160:163]
v_mfma_f32_16x16x32_bf16 v[80:83], a[188:191], v[20:23], v[80:83]
ds_read_b64_tr_b16 a[216:217], v188 offset:0
v_mfma_f32_16x16x32_bf16 v[80:83], a[192:195], v[40:43], v[80:83]
v_mfma_f32_16x16x32_bf16 v[80:83], a[196:199], v[60:63], v[80:83]
ds_read_b64_tr_b16 a[218:219], v188 offset:4096
s_waitcnt vmcnt(4)
v_mfma_f32_16x16x32_bf16 v[84:87], a[196:199], v[64:67], v[164:167]
v_mfma_f32_16x16x32_bf16 v[84:87], a[192:195], v[44:47], v[84:87]
ds_read_b64_tr_b16 a[220:221], v189 offset:0
s_add_u32 m0, s48, 147456
v_mfma_f32_16x16x32_bf16 v[84:87], a[188:191], v[24:27], v[84:87]
buffer_load_dwordx4 v222, s[20:23], s37 offen offset:2048 nt lds
v_mfma_f32_16x16x32_bf16 v[84:87], a[184:187], v[4:7], v[84:87]
ds_read_b64_tr_b16 a[222:223], v189 offset:4096
v_mfma_f32_16x16x32_bf16 v[88:91], a[184:187], v[8:11], v[168:171]
v_mfma_f32_16x16x32_bf16 v[88:91], a[188:191], v[28:31], v[88:91]
ds_read_b64_tr_b16 a[224:225], v190 offset:0
v_mfma_f32_16x16x32_bf16 v[88:91], a[192:195], v[48:51], v[88:91]
v_mfma_f32_16x16x32_bf16 v[88:91], a[196:199], v[68:71], v[88:91]
ds_read_b64_tr_b16 a[226:227], v190 offset:4096
v_mfma_f32_16x16x32_bf16 v[92:95], a[196:199], v[72:75], v[172:175]
v_exp_f32 v80, v80
v_mfma_f32_16x16x32_bf16 v[92:95], a[192:195], v[52:55], v[92:95]
ds_read_b64_tr_b16 a[228:229], v191 offset:0
s_waitcnt vmcnt(4)
v_mfma_f32_16x16x32_bf16 v[92:95], a[188:191], v[32:35], v[92:95]
v_exp_f32 v81, v81
v_mfma_f32_16x16x32_bf16 v[92:95], a[184:187], v[12:15], v[92:95]
ds_read_b64_tr_b16 a[230:231], v191 offset:4096
s_add_u32 m0, s48, 147456
v_mfma_f32_16x16x32_bf16 v[96:99], a[184:187], v[16:19], v[176:179]
buffer_load_dwordx4 v223, s[20:23], s37 offen offset:3072 nt lds
v_exp_f32 v82, v82
v_mfma_f32_16x16x32_bf16 v[96:99], a[188:191], v[36:39], v[96:99]
ds_read_b64_tr_b16 a[232:233], v192 offset:0
v_exp_f32 v83, v83
v_mfma_f32_16x16x32_bf16 v[96:99], a[192:195], v[56:59], v[96:99]
v_exp_f32 v84, v84
v_mfma_f32_16x16x32_bf16 v[96:99], a[196:199], v[76:79], v[96:99]
ds_read_b64_tr_b16 a[234:235], v192 offset:4096
v_cvt_pk_bf16_f32 v140, v80, v81
v_cvt_pk_bf16_f32 v141, v82, v83
v_mfma_f32_16x16x32_bf16 v[100:103], a[200:203], v[0:3], v[160:163]
v_exp_f32 v85, v85
v_mfma_f32_16x16x32_bf16 v[100:103], a[204:207], v[20:23], v[100:103]
ds_read_b64_tr_b16 a[236:237], v193 offset:0
v_exp_f32 v86, v86
v_mfma_f32_16x16x32_bf16 v[100:103], a[208:211], v[40:43], v[100:103]
v_exp_f32 v87, v87
v_mfma_f32_16x16x32_bf16 v[100:103], a[212:215], v[60:63], v[100:103]
ds_read_b64_tr_b16 a[238:239], v193 offset:4096
v_exp_f32 v88, v88
v_mfma_f32_16x16x32_bf16 v[104:107], a[212:215], v[64:67], v[164:167]
v_cvt_pk_bf16_f32 v144, v84, v85
v_cvt_pk_bf16_f32 v145, v86, v87
v_mfma_f32_16x16x32_bf16 v[104:107], a[208:211], v[44:47], v[104:107]
ds_read_b64_tr_b16 a[240:241], v194 offset:0
s_waitcnt vmcnt(4)
v_mfma_f32_16x16x32_bf16 v[104:107], a[204:207], v[24:27], v[104:107]
v_exp_f32 v89, v89
v_mfma_f32_16x16x32_bf16 v[104:107], a[200:203], v[4:7], v[104:107]
ds_read_b64_tr_b16 a[242:243], v194 offset:4096
s_add_u32 m0, s48, 32768
s_xor_b32 s36, s3, 212992
v_mfma_f32_16x16x32_bf16 v[108:111], a[200:203], v[8:11], v[168:171]
buffer_load_dwordx4 v220, s[16:19], s36 offen offset:0 nt lds
v_exp_f32 v90, v90
v_mfma_f32_16x16x32_bf16 v[108:111], a[204:207], v[28:31], v[108:111]
ds_read_b64_tr_b16 a[244:245], v195 offset:0
v_exp_f32 v91, v91
v_mfma_f32_16x16x32_bf16 v[108:111], a[208:211], v[48:51], v[108:111]
v_exp_f32 v92, v92
v_mfma_f32_16x16x32_bf16 v[108:111], a[212:215], v[68:71], v[108:111]
ds_read_b64_tr_b16 a[246:247], v195 offset:4096
v_cvt_pk_bf16_f32 v148, v88, v89
v_cvt_pk_bf16_f32 v149, v90, v91
v_mfma_f32_16x16x32_bf16 v[112:115], a[212:215], v[72:75], v[172:175]
v_exp_f32 v93, v93
v_mfma_f32_16x16x32_bf16 v[112:115], a[208:211], v[52:55], v[112:115]
v_exp_f32 v94, v94
v_mfma_f32_16x16x32_bf16 v[112:115], a[204:207], v[32:35], v[112:115]
s_waitcnt vmcnt(4)
v_exp_f32 v95, v95
v_mfma_f32_16x16x32_bf16 v[112:115], a[200:203], v[12:15], v[112:115]
v_exp_f32 v96, v96
v_mfma_f32_16x16x32_bf16 v[116:119], a[200:203], v[16:19], v[176:179]
s_add_u32 m0, s48, 32768
v_cvt_pk_bf16_f32 v152, v92, v93
v_cvt_pk_bf16_f32 v153, v94, v95
v_mfma_f32_16x16x32_bf16 v[116:119], a[204:207], v[36:39], v[116:119]
buffer_load_dwordx4 v221, s[16:19], s36 offen offset:1024 nt lds
v_exp_f32 v97, v97
v_mfma_f32_16x16x32_bf16 v[116:119], a[208:211], v[56:59], v[116:119]
v_exp_f32 v98, v98
v_mfma_f32_16x16x32_bf16 v[116:119], a[212:215], v[76:79], v[116:119]
v_exp_f32 v99, v99
v_mfma_f32_16x16x32_bf16 a[160:163], a[180:183], v[120:123], a[160:163]
v_cvt_pk_bf16_f32 v156, v96, v97
v_cvt_pk_bf16_f32 v157, v98, v99
v_mfma_f32_16x16x32_bf16 a[164:167], a[180:183], v[124:127], a[164:167]
v_exp_f32 v100, v100
v_mfma_f32_16x16x32_bf16 a[168:171], a[180:183], v[128:131], a[168:171]
v_exp_f32 v101, v101
v_mfma_f32_16x16x32_bf16 a[172:175], a[180:183], v[132:135], a[172:175]
s_waitcnt lgkmcnt(0)
s_barrier
v_mfma_f32_16x16x32_bf16 a[176:179], a[180:183], v[136:139], a[176:179]
v_exp_f32 v102, v102
v_mfma_f32_16x16x32_bf16 a[0:3], a[216:219], v[120:123], a[0:3]
ds_read_b128 a[184:187], v212 offset:0
s_waitcnt vmcnt(4)
v_mfma_f32_16x16x32_bf16 a[4:7], a[216:219], v[124:127], a[4:7]
v_exp_f32 v103, v103
v_mfma_f32_16x16x32_bf16 a[8:11], a[216:219], v[128:131], a[8:11]
s_add_u32 m0, s48, 32768
v_exp_f32 v104, v104
v_mfma_f32_16x16x32_bf16 a[12:15], a[216:219], v[132:135], a[12:15]
buffer_load_dwordx4 v222, s[16:19], s36 offen offset:2048 nt lds
v_cvt_pk_bf16_f32 v142, v100, v101
v_cvt_pk_bf16_f32 v143, v102, v103
v_mfma_f32_16x16x32_bf16 a[16:19], a[216:219], v[136:139], a[16:19]
ds_read_b128 a[188:191], v213 offset:0
v_exp_f32 v105, v105
v_mfma_f32_16x16x32_bf16 a[20:23], a[220:223], v[120:123], a[20:23]
v_exp_f32 v106, v106
v_mfma_f32_16x16x32_bf16 a[24:27], a[220:223], v[124:127], a[24:27]
v_exp_f32 v107, v107
v_mfma_f32_16x16x32_bf16 a[28:31], a[220:223], v[128:131], a[28:31]
v_exp_f32 v108, v108
v_mfma_f32_16x16x32_bf16 a[32:35], a[220:223], v[132:135], a[32:35]
ds_read_b128 a[192:195], v214 offset:0
v_cvt_pk_bf16_f32 v146, v104, v105
v_cvt_pk_bf16_f32 v147, v106, v107
v_mfma_f32_16x16x32_bf16 a[36:39], a[220:223], v[136:139], a[36:39]
v_exp_f32 v109, v109
v_mfma_f32_16x16x32_bf16 a[40:43], a[224:227], v[120:123], a[40:43]
v_exp_f32 v110, v110
v_mfma_f32_16x16x32_bf16 a[44:47], a[224:227], v[124:127], a[44:47]
s_waitcnt vmcnt(4)
v_exp_f32 v111, v111
v_mfma_f32_16x16x32_bf16 a[48:51], a[224:227], v[128:131], a[48:51]
ds_read_b128 a[196:199], v215 offset:0
v_exp_f32 v112, v112
v_mfma_f32_16x16x32_bf16 a[52:55], a[224:227], v[132:135], a[52:55]
s_add_u32 m0, s48, 32768
v_cvt_pk_bf16_f32 v150, v108, v109
v_cvt_pk_bf16_f32 v151, v110, v111
v_mfma_f32_16x16x32_bf16 a[56:59], a[224:227], v[136:139], a[56:59]
buffer_load_dwordx4 v223, s[16:19], s36 offen offset:3072 nt lds
v_exp_f32 v113, v113
v_mfma_f32_16x16x32_bf16 a[60:63], a[228:231], v[120:123], a[60:63]
v_exp_f32 v114, v114
v_mfma_f32_16x16x32_bf16 a[64:67], a[228:231], v[124:127], a[64:67]
ds_read_b128 a[200:203], v212 offset:4096
v_exp_f32 v115, v115
v_mfma_f32_16x16x32_bf16 a[68:71], a[228:231], v[128:131], a[68:71]
v_exp_f32 v116, v116
v_mfma_f32_16x16x32_bf16 a[72:75], a[228:231], v[132:135], a[72:75]
v_cvt_pk_bf16_f32 v154, v112, v113
v_cvt_pk_bf16_f32 v155, v114, v115
v_mfma_f32_16x16x32_bf16 a[76:79], a[228:231], v[136:139], a[76:79]
v_exp_f32 v117, v117
v_mfma_f32_16x16x32_bf16 a[80:83], a[232:235], v[120:123], a[80:83]
ds_read_b128 a[204:207], v213 offset:4096
v_exp_f32 v118, v118
v_mfma_f32_16x16x32_bf16 a[84:87], a[232:235], v[124:127], a[84:87]
v_exp_f32 v119, v119
v_mfma_f32_16x16x32_bf16 a[88:91], a[232:235], v[128:131], a[88:91]
s_waitcnt vmcnt(4)
v_cvt_pk_bf16_f32 v158, v116, v117
v_cvt_pk_bf16_f32 v159, v118, v119
v_mfma_f32_16x16x32_bf16 a[92:95], a[232:235], v[132:135], a[92:95]
v_mfma_f32_16x16x32_bf16 a[96:99], a[232:235], v[136:139], a[96:99]
ds_read_b128 a[208:211], v214 offset:4096
s_add_u32 m0, s48, 16384
s_xor_b32 s37, s3, 204800
v_mfma_f32_16x16x32_bf16 a[100:103], a[236:239], v[120:123], a[100:103]
buffer_load_dwordx4 v220, s[20:23], s37 offen offset:0 nt lds
v_mfma_f32_16x16x32_bf16 a[104:107], a[236:239], v[124:127], a[104:107]
v_mfma_f32_16x16x32_bf16 a[108:111], a[236:239], v[128:131], a[108:111]
v_mfma_f32_16x16x32_bf16 a[112:115], a[236:239], v[132:135], a[112:115]
ds_read_b128 a[212:215], v215 offset:4096
v_mfma_f32_16x16x32_bf16 a[116:119], a[236:239], v[136:139], a[116:119]
v_mfma_f32_16x16x32_bf16 a[120:123], a[240:243], v[120:123], a[120:123]
v_mfma_f32_16x16x32_bf16 a[124:127], a[240:243], v[124:127], a[124:127]
v_mfma_f32_16x16x32_bf16 a[128:131], a[240:243], v[128:131], a[128:131]
s_waitcnt vmcnt(4)
v_mfma_f32_16x16x32_bf16 a[132:135], a[240:243], v[132:135], a[132:135]
v_mfma_f32_16x16x32_bf16 a[136:139], a[240:243], v[136:139], a[136:139]
s_add_u32 m0, s48, 16384
v_mfma_f32_16x16x32_bf16 a[140:143], a[244:247], v[120:123], a[140:143]
buffer_load_dwordx4 v221, s[20:23], s37 offen offset:1024 nt lds
v_mfma_f32_16x16x32_bf16 a[144:147], a[244:247], v[124:127], a[144:147]
v_mfma_f32_16x16x32_bf16 a[148:151], a[244:247], v[128:131], a[148:151]
v_mfma_f32_16x16x32_bf16 a[152:155], a[244:247], v[132:135], a[152:155]
v_mfma_f32_16x16x32_bf16 a[156:159], a[244:247], v[136:139], a[156:159]
s_waitcnt lgkmcnt(0)
v_mfma_f32_16x16x32_bf16 v[80:83], a[184:187], v[0:3], v[160:163]
v_mfma_f32_16x16x32_bf16 v[80:83], a[188:191], v[20:23], v[80:83]
ds_read_b64_tr_b16 a[216:217], v188 offset:32768
v_mfma_f32_16x16x32_bf16 v[80:83], a[192:195], v[40:43], v[80:83]
v_mfma_f32_16x16x32_bf16 v[80:83], a[196:199], v[60:63], v[80:83]
ds_read_b64_tr_b16 a[218:219], v188 offset:36864
s_waitcnt vmcnt(4)
v_mfma_f32_16x16x32_bf16 v[84:87], a[196:199], v[64:67], v[164:167]
v_mfma_f32_16x16x32_bf16 v[84:87], a[192:195], v[44:47], v[84:87]
ds_read_b64_tr_b16 a[220:221], v189 offset:32768
s_add_u32 m0, s48, 16384
v_mfma_f32_16x16x32_bf16 v[84:87], a[188:191], v[24:27], v[84:87]
buffer_load_dwordx4 v222, s[20:23], s37 offen offset:2048 nt lds
v_mfma_f32_16x16x32_bf16 v[84:87], a[184:187], v[4:7], v[84:87]
ds_read_b64_tr_b16 a[222:223], v189 offset:36864
v_mfma_f32_16x16x32_bf16 v[88:91], a[184:187], v[8:11], v[168:171]
v_mfma_f32_16x16x32_bf16 v[88:91], a[188:191], v[28:31], v[88:91]
ds_read_b64_tr_b16 a[224:225], v190 offset:32768
v_mfma_f32_16x16x32_bf16 v[88:91], a[192:195], v[48:51], v[88:91]
v_mfma_f32_16x16x32_bf16 v[88:91], a[196:199], v[68:71], v[88:91]
ds_read_b64_tr_b16 a[226:227], v190 offset:36864
v_mfma_f32_16x16x32_bf16 v[92:95], a[196:199], v[72:75], v[172:175]
v_exp_f32 v80, v80
v_mfma_f32_16x16x32_bf16 v[92:95], a[192:195], v[52:55], v[92:95]
ds_read_b64_tr_b16 a[228:229], v191 offset:32768
v_exp_f32 v81, v81
v_mfma_f32_16x16x32_bf16 v[92:95], a[188:191], v[32:35], v[92:95]
v_exp_f32 v82, v82
v_mfma_f32_16x16x32_bf16 v[92:95], a[184:187], v[12:15], v[92:95]
ds_read_b64_tr_b16 a[230:231], v191 offset:36864
s_waitcnt vmcnt(4)
v_mfma_f32_16x16x32_bf16 v[96:99], a[184:187], v[16:19], v[176:179]
v_exp_f32 v83, v83
v_mfma_f32_16x16x32_bf16 v[96:99], a[188:191], v[36:39], v[96:99]
ds_read_b64_tr_b16 a[232:233], v192 offset:32768
s_add_u32 m0, s48, 16384
v_mfma_f32_16x16x32_bf16 v[96:99], a[192:195], v[56:59], v[96:99]
buffer_load_dwordx4 v223, s[20:23], s37 offen offset:3072 nt lds
v_exp_f32 v84, v84
v_mfma_f32_16x16x32_bf16 v[96:99], a[196:199], v[76:79], v[96:99]
ds_read_b64_tr_b16 a[234:235], v192 offset:36864
v_cvt_pk_bf16_f32 v120, v80, v81
v_cvt_pk_bf16_f32 v121, v82, v83
v_mfma_f32_16x16x32_bf16 v[100:103], a[200:203], v[0:3], v[160:163]
v_exp_f32 v85, v85
v_mfma_f32_16x16x32_bf16 v[100:103], a[204:207], v[20:23], v[100:103]
ds_read_b64_tr_b16 a[236:237], v193 offset:32768
v_exp_f32 v86, v86
v_mfma_f32_16x16x32_bf16 v[100:103], a[208:211], v[40:43], v[100:103]
v_exp_f32 v87, v87
v_mfma_f32_16x16x32_bf16 v[100:103], a[212:215], v[60:63], v[100:103]
ds_read_b64_tr_b16 a[238:239], v193 offset:36864
v_exp_f32 v88, v88
v_mfma_f32_16x16x32_bf16 v[104:107], a[212:215], v[64:67], v[164:167]
v_cvt_pk_bf16_f32 v124, v84, v85
v_cvt_pk_bf16_f32 v125, v86, v87
v_mfma_f32_16x16x32_bf16 v[104:107], a[208:211], v[44:47], v[104:107]
ds_read_b64_tr_b16 a[240:241], v194 offset:32768
s_waitcnt vmcnt(4)
v_mfma_f32_16x16x32_bf16 v[104:107], a[204:207], v[24:27], v[104:107]
v_exp_f32 v89, v89
v_mfma_f32_16x16x32_bf16 v[104:107], a[200:203], v[4:7], v[104:107]
ds_read_b64_tr_b16 a[242:243], v194 offset:36864
s_add_u32 m0, s48, 65536
s_xor_b32 s36, s3, 221184
v_mfma_f32_16x16x32_bf16 v[108:111], a[200:203], v[8:11], v[168:171]
buffer_load_dwordx4 v220, s[16:19], s36 offen offset:0 nt lds
v_exp_f32 v90, v90
v_mfma_f32_16x16x32_bf16 v[108:111], a[204:207], v[28:31], v[108:111]
ds_read_b64_tr_b16 a[244:245], v195 offset:32768
v_exp_f32 v91, v91
v_mfma_f32_16x16x32_bf16 v[108:111], a[208:211], v[48:51], v[108:111]
v_exp_f32 v92, v92
v_mfma_f32_16x16x32_bf16 v[108:111], a[212:215], v[68:71], v[108:111]
ds_read_b64_tr_b16 a[246:247], v195 offset:36864
v_cvt_pk_bf16_f32 v128, v88, v89
v_cvt_pk_bf16_f32 v129, v90, v91
v_mfma_f32_16x16x32_bf16 v[112:115], a[212:215], v[72:75], v[172:175]
v_exp_f32 v93, v93
v_mfma_f32_16x16x32_bf16 v[112:115], a[208:211], v[52:55], v[112:115]
v_exp_f32 v94, v94
v_mfma_f32_16x16x32_bf16 v[112:115], a[204:207], v[32:35], v[112:115]
v_exp_f32 v95, v95
v_mfma_f32_16x16x32_bf16 v[112:115], a[200:203], v[12:15], v[112:115]
s_waitcnt vmcnt(4)
v_exp_f32 v96, v96
v_mfma_f32_16x16x32_bf16 v[116:119], a[200:203], v[16:19], v[176:179]
v_cvt_pk_bf16_f32 v132, v92, v93
v_cvt_pk_bf16_f32 v133, v94, v95
v_mfma_f32_16x16x32_bf16 v[116:119], a[204:207], v[36:39], v[116:119]
s_add_u32 m0, s48, 65536
v_exp_f32 v97, v97
v_mfma_f32_16x16x32_bf16 v[116:119], a[208:211], v[56:59], v[116:119]
buffer_load_dwordx4 v221, s[16:19], s36 offen offset:1024 nt lds
v_exp_f32 v98, v98
v_mfma_f32_16x16x32_bf16 v[116:119], a[212:215], v[76:79], v[116:119]
v_exp_f32 v99, v99
v_mfma_f32_16x16x32_bf16 a[160:163], a[180:183], v[140:143], a[160:163]
v_cvt_pk_bf16_f32 v136, v96, v97
v_cvt_pk_bf16_f32 v137, v98, v99
v_mfma_f32_16x16x32_bf16 a[164:167], a[180:183], v[144:147], a[164:167]
v_exp_f32 v100, v100
v_mfma_f32_16x16x32_bf16 a[168:171], a[180:183], v[148:151], a[168:171]
v_exp_f32 v101, v101
v_mfma_f32_16x16x32_bf16 a[172:175], a[180:183], v[152:155], a[172:175]
s_waitcnt lgkmcnt(0)
s_barrier
v_mfma_f32_16x16x32_bf16 a[176:179], a[180:183], v[156:159], a[176:179]
v_exp_f32 v102, v102
v_mfma_f32_16x16x32_bf16 a[0:3], a[216:219], v[140:143], a[0:3]
ds_read_b128 a[184:187], v204 offset:0
v_exp_f32 v103, v103
v_mfma_f32_16x16x32_bf16 a[4:7], a[216:219], v[144:147], a[4:7]
v_exp_f32 v104, v104
v_mfma_f32_16x16x32_bf16 a[8:11], a[216:219], v[148:151], a[8:11]
s_waitcnt vmcnt(4)
v_cvt_pk_bf16_f32 v122, v100, v101
v_cvt_pk_bf16_f32 v123, v102, v103
v_mfma_f32_16x16x32_bf16 a[12:15], a[216:219], v[152:155], a[12:15]
v_exp_f32 v105, v105
v_mfma_f32_16x16x32_bf16 a[16:19], a[216:219], v[156:159], a[16:19]
ds_read_b128 a[188:191], v205 offset:0
s_add_u32 m0, s48, 65536
v_mfma_f32_16x16x32_bf16 a[20:23], a[220:223], v[140:143], a[20:23]
buffer_load_dwordx4 v222, s[16:19], s36 offen offset:2048 nt lds
v_exp_f32 v106, v106
v_mfma_f32_16x16x32_bf16 a[24:27], a[220:223], v[144:147], a[24:27]
v_exp_f32 v107, v107
v_mfma_f32_16x16x32_bf16 a[28:31], a[220:223], v[148:151], a[28:31]
v_exp_f32 v108, v108
v_mfma_f32_16x16x32_bf16 a[32:35], a[220:223], v[152:155], a[32:35]
ds_read_b128 a[192:195], v206 offset:0
v_cvt_pk_bf16_f32 v126, v104, v105
v_cvt_pk_bf16_f32 v127, v106, v107
v_mfma_f32_16x16x32_bf16 a[36:39], a[220:223], v[156:159], a[36:39]
v_exp_f32 v109, v109
v_mfma_f32_16x16x32_bf16 a[40:43], a[224:227], v[140:143], a[40:43]
v_exp_f32 v110, v110
v_mfma_f32_16x16x32_bf16 a[44:47], a[224:227], v[144:147], a[44:47]
v_exp_f32 v111, v111
v_mfma_f32_16x16x32_bf16 a[48:51], a[224:227], v[148:151], a[48:51]
ds_read_b128 a[196:199], v207 offset:0
s_waitcnt vmcnt(4)
v_mfma_f32_16x16x32_bf16 a[52:55], a[224:227], v[152:155], a[52:55]
v_exp_f32 v112, v112
v_mfma_f32_16x16x32_bf16 a[56:59], a[224:227], v[156:159], a[56:59]
s_add_u32 m0, s48, 65536
v_cvt_pk_bf16_f32 v130, v108, v109
v_cvt_pk_bf16_f32 v131, v110, v111
v_mfma_f32_16x16x32_bf16 a[60:63], a[228:231], v[140:143], a[60:63]
buffer_load_dwordx4 v223, s[16:19], s36 offen offset:3072 nt lds
v_exp_f32 v113, v113
v_mfma_f32_16x16x32_bf16 a[64:67], a[228:231], v[144:147], a[64:67]
ds_read_b128 a[200:203], v204 offset:4096
v_exp_f32 v114, v114
v_mfma_f32_16x16x32_bf16 a[68:71], a[228:231], v[148:151], a[68:71]
v_exp_f32 v115, v115
v_mfma_f32_16x16x32_bf16 a[72:75], a[228:231], v[152:155], a[72:75]
v_exp_f32 v116, v116
v_mfma_f32_16x16x32_bf16 a[76:79], a[228:231], v[156:159], a[76:79]
v_cvt_pk_bf16_f32 v134, v112, v113
v_cvt_pk_bf16_f32 v135, v114, v115
v_mfma_f32_16x16x32_bf16 a[80:83], a[232:235], v[140:143], a[80:83]
ds_read_b128 a[204:207], v205 offset:4096
v_exp_f32 v117, v117
v_mfma_f32_16x16x32_bf16 a[84:87], a[232:235], v[144:147], a[84:87]
v_exp_f32 v118, v118
v_mfma_f32_16x16x32_bf16 a[88:91], a[232:235], v[148:151], a[88:91]
v_exp_f32 v119, v119
v_mfma_f32_16x16x32_bf16 a[92:95], a[232:235], v[152:155], a[92:95]
s_waitcnt vmcnt(4)
v_cvt_pk_bf16_f32 v138, v116, v117
v_cvt_pk_bf16_f32 v139, v118, v119
v_mfma_f32_16x16x32_bf16 a[96:99], a[232:235], v[156:159], a[96:99]
ds_read_b128 a[208:211], v206 offset:4096
v_mfma_f32_16x16x32_bf16 a[100:103], a[236:239], v[140:143], a[100:103]
s_add_u32 m0, s48, 49152
s_xor_b32 s37, s3, 212992
v_mfma_f32_16x16x32_bf16 a[104:107], a[236:239], v[144:147], a[104:107]
buffer_load_dwordx4 v220, s[20:23], s37 offen offset:0 nt lds
v_mfma_f32_16x16x32_bf16 a[108:111], a[236:239], v[148:151], a[108:111]
v_mfma_f32_16x16x32_bf16 a[112:115], a[236:239], v[152:155], a[112:115]
ds_read_b128 a[212:215], v207 offset:4096
v_mfma_f32_16x16x32_bf16 a[116:119], a[236:239], v[156:159], a[116:119]
v_mfma_f32_16x16x32_bf16 a[120:123], a[240:243], v[140:143], a[120:123]
v_mfma_f32_16x16x32_bf16 a[124:127], a[240:243], v[144:147], a[124:127]
v_mfma_f32_16x16x32_bf16 a[128:131], a[240:243], v[148:151], a[128:131]
v_mfma_f32_16x16x32_bf16 a[132:135], a[240:243], v[152:155], a[132:135]
s_waitcnt vmcnt(4)
v_mfma_f32_16x16x32_bf16 a[136:139], a[240:243], v[156:159], a[136:139]
v_mfma_f32_16x16x32_bf16 a[140:143], a[244:247], v[140:143], a[140:143]
s_add_u32 m0, s48, 49152
v_mfma_f32_16x16x32_bf16 a[144:147], a[244:247], v[144:147], a[144:147]
buffer_load_dwordx4 v221, s[20:23], s37 offen offset:1024 nt lds
v_mfma_f32_16x16x32_bf16 a[148:151], a[244:247], v[148:151], a[148:151]
v_mfma_f32_16x16x32_bf16 a[152:155], a[244:247], v[152:155], a[152:155]
v_mfma_f32_16x16x32_bf16 a[156:159], a[244:247], v[156:159], a[156:159]
s_waitcnt lgkmcnt(0)
v_mfma_f32_16x16x32_bf16 v[80:83], a[184:187], v[0:3], v[160:163]
v_mfma_f32_16x16x32_bf16 v[80:83], a[188:191], v[20:23], v[80:83]
ds_read_b64_tr_b16 a[216:217], v196 offset:0
v_mfma_f32_16x16x32_bf16 v[80:83], a[192:195], v[40:43], v[80:83]
v_mfma_f32_16x16x32_bf16 v[80:83], a[196:199], v[60:63], v[80:83]
ds_read_b64_tr_b16 a[218:219], v196 offset:4096
v_mfma_f32_16x16x32_bf16 v[84:87], a[196:199], v[64:67], v[164:167]
v_mfma_f32_16x16x32_bf16 v[84:87], a[192:195], v[44:47], v[84:87]
ds_read_b64_tr_b16 a[220:221], v197 offset:0
s_waitcnt vmcnt(4)
v_mfma_f32_16x16x32_bf16 v[84:87], a[188:191], v[24:27], v[84:87]
v_mfma_f32_16x16x32_bf16 v[84:87], a[184:187], v[4:7], v[84:87]
ds_read_b64_tr_b16 a[222:223], v197 offset:4096
s_add_u32 m0, s48, 49152
v_mfma_f32_16x16x32_bf16 v[88:91], a[184:187], v[8:11], v[168:171]
buffer_load_dwordx4 v222, s[20:23], s37 offen offset:2048 nt lds
v_mfma_f32_16x16x32_bf16 v[88:91], a[188:191], v[28:31], v[88:91]
ds_read_b64_tr_b16 a[224:225], v198 offset:0
v_mfma_f32_16x16x32_bf16 v[88:91], a[192:195], v[48:51], v[88:91]
v_mfma_f32_16x16x32_bf16 v[88:91], a[196:199], v[68:71], v[88:91]
ds_read_b64_tr_b16 a[226:227], v198 offset:4096
v_mfma_f32_16x16x32_bf16 v[92:95], a[196:199], v[72:75], v[172:175]
v_exp_f32 v80, v80
v_mfma_f32_16x16x32_bf16 v[92:95], a[192:195], v[52:55], v[92:95]
ds_read_b64_tr_b16 a[228:229], v199 offset:0
v_exp_f32 v81, v81
v_mfma_f32_16x16x32_bf16 v[92:95], a[188:191], v[32:35], v[92:95]
v_exp_f32 v82, v82
v_mfma_f32_16x16x32_bf16 v[92:95], a[184:187], v[12:15], v[92:95]
ds_read_b64_tr_b16 a[230:231], v199 offset:4096
s_waitcnt vmcnt(4)
v_mfma_f32_16x16x32_bf16 v[96:99], a[184:187], v[16:19], v[176:179]
v_exp_f32 v83, v83
v_mfma_f32_16x16x32_bf16 v[96:99], a[188:191], v[36:39], v[96:99]
ds_read_b64_tr_b16 a[232:233], v200 offset:0
s_add_u32 m0, s48, 49152
v_mfma_f32_16x16x32_bf16 v[96:99], a[192:195], v[56:59], v[96:99]
buffer_load_dwordx4 v223, s[20:23], s37 offen offset:3072 nt lds
v_exp_f32 v84, v84
v_mfma_f32_16x16x32_bf16 v[96:99], a[196:199], v[76:79], v[96:99]
ds_read_b64_tr_b16 a[234:235], v200 offset:4096
v_cvt_pk_bf16_f32 v140, v80, v81
v_cvt_pk_bf16_f32 v141, v82, v83
v_mfma_f32_16x16x32_bf16 v[100:103], a[200:203], v[0:3], v[160:163]
v_exp_f32 v85, v85
v_mfma_f32_16x16x32_bf16 v[100:103], a[204:207], v[20:23], v[100:103]
ds_read_b64_tr_b16 a[236:237], v201 offset:0
v_exp_f32 v86, v86
v_mfma_f32_16x16x32_bf16 v[100:103], a[208:211], v[40:43], v[100:103]
v_exp_f32 v87, v87
v_mfma_f32_16x16x32_bf16 v[100:103], a[212:215], v[60:63], v[100:103]
ds_read_b64_tr_b16 a[238:239], v201 offset:4096
v_exp_f32 v88, v88
v_mfma_f32_16x16x32_bf16 v[104:107], a[212:215], v[64:67], v[164:167]
v_cvt_pk_bf16_f32 v144, v84, v85
v_cvt_pk_bf16_f32 v145, v86, v87
v_mfma_f32_16x16x32_bf16 v[104:107], a[208:211], v[44:47], v[104:107]
ds_read_b64_tr_b16 a[240:241], v202 offset:0
v_exp_f32 v89, v89
v_mfma_f32_16x16x32_bf16 v[104:107], a[204:207], v[24:27], v[104:107]
v_exp_f32 v90, v90
v_mfma_f32_16x16x32_bf16 v[104:107], a[200:203], v[4:7], v[104:107]
ds_read_b64_tr_b16 a[242:243], v202 offset:4096
s_waitcnt vmcnt(4)
v_mfma_f32_16x16x32_bf16 v[108:111], a[200:203], v[8:11], v[168:171]
v_exp_f32 v91, v91
v_mfma_f32_16x16x32_bf16 v[108:111], a[204:207], v[28:31], v[108:111]
ds_read_b64_tr_b16 a[244:245], v203 offset:0
s_add_u32 m0, s48, 98304
s_xor_b32 s36, s3, 229376
v_mfma_f32_16x16x32_bf16 v[108:111], a[208:211], v[48:51], v[108:111]
buffer_load_dwordx4 v220, s[16:19], s36 offen offset:0 nt lds
v_exp_f32 v92, v92
v_mfma_f32_16x16x32_bf16 v[108:111], a[212:215], v[68:71], v[108:111]
ds_read_b64_tr_b16 a[246:247], v203 offset:4096
v_cvt_pk_bf16_f32 v148, v88, v89
v_cvt_pk_bf16_f32 v149, v90, v91
v_mfma_f32_16x16x32_bf16 v[112:115], a[212:215], v[72:75], v[172:175]
v_exp_f32 v93, v93
v_mfma_f32_16x16x32_bf16 v[112:115], a[208:211], v[52:55], v[112:115]
v_exp_f32 v94, v94
v_mfma_f32_16x16x32_bf16 v[112:115], a[204:207], v[32:35], v[112:115]
v_exp_f32 v95, v95
v_mfma_f32_16x16x32_bf16 v[112:115], a[200:203], v[12:15], v[112:115]
v_exp_f32 v96, v96
v_mfma_f32_16x16x32_bf16 v[116:119], a[200:203], v[16:19], v[176:179]
s_waitcnt vmcnt(4)
v_cvt_pk_bf16_f32 v152, v92, v93
v_cvt_pk_bf16_f32 v153, v94, v95
v_mfma_f32_16x16x32_bf16 v[116:119], a[204:207], v[36:39], v[116:119]
v_exp_f32 v97, v97
v_mfma_f32_16x16x32_bf16 v[116:119], a[208:211], v[56:59], v[116:119]
s_add_u32 m0, s48, 98304
v_exp_f32 v98, v98
v_mfma_f32_16x16x32_bf16 v[116:119], a[212:215], v[76:79], v[116:119]
buffer_load_dwordx4 v221, s[16:19], s36 offen offset:1024 nt lds
v_exp_f32 v99, v99
v_mfma_f32_16x16x32_bf16 a[160:163], a[180:183], v[120:123], a[160:163]
v_cvt_pk_bf16_f32 v156, v96, v97
v_cvt_pk_bf16_f32 v157, v98, v99
v_mfma_f32_16x16x32_bf16 a[164:167], a[180:183], v[124:127], a[164:167]
v_exp_f32 v100, v100
v_mfma_f32_16x16x32_bf16 a[168:171], a[180:183], v[128:131], a[168:171]
v_exp_f32 v101, v101
v_mfma_f32_16x16x32_bf16 a[172:175], a[180:183], v[132:135], a[172:175]
s_waitcnt lgkmcnt(0)
s_barrier
v_mfma_f32_16x16x32_bf16 a[176:179], a[180:183], v[136:139], a[176:179]
v_exp_f32 v102, v102
v_mfma_f32_16x16x32_bf16 a[0:3], a[216:219], v[120:123], a[0:3]
ds_read_b128 a[184:187], v204 offset:32768
v_exp_f32 v103, v103
v_mfma_f32_16x16x32_bf16 a[4:7], a[216:219], v[124:127], a[4:7]
v_exp_f32 v104, v104
v_mfma_f32_16x16x32_bf16 a[8:11], a[216:219], v[128:131], a[8:11]
s_waitcnt vmcnt(4)
v_cvt_pk_bf16_f32 v142, v100, v101
v_cvt_pk_bf16_f32 v143, v102, v103
v_mfma_f32_16x16x32_bf16 a[12:15], a[216:219], v[132:135], a[12:15]
v_exp_f32 v105, v105
v_mfma_f32_16x16x32_bf16 a[16:19], a[216:219], v[136:139], a[16:19]
ds_read_b128 a[188:191], v205 offset:32768
s_add_u32 m0, s48, 98304
v_mfma_f32_16x16x32_bf16 a[20:23], a[220:223], v[120:123], a[20:23]
buffer_load_dwordx4 v222, s[16:19], s36 offen offset:2048 nt lds
v_exp_f32 v106, v106
v_mfma_f32_16x16x32_bf16 a[24:27], a[220:223], v[124:127], a[24:27]
v_exp_f32 v107, v107
v_mfma_f32_16x16x32_bf16 a[28:31], a[220:223], v[128:131], a[28:31]
v_exp_f32 v108, v108
v_mfma_f32_16x16x32_bf16 a[32:35], a[220:223], v[132:135], a[32:35]
ds_read_b128 a[192:195], v206 offset:32768
v_cvt_pk_bf16_f32 v146, v104, v105
v_cvt_pk_bf16_f32 v147, v106, v107
v_mfma_f32_16x16x32_bf16 a[36:39], a[220:223], v[136:139], a[36:39]
v_exp_f32 v109, v109
v_mfma_f32_16x16x32_bf16 a[40:43], a[224:227], v[120:123], a[40:43]
v_exp_f32 v110, v110
v_mfma_f32_16x16x32_bf16 a[44:47], a[224:227], v[124:127], a[44:47]
v_exp_f32 v111, v111
v_mfma_f32_16x16x32_bf16 a[48:51], a[224:227], v[128:131], a[48:51]
ds_read_b128 a[196:199], v207 offset:32768
v_exp_f32 v112, v112
v_mfma_f32_16x16x32_bf16 a[52:55], a[224:227], v[132:135], a[52:55]
v_cvt_pk_bf16_f32 v150, v108, v109
v_cvt_pk_bf16_f32 v151, v110, v111
v_mfma_f32_16x16x32_bf16 a[56:59], a[224:227], v[136:139], a[56:59]
s_waitcnt vmcnt(4)
v_exp_f32 v113, v113
v_mfma_f32_16x16x32_bf16 a[60:63], a[228:231], v[120:123], a[60:63]
v_exp_f32 v114, v114
v_mfma_f32_16x16x32_bf16 a[64:67], a[228:231], v[124:127], a[64:67]
ds_read_b128 a[200:203], v204 offset:36864
s_add_u32 m0, s48, 98304
v_mfma_f32_16x16x32_bf16 a[68:71], a[228:231], v[128:131], a[68:71]
buffer_load_dwordx4 v223, s[16:19], s36 offen offset:3072 nt lds
v_exp_f32 v115, v115
v_mfma_f32_16x16x32_bf16 a[72:75], a[228:231], v[132:135], a[72:75]
v_exp_f32 v116, v116
v_mfma_f32_16x16x32_bf16 a[76:79], a[228:231], v[136:139], a[76:79]
v_cvt_pk_bf16_f32 v154, v112, v113
v_cvt_pk_bf16_f32 v155, v114, v115
v_mfma_f32_16x16x32_bf16 a[80:83], a[232:235], v[120:123], a[80:83]
ds_read_b128 a[204:207], v205 offset:36864
v_exp_f32 v117, v117
v_mfma_f32_16x16x32_bf16 a[84:87], a[232:235], v[124:127], a[84:87]
v_exp_f32 v118, v118
v_mfma_f32_16x16x32_bf16 a[88:91], a[232:235], v[128:131], a[88:91]
v_exp_f32 v119, v119
v_mfma_f32_16x16x32_bf16 a[92:95], a[232:235], v[132:135], a[92:95]
v_cvt_pk_bf16_f32 v158, v116, v117
v_cvt_pk_bf16_f32 v159, v118, v119
v_mfma_f32_16x16x32_bf16 a[96:99], a[232:235], v[136:139], a[96:99]
ds_read_b128 a[208:211], v206 offset:36864
s_waitcnt vmcnt(4)
v_mfma_f32_16x16x32_bf16 a[100:103], a[236:239], v[120:123], a[100:103]
v_mfma_f32_16x16x32_bf16 a[104:107], a[236:239], v[124:127], a[104:107]
s_add_u32 m0, s48, 81920
s_xor_b32 s37, s3, 221184
v_mfma_f32_16x16x32_bf16 a[108:111], a[236:239], v[128:131], a[108:111]
buffer_load_dwordx4 v220, s[20:23], s37 offen offset:0 nt lds
v_mfma_f32_16x16x32_bf16 a[112:115], a[236:239], v[132:135], a[112:115]
ds_read_b128 a[212:215], v207 offset:36864
v_mfma_f32_16x16x32_bf16 a[116:119], a[236:239], v[136:139], a[116:119]
v_mfma_f32_16x16x32_bf16 a[120:123], a[240:243], v[120:123], a[120:123]
v_mfma_f32_16x16x32_bf16 a[124:127], a[240:243], v[124:127], a[124:127]
v_mfma_f32_16x16x32_bf16 a[128:131], a[240:243], v[128:131], a[128:131]
v_mfma_f32_16x16x32_bf16 a[132:135], a[240:243], v[132:135], a[132:135]
v_mfma_f32_16x16x32_bf16 a[136:139], a[240:243], v[136:139], a[136:139]
s_waitcnt vmcnt(4)
v_mfma_f32_16x16x32_bf16 a[140:143], a[244:247], v[120:123], a[140:143]
v_mfma_f32_16x16x32_bf16 a[144:147], a[244:247], v[124:127], a[144:147]
s_add_u32 m0, s48, 81920
v_mfma_f32_16x16x32_bf16 a[148:151], a[244:247], v[128:131], a[148:151]
buffer_load_dwordx4 v221, s[20:23], s37 offen offset:1024 nt lds
v_mfma_f32_16x16x32_bf16 a[152:155], a[244:247], v[132:135], a[152:155]
v_mfma_f32_16x16x32_bf16 a[156:159], a[244:247], v[136:139], a[156:159]
s_waitcnt lgkmcnt(0)
v_mfma_f32_16x16x32_bf16 v[80:83], a[184:187], v[0:3], v[160:163]
v_mfma_f32_16x16x32_bf16 v[80:83], a[188:191], v[20:23], v[80:83]
ds_read_b64_tr_b16 a[216:217], v180 offset:0
v_mfma_f32_16x16x32_bf16 v[80:83], a[192:195], v[40:43], v[80:83]
v_mfma_f32_16x16x32_bf16 v[80:83], a[196:199], v[60:63], v[80:83]
ds_read_b64_tr_b16 a[218:219], v180 offset:4096
v_mfma_f32_16x16x32_bf16 v[84:87], a[196:199], v[64:67], v[164:167]
v_mfma_f32_16x16x32_bf16 v[84:87], a[192:195], v[44:47], v[84:87]
ds_read_b64_tr_b16 a[220:221], v181 offset:0
s_waitcnt vmcnt(4)
v_mfma_f32_16x16x32_bf16 v[84:87], a[188:191], v[24:27], v[84:87]
v_mfma_f32_16x16x32_bf16 v[84:87], a[184:187], v[4:7], v[84:87]
ds_read_b64_tr_b16 a[222:223], v181 offset:4096
s_add_u32 m0, s48, 81920
v_mfma_f32_16x16x32_bf16 v[88:91], a[184:187], v[8:11], v[168:171]
buffer_load_dwordx4 v222, s[20:23], s37 offen offset:2048 nt lds
v_mfma_f32_16x16x32_bf16 v[88:91], a[188:191], v[28:31], v[88:91]
ds_read_b64_tr_b16 a[224:225], v182 offset:0
v_mfma_f32_16x16x32_bf16 v[88:91], a[192:195], v[48:51], v[88:91]
v_mfma_f32_16x16x32_bf16 v[88:91], a[196:199], v[68:71], v[88:91]
ds_read_b64_tr_b16 a[226:227], v182 offset:4096
v_mfma_f32_16x16x32_bf16 v[92:95], a[196:199], v[72:75], v[172:175]
v_exp_f32 v80, v80
v_mfma_f32_16x16x32_bf16 v[92:95], a[192:195], v[52:55], v[92:95]
ds_read_b64_tr_b16 a[228:229], v183 offset:0
v_exp_f32 v81, v81
v_mfma_f32_16x16x32_bf16 v[92:95], a[188:191], v[32:35], v[92:95]
v_exp_f32 v82, v82
v_mfma_f32_16x16x32_bf16 v[92:95], a[184:187], v[12:15], v[92:95]
ds_read_b64_tr_b16 a[230:231], v183 offset:4096
v_exp_f32 v83, v83
v_mfma_f32_16x16x32_bf16 v[96:99], a[184:187], v[16:19], v[176:179]
v_exp_f32 v84, v84
v_mfma_f32_16x16x32_bf16 v[96:99], a[188:191], v[36:39], v[96:99]
ds_read_b64_tr_b16 a[232:233], v184 offset:0
s_waitcnt vmcnt(4)
v_cvt_pk_bf16_f32 v120, v80, v81
v_mfma_f32_16x16x32_bf16 v[96:99], a[192:195], v[56:59], v[96:99]
v_cvt_pk_bf16_f32 v121, v82, v83
v_mfma_f32_16x16x32_bf16 v[96:99], a[196:199], v[76:79], v[96:99]
ds_read_b64_tr_b16 a[234:235], v184 offset:4096
s_add_u32 m0, s48, 81920
v_mfma_f32_16x16x32_bf16 v[100:103], a[200:203], v[0:3], v[160:163]
buffer_load_dwordx4 v223, s[20:23], s37 offen offset:3072 nt lds
v_exp_f32 v85, v85
v_mfma_f32_16x16x32_bf16 v[100:103], a[204:207], v[20:23], v[100:103]
ds_read_b64_tr_b16 a[236:237], v185 offset:0
v_exp_f32 v86, v86
v_mfma_f32_16x16x32_bf16 v[100:103], a[208:211], v[40:43], v[100:103]
v_exp_f32 v87, v87
v_mfma_f32_16x16x32_bf16 v[100:103], a[212:215], v[60:63], v[100:103]
ds_read_b64_tr_b16 a[238:239], v185 offset:4096
v_exp_f32 v88, v88
v_mfma_f32_16x16x32_bf16 v[104:107], a[212:215], v[64:67], v[164:167]
v_cvt_pk_bf16_f32 v124, v84, v85
v_cvt_pk_bf16_f32 v125, v86, v87
v_mfma_f32_16x16x32_bf16 v[104:107], a[208:211], v[44:47], v[104:107]
ds_read_b64_tr_b16 a[240:241], v186 offset:0
v_exp_f32 v89, v89
v_mfma_f32_16x16x32_bf16 v[104:107], a[204:207], v[24:27], v[104:107]
v_exp_f32 v90, v90
v_mfma_f32_16x16x32_bf16 v[104:107], a[200:203], v[4:7], v[104:107]
ds_read_b64_tr_b16 a[242:243], v186 offset:4096
s_waitcnt vmcnt(4)
v_mfma_f32_16x16x32_bf16 v[108:111], a[200:203], v[8:11], v[168:171]
v_exp_f32 v91, v91
v_mfma_f32_16x16x32_bf16 v[108:111], a[204:207], v[28:31], v[108:111]
ds_read_b64_tr_b16 a[244:245], v187 offset:0
s_add_u32 m0, s48, 131072
s_xor_b32 s36, s3, 237568
v_mfma_f32_16x16x32_bf16 v[108:111], a[208:211], v[48:51], v[108:111]
buffer_load_dwordx4 v220, s[16:19], s36 offen offset:0 nt lds
v_exp_f32 v92, v92
v_mfma_f32_16x16x32_bf16 v[108:111], a[212:215], v[68:71], v[108:111]
ds_read_b64_tr_b16 a[246:247], v187 offset:4096
v_cvt_pk_bf16_f32 v128, v88, v89
v_cvt_pk_bf16_f32 v129, v90, v91
v_mfma_f32_16x16x32_bf16 v[112:115], a[212:215], v[72:75], v[172:175]
v_exp_f32 v93, v93
v_mfma_f32_16x16x32_bf16 v[112:115], a[208:211], v[52:55], v[112:115]
v_exp_f32 v94, v94
v_mfma_f32_16x16x32_bf16 v[112:115], a[204:207], v[32:35], v[112:115]
v_exp_f32 v95, v95
v_mfma_f32_16x16x32_bf16 v[112:115], a[200:203], v[12:15], v[112:115]
v_exp_f32 v96, v96
v_mfma_f32_16x16x32_bf16 v[116:119], a[200:203], v[16:19], v[176:179]
v_cvt_pk_bf16_f32 v132, v92, v93
v_cvt_pk_bf16_f32 v133, v94, v95
v_mfma_f32_16x16x32_bf16 v[116:119], a[204:207], v[36:39], v[116:119]
s_waitcnt vmcnt(4)
v_exp_f32 v97, v97
v_mfma_f32_16x16x32_bf16 v[116:119], a[208:211], v[56:59], v[116:119]
v_exp_f32 v98, v98
v_mfma_f32_16x16x32_bf16 v[116:119], a[212:215], v[76:79], v[116:119]
s_add_u32 m0, s48, 131072
v_exp_f32 v99, v99
v_mfma_f32_16x16x32_bf16 a[160:163], a[180:183], v[140:143], a[160:163]
buffer_load_dwordx4 v221, s[16:19], s36 offen offset:1024 nt lds
v_cvt_pk_bf16_f32 v136, v96, v97
v_cvt_pk_bf16_f32 v137, v98, v99
v_mfma_f32_16x16x32_bf16 a[164:167], a[180:183], v[144:147], a[164:167]
v_exp_f32 v100, v100
v_mfma_f32_16x16x32_bf16 a[168:171], a[180:183], v[148:151], a[168:171]
v_exp_f32 v101, v101
v_mfma_f32_16x16x32_bf16 a[172:175], a[180:183], v[152:155], a[172:175]
s_waitcnt lgkmcnt(0)
s_barrier
v_mfma_f32_16x16x32_bf16 a[176:179], a[180:183], v[156:159], a[176:179]
v_exp_f32 v102, v102
v_mfma_f32_16x16x32_bf16 a[0:3], a[216:219], v[140:143], a[0:3]
ds_read_b128 a[184:187], v208 offset:0
v_exp_f32 v103, v103
v_mfma_f32_16x16x32_bf16 a[4:7], a[216:219], v[144:147], a[4:7]
v_exp_f32 v104, v104
v_mfma_f32_16x16x32_bf16 a[8:11], a[216:219], v[148:151], a[8:11]
v_cvt_pk_bf16_f32 v122, v100, v101
v_cvt_pk_bf16_f32 v123, v102, v103
v_mfma_f32_16x16x32_bf16 a[12:15], a[216:219], v[152:155], a[12:15]
s_waitcnt vmcnt(4)
v_exp_f32 v105, v105
v_mfma_f32_16x16x32_bf16 a[16:19], a[216:219], v[156:159], a[16:19]
ds_read_b128 a[188:191], v209 offset:0
v_exp_f32 v106, v106
v_mfma_f32_16x16x32_bf16 a[20:23], a[220:223], v[140:143], a[20:23]
s_add_u32 m0, s48, 131072
v_exp_f32 v107, v107
v_mfma_f32_16x16x32_bf16 a[24:27], a[220:223], v[144:147], a[24:27]
buffer_load_dwordx4 v222, s[16:19], s36 offen offset:2048 nt lds
v_exp_f32 v108, v108
v_mfma_f32_16x16x32_bf16 a[28:31], a[220:223], v[148:151], a[28:31]
v_cvt_pk_bf16_f32 v126, v104, v105
v_cvt_pk_bf16_f32 v127, v106, v107
v_mfma_f32_16x16x32_bf16 a[32:35], a[220:223], v[152:155], a[32:35]
ds_read_b128 a[192:195], v210 offset:0
v_exp_f32 v109, v109
v_mfma_f32_16x16x32_bf16 a[36:39], a[220:223], v[156:159], a[36:39]
v_exp_f32 v110, v110
v_mfma_f32_16x16x32_bf16 a[40:43], a[224:227], v[140:143], a[40:43]
v_exp_f32 v111, v111
v_mfma_f32_16x16x32_bf16 a[44:47], a[224:227], v[144:147], a[44:47]
v_exp_f32 v112, v112
v_mfma_f32_16x16x32_bf16 a[48:51], a[224:227], v[148:151], a[48:51]
ds_read_b128 a[196:199], v211 offset:0
v_cvt_pk_bf16_f32 v130, v108, v109
v_cvt_pk_bf16_f32 v131, v110, v111
v_mfma_f32_16x16x32_bf16 a[52:55], a[224:227], v[152:155], a[52:55]
v_exp_f32 v113, v113
v_mfma_f32_16x16x32_bf16 a[56:59], a[224:227], v[156:159], a[56:59]
s_waitcnt vmcnt(4)
v_exp_f32 v114, v114
v_mfma_f32_16x16x32_bf16 a[60:63], a[228:231], v[140:143], a[60:63]
v_exp_f32 v115, v115
v_mfma_f32_16x16x32_bf16 a[64:67], a[228:231], v[144:147], a[64:67]
ds_read_b128 a[200:203], v208 offset:4096
s_add_u32 m0, s48, 131072
v_mfma_f32_16x16x32_bf16 a[68:71], a[228:231], v[148:151], a[68:71]
buffer_load_dwordx4 v223, s[16:19], s36 offen offset:3072 nt lds
v_exp_f32 v116, v116
v_mfma_f32_16x16x32_bf16 a[72:75], a[228:231], v[152:155], a[72:75]
v_cvt_pk_bf16_f32 v134, v112, v113
v_cvt_pk_bf16_f32 v135, v114, v115
v_mfma_f32_16x16x32_bf16 a[76:79], a[228:231], v[156:159], a[76:79]
v_exp_f32 v117, v117
v_mfma_f32_16x16x32_bf16 a[80:83], a[232:235], v[140:143], a[80:83]
ds_read_b128 a[204:207], v209 offset:4096
v_exp_f32 v118, v118
v_mfma_f32_16x16x32_bf16 a[84:87], a[232:235], v[144:147], a[84:87]
v_exp_f32 v119, v119
v_mfma_f32_16x16x32_bf16 a[88:91], a[232:235], v[148:151], a[88:91]
v_cvt_pk_bf16_f32 v138, v116, v117
v_cvt_pk_bf16_f32 v139, v118, v119
v_mfma_f32_16x16x32_bf16 a[92:95], a[232:235], v[152:155], a[92:95]
v_mfma_f32_16x16x32_bf16 a[96:99], a[232:235], v[156:159], a[96:99]
ds_read_b128 a[208:211], v210 offset:4096
v_mfma_f32_16x16x32_bf16 a[100:103], a[236:239], v[140:143], a[100:103]
v_mfma_f32_16x16x32_bf16 a[104:107], a[236:239], v[144:147], a[104:107]
s_waitcnt vmcnt(4)
v_mfma_f32_16x16x32_bf16 a[108:111], a[236:239], v[148:151], a[108:111]
v_mfma_f32_16x16x32_bf16 a[112:115], a[236:239], v[152:155], a[112:115]
ds_read_b128 a[212:215], v211 offset:4096
s_add_u32 m0, s48, 114688
s_xor_b32 s37, s3, 229376
v_mfma_f32_16x16x32_bf16 a[116:119], a[236:239], v[156:159], a[116:119]
buffer_load_dwordx4 v220, s[20:23], s37 offen offset:0 nt lds
v_mfma_f32_16x16x32_bf16 a[120:123], a[240:243], v[140:143], a[120:123]
v_mfma_f32_16x16x32_bf16 a[124:127], a[240:243], v[144:147], a[124:127]
v_mfma_f32_16x16x32_bf16 a[128:131], a[240:243], v[148:151], a[128:131]
v_mfma_f32_16x16x32_bf16 a[132:135], a[240:243], v[152:155], a[132:135]
v_mfma_f32_16x16x32_bf16 a[136:139], a[240:243], v[156:159], a[136:139]
s_waitcnt vmcnt(4)
v_mfma_f32_16x16x32_bf16 a[140:143], a[244:247], v[140:143], a[140:143]
v_mfma_f32_16x16x32_bf16 a[144:147], a[244:247], v[144:147], a[144:147]
s_add_u32 m0, s48, 114688
v_mfma_f32_16x16x32_bf16 a[148:151], a[244:247], v[148:151], a[148:151]
buffer_load_dwordx4 v221, s[20:23], s37 offen offset:1024 nt lds
v_mfma_f32_16x16x32_bf16 a[152:155], a[244:247], v[152:155], a[152:155]
v_mfma_f32_16x16x32_bf16 a[156:159], a[244:247], v[156:159], a[156:159]
s_waitcnt lgkmcnt(0)
v_mfma_f32_16x16x32_bf16 v[80:83], a[184:187], v[0:3], v[160:163]
v_mfma_f32_16x16x32_bf16 v[80:83], a[188:191], v[20:23], v[80:83]
ds_read_b64_tr_b16 a[216:217], v180 offset:32768
v_mfma_f32_16x16x32_bf16 v[80:83], a[192:195], v[40:43], v[80:83]
v_mfma_f32_16x16x32_bf16 v[80:83], a[196:199], v[60:63], v[80:83]
ds_read_b64_tr_b16 a[218:219], v180 offset:36864
v_mfma_f32_16x16x32_bf16 v[84:87], a[196:199], v[64:67], v[164:167]
v_mfma_f32_16x16x32_bf16 v[84:87], a[192:195], v[44:47], v[84:87]
ds_read_b64_tr_b16 a[220:221], v181 offset:32768
v_mfma_f32_16x16x32_bf16 v[84:87], a[188:191], v[24:27], v[84:87]
v_mfma_f32_16x16x32_bf16 v[84:87], a[184:187], v[4:7], v[84:87]
ds_read_b64_tr_b16 a[222:223], v181 offset:36864
s_waitcnt vmcnt(4)
v_mfma_f32_16x16x32_bf16 v[88:91], a[184:187], v[8:11], v[168:171]
v_mfma_f32_16x16x32_bf16 v[88:91], a[188:191], v[28:31], v[88:91]
ds_read_b64_tr_b16 a[224:225], v182 offset:32768
s_add_u32 m0, s48, 114688
v_mfma_f32_16x16x32_bf16 v[88:91], a[192:195], v[48:51], v[88:91]
buffer_load_dwordx4 v222, s[20:23], s37 offen offset:2048 nt lds
v_mfma_f32_16x16x32_bf16 v[88:91], a[196:199], v[68:71], v[88:91]
ds_read_b64_tr_b16 a[226:227], v182 offset:36864
v_mfma_f32_16x16x32_bf16 v[92:95], a[196:199], v[72:75], v[172:175]
v_exp_f32 v80, v80
v_mfma_f32_16x16x32_bf16 v[92:95], a[192:195], v[52:55], v[92:95]
ds_read_b64_tr_b16 a[228:229], v183 offset:32768
v_exp_f32 v81, v81
v_mfma_f32_16x16x32_bf16 v[92:95], a[188:191], v[32:35], v[92:95]
v_exp_f32 v82, v82
v_mfma_f32_16x16x32_bf16 v[92:95], a[184:187], v[12:15], v[92:95]
ds_read_b64_tr_b16 a[230:231], v183 offset:36864
v_exp_f32 v83, v83
v_mfma_f32_16x16x32_bf16 v[96:99], a[184:187], v[16:19], v[176:179]
v_exp_f32 v84, v84
v_mfma_f32_16x16x32_bf16 v[96:99], a[188:191], v[36:39], v[96:99]
ds_read_b64_tr_b16 a[232:233], v184 offset:32768
s_waitcnt vmcnt(4)
v_cvt_pk_bf16_f32 v140, v80, v81
v_mfma_f32_16x16x32_bf16 v[96:99], a[192:195], v[56:59], v[96:99]
v_cvt_pk_bf16_f32 v141, v82, v83
v_mfma_f32_16x16x32_bf16 v[96:99], a[196:199], v[76:79], v[96:99]
ds_read_b64_tr_b16 a[234:235], v184 offset:36864
s_add_u32 m0, s48, 114688
v_mfma_f32_16x16x32_bf16 v[100:103], a[200:203], v[0:3], v[160:163]
buffer_load_dwordx4 v223, s[20:23], s37 offen offset:3072 nt lds
v_exp_f32 v85, v85
v_mfma_f32_16x16x32_bf16 v[100:103], a[204:207], v[20:23], v[100:103]
ds_read_b64_tr_b16 a[236:237], v185 offset:32768
v_exp_f32 v86, v86
v_mfma_f32_16x16x32_bf16 v[100:103], a[208:211], v[40:43], v[100:103]
v_exp_f32 v87, v87
v_mfma_f32_16x16x32_bf16 v[100:103], a[212:215], v[60:63], v[100:103]
ds_read_b64_tr_b16 a[238:239], v185 offset:36864
v_exp_f32 v88, v88
v_mfma_f32_16x16x32_bf16 v[104:107], a[212:215], v[64:67], v[164:167]
v_cvt_pk_bf16_f32 v144, v84, v85
v_cvt_pk_bf16_f32 v145, v86, v87
v_mfma_f32_16x16x32_bf16 v[104:107], a[208:211], v[44:47], v[104:107]
ds_read_b64_tr_b16 a[240:241], v186 offset:32768
v_exp_f32 v89, v89
v_mfma_f32_16x16x32_bf16 v[104:107], a[204:207], v[24:27], v[104:107]
v_exp_f32 v90, v90
v_mfma_f32_16x16x32_bf16 v[104:107], a[200:203], v[4:7], v[104:107]
ds_read_b64_tr_b16 a[242:243], v186 offset:36864
v_exp_f32 v91, v91
v_mfma_f32_16x16x32_bf16 v[108:111], a[200:203], v[8:11], v[168:171]
v_exp_f32 v92, v92
v_mfma_f32_16x16x32_bf16 v[108:111], a[204:207], v[28:31], v[108:111]
ds_read_b64_tr_b16 a[244:245], v187 offset:32768
s_waitcnt vmcnt(4)
v_cvt_pk_bf16_f32 v148, v88, v89
v_mfma_f32_16x16x32_bf16 v[108:111], a[208:211], v[48:51], v[108:111]
v_cvt_pk_bf16_f32 v149, v90, v91
v_mfma_f32_16x16x32_bf16 v[108:111], a[212:215], v[68:71], v[108:111]
ds_read_b64_tr_b16 a[246:247], v187 offset:36864
s_add_u32 m0, s48, 0
s_xor_b32 s36, s3, 245760
v_mfma_f32_16x16x32_bf16 v[112:115], a[212:215], v[72:75], v[172:175]
buffer_load_dwordx4 v220, s[16:19], s36 offen offset:0 nt lds
v_exp_f32 v93, v93
v_mfma_f32_16x16x32_bf16 v[112:115], a[208:211], v[52:55], v[112:115]
v_exp_f32 v94, v94
v_mfma_f32_16x16x32_bf16 v[112:115], a[204:207], v[32:35], v[112:115]
v_exp_f32 v95, v95
v_mfma_f32_16x16x32_bf16 v[112:115], a[200:203], v[12:15], v[112:115]
v_exp_f32 v96, v96
v_mfma_f32_16x16x32_bf16 v[116:119], a[200:203], v[16:19], v[176:179]
v_cvt_pk_bf16_f32 v152, v92, v93
v_cvt_pk_bf16_f32 v153, v94, v95
v_mfma_f32_16x16x32_bf16 v[116:119], a[204:207], v[36:39], v[116:119]
v_exp_f32 v97, v97
v_mfma_f32_16x16x32_bf16 v[116:119], a[208:211], v[56:59], v[116:119]
s_waitcnt vmcnt(4)
v_exp_f32 v98, v98
v_mfma_f32_16x16x32_bf16 v[116:119], a[212:215], v[76:79], v[116:119]
v_exp_f32 v99, v99
v_mfma_f32_16x16x32_bf16 a[160:163], a[180:183], v[120:123], a[160:163]
s_add_u32 m0, s48, 0
v_cvt_pk_bf16_f32 v156, v96, v97
v_cvt_pk_bf16_f32 v157, v98, v99
v_mfma_f32_16x16x32_bf16 a[164:167], a[180:183], v[124:127], a[164:167]
buffer_load_dwordx4 v221, s[16:19], s36 offen offset:1024 nt lds
v_exp_f32 v100, v100
v_mfma_f32_16x16x32_bf16 a[168:171], a[180:183], v[128:131], a[168:171]
v_exp_f32 v101, v101
v_mfma_f32_16x16x32_bf16 a[172:175], a[180:183], v[132:135], a[172:175]
s_waitcnt lgkmcnt(0)
s_barrier
v_mfma_f32_16x16x32_bf16 a[176:179], a[180:183], v[136:139], a[176:179]
v_exp_f32 v102, v102
v_mfma_f32_16x16x32_bf16 a[0:3], a[216:219], v[120:123], a[0:3]
ds_read_b128 a[184:187], v208 offset:32768
v_exp_f32 v103, v103
v_mfma_f32_16x16x32_bf16 a[4:7], a[216:219], v[124:127], a[4:7]
v_exp_f32 v104, v104
v_mfma_f32_16x16x32_bf16 a[8:11], a[216:219], v[128:131], a[8:11]
v_cvt_pk_bf16_f32 v142, v100, v101
v_cvt_pk_bf16_f32 v143, v102, v103
v_mfma_f32_16x16x32_bf16 a[12:15], a[216:219], v[132:135], a[12:15]
v_exp_f32 v105, v105
v_mfma_f32_16x16x32_bf16 a[16:19], a[216:219], v[136:139], a[16:19]
ds_read_b128 a[188:191], v209 offset:32768
s_waitcnt vmcnt(4)
v_mfma_f32_16x16x32_bf16 a[20:23], a[220:223], v[120:123], a[20:23]
v_exp_f32 v106, v106
v_mfma_f32_16x16x32_bf16 a[24:27], a[220:223], v[124:127], a[24:27]
s_add_u32 m0, s48, 0
v_exp_f32 v107, v107
v_mfma_f32_16x16x32_bf16 a[28:31], a[220:223], v[128:131], a[28:31]
buffer_load_dwordx4 v222, s[16:19], s36 offen offset:2048 nt lds
v_exp_f32 v108, v108
v_mfma_f32_16x16x32_bf16 a[32:35], a[220:223], v[132:135], a[32:35]
ds_read_b128 a[192:195], v210 offset:32768
v_cvt_pk_bf16_f32 v146, v104, v105
v_cvt_pk_bf16_f32 v147, v106, v107
v_mfma_f32_16x16x32_bf16 a[36:39], a[220:223], v[136:139], a[36:39]
v_exp_f32 v109, v109
v_mfma_f32_16x16x32_bf16 a[40:43], a[224:227], v[120:123], a[40:43]
v_exp_f32 v110, v110
v_mfma_f32_16x16x32_bf16 a[44:47], a[224:227], v[124:127], a[44:47]
v_exp_f32 v111, v111
v_mfma_f32_16x16x32_bf16 a[48:51], a[224:227], v[128:131], a[48:51]
ds_read_b128 a[196:199], v211 offset:32768
v_exp_f32 v112, v112
v_mfma_f32_16x16x32_bf16 a[52:55], a[224:227], v[132:135], a[52:55]
v_cvt_pk_bf16_f32 v150, v108, v109
v_cvt_pk_bf16_f32 v151, v110, v111
v_mfma_f32_16x16x32_bf16 a[56:59], a[224:227], v[136:139], a[56:59]
v_exp_f32 v113, v113
v_mfma_f32_16x16x32_bf16 a[60:63], a[228:231], v[120:123], a[60:63]
s_waitcnt vmcnt(4)
v_exp_f32 v114, v114
v_mfma_f32_16x16x32_bf16 a[64:67], a[228:231], v[124:127], a[64:67]
ds_read_b128 a[200:203], v208 offset:36864
v_exp_f32 v115, v115
v_mfma_f32_16x16x32_bf16 a[68:71], a[228:231], v[128:131], a[68:71]
s_add_u32 m0, s48, 0
v_exp_f32 v116, v116
v_mfma_f32_16x16x32_bf16 a[72:75], a[228:231], v[132:135], a[72:75]
buffer_load_dwordx4 v223, s[16:19], s36 offen offset:3072 nt lds
v_cvt_pk_bf16_f32 v154, v112, v113
v_cvt_pk_bf16_f32 v155, v114, v115
v_mfma_f32_16x16x32_bf16 a[76:79], a[228:231], v[136:139], a[76:79]
v_exp_f32 v117, v117
v_mfma_f32_16x16x32_bf16 a[80:83], a[232:235], v[120:123], a[80:83]
ds_read_b128 a[204:207], v209 offset:36864
v_exp_f32 v118, v118
v_mfma_f32_16x16x32_bf16 a[84:87], a[232:235], v[124:127], a[84:87]
v_exp_f32 v119, v119
v_mfma_f32_16x16x32_bf16 a[88:91], a[232:235], v[128:131], a[88:91]
v_cvt_pk_bf16_f32 v158, v116, v117
v_cvt_pk_bf16_f32 v159, v118, v119
v_mfma_f32_16x16x32_bf16 a[92:95], a[232:235], v[132:135], a[92:95]
v_mfma_f32_16x16x32_bf16 a[96:99], a[232:235], v[136:139], a[96:99]
ds_read_b128 a[208:211], v210 offset:36864
v_mfma_f32_16x16x32_bf16 a[100:103], a[236:239], v[120:123], a[100:103]
v_mfma_f32_16x16x32_bf16 a[104:107], a[236:239], v[124:127], a[104:107]
s_waitcnt vmcnt(4)
v_mfma_f32_16x16x32_bf16 a[108:111], a[236:239], v[128:131], a[108:111]
v_mfma_f32_16x16x32_bf16 a[112:115], a[236:239], v[132:135], a[112:115]
ds_read_b128 a[212:215], v211 offset:36864
s_add_u32 m0, s48, 147456
s_xor_b32 s37, s3, 237568
v_mfma_f32_16x16x32_bf16 a[116:119], a[236:239], v[136:139], a[116:119]
buffer_load_dwordx4 v220, s[20:23], s37 offen offset:0 nt lds
v_mfma_f32_16x16x32_bf16 a[120:123], a[240:243], v[120:123], a[120:123]
v_mfma_f32_16x16x32_bf16 a[124:127], a[240:243], v[124:127], a[124:127]
v_mfma_f32_16x16x32_bf16 a[128:131], a[240:243], v[128:131], a[128:131]
v_mfma_f32_16x16x32_bf16 a[132:135], a[240:243], v[132:135], a[132:135]
v_mfma_f32_16x16x32_bf16 a[136:139], a[240:243], v[136:139], a[136:139]
s_waitcnt vmcnt(4)
v_mfma_f32_16x16x32_bf16 a[140:143], a[244:247], v[120:123], a[140:143]
v_mfma_f32_16x16x32_bf16 a[144:147], a[244:247], v[124:127], a[144:147]
s_add_u32 m0, s48, 147456
v_mfma_f32_16x16x32_bf16 a[148:151], a[244:247], v[128:131], a[148:151]
buffer_load_dwordx4 v221, s[20:23], s37 offen offset:1024 nt lds
v_mfma_f32_16x16x32_bf16 a[152:155], a[244:247], v[132:135], a[152:155]
v_mfma_f32_16x16x32_bf16 a[156:159], a[244:247], v[136:139], a[156:159]
s_waitcnt lgkmcnt(0)
v_mfma_f32_16x16x32_bf16 v[80:83], a[184:187], v[0:3], v[160:163]
v_mfma_f32_16x16x32_bf16 v[80:83], a[188:191], v[20:23], v[80:83]
ds_read_b64_tr_b16 a[216:217], v188 offset:0
v_mfma_f32_16x16x32_bf16 v[80:83], a[192:195], v[40:43], v[80:83]
v_mfma_f32_16x16x32_bf16 v[80:83], a[196:199], v[60:63], v[80:83]
ds_read_b64_tr_b16 a[218:219], v188 offset:4096
v_mfma_f32_16x16x32_bf16 v[84:87], a[196:199], v[64:67], v[164:167]
v_mfma_f32_16x16x32_bf16 v[84:87], a[192:195], v[44:47], v[84:87]
ds_read_b64_tr_b16 a[220:221], v189 offset:0
v_mfma_f32_16x16x32_bf16 v[84:87], a[188:191], v[24:27], v[84:87]
v_mfma_f32_16x16x32_bf16 v[84:87], a[184:187], v[4:7], v[84:87]
ds_read_b64_tr_b16 a[222:223], v189 offset:4096
s_waitcnt vmcnt(4)
v_mfma_f32_16x16x32_bf16 v[88:91], a[184:187], v[8:11], v[168:171]
v_mfma_f32_16x16x32_bf16 v[88:91], a[188:191], v[28:31], v[88:91]
ds_read_b64_tr_b16 a[224:225], v190 offset:0
s_add_u32 m0, s48, 147456
v_mfma_f32_16x16x32_bf16 v[88:91], a[192:195], v[48:51], v[88:91]
buffer_load_dwordx4 v222, s[20:23], s37 offen offset:2048 nt lds
v_mfma_f32_16x16x32_bf16 v[88:91], a[196:199], v[68:71], v[88:91]
ds_read_b64_tr_b16 a[226:227], v190 offset:4096
v_mfma_f32_16x16x32_bf16 v[92:95], a[196:199], v[72:75], v[172:175]
v_exp_f32 v80, v80
v_mfma_f32_16x16x32_bf16 v[92:95], a[192:195], v[52:55], v[92:95]
ds_read_b64_tr_b16 a[228:229], v191 offset:0
v_exp_f32 v81, v81
v_mfma_f32_16x16x32_bf16 v[92:95], a[188:191], v[32:35], v[92:95]
v_exp_f32 v82, v82
v_mfma_f32_16x16x32_bf16 v[92:95], a[184:187], v[12:15], v[92:95]
ds_read_b64_tr_b16 a[230:231], v191 offset:4096
v_exp_f32 v83, v83
v_mfma_f32_16x16x32_bf16 v[96:99], a[184:187], v[16:19], v[176:179]
v_exp_f32 v84, v84
v_mfma_f32_16x16x32_bf16 v[96:99], a[188:191], v[36:39], v[96:99]
ds_read_b64_tr_b16 a[232:233], v192 offset:0
v_cvt_pk_bf16_f32 v120, v80, v81
v_cvt_pk_bf16_f32 v121, v82, v83
v_mfma_f32_16x16x32_bf16 v[96:99], a[192:195], v[56:59], v[96:99]
v_exp_f32 v85, v85
v_mfma_f32_16x16x32_bf16 v[96:99], a[196:199], v[76:79], v[96:99]
ds_read_b64_tr_b16 a[234:235], v192 offset:4096
s_waitcnt vmcnt(4)
v_mfma_f32_16x16x32_bf16 v[100:103], a[200:203], v[0:3], v[160:163]
v_exp_f32 v86, v86
v_mfma_f32_16x16x32_bf16 v[100:103], a[204:207], v[20:23], v[100:103]
ds_read_b64_tr_b16 a[236:237], v193 offset:0
s_add_u32 m0, s48, 147456
v_mfma_f32_16x16x32_bf16 v[100:103], a[208:211], v[40:43], v[100:103]
buffer_load_dwordx4 v223, s[20:23], s37 offen offset:3072 nt lds
v_exp_f32 v87, v87
v_mfma_f32_16x16x32_bf16 v[100:103], a[212:215], v[60:63], v[100:103]
ds_read_b64_tr_b16 a[238:239], v193 offset:4096
v_exp_f32 v88, v88
v_mfma_f32_16x16x32_bf16 v[104:107], a[212:215], v[64:67], v[164:167]
v_cvt_pk_bf16_f32 v124, v84, v85
v_cvt_pk_bf16_f32 v125, v86, v87
v_mfma_f32_16x16x32_bf16 v[104:107], a[208:211], v[44:47], v[104:107]
ds_read_b64_tr_b16 a[240:241], v194 offset:0
v_exp_f32 v89, v89
v_mfma_f32_16x16x32_bf16 v[104:107], a[204:207], v[24:27], v[104:107]
v_exp_f32 v90, v90
v_mfma_f32_16x16x32_bf16 v[104:107], a[200:203], v[4:7], v[104:107]
ds_read_b64_tr_b16 a[242:243], v194 offset:4096
v_exp_f32 v91, v91
v_mfma_f32_16x16x32_bf16 v[108:111], a[200:203], v[8:11], v[168:171]
v_exp_f32 v92, v92
v_mfma_f32_16x16x32_bf16 v[108:111], a[204:207], v[28:31], v[108:111]
ds_read_b64_tr_b16 a[244:245], v195 offset:0
s_waitcnt vmcnt(4)
v_cvt_pk_bf16_f32 v128, v88, v89
v_mfma_f32_16x16x32_bf16 v[108:111], a[208:211], v[48:51], v[108:111]
v_cvt_pk_bf16_f32 v129, v90, v91
v_mfma_f32_16x16x32_bf16 v[108:111], a[212:215], v[68:71], v[108:111]
ds_read_b64_tr_b16 a[246:247], v195 offset:4096
s_add_u32 m0, s48, 32768
s_xor_b32 s36, s3, 253952
v_mfma_f32_16x16x32_bf16 v[112:115], a[212:215], v[72:75], v[172:175]
buffer_load_dwordx4 v220, s[16:19], s36 offen offset:0 nt lds
v_exp_f32 v93, v93
v_mfma_f32_16x16x32_bf16 v[112:115], a[208:211], v[52:55], v[112:115]
v_exp_f32 v94, v94
v_mfma_f32_16x16x32_bf16 v[112:115], a[204:207], v[32:35], v[112:115]
v_exp_f32 v95, v95
v_mfma_f32_16x16x32_bf16 v[112:115], a[200:203], v[12:15], v[112:115]
v_exp_f32 v96, v96
v_mfma_f32_16x16x32_bf16 v[116:119], a[200:203], v[16:19], v[176:179]
v_cvt_pk_bf16_f32 v132, v92, v93
v_cvt_pk_bf16_f32 v133, v94, v95
v_mfma_f32_16x16x32_bf16 v[116:119], a[204:207], v[36:39], v[116:119]
s_waitcnt vmcnt(4)
v_exp_f32 v97, v97
v_mfma_f32_16x16x32_bf16 v[116:119], a[208:211], v[56:59], v[116:119]
v_exp_f32 v98, v98
v_mfma_f32_16x16x32_bf16 v[116:119], a[212:215], v[76:79], v[116:119]
s_add_u32 m0, s48, 32768
v_exp_f32 v99, v99
v_mfma_f32_16x16x32_bf16 a[160:163], a[180:183], v[140:143], a[160:163]
buffer_load_dwordx4 v221, s[16:19], s36 offen offset:1024 nt lds
v_cvt_pk_bf16_f32 v136, v96, v97
v_cvt_pk_bf16_f32 v137, v98, v99
v_mfma_f32_16x16x32_bf16 a[164:167], a[180:183], v[144:147], a[164:167]
v_exp_f32 v100, v100
v_mfma_f32_16x16x32_bf16 a[168:171], a[180:183], v[148:151], a[168:171]
v_exp_f32 v101, v101
v_mfma_f32_16x16x32_bf16 a[172:175], a[180:183], v[152:155], a[172:175]
s_waitcnt lgkmcnt(0)
s_barrier
v_mfma_f32_16x16x32_bf16 a[176:179], a[180:183], v[156:159], a[176:179]
v_exp_f32 v102, v102
v_mfma_f32_16x16x32_bf16 a[0:3], a[216:219], v[140:143], a[0:3]
ds_read_b128 a[184:187], v212 offset:0
v_exp_f32 v103, v103
v_mfma_f32_16x16x32_bf16 a[4:7], a[216:219], v[144:147], a[4:7]
v_exp_f32 v104, v104
v_mfma_f32_16x16x32_bf16 a[8:11], a[216:219], v[148:151], a[8:11]
v_cvt_pk_bf16_f32 v122, v100, v101
v_cvt_pk_bf16_f32 v123, v102, v103
v_mfma_f32_16x16x32_bf16 a[12:15], a[216:219], v[152:155], a[12:15]
v_exp_f32 v105, v105
v_mfma_f32_16x16x32_bf16 a[16:19], a[216:219], v[156:159], a[16:19]
ds_read_b128 a[188:191], v213 offset:0
v_exp_f32 v106, v106
v_mfma_f32_16x16x32_bf16 a[20:23], a[220:223], v[140:143], a[20:23]
v_exp_f32 v107, v107
v_mfma_f32_16x16x32_bf16 a[24:27], a[220:223], v[144:147], a[24:27]
s_waitcnt vmcnt(4)
v_exp_f32 v108, v108
v_mfma_f32_16x16x32_bf16 a[28:31], a[220:223], v[148:151], a[28:31]
v_cvt_pk_bf16_f32 v126, v104, v105
v_cvt_pk_bf16_f32 v127, v106, v107
v_mfma_f32_16x16x32_bf16 a[32:35], a[220:223], v[152:155], a[32:35]
ds_read_b128 a[192:195], v214 offset:0
s_add_u32 m0, s48, 32768
v_mfma_f32_16x16x32_bf16 a[36:39], a[220:223], v[156:159], a[36:39]
buffer_load_dwordx4 v222, s[16:19], s36 offen offset:2048 nt lds
v_exp_f32 v109, v109
v_mfma_f32_16x16x32_bf16 a[40:43], a[224:227], v[140:143], a[40:43]
v_exp_f32 v110, v110
v_mfma_f32_16x16x32_bf16 a[44:47], a[224:227], v[144:147], a[44:47]
v_exp_f32 v111, v111
v_mfma_f32_16x16x32_bf16 a[48:51], a[224:227], v[148:151], a[48:51]
ds_read_b128 a[196:199], v215 offset:0
v_exp_f32 v112, v112
v_mfma_f32_16x16x32_bf16 a[52:55], a[224:227], v[152:155], a[52:55]
v_cvt_pk_bf16_f32 v130, v108, v109
v_cvt_pk_bf16_f32 v131, v110, v111
v_mfma_f32_16x16x32_bf16 a[56:59], a[224:227], v[156:159], a[56:59]
v_exp_f32 v113, v113
v_mfma_f32_16x16x32_bf16 a[60:63], a[228:231], v[140:143], a[60:63]
v_exp_f32 v114, v114
v_mfma_f32_16x16x32_bf16 a[64:67], a[228:231], v[144:147], a[64:67]
ds_read_b128 a[200:203], v212 offset:4096
s_waitcnt vmcnt(4)
v_mfma_f32_16x16x32_bf16 a[68:71], a[228:231], v[148:151], a[68:71]
v_exp_f32 v115, v115
v_mfma_f32_16x16x32_bf16 a[72:75], a[228:231], v[152:155], a[72:75]
s_add_u32 m0, s48, 32768
v_exp_f32 v116, v116
v_mfma_f32_16x16x32_bf16 a[76:79], a[228:231], v[156:159], a[76:79]
buffer_load_dwordx4 v223, s[16:19], s36 offen offset:3072 nt lds
v_cvt_pk_bf16_f32 v134, v112, v113
v_cvt_pk_bf16_f32 v135, v114, v115
v_mfma_f32_16x16x32_bf16 a[80:83], a[232:235], v[140:143], a[80:83]
ds_read_b128 a[204:207], v213 offset:4096
v_exp_f32 v117, v117
v_mfma_f32_16x16x32_bf16 a[84:87], a[232:235], v[144:147], a[84:87]
v_exp_f32 v118, v118
v_mfma_f32_16x16x32_bf16 a[88:91], a[232:235], v[148:151], a[88:91]
v_exp_f32 v119, v119
v_mfma_f32_16x16x32_bf16 a[92:95], a[232:235], v[152:155], a[92:95]
v_cvt_pk_bf16_f32 v138, v116, v117
v_cvt_pk_bf16_f32 v139, v118, v119
v_mfma_f32_16x16x32_bf16 a[96:99], a[232:235], v[156:159], a[96:99]
ds_read_b128 a[208:211], v214 offset:4096
v_mfma_f32_16x16x32_bf16 a[100:103], a[236:239], v[140:143], a[100:103]
v_mfma_f32_16x16x32_bf16 a[104:107], a[236:239], v[144:147], a[104:107]
v_mfma_f32_16x16x32_bf16 a[108:111], a[236:239], v[148:151], a[108:111]
s_waitcnt vmcnt(4)
v_mfma_f32_16x16x32_bf16 a[112:115], a[236:239], v[152:155], a[112:115]
ds_read_b128 a[212:215], v215 offset:4096
v_mfma_f32_16x16x32_bf16 a[116:119], a[236:239], v[156:159], a[116:119]
s_add_u32 m0, s48, 16384
s_xor_b32 s37, s3, 245760
v_mfma_f32_16x16x32_bf16 a[120:123], a[240:243], v[140:143], a[120:123]
buffer_load_dwordx4 v220, s[20:23], s37 offen offset:0 nt lds
v_mfma_f32_16x16x32_bf16 a[124:127], a[240:243], v[144:147], a[124:127]
v_mfma_f32_16x16x32_bf16 a[128:131], a[240:243], v[148:151], a[128:131]
v_mfma_f32_16x16x32_bf16 a[132:135], a[240:243], v[152:155], a[132:135]
v_mfma_f32_16x16x32_bf16 a[136:139], a[240:243], v[156:159], a[136:139]
v_mfma_f32_16x16x32_bf16 a[140:143], a[244:247], v[140:143], a[140:143]
v_mfma_f32_16x16x32_bf16 a[144:147], a[244:247], v[144:147], a[144:147]
v_mfma_f32_16x16x32_bf16 a[148:151], a[244:247], v[148:151], a[148:151]
v_mfma_f32_16x16x32_bf16 a[152:155], a[244:247], v[152:155], a[152:155]
v_mfma_f32_16x16x32_bf16 a[156:159], a[244:247], v[156:159], a[156:159]
s_waitcnt lgkmcnt(0)
L_afin:
v_mfma_f32_16x16x32_bf16 v[80:83], a[184:187], v[0:3], v[160:163]
s_waitcnt vmcnt(4)
v_mfma_f32_16x16x32_bf16 v[80:83], a[188:191], v[20:23], v[80:83]
ds_read_b64_tr_b16 a[216:217], v188 offset:32768
s_add_u32 m0, s48, 16384
v_mfma_f32_16x16x32_bf16 v[80:83], a[192:195], v[40:43], v[80:83]
buffer_load_dwordx4 v221, s[20:23], s37 offen offset:1024 nt lds
v_mfma_f32_16x16x32_bf16 v[80:83], a[196:199], v[60:63], v[80:83]
ds_read_b64_tr_b16 a[218:219], v188 offset:36864
v_mfma_f32_16x16x32_bf16 v[84:87], a[196:199], v[64:67], v[164:167]
v_mfma_f32_16x16x32_bf16 v[84:87], a[192:195], v[44:47], v[84:87]
ds_read_b64_tr_b16 a[220:221], v189 offset:32768
v_mfma_f32_16x16x32_bf16 v[84:87], a[188:191], v[24:27], v[84:87]
v_mfma_f32_16x16x32_bf16 v[84:87], a[184:187], v[4:7], v[84:87]
ds_read_b64_tr_b16 a[222:223], v189 offset:36864
v_mfma_f32_16x16x32_bf16 v[88:91], a[184:187], v[8:11], v[168:171]
v_mfma_f32_16x16x32_bf16 v[88:91], a[188:191], v[28:31], v[88:91]
ds_read_b64_tr_b16 a[224:225], v190 offset:32768
s_waitcnt vmcnt(4)
v_mfma_f32_16x16x32_bf16 v[88:91], a[192:195], v[48:51], v[88:91]
v_mfma_f32_16x16x32_bf16 v[88:91], a[196:199], v[68:71], v[88:91]
ds_read_b64_tr_b16 a[226:227], v190 offset:36864
s_add_u32 m0, s48, 16384
v_mfma_f32_16x16x32_bf16 v[92:95], a[196:199], v[72:75], v[172:175]
buffer_load_dwordx4 v222, s[20:23], s37 offen offset:2048 nt lds
v_exp_f32 v80, v80
v_mfma_f32_16x16x32_bf16 v[92:95], a[192:195], v[52:55], v[92:95]
ds_read_b64_tr_b16 a[228:229], v191 offset:32768
v_exp_f32 v81, v81
v_mfma_f32_16x16x32_bf16 v[92:95], a[188:191], v[32:35], v[92:95]
v_exp_f32 v82, v82
v_mfma_f32_16x16x32_bf16 v[92:95], a[184:187], v[12:15], v[92:95]
ds_read_b64_tr_b16 a[230:231], v191 offset:36864
v_exp_f32 v83, v83
v_mfma_f32_16x16x32_bf16 v[96:99], a[184:187], v[16:19], v[176:179]
v_exp_f32 v84, v84
v_mfma_f32_16x16x32_bf16 v[96:99], a[188:191], v[36:39], v[96:99]
ds_read_b64_tr_b16 a[232:233], v192 offset:32768
v_cvt_pk_bf16_f32 v140, v80, v81
v_cvt_pk_bf16_f32 v141, v82, v83
v_mfma_f32_16x16x32_bf16 v[96:99], a[192:195], v[56:59], v[96:99]
v_exp_f32 v85, v85
v_mfma_f32_16x16x32_bf16 v[96:99], a[196:199], v[76:79], v[96:99]
ds_read_b64_tr_b16 a[234:235], v192 offset:36864
s_waitcnt vmcnt(4)
v_mfma_f32_16x16x32_bf16 v[100:103], a[200:203], v[0:3], v[160:163]
v_exp_f32 v86, v86
v_mfma_f32_16x16x32_bf16 v[100:103], a[204:207], v[20:23], v[100:103]
ds_read_b64_tr_b16 a[236:237], v193 offset:32768
s_add_u32 m0, s48, 16384
v_mfma_f32_16x16x32_bf16 v[100:103], a[208:211], v[40:43], v[100:103]
buffer_load_dwordx4 v223, s[20:23], s37 offen offset:3072 nt lds
v_exp_f32 v87, v87
v_mfma_f32_16x16x32_bf16 v[100:103], a[212:215], v[60:63], v[100:103]
ds_read_b64_tr_b16 a[238:239], v193 offset:36864
v_exp_f32 v88, v88
v_mfma_f32_16x16x32_bf16 v[104:107], a[212:215], v[64:67], v[164:167]
v_cvt_pk_bf16_f32 v144, v84, v85
v_cvt_pk_bf16_f32 v145, v86, v87
v_mfma_f32_16x16x32_bf16 v[104:107], a[208:211], v[44:47], v[104:107]
ds_read_b64_tr_b16 a[240:241], v194 offset:32768
v_exp_f32 v89, v89
v_mfma_f32_16x16x32_bf16 v[104:107], a[204:207], v[24:27], v[104:107]
v_exp_f32 v90, v90
v_mfma_f32_16x16x32_bf16 v[104:107], a[200:203], v[4:7], v[104:107]
ds_read_b64_tr_b16 a[242:243], v194 offset:36864
v_exp_f32 v91, v91
v_mfma_f32_16x16x32_bf16 v[108:111], a[200:203], v[8:11], v[168:171]
v_exp_f32 v92, v92
v_mfma_f32_16x16x32_bf16 v[108:111], a[204:207], v[28:31], v[108:111]
ds_read_b64_tr_b16 a[244:245], v195 offset:32768
v_cvt_pk_bf16_f32 v148, v88, v89
v_cvt_pk_bf16_f32 v149, v90, v91
v_mfma_f32_16x16x32_bf16 v[108:111], a[208:211], v[48:51], v[108:111]
s_waitcnt vmcnt(4)
v_exp_f32 v93, v93
v_mfma_f32_16x16x32_bf16 v[108:111], a[212:215], v[68:71], v[108:111]
ds_read_b64_tr_b16 a[246:247], v195 offset:36864
v_exp_f32 v94, v94
v_mfma_f32_16x16x32_bf16 v[112:115], a[212:215], v[72:75], v[172:175]
s_add_u32 m0, s48, 49152
s_xor_b32 s37, s3, 253952
v_mfma_f32_16x16x32_bf16 v[112:115], a[208:211], v[52:55], v[112:115]
buffer_load_dwordx4 v220, s[20:23], s37 offen offset:0 nt lds
v_exp_f32 v95, v95
v_mfma_f32_16x16x32_bf16 v[112:115], a[204:207], v[32:35], v[112:115]
v_exp_f32 v96, v96
v_mfma_f32_16x16x32_bf16 v[112:115], a[200:203], v[12:15], v[112:115]
v_cvt_pk_bf16_f32 v152, v92, v93
v_cvt_pk_bf16_f32 v153, v94, v95
v_mfma_f32_16x16x32_bf16 v[116:119], a[200:203], v[16:19], v[176:179]
v_exp_f32 v97, v97
v_mfma_f32_16x16x32_bf16 v[116:119], a[204:207], v[36:39], v[116:119]
v_exp_f32 v98, v98
v_mfma_f32_16x16x32_bf16 v[116:119], a[208:211], v[56:59], v[116:119]
v_exp_f32 v99, v99
v_mfma_f32_16x16x32_bf16 v[116:119], a[212:215], v[76:79], v[116:119]
v_cvt_pk_bf16_f32 v156, v96, v97
v_cvt_pk_bf16_f32 v157, v98, v99
v_mfma_f32_16x16x32_bf16 a[160:163], a[180:183], v[120:123], a[160:163]
v_exp_f32 v100, v100
v_mfma_f32_16x16x32_bf16 a[164:167], a[180:183], v[124:127], a[164:167]
v_exp_f32 v101, v101
v_mfma_f32_16x16x32_bf16 a[168:171], a[180:183], v[128:131], a[168:171]
v_exp_f32 v102, v102
v_mfma_f32_16x16x32_bf16 a[172:175], a[180:183], v[132:135], a[172:175]
s_waitcnt lgkmcnt(0)
s_barrier
s_waitcnt vmcnt(4)
v_mfma_f32_16x16x32_bf16 a[176:179], a[180:183], v[136:139], a[176:179]
v_exp_f32 v103, v103
v_mfma_f32_16x16x32_bf16 a[0:3], a[216:219], v[120:123], a[0:3]
ds_read_b128 a[184:187], v204 offset:0
s_add_u32 m0, s48, 49152
v_mfma_f32_16x16x32_bf16 a[4:7], a[216:219], v[124:127], a[4:7]
buffer_load_dwordx4 v221, s[20:23], s37 offen offset:1024 nt lds
v_exp_f32 v104, v104
v_mfma_f32_16x16x32_bf16 a[8:11], a[216:219], v[128:131], a[8:11]
v_cvt_pk_bf16_f32 v142, v100, v101
v_cvt_pk_bf16_f32 v143, v102, v103
v_mfma_f32_16x16x32_bf16 a[12:15], a[216:219], v[132:135], a[12:15]
v_exp_f32 v105, v105
v_mfma_f32_16x16x32_bf16 a[16:19], a[216:219], v[136:139], a[16:19]
ds_read_b128 a[188:191], v205 offset:0
v_exp_f32 v106, v106
v_mfma_f32_16x16x32_bf16 a[20:23], a[220:223], v[120:123], a[20:23]
v_exp_f32 v107, v107
v_mfma_f32_16x16x32_bf16 a[24:27], a[220:223], v[124:127], a[24:27]
s_waitcnt vmcnt(4)
v_exp_f32 v108, v108
v_mfma_f32_16x16x32_bf16 a[28:31], a[220:223], v[128:131], a[28:31]
v_cvt_pk_bf16_f32 v146, v104, v105
v_cvt_pk_bf16_f32 v147, v106, v107
v_mfma_f32_16x16x32_bf16 a[32:35], a[220:223], v[132:135], a[32:35]
ds_read_b128 a[192:195], v206 offset:0
s_add_u32 m0, s48, 49152
v_mfma_f32_16x16x32_bf16 a[36:39], a[220:223], v[136:139], a[36:39]
buffer_load_dwordx4 v222, s[20:23], s37 offen offset:2048 nt lds
v_exp_f32 v109, v109
v_mfma_f32_16x16x32_bf16 a[40:43], a[224:227], v[120:123], a[40:43]
v_exp_f32 v110, v110
v_mfma_f32_16x16x32_bf16 a[44:47], a[224:227], v[124:127], a[44:47]
v_exp_f32 v111, v111
v_mfma_f32_16x16x32_bf16 a[48:51], a[224:227], v[128:131], a[48:51]
ds_read_b128 a[196:199], v207 offset:0
v_exp_f32 v112, v112
v_mfma_f32_16x16x32_bf16 a[52:55], a[224:227], v[132:135], a[52:55]
v_cvt_pk_bf16_f32 v150, v108, v109
v_cvt_pk_bf16_f32 v151, v110, v111
v_mfma_f32_16x16x32_bf16 a[56:59], a[224:227], v[136:139], a[56:59]
v_exp_f32 v113, v113
v_mfma_f32_16x16x32_bf16 a[60:63], a[228:231], v[120:123], a[60:63]
v_exp_f32 v114, v114
v_mfma_f32_16x16x32_bf16 a[64:67], a[228:231], v[124:127], a[64:67]
ds_read_b128 a[200:203], v204 offset:4096
v_exp_f32 v115, v115
v_mfma_f32_16x16x32_bf16 a[68:71], a[228:231], v[128:131], a[68:71]
v_exp_f32 v116, v116
v_mfma_f32_16x16x32_bf16 a[72:75], a[228:231], v[132:135], a[72:75]
s_waitcnt vmcnt(4)
v_cvt_pk_bf16_f32 v154, v112, v113
v_cvt_pk_bf16_f32 v155, v114, v115
v_mfma_f32_16x16x32_bf16 a[76:79], a[228:231], v[136:139], a[76:79]
v_exp_f32 v117, v117
v_mfma_f32_16x16x32_bf16 a[80:83], a[232:235], v[120:123], a[80:83]
ds_read_b128 a[204:207], v205 offset:4096
s_add_u32 m0, s48, 49152
v_mfma_f32_16x16x32_bf16 a[84:87], a[232:235], v[124:127], a[84:87]
buffer_load_dwordx4 v223, s[20:23], s37 offen offset:3072 nt lds
v_exp_f32 v118, v118
v_mfma_f32_16x16x32_bf16 a[88:91], a[232:235], v[128:131], a[88:91]
v_exp_f32 v119, v119
v_mfma_f32_16x16x32_bf16 a[92:95], a[232:235], v[132:135], a[92:95]
v_cvt_pk_bf16_f32 v158, v116, v117
v_cvt_pk_bf16_f32 v159, v118, v119
v_mfma_f32_16x16x32_bf16 a[96:99], a[232:235], v[136:139], a[96:99]
ds_read_b128 a[208:211], v206 offset:4096
v_mfma_f32_16x16x32_bf16 a[100:103], a[236:239], v[120:123], a[100:103]
v_mfma_f32_16x16x32_bf16 a[104:107], a[236:239], v[124:127], a[104:107]
v_mfma_f32_16x16x32_bf16 a[108:111], a[236:239], v[128:131], a[108:111]
v_mfma_f32_16x16x32_bf16 a[112:115], a[236:239], v[132:135], a[112:115]
ds_read_b128 a[212:215], v207 offset:4096
v_mfma_f32_16x16x32_bf16 a[116:119], a[236:239], v[136:139], a[116:119]
v_mfma_f32_16x16x32_bf16 a[120:123], a[240:243], v[120:123], a[120:123]
v_mfma_f32_16x16x32_bf16 a[124:127], a[240:243], v[124:127], a[124:127]
v_mfma_f32_16x16x32_bf16 a[128:131], a[240:243], v[128:131], a[128:131]
v_mfma_f32_16x16x32_bf16 a[132:135], a[240:243], v[132:135], a[132:135]
v_mfma_f32_16x16x32_bf16 a[136:139], a[240:243], v[136:139], a[136:139]
v_mfma_f32_16x16x32_bf16 a[140:143], a[244:247], v[120:123], a[140:143]
v_mfma_f32_16x16x32_bf16 a[144:147], a[244:247], v[124:127], a[144:147]
v_mfma_f32_16x16x32_bf16 a[148:151], a[244:247], v[128:131], a[148:151]
v_mfma_f32_16x16x32_bf16 a[152:155], a[244:247], v[132:135], a[152:155]
v_mfma_f32_16x16x32_bf16 a[156:159], a[244:247], v[136:139], a[156:159]
s_waitcnt lgkmcnt(0)
v_mfma_f32_16x16x32_bf16 v[80:83], a[184:187], v[0:3], v[160:163]
v_mfma_f32_16x16x32_bf16 v[80:83], a[188:191], v[20:23], v[80:83]
ds_read_b64_tr_b16 a[216:217], v196 offset:0
v_mfma_f32_16x16x32_bf16 v[80:83], a[192:195], v[40:43], v[80:83]
v_mfma_f32_16x16x32_bf16 v[80:83], a[196:199], v[60:63], v[80:83]
ds_read_b64_tr_b16 a[218:219], v196 offset:4096
v_mfma_f32_16x16x32_bf16 v[84:87], a[196:199], v[64:67], v[164:167]
v_mfma_f32_16x16x32_bf16 v[84:87], a[192:195], v[44:47], v[84:87]
ds_read_b64_tr_b16 a[220:221], v197 offset:0
v_mfma_f32_16x16x32_bf16 v[84:87], a[188:191], v[24:27], v[84:87]
v_mfma_f32_16x16x32_bf16 v[84:87], a[184:187], v[4:7], v[84:87]
ds_read_b64_tr_b16 a[222:223], v197 offset:4096
v_mfma_f32_16x16x32_bf16 v[88:91], a[184:187], v[8:11], v[168:171]
v_mfma_f32_16x16x32_bf16 v[88:91], a[188:191], v[28:31], v[88:91]
ds_read_b64_tr_b16 a[224:225], v198 offset:0
v_mfma_f32_16x16x32_bf16 v[88:91], a[192:195], v[48:51], v[88:91]
v_mfma_f32_16x16x32_bf16 v[88:91], a[196:199], v[68:71], v[88:91]
ds_read_b64_tr_b16 a[226:227], v198 offset:4096
v_mfma_f32_16x16x32_bf16 v[92:95], a[196:199], v[72:75], v[172:175]
v_exp_f32 v80, v80
v_mfma_f32_16x16x32_bf16 v[92:95], a[192:195], v[52:55], v[92:95]
ds_read_b64_tr_b16 a[228:229], v199 offset:0
v_exp_f32 v81, v81
v_mfma_f32_16x16x32_bf16 v[92:95], a[188:191], v[32:35], v[92:95]
v_exp_f32 v82, v82
v_mfma_f32_16x16x32_bf16 v[92:95], a[184:187], v[12:15], v[92:95]
ds_read_b64_tr_b16 a[230:231], v199 offset:4096
v_exp_f32 v83, v83
v_mfma_f32_16x16x32_bf16 v[96:99], a[184:187], v[16:19], v[176:179]
v_exp_f32 v84, v84
v_mfma_f32_16x16x32_bf16 v[96:99], a[188:191], v[36:39], v[96:99]
ds_read_b64_tr_b16 a[232:233], v200 offset:0
v_cvt_pk_bf16_f32 v120, v80, v81
v_cvt_pk_bf16_f32 v121, v82, v83
v_mfma_f32_16x16x32_bf16 v[96:99], a[192:195], v[56:59], v[96:99]
v_exp_f32 v85, v85
v_mfma_f32_16x16x32_bf16 v[96:99], a[196:199], v[76:79], v[96:99]
ds_read_b64_tr_b16 a[234:235], v200 offset:4096
v_exp_f32 v86, v86
v_mfma_f32_16x16x32_bf16 v[100:103], a[200:203], v[0:3], v[160:163]
v_exp_f32 v87, v87
v_mfma_f32_16x16x32_bf16 v[100:103], a[204:207], v[20:23], v[100:103]
ds_read_b64_tr_b16 a[236:237], v201 offset:0
v_exp_f32 v88, v88
v_mfma_f32_16x16x32_bf16 v[100:103], a[208:211], v[40:43], v[100:103]
v_cvt_pk_bf16_f32 v124, v84, v85
v_cvt_pk_bf16_f32 v125, v86, v87
v_mfma_f32_16x16x32_bf16 v[100:103], a[212:215], v[60:63], v[100:103]
ds_read_b64_tr_b16 a[238:239], v201 offset:4096
v_exp_f32 v89, v89
v_mfma_f32_16x16x32_bf16 v[104:107], a[212:215], v[64:67], v[164:167]
v_exp_f32 v90, v90
v_mfma_f32_16x16x32_bf16 v[104:107], a[208:211], v[44:47], v[104:107]
ds_read_b64_tr_b16 a[240:241], v202 offset:0
v_exp_f32 v91, v91
v_mfma_f32_16x16x32_bf16 v[104:107], a[204:207], v[24:27], v[104:107]
v_exp_f32 v92, v92
v_mfma_f32_16x16x32_bf16 v[104:107], a[200:203], v[4:7], v[104:107]
ds_read_b64_tr_b16 a[242:243], v202 offset:4096
v_cvt_pk_bf16_f32 v128, v88, v89
v_cvt_pk_bf16_f32 v129, v90, v91
v_mfma_f32_16x16x32_bf16 v[108:111], a[200:203], v[8:11], v[168:171]
v_exp_f32 v93, v93
v_mfma_f32_16x16x32_bf16 v[108:111], a[204:207], v[28:31], v[108:111]
ds_read_b64_tr_b16 a[244:245], v203 offset:0
v_exp_f32 v94, v94
v_mfma_f32_16x16x32_bf16 v[108:111], a[208:211], v[48:51], v[108:111]
v_exp_f32 v95, v95
v_mfma_f32_16x16x32_bf16 v[108:111], a[212:215], v[68:71], v[108:111]
ds_read_b64_tr_b16 a[246:247], v203 offset:4096
v_exp_f32 v96, v96
v_mfma_f32_16x16x32_bf16 v[112:115], a[212:215], v[72:75], v[172:175]
v_cvt_pk_bf16_f32 v132, v92, v93
v_cvt_pk_bf16_f32 v133, v94, v95
v_mfma_f32_16x16x32_bf16 v[112:115], a[208:211], v[52:55], v[112:115]
v_exp_f32 v97, v97
v_mfma_f32_16x16x32_bf16 v[112:115], a[204:207], v[32:35], v[112:115]
v_exp_f32 v98, v98
v_mfma_f32_16x16x32_bf16 v[112:115], a[200:203], v[12:15], v[112:115]
v_exp_f32 v99, v99
v_mfma_f32_16x16x32_bf16 v[116:119], a[200:203], v[16:19], v[176:179]
v_cvt_pk_bf16_f32 v136, v96, v97
v_cvt_pk_bf16_f32 v137, v98, v99
v_mfma_f32_16x16x32_bf16 v[116:119], a[204:207], v[36:39], v[116:119]
v_exp_f32 v100, v100
v_mfma_f32_16x16x32_bf16 v[116:119], a[208:211], v[56:59], v[116:119]
v_exp_f32 v101, v101
v_mfma_f32_16x16x32_bf16 v[116:119], a[212:215], v[76:79], v[116:119]
v_exp_f32 v102, v102
v_mfma_f32_16x16x32_bf16 a[160:163], a[180:183], v[140:143], a[160:163]
v_exp_f32 v103, v103
v_mfma_f32_16x16x32_bf16 a[164:167], a[180:183], v[144:147], a[164:167]
v_exp_f32 v104, v104
v_mfma_f32_16x16x32_bf16 a[168:171], a[180:183], v[148:151], a[168:171]
v_cvt_pk_bf16_f32 v122, v100, v101
v_cvt_pk_bf16_f32 v123, v102, v103
v_mfma_f32_16x16x32_bf16 a[172:175], a[180:183], v[152:155], a[172:175]
s_waitcnt vmcnt(4) lgkmcnt(0)
s_barrier
v_mfma_f32_16x16x32_bf16 a[176:179], a[180:183], v[156:159], a[176:179]
v_exp_f32 v105, v105
v_mfma_f32_16x16x32_bf16 a[0:3], a[216:219], v[140:143], a[0:3]
ds_read_b128 a[184:187], v204 offset:32768
v_exp_f32 v106, v106
v_mfma_f32_16x16x32_bf16 a[4:7], a[216:219], v[144:147], a[4:7]
s_add_u32 m0, s48, 131072
s_xor_b32 s35, s43, 0
v_mfma_f32_16x16x32_bf16 a[8:11], a[216:219], v[148:151], a[8:11]
buffer_load_dwordx4 v248, s[12:15], s35 offen offset:0 lds
v_exp_f32 v107, v107
v_mfma_f32_16x16x32_bf16 a[12:15], a[216:219], v[152:155], a[12:15]
v_exp_f32 v108, v108
v_mfma_f32_16x16x32_bf16 a[16:19], a[216:219], v[156:159], a[16:19]
ds_read_b128 a[188:191], v205 offset:32768
v_cvt_pk_bf16_f32 v126, v104, v105
v_cvt_pk_bf16_f32 v127, v106, v107
v_mfma_f32_16x16x32_bf16 a[20:23], a[220:223], v[140:143], a[20:23]
s_add_u32 m0, s48, 131072
v_exp_f32 v109, v109
v_mfma_f32_16x16x32_bf16 a[24:27], a[220:223], v[144:147], a[24:27]
buffer_load_dwordx4 v249, s[12:15], s35 offen offset:1024 lds
v_exp_f32 v110, v110
v_mfma_f32_16x16x32_bf16 a[28:31], a[220:223], v[148:151], a[28:31]
v_exp_f32 v111, v111
v_mfma_f32_16x16x32_bf16 a[32:35], a[220:223], v[152:155], a[32:35]
ds_read_b128 a[192:195], v206 offset:32768
v_exp_f32 v112, v112
v_mfma_f32_16x16x32_bf16 a[36:39], a[220:223], v[156:159], a[36:39]
s_add_u32 m0, s48, 131072
v_cvt_pk_bf16_f32 v130, v108, v109
v_cvt_pk_bf16_f32 v131, v110, v111
v_mfma_f32_16x16x32_bf16 a[40:43], a[224:227], v[140:143], a[40:43]
buffer_load_dwordx4 v250, s[12:15], s35 offen offset:2048 lds
v_exp_f32 v113, v113
v_mfma_f32_16x16x32_bf16 a[44:47], a[224:227], v[144:147], a[44:47]
v_exp_f32 v114, v114
v_mfma_f32_16x16x32_bf16 a[48:51], a[224:227], v[148:151], a[48:51]
ds_read_b128 a[196:199], v207 offset:32768
v_exp_f32 v115, v115
v_mfma_f32_16x16x32_bf16 a[52:55], a[224:227], v[152:155], a[52:55]
s_add_u32 m0, s48, 131072
v_exp_f32 v116, v116
v_mfma_f32_16x16x32_bf16 a[56:59], a[224:227], v[156:159], a[56:59]
buffer_load_dwordx4 v251, s[12:15], s35 offen offset:3072 lds
v_cvt_pk_bf16_f32 v134, v112, v113
v_cvt_pk_bf16_f32 v135, v114, v115
v_mfma_f32_16x16x32_bf16 a[60:63], a[228:231], v[140:143], a[60:63]
v_exp_f32 v117, v117
v_mfma_f32_16x16x32_bf16 a[64:67], a[228:231], v[144:147], a[64:67]
ds_read_b128 a[200:203], v204 offset:36864
v_exp_f32 v118, v118
v_mfma_f32_16x16x32_bf16 a[68:71], a[228:231], v[148:151], a[68:71]
s_add_u32 m0, s48, 147456
s_xor_b32 s35, s43, 128
v_mfma_f32_16x16x32_bf16 a[72:75], a[228:231], v[152:155], a[72:75]
buffer_load_dwordx4 v248, s[12:15], s35 offen offset:0 lds
v_exp_f32 v119, v119
v_mfma_f32_16x16x32_bf16 a[76:79], a[228:231], v[156:159], a[76:79]
v_cvt_pk_bf16_f32 v138, v116, v117
v_cvt_pk_bf16_f32 v139, v118, v119
v_mfma_f32_16x16x32_bf16 a[80:83], a[232:235], v[140:143], a[80:83]
ds_read_b128 a[204:207], v205 offset:36864
v_mfma_f32_16x16x32_bf16 a[84:87], a[232:235], v[144:147], a[84:87]
s_add_u32 m0, s48, 147456
v_mfma_f32_16x16x32_bf16 a[88:91], a[232:235], v[148:151], a[88:91]
buffer_load_dwordx4 v249, s[12:15], s35 offen offset:1024 lds
v_mfma_f32_16x16x32_bf16 a[92:95], a[232:235], v[152:155], a[92:95]
v_mfma_f32_16x16x32_bf16 a[96:99], a[232:235], v[156:159], a[96:99]
ds_read_b128 a[208:211], v206 offset:36864
v_mfma_f32_16x16x32_bf16 a[100:103], a[236:239], v[140:143], a[100:103]
s_add_u32 m0, s48, 147456
v_mfma_f32_16x16x32_bf16 a[104:107], a[236:239], v[144:147], a[104:107]
buffer_load_dwordx4 v250, s[12:15], s35 offen offset:2048 lds
v_mfma_f32_16x16x32_bf16 a[108:111], a[236:239], v[148:151], a[108:111]
v_mfma_f32_16x16x32_bf16 a[112:115], a[236:239], v[152:155], a[112:115]
ds_read_b128 a[212:215], v207 offset:36864
v_mfma_f32_16x16x32_bf16 a[116:119], a[236:239], v[156:159], a[116:119]
v_mfma_f32_16x16x32_bf16 a[120:123], a[240:243], v[140:143], a[120:123]
s_add_u32 m0, s48, 147456
v_mfma_f32_16x16x32_bf16 a[124:127], a[240:243], v[144:147], a[124:127]
buffer_load_dwordx4 v251, s[12:15], s35 offen offset:3072 lds
v_mfma_f32_16x16x32_bf16 a[128:131], a[240:243], v[148:151], a[128:131]
v_mfma_f32_16x16x32_bf16 a[132:135], a[240:243], v[152:155], a[132:135]
v_mfma_f32_16x16x32_bf16 a[136:139], a[240:243], v[156:159], a[136:139]
v_mfma_f32_16x16x32_bf16 a[140:143], a[244:247], v[140:143], a[140:143]
v_mfma_f32_16x16x32_bf16 a[144:147], a[244:247], v[144:147], a[144:147]
v_mfma_f32_16x16x32_bf16 a[148:151], a[244:247], v[148:151], a[148:151]
v_mfma_f32_16x16x32_bf16 a[152:155], a[244:247], v[152:155], a[152:155]
v_mfma_f32_16x16x32_bf16 a[156:159], a[244:247], v[156:159], a[156:159]
s_waitcnt lgkmcnt(0)
v_mfma_f32_16x16x32_bf16 v[80:83], a[184:187], v[0:3], v[160:163]
v_mfma_f32_16x16x32_bf16 v[80:83], a[188:191], v[20:23], v[80:83]
ds_read_b64_tr_b16 a[216:217], v180 offset:0
s_add_u32 m0, s48, 81920
s_xor_b32 s35, s43, 65536
v_mfma_f32_16x16x32_bf16 v[80:83], a[192:195], v[40:43], v[80:83]
buffer_load_dwordx4 v248, s[12:15], s35 offen offset:0 lds
v_mfma_f32_16x16x32_bf16 v[80:83], a[196:199], v[60:63], v[80:83]
ds_read_b64_tr_b16 a[218:219], v180 offset:4096
v_mfma_f32_16x16x32_bf16 v[84:87], a[196:199], v[64:67], v[164:167]
v_mfma_f32_16x16x32_bf16 v[84:87], a[192:195], v[44:47], v[84:87]
ds_read_b64_tr_b16 a[220:221], v181 offset:0
s_add_u32 m0, s48, 81920
v_mfma_f32_16x16x32_bf16 v[84:87], a[188:191], v[24:27], v[84:87]
buffer_load_dwordx4 v249, s[12:15], s35 offen offset:1024 lds
v_mfma_f32_16x16x32_bf16 v[84:87], a[184:187], v[4:7], v[84:87]
ds_read_b64_tr_b16 a[222:223], v181 offset:4096
v_exp_f32 v80, v80
v_mfma_f32_16x16x32_bf16 v[88:91], a[184:187], v[8:11], v[168:171]
v_exp_f32 v81, v81
v_mfma_f32_16x16x32_bf16 v[88:91], a[188:191], v[28:31], v[88:91]
ds_read_b64_tr_b16 a[224:225], v182 offset:0
s_add_u32 m0, s48, 81920
v_mfma_f32_16x16x32_bf16 v[88:91], a[192:195], v[48:51], v[88:91]
buffer_load_dwordx4 v250, s[12:15], s35 offen offset:2048 lds
v_exp_f32 v82, v82
v_mfma_f32_16x16x32_bf16 v[88:91], a[196:199], v[68:71], v[88:91]
ds_read_b64_tr_b16 a[226:227], v182 offset:4096
v_exp_f32 v83, v83
v_mfma_f32_16x16x32_bf16 v[92:95], a[196:199], v[72:75], v[172:175]
v_exp_f32 v84, v84
v_mfma_f32_16x16x32_bf16 v[92:95], a[192:195], v[52:55], v[92:95]
ds_read_b64_tr_b16 a[228:229], v183 offset:0
s_add_u32 m0, s48, 81920
v_cvt_pk_bf16_f32 v140, v80, v81
v_mfma_f32_16x16x32_bf16 v[92:95], a[188:191], v[32:35], v[92:95]
buffer_load_dwordx4 v251, s[12:15], s35 offen offset:3072 lds
v_cvt_pk_bf16_f32 v141, v82, v83
v_mfma_f32_16x16x32_bf16 v[92:95], a[184:187], v[12:15], v[92:95]
ds_read_b64_tr_b16 a[230:231], v183 offset:4096
v_exp_f32 v85, v85
v_mfma_f32_16x16x32_bf16 v[96:99], a[184:187], v[16:19], v[176:179]
v_exp_f32 v86, v86
v_mfma_f32_16x16x32_bf16 v[96:99], a[188:191], v[36:39], v[96:99]
ds_read_b64_tr_b16 a[232:233], v184 offset:0
s_add_u32 m0, s48, 98304
s_xor_b32 s35, s43, 65664
v_mfma_f32_16x16x32_bf16 v[96:99], a[192:195], v[56:59], v[96:99]
buffer_load_dwordx4 v248, s[12:15], s35 offen offset:0 lds
v_exp_f32 v87, v87
v_mfma_f32_16x16x32_bf16 v[96:99], a[196:199], v[76:79], v[96:99]
ds_read_b64_tr_b16 a[234:235], v184 offset:4096
v_exp_f32 v88, v88
v_mfma_f32_16x16x32_bf16 v[100:103], a[200:203], v[0:3], v[160:163]
v_cvt_pk_bf16_f32 v144, v84, v85
v_cvt_pk_bf16_f32 v145, v86, v87
v_mfma_f32_16x16x32_bf16 v[100:103], a[204:207], v[20:23], v[100:103]
ds_read_b64_tr_b16 a[236:237], v185 offset:0
s_add_u32 m0, s48, 98304
v_mfma_f32_16x16x32_bf16 v[100:103], a[208:211], v[40:43], v[100:103]
buffer_load_dwordx4 v249, s[12:15], s35 offen offset:1024 lds
v_exp_f32 v89, v89
v_mfma_f32_16x16x32_bf16 v[100:103], a[212:215], v[60:63], v[100:103]
ds_read_b64_tr_b16 a[238:239], v185 offset:4096
v_exp_f32 v90, v90
v_mfma_f32_16x16x32_bf16 v[104:107], a[212:215], v[64:67], v[164:167]
v_exp_f32 v91, v91
v_mfma_f32_16x16x32_bf16 v[104:107], a[208:211], v[44:47], v[104:107]
ds_read_b64_tr_b16 a[240:241], v186 offset:0
s_add_u32 m0, s48, 98304
v_mfma_f32_16x16x32_bf16 v[104:107], a[204:207], v[24:27], v[104:107]
buffer_load_dwordx4 v250, s[12:15], s35 offen offset:2048 lds
v_exp_f32 v92, v92
v_mfma_f32_16x16x32_bf16 v[104:107], a[200:203], v[4:7], v[104:107]
ds_read_b64_tr_b16 a[242:243], v186 offset:4096
v_cvt_pk_bf16_f32 v148, v88, v89
v_cvt_pk_bf16_f32 v149, v90, v91
v_mfma_f32_16x16x32_bf16 v[108:111], a[200:203], v[8:11], v[168:171]
v_exp_f32 v93, v93
v_mfma_f32_16x16x32_bf16 v[108:111], a[204:207], v[28:31], v[108:111]
ds_read_b64_tr_b16 a[244:245], v187 offset:0
s_add_u32 m0, s48, 98304
v_mfma_f32_16x16x32_bf16 v[108:111], a[208:211], v[48:51], v[108:111]
buffer_load_dwordx4 v251, s[12:15], s35 offen offset:3072 lds
v_exp_f32 v94, v94
v_mfma_f32_16x16x32_bf16 v[108:111], a[212:215], v[68:71], v[108:111]
ds_read_b64_tr_b16 a[246:247], v187 offset:4096
v_exp_f32 v95, v95
v_mfma_f32_16x16x32_bf16 v[112:115], a[212:215], v[72:75], v[172:175]
s_add_u32 m0, s48, 114688
s_xor_b32 s35, s43, 131072
v_mfma_f32_16x16x32_bf16 v[112:115], a[208:211], v[52:55], v[112:115]
buffer_load_dwordx4 v248, s[12:15], s35 offen offset:0 lds
v_exp_f32 v96, v96
v_mfma_f32_16x16x32_bf16 v[112:115], a[204:207], v[32:35], v[112:115]
v_cvt_pk_bf16_f32 v152, v92, v93
v_cvt_pk_bf16_f32 v153, v94, v95
v_mfma_f32_16x16x32_bf16 v[112:115], a[200:203], v[12:15], v[112:115]
s_add_u32 m0, s48, 114688
v_exp_f32 v97, v97
v_mfma_f32_16x16x32_bf16 v[116:119], a[200:203], v[16:19], v[176:179]
buffer_load_dwordx4 v249, s[12:15], s35 offen offset:1024 lds
v_exp_f32 v98, v98
v_mfma_f32_16x16x32_bf16 v[116:119], a[204:207], v[36:39], v[116:119]
v_exp_f32 v99, v99
v_mfma_f32_16x16x32_bf16 v[116:119], a[208:211], v[56:59], v[116:119]
s_add_u32 m0, s48, 114688
v_cvt_pk_bf16_f32 v156, v96, v97
v_cvt_pk_bf16_f32 v157, v98, v99
v_mfma_f32_16x16x32_bf16 v[116:119], a[212:215], v[76:79], v[116:119]
buffer_load_dwordx4 v250, s[12:15], s35 offen offset:2048 lds
v_exp_f32 v100, v100
v_mfma_f32_16x16x32_bf16 a[160:163], a[180:183], v[120:123], a[160:163]
v_exp_f32 v101, v101
v_mfma_f32_16x16x32_bf16 a[164:167], a[180:183], v[124:127], a[164:167]
s_add_u32 m0, s48, 114688
v_exp_f32 v102, v102
v_mfma_f32_16x16x32_bf16 a[168:171], a[180:183], v[128:131], a[168:171]
buffer_load_dwordx4 v251, s[12:15], s35 offen offset:3072 lds
v_exp_f32 v103, v103
v_mfma_f32_16x16x32_bf16 a[172:175], a[180:183], v[132:135], a[172:175]
s_waitcnt vmcnt(20) lgkmcnt(0)
s_barrier
v_mfma_f32_16x16x32_bf16 a[176:179], a[180:183], v[136:139], a[176:179]
ds_read_b64_tr_b16 a[184:185], v180 offset:32768
v_exp_f32 v104, v104
v_mfma_f32_16x16x32_bf16 a[0:3], a[216:219], v[120:123], a[0:3]
ds_read_b64_tr_b16 a[186:187], v180 offset:36864
v_cvt_pk_bf16_f32 v142, v100, v101
v_cvt_pk_bf16_f32 v143, v102, v103
v_mfma_f32_16x16x32_bf16 a[4:7], a[216:219], v[124:127], a[4:7]
ds_read_b64_tr_b16 a[188:189], v181 offset:32768
v_exp_f32 v105, v105
v_mfma_f32_16x16x32_bf16 a[8:11], a[216:219], v[128:131], a[8:11]
ds_read_b64_tr_b16 a[190:191], v181 offset:36864
v_exp_f32 v106, v106
v_mfma_f32_16x16x32_bf16 a[12:15], a[216:219], v[132:135], a[12:15]
ds_read_b64_tr_b16 a[192:193], v182 offset:32768
v_exp_f32 v107, v107
v_mfma_f32_16x16x32_bf16 a[16:19], a[216:219], v[136:139], a[16:19]
ds_read_b64_tr_b16 a[194:195], v182 offset:36864
v_exp_f32 v108, v108
v_mfma_f32_16x16x32_bf16 a[20:23], a[220:223], v[120:123], a[20:23]
ds_read_b64_tr_b16 a[196:197], v183 offset:32768
v_cvt_pk_bf16_f32 v146, v104, v105
v_cvt_pk_bf16_f32 v147, v106, v107
v_mfma_f32_16x16x32_bf16 a[24:27], a[220:223], v[124:127], a[24:27]
ds_read_b64_tr_b16 a[198:199], v183 offset:36864
v_exp_f32 v109, v109
v_mfma_f32_16x16x32_bf16 a[28:31], a[220:223], v[128:131], a[28:31]
ds_read_b64_tr_b16 a[200:201], v184 offset:32768
v_exp_f32 v110, v110
v_mfma_f32_16x16x32_bf16 a[32:35], a[220:223], v[132:135], a[32:35]
ds_read_b64_tr_b16 a[202:203], v184 offset:36864
v_exp_f32 v111, v111
v_mfma_f32_16x16x32_bf16 a[36:39], a[220:223], v[136:139], a[36:39]
ds_read_b64_tr_b16 a[204:205], v185 offset:32768
v_exp_f32 v112, v112
v_mfma_f32_16x16x32_bf16 a[40:43], a[224:227], v[120:123], a[40:43]
ds_read_b64_tr_b16 a[206:207], v185 offset:36864
v_cvt_pk_bf16_f32 v150, v108, v109
v_cvt_pk_bf16_f32 v151, v110, v111
v_mfma_f32_16x16x32_bf16 a[44:47], a[224:227], v[124:127], a[44:47]
ds_read_b64_tr_b16 a[208:209], v186 offset:32768
v_exp_f32 v113, v113
v_mfma_f32_16x16x32_bf16 a[48:51], a[224:227], v[128:131], a[48:51]
ds_read_b64_tr_b16 a[210:211], v186 offset:36864
v_exp_f32 v114, v114
v_mfma_f32_16x16x32_bf16 a[52:55], a[224:227], v[132:135], a[52:55]
ds_read_b64_tr_b16 a[212:213], v187 offset:32768
v_exp_f32 v115, v115
v_mfma_f32_16x16x32_bf16 a[56:59], a[224:227], v[136:139], a[56:59]
ds_read_b64_tr_b16 a[214:215], v187 offset:36864
v_exp_f32 v116, v116
v_mfma_f32_16x16x32_bf16 a[60:63], a[228:231], v[120:123], a[60:63]
v_cvt_pk_bf16_f32 v154, v112, v113
v_cvt_pk_bf16_f32 v155, v114, v115
v_mfma_f32_16x16x32_bf16 a[64:67], a[228:231], v[124:127], a[64:67]
v_exp_f32 v117, v117
v_mfma_f32_16x16x32_bf16 a[68:71], a[228:231], v[128:131], a[68:71]
v_exp_f32 v118, v118
v_mfma_f32_16x16x32_bf16 a[72:75], a[228:231], v[132:135], a[72:75]
v_exp_f32 v119, v119
v_mfma_f32_16x16x32_bf16 a[76:79], a[228:231], v[136:139], a[76:79]
v_cvt_pk_bf16_f32 v158, v116, v117
v_cvt_pk_bf16_f32 v159, v118, v119
v_mfma_f32_16x16x32_bf16 a[160:163], a[180:183], v[140:143], a[160:163]
buffer_load_dword v253, v218, s[56:59], 0 offen sc1
s_mov_b32 s49, 0x4e800000
v_mfma_f32_16x16x32_bf16 a[164:167], a[180:183], v[144:147], a[164:167]
v_mfma_f32_16x16x32_bf16 a[168:171], a[180:183], v[148:151], a[168:171]
v_mfma_f32_16x16x32_bf16 a[172:175], a[180:183], v[152:155], a[172:175]
v_mfma_f32_16x16x32_bf16 a[176:179], a[180:183], v[156:159], a[176:179]
s_waitcnt lgkmcnt(0)
v_mfma_f32_16x16x32_bf16 a[0:3], a[184:187], v[140:143], a[0:3]
v_mfma_f32_16x16x32_bf16 a[4:7], a[184:187], v[144:147], a[4:7]
v_accvgpr_read_b32 v80, a160
s_nop 0
v_accvgpr_read_b32 v81, a164
v_mfma_f32_16x16x32_bf16 a[8:11], a[184:187], v[148:151], a[8:11]
v_accvgpr_read_b32 v82, a168
v_accvgpr_read_b32 v83, a172
v_mfma_f32_16x16x32_bf16 a[12:15], a[184:187], v[152:155], a[12:15]
v_accvgpr_read_b32 v84, a176
v_add_f32 v85, v80, v81
v_mfma_f32_16x16x32_bf16 a[16:19], a[184:187], v[156:159], a[16:19]
v_add_f32 v86, v82, v83
v_add_f32 v85, v85, v84
v_mfma_f32_16x16x32_bf16 a[20:23], a[188:191], v[140:143], a[20:23]
v_add_f32 v85, v85, v86
v_cmp_nge_f32 vcc, s49, v85
v_mfma_f32_16x16x32_bf16 a[24:27], a[188:191], v[144:147], a[24:27]
v_rcp_f32 v80, v80
v_mfma_f32_16x16x32_bf16 a[28:31], a[188:191], v[148:151], a[28:31]
s_or_b32 s49, vcc_lo, vcc_hi
s_and_b32 s49, s49, s53
v_mov_b32 v85, s49
v_mfma_f32_16x16x32_bf16 a[32:35], a[188:191], v[152:155], a[32:35]
ds_write_b32 v216, v85
v_rcp_f32 v81, v81
v_mfma_f32_16x16x32_bf16 a[36:39], a[188:191], v[156:159], a[36:39]
v_rcp_f32 v82, v82
v_mfma_f32_16x16x32_bf16 a[40:43], a[192:195], v[140:143], a[40:43]
v_rcp_f32 v83, v83
v_mfma_f32_16x16x32_bf16 a[44:47], a[192:195], v[144:147], a[44:47]
v_rcp_f32 v84, v84
v_mfma_f32_16x16x32_bf16 a[48:51], a[192:195], v[148:151], a[48:51]
s_waitcnt lgkmcnt(0)
s_barrier
ds_read_b32 v85, v217
v_mfma_f32_16x16x32_bf16 a[52:55], a[192:195], v[152:155], a[52:55]
v_accvgpr_read_b32 v88, a0
v_accvgpr_read_b32 v89, a1
v_mfma_f32_16x16x32_bf16 a[56:59], a[192:195], v[156:159], a[56:59]
v_accvgpr_read_b32 v90, a2
v_accvgpr_read_b32 v91, a3
v_mfma_f32_16x16x32_bf16 a[60:63], a[196:199], v[140:143], a[60:63]
v_accvgpr_read_b32 v92, a20
v_accvgpr_read_b32 v93, a21
v_mfma_f32_16x16x32_bf16 a[64:67], a[196:199], v[144:147], a[64:67]
v_accvgpr_read_b32 v94, a22
v_accvgpr_read_b32 v95, a23
v_mfma_f32_16x16x32_bf16 a[68:71], a[196:199], v[148:151], a[68:71]
s_waitcnt lgkmcnt(0)
v_cmp_ne_u32 vcc, 0, v85
v_mul_f32 v88, v88, v80
v_mfma_f32_16x16x32_bf16 a[72:75], a[196:199], v[152:155], a[72:75]
v_mul_f32 v89, v89, v80
v_mul_f32 v90, v90, v80
v_mfma_f32_16x16x32_bf16 a[76:79], a[196:199], v[156:159], a[76:79]
s_cbranch_vccnz L_fb
v_mul_f32 v91, v91, v80
v_mul_f32 v92, v92, v80
v_mfma_f32_16x16x32_bf16 a[80:83], a[232:235], v[120:123], a[80:83]
v_mul_f32 v93, v93, v80
v_mul_f32 v94, v94, v80
v_mfma_f32_16x16x32_bf16 a[80:83], a[200:203], v[140:143], a[80:83]
v_mul_f32 v95, v95, v80
v_cvt_pk_bf16_f32 v0, v88, v89
v_mfma_f32_16x16x32_bf16 a[84:87], a[200:203], v[144:147], a[84:87]
v_cvt_pk_bf16_f32 v1, v90, v91
v_cvt_pk_bf16_f32 v2, v92, v93
v_mfma_f32_16x16x32_bf16 a[84:87], a[232:235], v[124:127], a[84:87]
v_cvt_pk_bf16_f32 v3, v94, v95
ds_write_b128 v244, v[0:3] offset:0
s_movk_i32 s51, 0
v_mfma_f32_16x16x32_bf16 a[88:91], a[232:235], v[128:131], a[88:91]
buffer_store_dwordx4 v[0:3], v244, s[24:27], s51 offen offset:0 sc1
v_accvgpr_read_b32 v96, a4
v_accvgpr_read_b32 v97, a5
v_mfma_f32_16x16x32_bf16 a[88:91], a[200:203], v[148:151], a[88:91]
v_accvgpr_read_b32 v98, a6
v_accvgpr_read_b32 v99, a7
v_mfma_f32_16x16x32_bf16 a[92:95], a[200:203], v[152:155], a[92:95]
v_accvgpr_read_b32 v100, a24
v_accvgpr_read_b32 v101, a25
v_mfma_f32_16x16x32_bf16 a[92:95], a[232:235], v[132:135], a[92:95]
v_accvgpr_read_b32 v102, a26
v_accvgpr_read_b32 v103, a27
v_mfma_f32_16x16x32_bf16 a[96:99], a[232:235], v[136:139], a[96:99]
v_mul_f32 v96, v96, v81
v_mul_f32 v97, v97, v81
v_mfma_f32_16x16x32_bf16 a[96:99], a[200:203], v[156:159], a[96:99]
v_mul_f32 v98, v98, v81
v_mul_f32 v99, v99, v81
v_mfma_f32_16x16x32_bf16 a[100:103], a[236:239], v[120:123], a[100:103]
v_mul_f32 v100, v100, v81
v_mul_f32 v101, v101, v81
v_mfma_f32_16x16x32_bf16 a[100:103], a[204:207], v[140:143], a[100:103]
v_mul_f32 v102, v102, v81
v_mul_f32 v103, v103, v81
v_mfma_f32_16x16x32_bf16 a[104:107], a[204:207], v[144:147], a[104:107]
v_cvt_pk_bf16_f32 v4, v96, v97
v_cvt_pk_bf16_f32 v5, v98, v99
v_mfma_f32_16x16x32_bf16 a[104:107], a[236:239], v[124:127], a[104:107]
v_cvt_pk_bf16_f32 v6, v100, v101
v_cvt_pk_bf16_f32 v7, v102, v103
v_mfma_f32_16x16x32_bf16 a[108:111], a[236:239], v[128:131], a[108:111]
ds_write_b128 v244, v[4:7] offset:2048
s_movk_i32 s51, 0
buffer_store_dwordx4 v[4:7], v244, s[24:27], s51 offen offset:2048 sc1
v_mfma_f32_16x16x32_bf16 a[108:111], a[204:207], v[148:151], a[108:111]
v_accvgpr_read_b32 v104, a8
v_accvgpr_read_b32 v105, a9
v_mfma_f32_16x16x32_bf16 a[112:115], a[204:207], v[152:155], a[112:115]
v_accvgpr_read_b32 v106, a10
v_accvgpr_read_b32 v107, a11
v_mfma_f32_16x16x32_bf16 a[112:115], a[236:239], v[132:135], a[112:115]
v_accvgpr_read_b32 v108, a28
v_accvgpr_read_b32 v109, a29
v_mfma_f32_16x16x32_bf16 a[116:119], a[236:239], v[136:139], a[116:119]
v_accvgpr_read_b32 v110, a30
v_accvgpr_read_b32 v111, a31
v_mfma_f32_16x16x32_bf16 a[116:119], a[204:207], v[156:159], a[116:119]
v_mul_f32 v104, v104, v82
v_mul_f32 v105, v105, v82
v_mfma_f32_16x16x32_bf16 a[120:123], a[240:243], v[120:123], a[120:123]
v_mul_f32 v106, v106, v82
v_mul_f32 v107, v107, v82
v_mfma_f32_16x16x32_bf16 a[120:123], a[208:211], v[140:143], a[120:123]
v_mul_f32 v108, v108, v82
v_mul_f32 v109, v109, v82
v_mfma_f32_16x16x32_bf16 a[124:127], a[208:211], v[144:147], a[124:127]
v_mul_f32 v110, v110, v82
v_mul_f32 v111, v111, v82
v_mfma_f32_16x16x32_bf16 a[124:127], a[240:243], v[124:127], a[124:127]
v_cvt_pk_bf16_f32 v8, v104, v105
v_cvt_pk_bf16_f32 v9, v106, v107
v_mfma_f32_16x16x32_bf16 a[128:131], a[240:243], v[128:131], a[128:131]
v_cvt_pk_bf16_f32 v10, v108, v109
v_cvt_pk_bf16_f32 v11, v110, v111
v_mfma_f32_16x16x32_bf16 a[128:131], a[208:211], v[148:151], a[128:131]
ds_write_b128 v244, v[8:11] offset:4096
s_movk_i32 s51, 4096
buffer_store_dwordx4 v[8:11], v244, s[24:27], s51 offen offset:0 sc1
v_mfma_f32_16x16x32_bf16 a[132:135], a[208:211], v[152:155], a[132:135]
v_accvgpr_read_b32 v112, a12
v_accvgpr_read_b32 v113, a13
v_mfma_f32_16x16x32_bf16 a[132:135], a[240:243], v[132:135], a[132:135]
v_accvgpr_read_b32 v114, a14
v_accvgpr_read_b32 v115, a15
v_mfma_f32_16x16x32_bf16 a[136:139], a[240:243], v[136:139], a[136:139]
v_accvgpr_read_b32 v116, a32
v_accvgpr_read_b32 v117, a33
v_mfma_f32_16x16x32_bf16 a[136:139], a[208:211], v[156:159], a[136:139]
v_accvgpr_read_b32 v118, a34
v_accvgpr_read_b32 v119, a35
v_mfma_f32_16x16x32_bf16 a[140:143], a[244:247], v[120:123], a[140:143]
v_mul_f32 v112, v112, v83
v_mul_f32 v113, v113, v83
v_mfma_f32_16x16x32_bf16 a[140:143], a[212:215], v[140:143], a[140:143]
v_mul_f32 v114, v114, v83
v_mul_f32 v115, v115, v83
v_mfma_f32_16x16x32_bf16 a[144:147], a[212:215], v[144:147], a[144:147]
v_mul_f32 v116, v116, v83
v_mul_f32 v117, v117, v83
v_mfma_f32_16x16x32_bf16 a[144:147], a[244:247], v[124:127], a[144:147]
v_mul_f32 v118, v118, v83
v_mul_f32 v119, v119, v83
v_mfma_f32_16x16x32_bf16 a[148:151], a[244:247], v[128:131], a[148:151]
v_cvt_pk_bf16_f32 v12, v112, v113
v_cvt_pk_bf16_f32 v13, v114, v115
v_mfma_f32_16x16x32_bf16 a[148:151], a[212:215], v[148:151], a[148:151]
v_cvt_pk_bf16_f32 v14, v116, v117
v_cvt_pk_bf16_f32 v15, v118, v119
v_mfma_f32_16x16x32_bf16 a[152:155], a[212:215], v[152:155], a[152:155]
ds_write_b128 v244, v[12:15] offset:6144
s_movk_i32 s51, 4096
buffer_store_dwordx4 v[12:15], v244, s[24:27], s51 offen offset:2048 sc1
v_mfma_f32_16x16x32_bf16 a[152:155], a[244:247], v[132:135], a[152:155]
v_accvgpr_read_b32 v88, a16
v_accvgpr_read_b32 v89, a17
v_mfma_f32_16x16x32_bf16 a[156:159], a[244:247], v[136:139], a[156:159]
v_accvgpr_read_b32 v90, a18
v_accvgpr_read_b32 v91, a19
v_mfma_f32_16x16x32_bf16 a[156:159], a[212:215], v[156:159], a[156:159]
v_accvgpr_read_b32 v92, a36
v_accvgpr_read_b32 v93, a37
v_accvgpr_read_b32 v94, a38
v_accvgpr_read_b32 v95, a39
v_mul_f32 v88, v88, v84
v_mul_f32 v89, v89, v84
v_mul_f32 v90, v90, v84
v_mul_f32 v91, v91, v84
v_mul_f32 v92, v92, v84
v_mul_f32 v93, v93, v84
v_mul_f32 v94, v94, v84
v_mul_f32 v95, v95, v84
v_cvt_pk_bf16_f32 v16, v88, v89
v_cvt_pk_bf16_f32 v17, v90, v91
v_cvt_pk_bf16_f32 v18, v92, v93
v_cvt_pk_bf16_f32 v19, v94, v95
ds_write_b128 v244, v[16:19] offset:8192
s_movk_i32 s51, 8192
buffer_store_dwordx4 v[16:19], v244, s[24:27], s51 offen offset:0 sc1
v_accvgpr_read_b32 v96, a40
v_accvgpr_read_b32 v97, a41
v_accvgpr_read_b32 v98, a42
v_accvgpr_read_b32 v99, a43
v_accvgpr_read_b32 v100, a60
v_accvgpr_read_b32 v101, a61
v_accvgpr_read_b32 v102, a62
v_accvgpr_read_b32 v103, a63
v_mul_f32 v96, v96, v80
v_mul_f32 v97, v97, v80
v_mul_f32 v98, v98, v80
v_mul_f32 v99, v99, v80
v_mul_f32 v100, v100, v80
v_mul_f32 v101, v101, v80
v_mul_f32 v102, v102, v80
v_mul_f32 v103, v103, v80
v_cvt_pk_bf16_f32 v20, v96, v97
v_cvt_pk_bf16_f32 v21, v98, v99
v_cvt_pk_bf16_f32 v22, v100, v101
v_cvt_pk_bf16_f32 v23, v102, v103
ds_write_b128 v244, v[20:23] offset:20480
s_movk_i32 s51, 20480
buffer_store_dwordx4 v[20:23], v244, s[24:27], s51 offen offset:0 sc1
v_accvgpr_read_b32 v104, a44
v_accvgpr_read_b32 v105, a45
v_accvgpr_read_b32 v106, a46
v_accvgpr_read_b32 v107, a47
v_accvgpr_read_b32 v108, a64
v_accvgpr_read_b32 v109, a65
v_accvgpr_read_b32 v110, a66
v_accvgpr_read_b32 v111, a67
v_mul_f32 v104, v104, v81
v_mul_f32 v105, v105, v81
v_mul_f32 v106, v106, v81
v_mul_f32 v107, v107, v81
v_mul_f32 v108, v108, v81
v_mul_f32 v109, v109, v81
v_mul_f32 v110, v110, v81
v_mul_f32 v111, v111, v81
v_cvt_pk_bf16_f32 v24, v104, v105
v_cvt_pk_bf16_f32 v25, v106, v107
v_cvt_pk_bf16_f32 v26, v108, v109
v_cvt_pk_bf16_f32 v27, v110, v111
ds_write_b128 v244, v[24:27] offset:22528
s_movk_i32 s51, 20480
buffer_store_dwordx4 v[24:27], v244, s[24:27], s51 offen offset:2048 sc1
v_accvgpr_read_b32 v112, a48
v_accvgpr_read_b32 v113, a49
v_accvgpr_read_b32 v114, a50
v_accvgpr_read_b32 v115, a51
v_accvgpr_read_b32 v116, a68
v_accvgpr_read_b32 v117, a69
v_accvgpr_read_b32 v118, a70
v_accvgpr_read_b32 v119, a71
v_mul_f32 v112, v112, v82
v_mul_f32 v113, v113, v82
v_mul_f32 v114, v114, v82
v_mul_f32 v115, v115, v82
v_mul_f32 v116, v116, v82
v_mul_f32 v117, v117, v82
v_mul_f32 v118, v118, v82
v_mul_f32 v119, v119, v82
v_cvt_pk_bf16_f32 v28, v112, v113
v_cvt_pk_bf16_f32 v29, v114, v115
v_cvt_pk_bf16_f32 v30, v116, v117
v_cvt_pk_bf16_f32 v31, v118, v119
ds_write_b128 v244, v[28:31] offset:24576
s_movk_i32 s51, 24576
buffer_store_dwordx4 v[28:31], v244, s[24:27], s51 offen offset:0 sc1
v_accvgpr_read_b32 v88, a52
v_accvgpr_read_b32 v89, a53
v_accvgpr_read_b32 v90, a54
v_accvgpr_read_b32 v91, a55
v_accvgpr_read_b32 v92, a72
v_accvgpr_read_b32 v93, a73
v_accvgpr_read_b32 v94, a74
v_accvgpr_read_b32 v95, a75
v_mul_f32 v88, v88, v83
v_mul_f32 v89, v89, v83
v_mul_f32 v90, v90, v83
v_mul_f32 v91, v91, v83
v_mul_f32 v92, v92, v83
v_mul_f32 v93, v93, v83
v_mul_f32 v94, v94, v83
v_mul_f32 v95, v95, v83
v_cvt_pk_bf16_f32 v32, v88, v89
v_cvt_pk_bf16_f32 v33, v90, v91
v_cvt_pk_bf16_f32 v34, v92, v93
v_cvt_pk_bf16_f32 v35, v94, v95
ds_write_b128 v244, v[32:35] offset:26624
s_movk_i32 s51, 24576
buffer_store_dwordx4 v[32:35], v244, s[24:27], s51 offen offset:2048 sc1
v_accvgpr_read_b32 v96, a56
v_accvgpr_read_b32 v97, a57
v_accvgpr_read_b32 v98, a58
v_accvgpr_read_b32 v99, a59
v_accvgpr_read_b32 v100, a76
v_accvgpr_read_b32 v101, a77
v_accvgpr_read_b32 v102, a78
v_accvgpr_read_b32 v103, a79
v_mul_f32 v96, v96, v84
v_mul_f32 v97, v97, v84
v_mul_f32 v98, v98, v84
v_mul_f32 v99, v99, v84
v_mul_f32 v100, v100, v84
v_mul_f32 v101, v101, v84
v_mul_f32 v102, v102, v84
v_mul_f32 v103, v103, v84
v_cvt_pk_bf16_f32 v36, v96, v97
v_cvt_pk_bf16_f32 v37, v98, v99
v_cvt_pk_bf16_f32 v38, v100, v101
v_cvt_pk_bf16_f32 v39, v102, v103
ds_write_b128 v244, v[36:39] offset:28672
s_movk_i32 s51, 28672
buffer_store_dwordx4 v[36:39], v244, s[24:27], s51 offen offset:0 sc1
v_accvgpr_read_b32 v104, a80
v_accvgpr_read_b32 v105, a81
v_accvgpr_read_b32 v106, a82
v_accvgpr_read_b32 v107, a83
v_accvgpr_read_b32 v108, a100
v_accvgpr_read_b32 v109, a101
v_accvgpr_read_b32 v110, a102
v_accvgpr_read_b32 v111, a103
v_mul_f32 v104, v104, v80
v_mul_f32 v105, v105, v80
v_mul_f32 v106, v106, v80
v_mul_f32 v107, v107, v80
v_mul_f32 v108, v108, v80
v_mul_f32 v109, v109, v80
v_mul_f32 v110, v110, v80
v_mul_f32 v111, v111, v80
v_cvt_pk_bf16_f32 v40, v104, v105
v_cvt_pk_bf16_f32 v41, v106, v107
v_cvt_pk_bf16_f32 v42, v108, v109
v_cvt_pk_bf16_f32 v43, v110, v111
ds_write_b128 v245, v[40:43] offset:0
s_movk_i32 s51, 0
buffer_store_dwordx4 v[40:43], v245, s[24:27], s51 offen offset:0 sc1
v_accvgpr_read_b32 v112, a84
v_accvgpr_read_b32 v113, a85
v_accvgpr_read_b32 v114, a86
v_accvgpr_read_b32 v115, a87
v_accvgpr_read_b32 v116, a104
v_accvgpr_read_b32 v117, a105
v_accvgpr_read_b32 v118, a106
v_accvgpr_read_b32 v119, a107
v_mul_f32 v112, v112, v81
v_mul_f32 v113, v113, v81
v_mul_f32 v114, v114, v81
v_mul_f32 v115, v115, v81
v_mul_f32 v116, v116, v81
v_mul_f32 v117, v117, v81
v_mul_f32 v118, v118, v81
v_mul_f32 v119, v119, v81
v_cvt_pk_bf16_f32 v44, v112, v113
v_cvt_pk_bf16_f32 v45, v114, v115
v_cvt_pk_bf16_f32 v46, v116, v117
v_cvt_pk_bf16_f32 v47, v118, v119
ds_write_b128 v245, v[44:47] offset:2048
s_movk_i32 s51, 0
buffer_store_dwordx4 v[44:47], v245, s[24:27], s51 offen offset:2048 sc1
v_accvgpr_read_b32 v88, a88
v_accvgpr_read_b32 v89, a89
v_accvgpr_read_b32 v90, a90
v_accvgpr_read_b32 v91, a91
v_accvgpr_read_b32 v92, a108
v_accvgpr_read_b32 v93, a109
v_accvgpr_read_b32 v94, a110
v_accvgpr_read_b32 v95, a111
v_mul_f32 v88, v88, v82
v_mul_f32 v89, v89, v82
v_mul_f32 v90, v90, v82
v_mul_f32 v91, v91, v82
v_mul_f32 v92, v92, v82
v_mul_f32 v93, v93, v82
v_mul_f32 v94, v94, v82
v_mul_f32 v95, v95, v82
v_cvt_pk_bf16_f32 v48, v88, v89
v_cvt_pk_bf16_f32 v49, v90, v91
v_cvt_pk_bf16_f32 v50, v92, v93
v_cvt_pk_bf16_f32 v51, v94, v95
ds_write_b128 v245, v[48:51] offset:4096
s_movk_i32 s51, 4096
buffer_store_dwordx4 v[48:51], v245, s[24:27], s51 offen offset:0 sc1
v_accvgpr_read_b32 v96, a92
v_accvgpr_read_b32 v97, a93
v_accvgpr_read_b32 v98, a94
v_accvgpr_read_b32 v99, a95
v_accvgpr_read_b32 v100, a112
v_accvgpr_read_b32 v101, a113
v_accvgpr_read_b32 v102, a114
v_accvgpr_read_b32 v103, a115
v_mul_f32 v96, v96, v83
v_mul_f32 v97, v97, v83
v_mul_f32 v98, v98, v83
v_mul_f32 v99, v99, v83
v_mul_f32 v100, v100, v83
v_mul_f32 v101, v101, v83
v_mul_f32 v102, v102, v83
v_mul_f32 v103, v103, v83
v_cvt_pk_bf16_f32 v52, v96, v97
v_cvt_pk_bf16_f32 v53, v98, v99
v_cvt_pk_bf16_f32 v54, v100, v101
v_cvt_pk_bf16_f32 v55, v102, v103
ds_write_b128 v245, v[52:55] offset:6144
s_movk_i32 s51, 4096
buffer_store_dwordx4 v[52:55], v245, s[24:27], s51 offen offset:2048 sc1
v_accvgpr_read_b32 v104, a96
v_accvgpr_read_b32 v105, a97
v_accvgpr_read_b32 v106, a98
v_accvgpr_read_b32 v107, a99
v_accvgpr_read_b32 v108, a116
v_accvgpr_read_b32 v109, a117
v_accvgpr_read_b32 v110, a118
v_accvgpr_read_b32 v111, a119
v_mul_f32 v104, v104, v84
v_mul_f32 v105, v105, v84
v_mul_f32 v106, v106, v84
v_mul_f32 v107, v107, v84
v_mul_f32 v108, v108, v84
v_mul_f32 v109, v109, v84
v_mul_f32 v110, v110, v84
v_mul_f32 v111, v111, v84
v_cvt_pk_bf16_f32 v56, v104, v105
v_cvt_pk_bf16_f32 v57, v106, v107
v_cvt_pk_bf16_f32 v58, v108, v109
v_cvt_pk_bf16_f32 v59, v110, v111
ds_write_b128 v245, v[56:59] offset:8192
v_accvgpr_read_b32 v112, a120
v_accvgpr_read_b32 v113, a121
v_accvgpr_read_b32 v114, a122
v_accvgpr_read_b32 v115, a123
v_accvgpr_read_b32 v116, a140
v_accvgpr_read_b32 v117, a141
v_accvgpr_read_b32 v118, a142
v_accvgpr_read_b32 v119, a143
v_mul_f32 v112, v112, v80
v_mul_f32 v113, v113, v80
v_mul_f32 v114, v114, v80
v_mul_f32 v115, v115, v80
v_mul_f32 v116, v116, v80
v_mul_f32 v117, v117, v80
v_mul_f32 v118, v118, v80
v_mul_f32 v119, v119, v80
v_cvt_pk_bf16_f32 v0, v112, v113
v_cvt_pk_bf16_f32 v1, v114, v115
v_cvt_pk_bf16_f32 v2, v116, v117
v_cvt_pk_bf16_f32 v3, v118, v119
ds_write_b128 v245, v[0:3] offset:20480
v_accvgpr_read_b32 v88, a124
v_accvgpr_read_b32 v89, a125
v_accvgpr_read_b32 v90, a126
v_accvgpr_read_b32 v91, a127
v_accvgpr_read_b32 v92, a144
v_accvgpr_read_b32 v93, a145
v_accvgpr_read_b32 v94, a146
v_accvgpr_read_b32 v95, a147
v_mul_f32 v88, v88, v81
v_mul_f32 v89, v89, v81
v_mul_f32 v90, v90, v81
v_mul_f32 v91, v91, v81
v_mul_f32 v92, v92, v81
v_mul_f32 v93, v93, v81
v_mul_f32 v94, v94, v81
v_mul_f32 v95, v95, v81
v_cvt_pk_bf16_f32 v4, v88, v89
v_cvt_pk_bf16_f32 v5, v90, v91
v_cvt_pk_bf16_f32 v6, v92, v93
v_cvt_pk_bf16_f32 v7, v94, v95
ds_write_b128 v245, v[4:7] offset:22528
v_accvgpr_read_b32 v96, a128
v_accvgpr_read_b32 v97, a129
v_accvgpr_read_b32 v98, a130
v_accvgpr_read_b32 v99, a131
v_accvgpr_read_b32 v100, a148
v_accvgpr_read_b32 v101, a149
v_accvgpr_read_b32 v102, a150
v_accvgpr_read_b32 v103, a151
v_mul_f32 v96, v96, v82
v_mul_f32 v97, v97, v82
v_mul_f32 v98, v98, v82
v_mul_f32 v99, v99, v82
v_mul_f32 v100, v100, v82
v_mul_f32 v101, v101, v82
v_mul_f32 v102, v102, v82
v_mul_f32 v103, v103, v82
v_cvt_pk_bf16_f32 v8, v96, v97
v_cvt_pk_bf16_f32 v9, v98, v99
v_cvt_pk_bf16_f32 v10, v100, v101
v_cvt_pk_bf16_f32 v11, v102, v103
ds_write_b128 v245, v[8:11] offset:24576
v_accvgpr_read_b32 v104, a132
v_accvgpr_read_b32 v105, a133
v_accvgpr_read_b32 v106, a134
v_accvgpr_read_b32 v107, a135
v_accvgpr_read_b32 v108, a152
v_accvgpr_read_b32 v109, a153
v_accvgpr_read_b32 v110, a154
v_accvgpr_read_b32 v111, a155
v_mul_f32 v104, v104, v83
v_mul_f32 v105, v105, v83
v_mul_f32 v106, v106, v83
v_mul_f32 v107, v107, v83
v_mul_f32 v108, v108, v83
v_mul_f32 v109, v109, v83
v_mul_f32 v110, v110, v83
v_mul_f32 v111, v111, v83
v_cvt_pk_bf16_f32 v12, v104, v105
v_cvt_pk_bf16_f32 v13, v106, v107
v_cvt_pk_bf16_f32 v14, v108, v109
v_cvt_pk_bf16_f32 v15, v110, v111
ds_write_b128 v245, v[12:15] offset:26624
v_accvgpr_read_b32 v112, a136
v_accvgpr_read_b32 v113, a137
v_accvgpr_read_b32 v114, a138
v_accvgpr_read_b32 v115, a139
v_accvgpr_read_b32 v116, a156
v_accvgpr_read_b32 v117, a157
v_accvgpr_read_b32 v118, a158
v_accvgpr_read_b32 v119, a159
v_mul_f32 v112, v112, v84
v_mul_f32 v113, v113, v84
v_mul_f32 v114, v114, v84
v_mul_f32 v115, v115, v84
v_mul_f32 v116, v116, v84
v_mul_f32 v117, v117, v84
v_mul_f32 v118, v118, v84
v_mul_f32 v119, v119, v84
v_cvt_pk_bf16_f32 v16, v112, v113
v_cvt_pk_bf16_f32 v17, v114, v115
v_cvt_pk_bf16_f32 v18, v116, v117
v_cvt_pk_bf16_f32 v19, v118, v119
ds_write_b128 v245, v[16:19] offset:28672
s_waitcnt vmcnt(31) lgkmcnt(0)
s_barrier
ds_read_b64_tr_b16 a[184:185], v237 offset:0
ds_read_b64_tr_b16 a[186:187], v237 offset:1024
ds_read_b64_tr_b16 a[188:189], v239 offset:0
ds_read_b64_tr_b16 a[190:191], v239 offset:1024
ds_read_b128 a[200:203], v241 offset:0
ds_read_b128 a[220:223], v241 offset:1024
ds_read_b128 a[204:207], v241 offset:2048
ds_read_b128 a[224:227], v241 offset:3072
ds_read_b128 a[208:211], v241 offset:4096
ds_read_b128 a[228:231], v241 offset:5120
ds_read_b128 a[212:215], v241 offset:6144
ds_read_b128 a[232:235], v241 offset:7168
ds_read_b128 a[216:219], v241 offset:8192
ds_read_b128 a[236:239], v241 offset:9216
ds_read_b64_tr_b16 a[192:193], v237 offset:8
ds_read_b64_tr_b16 a[194:195], v237 offset:1032
ds_read_b64_tr_b16 a[196:197], v239 offset:8
ds_read_b64_tr_b16 a[198:199], v239 offset:1032
ds_read_b64_tr_b16 a[240:241], v238 offset:0
ds_read_b64_tr_b16 a[242:243], v238 offset:1024
ds_read_b64_tr_b16 a[244:245], v240 offset:0
ds_read_b64_tr_b16 a[246:247], v240 offset:1024
s_waitcnt lgkmcnt(13)
v_mfma_f32_16x16x32_bf16 v[80:83], a[184:187], a[200:203], 0
ds_read_b64_tr_b16 a[248:249], v238 offset:8
v_mfma_f32_16x16x32_bf16 v[80:83], a[188:191], a[220:223], v[80:83]
ds_read_b64_tr_b16 a[250:251], v238 offset:1032
v_mfma_f32_16x16x32_bf16 v[84:87], a[188:191], a[224:227], 0
ds_read_b64_tr_b16 a[252:253], v240 offset:8
v_mfma_f32_16x16x32_bf16 v[84:87], a[184:187], a[204:207], v[84:87]
ds_read_b64_tr_b16 a[254:255], v240 offset:1032
v_mfma_f32_16x16x32_bf16 v[88:91], a[184:187], a[208:211], 0
s_waitcnt lgkmcnt(7)
v_mfma_f32_16x16x32_bf16 v[88:91], a[188:191], a[228:231], v[88:91]
v_mfma_f32_16x16x32_bf16 v[92:95], a[188:191], a[232:235], 0
v_mov_b32 v246, 1
v_mfma_f32_16x16x32_bf16 v[92:95], a[184:187], a[212:215], v[92:95]
s_waitcnt vmcnt(4)
buffer_store_dword v246, v255, s[92:95], 0 offen sc1
v_mfma_f32_16x16x32_bf16 v[96:99], a[184:187], a[216:219], 0
v_mfma_f32_16x16x32_bf16 v[96:99], a[188:191], a[236:239], v[96:99]
s_waitcnt lgkmcnt(0)
s_barrier
v_mfma_f32_16x16x32_bf16 v[100:103], a[192:195], a[200:203], 0
ds_read_b64_tr_b16 a[184:185], v237 offset:16384
v_mfma_f32_16x16x32_bf16 v[100:103], a[196:199], a[220:223], v[100:103]
ds_read_b64_tr_b16 a[186:187], v237 offset:17408
v_mfma_f32_16x16x32_bf16 v[104:107], a[196:199], a[224:227], 0
v_mfma_f32_16x16x32_bf16 v[104:107], a[192:195], a[204:207], v[104:107]
ds_read_b64_tr_b16 a[188:189], v239 offset:16384
v_mfma_f32_16x16x32_bf16 v[108:111], a[192:195], a[208:211], 0
ds_read_b64_tr_b16 a[190:191], v239 offset:17408
v_mfma_f32_16x16x32_bf16 v[108:111], a[196:199], a[228:231], v[108:111]
v_mfma_f32_16x16x32_bf16 v[112:115], a[196:199], a[232:235], 0
v_mfma_f32_16x16x32_bf16 v[112:115], a[192:195], a[212:215], v[112:115]
s_movk_i32 s51, 8192
buffer_store_dwordx4 v[56:59], v245, s[24:27], s51 offen offset:0 sc1
v_mfma_f32_16x16x32_bf16 v[116:119], a[192:195], a[216:219], 0
v_mfma_f32_16x16x32_bf16 v[116:119], a[196:199], a[236:239], v[116:119]
v_mfma_f32_16x16x32_bf16 v[60:63], a[240:243], a[200:203], 0
ds_read_b64_tr_b16 a[192:193], v237 offset:16392
v_mfma_f32_16x16x32_bf16 v[60:63], a[244:247], a[220:223], v[60:63]
ds_read_b64_tr_b16 a[194:195], v237 offset:17416
v_mfma_f32_16x16x32_bf16 v[64:67], a[244:247], a[224:227], 0
v_mfma_f32_16x16x32_bf16 v[64:67], a[240:243], a[204:207], v[64:67]
ds_read_b64_tr_b16 a[196:197], v239 offset:16392
v_mfma_f32_16x16x32_bf16 v[68:71], a[240:243], a[208:211], 0
ds_read_b64_tr_b16 a[198:199], v239 offset:17416
v_mfma_f32_16x16x32_bf16 v[68:71], a[244:247], a[228:231], v[68:71]
v_mfma_f32_16x16x32_bf16 v[72:75], a[244:247], a[232:235], 0
v_mfma_f32_16x16x32_bf16 v[72:75], a[240:243], a[212:215], v[72:75]
s_movk_i32 s51, 20480
buffer_store_dwordx4 v[0:3], v245, s[24:27], s51 offen offset:0 sc1
v_mfma_f32_16x16x32_bf16 v[76:79], a[240:243], a[216:219], 0
v_mfma_f32_16x16x32_bf16 v[76:79], a[244:247], a[236:239], v[76:79]
v_mfma_f32_16x16x32_bf16 v[120:123], a[248:251], a[200:203], 0
ds_read_b64_tr_b16 a[240:241], v238 offset:16384
v_mfma_f32_16x16x32_bf16 v[120:123], a[252:255], a[220:223], v[120:123]
ds_read_b64_tr_b16 a[242:243], v238 offset:17408
v_mfma_f32_16x16x32_bf16 v[124:127], a[252:255], a[224:227], 0
v_mfma_f32_16x16x32_bf16 v[124:127], a[248:251], a[204:207], v[124:127]
ds_read_b64_tr_b16 a[244:245], v240 offset:16384
v_mfma_f32_16x16x32_bf16 v[128:131], a[248:251], a[208:211], 0
ds_read_b64_tr_b16 a[246:247], v240 offset:17408
v_mfma_f32_16x16x32_bf16 v[128:131], a[252:255], a[228:231], v[128:131]
v_mfma_f32_16x16x32_bf16 v[132:135], a[252:255], a[232:235], 0
v_mfma_f32_16x16x32_bf16 v[132:135], a[248:251], a[212:215], v[132:135]
s_movk_i32 s51, 20480
buffer_store_dwordx4 v[4:7], v245, s[24:27], s51 offen offset:2048 sc1
v_mfma_f32_16x16x32_bf16 v[136:139], a[248:251], a[216:219], 0
v_mfma_f32_16x16x32_bf16 v[136:139], a[252:255], a[236:239], v[136:139]
s_waitcnt lgkmcnt(4)
v_mfma_f32_16x16x32_bf16 v[140:143], a[184:187], a[200:203], 0
ds_read_b64_tr_b16 a[248:249], v238 offset:16392
v_mfma_f32_16x16x32_bf16 v[140:143], a[188:191], a[220:223], v[140:143]
ds_read_b64_tr_b16 a[250:251], v238 offset:17416
v_mfma_f32_16x16x32_bf16 v[144:147], a[188:191], a[224:227], 0
ds_read_b64_tr_b16 a[252:253], v240 offset:16392
v_mfma_f32_16x16x32_bf16 v[144:147], a[184:187], a[204:207], v[144:147]
ds_read_b64_tr_b16 a[254:255], v240 offset:17416
v_mfma_f32_16x16x32_bf16 v[148:151], a[184:187], a[208:211], 0
v_mfma_f32_16x16x32_bf16 v[148:151], a[188:191], a[228:231], v[148:151]
v_mfma_f32_16x16x32_bf16 v[152:155], a[188:191], a[232:235], 0
v_mfma_f32_16x16x32_bf16 v[152:155], a[184:187], a[212:215], v[152:155]
s_movk_i32 s51, 24576
buffer_store_dwordx4 v[8:11], v245, s[24:27], s51 offen offset:0 sc1
v_mfma_f32_16x16x32_bf16 v[156:159], a[184:187], a[216:219], 0
v_mfma_f32_16x16x32_bf16 v[156:159], a[188:191], a[236:239], v[156:159]
s_waitcnt lgkmcnt(0)
s_barrier
v_mfma_f32_16x16x32_bf16 v[160:163], a[192:195], a[200:203], 0
ds_read_b64_tr_b16 a[184:185], v233 offset:0
v_mfma_f32_16x16x32_bf16 v[160:163], a[196:199], a[220:223], v[160:163]
ds_read_b64_tr_b16 a[186:187], v233 offset:1024
v_mfma_f32_16x16x32_bf16 v[164:167], a[196:199], a[224:227], 0
v_mfma_f32_16x16x32_bf16 v[164:167], a[192:195], a[204:207], v[164:167]
ds_read_b64_tr_b16 a[188:189], v235 offset:0
v_mfma_f32_16x16x32_bf16 v[168:171], a[192:195], a[208:211], 0
ds_read_b64_tr_b16 a[190:191], v235 offset:1024
v_mfma_f32_16x16x32_bf16 v[168:171], a[196:199], a[228:231], v[168:171]
ds_read_b128 a[0:3], v241 offset:20480
v_mfma_f32_16x16x32_bf16 v[172:175], a[196:199], a[232:235], 0
ds_read_b128 a[20:23], v241 offset:21504
v_mfma_f32_16x16x32_bf16 v[172:175], a[192:195], a[212:215], v[172:175]
s_movk_i32 s51, 24576
buffer_store_dwordx4 v[12:15], v245, s[24:27], s51 offen offset:2048 sc1
v_mfma_f32_16x16x32_bf16 v[176:179], a[192:195], a[216:219], 0
ds_read_b128 a[4:7], v241 offset:22528
v_mfma_f32_16x16x32_bf16 v[176:179], a[196:199], a[236:239], v[176:179]
ds_read_b128 a[24:27], v241 offset:23552
v_mfma_f32_16x16x32_bf16 v[180:183], a[240:243], a[200:203], 0
ds_read_b64_tr_b16 a[192:193], v233 offset:8
v_mfma_f32_16x16x32_bf16 v[180:183], a[244:247], a[220:223], v[180:183]
ds_read_b64_tr_b16 a[194:195], v233 offset:1032
v_mfma_f32_16x16x32_bf16 v[184:187], a[244:247], a[224:227], 0
v_readfirstlane_b32 s49, v253
v_mfma_f32_16x16x32_bf16 v[184:187], a[240:243], a[204:207], v[184:187]
ds_read_b64_tr_b16 a[196:197], v235 offset:8
v_mfma_f32_16x16x32_bf16 v[188:191], a[240:243], a[208:211], 0
ds_read_b64_tr_b16 a[198:199], v235 offset:1032
v_mfma_f32_16x16x32_bf16 v[188:191], a[244:247], a[228:231], v[188:191]
ds_read_b128 a[8:11], v241 offset:24576
v_mfma_f32_16x16x32_bf16 v[192:195], a[244:247], a[232:235], 0
ds_read_b128 a[28:31], v241 offset:25600
v_mfma_f32_16x16x32_bf16 v[192:195], a[240:243], a[212:215], v[192:195]
s_movk_i32 s51, 28672
buffer_store_dwordx4 v[16:19], v245, s[24:27], s51 offen offset:0 sc1
v_mfma_f32_16x16x32_bf16 v[196:199], a[240:243], a[216:219], 0
ds_read_b128 a[12:15], v241 offset:26624
v_mfma_f32_16x16x32_bf16 v[196:199], a[244:247], a[236:239], v[196:199]
ds_read_b128 a[32:35], v241 offset:27648
v_mfma_f32_16x16x32_bf16 v[200:203], a[248:251], a[200:203], 0
ds_read_b64_tr_b16 a[240:241], v234 offset:0
s_cmp_ge_u32 s49, 16
s_cbranch_scc0 L_famwait
L_famok:
v_mfma_f32_16x16x32_bf16 v[200:203], a[252:255], a[220:223], v[200:203]
ds_read_b64_tr_b16 a[242:243], v234 offset:1024
v_mfma_f32_16x16x32_bf16 v[204:207], a[252:255], a[224:227], 0
ds_read_b128 a[16:19], v241 offset:28672
v_mfma_f32_16x16x32_bf16 v[204:207], a[248:251], a[204:207], v[204:207]
ds_read_b64_tr_b16 a[244:245], v236 offset:0
v_mfma_f32_16x16x32_bf16 v[208:211], a[248:251], a[208:211], 0
ds_read_b64_tr_b16 a[246:247], v236 offset:1024
v_mfma_f32_16x16x32_bf16 v[208:211], a[252:255], a[228:231], v[208:211]
ds_read_b128 a[36:39], v241 offset:29696
v_mfma_f32_16x16x32_bf16 v[212:215], a[252:255], a[232:235], 0
v_mfma_f32_16x16x32_bf16 v[212:215], a[248:251], a[212:215], v[212:215]
v_mfma_f32_16x16x32_bf16 v[216:219], a[248:251], a[216:219], 0
v_mfma_f32_16x16x32_bf16 v[216:219], a[252:255], a[236:239], v[216:219]
s_waitcnt lgkmcnt(1)
v_mfma_f32_16x16x32_bf16 v[80:83], a[184:187], a[0:3], v[80:83]
ds_read_b64_tr_b16 a[248:249], v234 offset:8
v_mfma_f32_16x16x32_bf16 v[80:83], a[188:191], a[20:23], v[80:83]
ds_read_b64_tr_b16 a[250:251], v234 offset:1032
s_add_u32 m0, s48, 131072
s_xor_b32 s35, s43, 131200
v_mfma_f32_16x16x32_bf16 v[84:87], a[188:191], a[24:27], v[84:87]
ds_read_b64_tr_b16 a[252:253], v236 offset:8
buffer_load_dwordx4 v248, s[12:15], s35 offen offset:0 lds
v_mfma_f32_16x16x32_bf16 v[84:87], a[184:187], a[4:7], v[84:87]
ds_read_b64_tr_b16 a[254:255], v236 offset:1032
v_mfma_f32_16x16x32_bf16 v[88:91], a[184:187], a[8:11], v[88:91]
v_mfma_f32_16x16x32_bf16 v[88:91], a[188:191], a[28:31], v[88:91]
s_add_u32 m0, s48, 131072
v_mfma_f32_16x16x32_bf16 v[92:95], a[188:191], a[32:35], v[92:95]
buffer_load_dwordx4 v249, s[12:15], s35 offen offset:1024 lds
v_mfma_f32_16x16x32_bf16 v[92:95], a[184:187], a[12:15], v[92:95]
v_mfma_f32_16x16x32_bf16 v[96:99], a[184:187], a[16:19], v[96:99]
s_waitcnt lgkmcnt(2)
v_mfma_f32_16x16x32_bf16 v[96:99], a[188:191], a[36:39], v[96:99]
s_waitcnt lgkmcnt(0)
s_barrier
v_mfma_f32_16x16x32_bf16 v[100:103], a[192:195], a[0:3], v[100:103]
ds_read_b64_tr_b16 a[184:185], v233 offset:16384
v_mfma_f32_16x16x32_bf16 v[100:103], a[196:199], a[20:23], v[100:103]
ds_read_b64_tr_b16 a[186:187], v233 offset:17408
s_add_u32 m0, s48, 131072
v_mfma_f32_16x16x32_bf16 v[104:107], a[196:199], a[24:27], v[104:107]
buffer_load_dwordx4 v250, s[12:15], s35 offen offset:2048 lds
v_mfma_f32_16x16x32_bf16 v[104:107], a[192:195], a[4:7], v[104:107]
ds_read_b64_tr_b16 a[188:189], v235 offset:16384
v_mfma_f32_16x16x32_bf16 v[108:111], a[192:195], a[8:11], v[108:111]
ds_read_b64_tr_b16 a[190:191], v235 offset:17408
v_mfma_f32_16x16x32_bf16 v[108:111], a[196:199], a[28:31], v[108:111]
s_add_u32 m0, s48, 131072
v_mfma_f32_16x16x32_bf16 v[112:115], a[196:199], a[32:35], v[112:115]
buffer_load_dwordx4 v251, s[12:15], s35 offen offset:3072 lds
v_mfma_f32_16x16x32_bf16 v[112:115], a[192:195], a[12:15], v[112:115]
v_mfma_f32_16x16x32_bf16 v[116:119], a[192:195], a[16:19], v[116:119]
v_mfma_f32_16x16x32_bf16 v[116:119], a[196:199], a[36:39], v[116:119]
v_mfma_f32_16x16x32_bf16 v[60:63], a[240:243], a[0:3], v[60:63]
ds_read_b64_tr_b16 a[192:193], v233 offset:16392
v_mfma_f32_16x16x32_bf16 v[60:63], a[244:247], a[20:23], v[60:63]
ds_read_b64_tr_b16 a[194:195], v233 offset:17416
s_add_u32 m0, s48, 147456
s_xor_b32 s35, s43, 196608
v_mfma_f32_16x16x32_bf16 v[64:67], a[244:247], a[24:27], v[64:67]
buffer_load_dwordx4 v248, s[12:15], s35 offen offset:0 lds
v_mfma_f32_16x16x32_bf16 v[64:67], a[240:243], a[4:7], v[64:67]
ds_read_b64_tr_b16 a[196:197], v235 offset:16392
v_mfma_f32_16x16x32_bf16 v[68:71], a[240:243], a[8:11], v[68:71]
ds_read_b64_tr_b16 a[198:199], v235 offset:17416
v_mfma_f32_16x16x32_bf16 v[68:71], a[244:247], a[28:31], v[68:71]
s_add_u32 m0, s48, 147456
v_mfma_f32_16x16x32_bf16 v[72:75], a[244:247], a[32:35], v[72:75]
buffer_load_dwordx4 v249, s[12:15], s35 offen offset:1024 lds
v_mfma_f32_16x16x32_bf16 v[72:75], a[240:243], a[12:15], v[72:75]
v_mfma_f32_16x16x32_bf16 v[76:79], a[240:243], a[16:19], v[76:79]
v_mfma_f32_16x16x32_bf16 v[76:79], a[244:247], a[36:39], v[76:79]
v_mfma_f32_16x16x32_bf16 v[120:123], a[248:251], a[0:3], v[120:123]
ds_read_b64_tr_b16 a[240:241], v234 offset:16384
v_mfma_f32_16x16x32_bf16 v[120:123], a[252:255], a[20:23], v[120:123]
ds_read_b64_tr_b16 a[242:243], v234 offset:17408
s_add_u32 m0, s48, 147456
v_mfma_f32_16x16x32_bf16 v[124:127], a[252:255], a[24:27], v[124:127]
buffer_load_dwordx4 v250, s[12:15], s35 offen offset:2048 lds
v_mfma_f32_16x16x32_bf16 v[124:127], a[248:251], a[4:7], v[124:127]
ds_read_b64_tr_b16 a[244:245], v236 offset:16384
v_mfma_f32_16x16x32_bf16 v[128:131], a[248:251], a[8:11], v[128:131]
ds_read_b64_tr_b16 a[246:247], v236 offset:17408
v_mfma_f32_16x16x32_bf16 v[128:131], a[252:255], a[28:31], v[128:131]
s_add_u32 m0, s48, 147456
v_mfma_f32_16x16x32_bf16 v[132:135], a[252:255], a[32:35], v[132:135]
buffer_load_dwordx4 v251, s[12:15], s35 offen offset:3072 lds
v_mfma_f32_16x16x32_bf16 v[132:135], a[248:251], a[12:15], v[132:135]
v_mfma_f32_16x16x32_bf16 v[136:139], a[248:251], a[16:19], v[136:139]
v_mfma_f32_16x16x32_bf16 v[136:139], a[252:255], a[36:39], v[136:139]
s_waitcnt lgkmcnt(4)
v_mfma_f32_16x16x32_bf16 v[140:143], a[184:187], a[0:3], v[140:143]
ds_read_b64_tr_b16 a[248:249], v234 offset:16392
v_mfma_f32_16x16x32_bf16 v[140:143], a[188:191], a[20:23], v[140:143]
ds_read_b64_tr_b16 a[250:251], v234 offset:17416
s_add_u32 m0, s48, 81920
s_xor_b32 s35, s43, 196736
v_mfma_f32_16x16x32_bf16 v[144:147], a[188:191], a[24:27], v[144:147]
ds_read_b64_tr_b16 a[252:253], v236 offset:16392
buffer_load_dwordx4 v248, s[12:15], s35 offen offset:0 lds
v_mfma_f32_16x16x32_bf16 v[144:147], a[184:187], a[4:7], v[144:147]
ds_read_b64_tr_b16 a[254:255], v236 offset:17416
v_mfma_f32_16x16x32_bf16 v[148:151], a[184:187], a[8:11], v[148:151]
v_mfma_f32_16x16x32_bf16 v[148:151], a[188:191], a[28:31], v[148:151]
s_add_u32 m0, s48, 81920
v_mfma_f32_16x16x32_bf16 v[152:155], a[188:191], a[32:35], v[152:155]
buffer_load_dwordx4 v249, s[12:15], s35 offen offset:1024 lds
v_mfma_f32_16x16x32_bf16 v[152:155], a[184:187], a[12:15], v[152:155]
v_mfma_f32_16x16x32_bf16 v[156:159], a[184:187], a[16:19], v[156:159]
v_mfma_f32_16x16x32_bf16 v[156:159], a[188:191], a[36:39], v[156:159]
s_waitcnt lgkmcnt(0)
s_barrier
v_mfma_f32_16x16x32_bf16 v[160:163], a[192:195], a[0:3], v[160:163]
ds_read_b64_tr_b16 a[184:185], v233 offset:32768
v_mfma_f32_16x16x32_bf16 v[160:163], a[196:199], a[20:23], v[160:163]
ds_read_b64_tr_b16 a[186:187], v233 offset:33792
s_add_u32 m0, s48, 81920
v_mfma_f32_16x16x32_bf16 v[164:167], a[196:199], a[24:27], v[164:167]
buffer_load_dwordx4 v250, s[12:15], s35 offen offset:2048 lds
v_mfma_f32_16x16x32_bf16 v[164:167], a[192:195], a[4:7], v[164:167]
ds_read_b64_tr_b16 a[188:189], v235 offset:32768
v_mfma_f32_16x16x32_bf16 v[168:171], a[192:195], a[8:11], v[168:171]
ds_read_b64_tr_b16 a[190:191], v235 offset:33792
v_mfma_f32_16x16x32_bf16 v[168:171], a[196:199], a[28:31], v[168:171]
ds_read_b128 a[200:203], v242 offset:0
s_add_u32 m0, s48, 81920
v_mfma_f32_16x16x32_bf16 v[172:175], a[196:199], a[32:35], v[172:175]
ds_read_b128 a[220:223], v242 offset:1024
buffer_load_dwordx4 v251, s[12:15], s35 offen offset:3072 lds
v_mfma_f32_16x16x32_bf16 v[172:175], a[192:195], a[12:15], v[172:175]
v_mfma_f32_16x16x32_bf16 v[176:179], a[192:195], a[16:19], v[176:179]
ds_read_b128 a[204:207], v242 offset:2048
v_mfma_f32_16x16x32_bf16 v[176:179], a[196:199], a[36:39], v[176:179]
ds_read_b128 a[224:227], v242 offset:3072
v_mfma_f32_16x16x32_bf16 v[180:183], a[240:243], a[0:3], v[180:183]
ds_read_b64_tr_b16 a[192:193], v233 offset:32776
v_mfma_f32_16x16x32_bf16 v[180:183], a[244:247], a[20:23], v[180:183]
ds_read_b64_tr_b16 a[194:195], v233 offset:33800
v_mfma_f32_16x16x32_bf16 v[184:187], a[244:247], a[24:27], v[184:187]
s_add_u32 m0, s48, 98304
s_xor_b32 s35, s43, 2097152
buffer_load_dword v253, v252, s[92:95], 0 offen sc1
v_mfma_f32_16x16x32_bf16 v[184:187], a[240:243], a[4:7], v[184:187]
ds_read_b64_tr_b16 a[196:197], v235 offset:32776
buffer_load_dwordx4 v248, s[12:15], s35 offen offset:0 lds
v_mfma_f32_16x16x32_bf16 v[188:191], a[240:243], a[8:11], v[188:191]
ds_read_b64_tr_b16 a[198:199], v235 offset:33800
v_mfma_f32_16x16x32_bf16 v[188:191], a[244:247], a[28:31], v[188:191]
ds_read_b128 a[208:211], v242 offset:4096
v_mfma_f32_16x16x32_bf16 v[192:195], a[244:247], a[32:35], v[192:195]
ds_read_b128 a[228:231], v242 offset:5120
s_add_u32 m0, s48, 98304
v_mfma_f32_16x16x32_bf16 v[192:195], a[240:243], a[12:15], v[192:195]
buffer_load_dwordx4 v249, s[12:15], s35 offen offset:1024 lds
v_mfma_f32_16x16x32_bf16 v[196:199], a[240:243], a[16:19], v[196:199]
ds_read_b128 a[212:215], v242 offset:6144
v_mfma_f32_16x16x32_bf16 v[196:199], a[244:247], a[36:39], v[196:199]
ds_read_b128 a[232:235], v242 offset:7168
v_mfma_f32_16x16x32_bf16 v[200:203], a[248:251], a[0:3], v[200:203]
ds_read_b64_tr_b16 a[240:241], v234 offset:32768
v_mfma_f32_16x16x32_bf16 v[200:203], a[252:255], a[20:23], v[200:203]
ds_read_b64_tr_b16 a[242:243], v234 offset:33792
s_add_u32 m0, s48, 98304
v_mfma_f32_16x16x32_bf16 v[204:207], a[252:255], a[24:27], v[204:207]
ds_read_b128 a[216:219], v242 offset:8192
buffer_load_dwordx4 v250, s[12:15], s35 offen offset:2048 lds
s_mov_b32 s36, 1
s_mov_b32 s100, 15
v_mfma_f32_16x16x32_bf16 v[204:207], a[248:251], a[4:7], v[204:207]
ds_read_b64_tr_b16 a[244:245], v236 offset:32768
s_waitcnt vmcnt(3)
v_cmp_gt_u32 vcc, 1, v253
v_mfma_f32_16x16x32_bf16 v[208:211], a[248:251], a[8:11], v[208:211]
ds_read_b64_tr_b16 a[246:247], v236 offset:33792
v_mfma_f32_16x16x32_bf16 v[208:211], a[252:255], a[28:31], v[208:211]
ds_read_b128 a[236:239], v242 offset:9216
s_and_b32 s49, vcc_lo, 15
s_cbranch_scc1 L_slow_a
L_back_a:
v_mfma_f32_16x16x32_bf16 v[212:215], a[252:255], a[32:35], v[212:215]
s_add_u32 m0, s48, 98304
v_mfma_f32_16x16x32_bf16 v[212:215], a[248:251], a[12:15], v[212:215]
buffer_load_dwordx4 v251, s[12:15], s35 offen offset:3072 lds
v_mfma_f32_16x16x32_bf16 v[216:219], a[248:251], a[16:19], v[216:219]
v_mfma_f32_16x16x32_bf16 v[216:219], a[252:255], a[36:39], v[216:219]
s_waitcnt lgkmcnt(1)
v_mfma_f32_16x16x32_bf16 v[80:83], a[184:187], a[200:203], v[80:83]
ds_read_b64_tr_b16 a[248:249], v234 offset:32776
v_mfma_f32_16x16x32_bf16 v[80:83], a[188:191], a[220:223], v[80:83]
ds_read_b64_tr_b16 a[250:251], v234 offset:33800
s_add_u32 m0, s39, 0
s_add_u32 s34, s40, 0
v_mfma_f32_16x16x32_bf16 v[84:87], a[188:191], a[224:227], v[84:87]
ds_read_b64_tr_b16 a[252:253], v236 offset:32776
buffer_load_dwordx4 v243, s[8:11], s34 offen offset:0 sc1 lds
v_mfma_f32_16x16x32_bf16 v[84:87], a[184:187], a[204:207], v[84:87]
ds_read_b64_tr_b16 a[254:255], v236 offset:33800
v_mfma_f32_16x16x32_bf16 v[88:91], a[184:187], a[208:211], v[88:91]
v_mov_b32 v246, 2
v_mfma_f32_16x16x32_bf16 v[88:91], a[188:191], a[228:231], v[88:91]
buffer_store_dword v246, v255, s[92:95], 0 offen sc1
v_mfma_f32_16x16x32_bf16 v[92:95], a[188:191], a[232:235], v[92:95]
s_add_u32 m0, s39, 0
v_mfma_f32_16x16x32_bf16 v[92:95], a[184:187], a[212:215], v[92:95]
buffer_load_dwordx4 v243, s[8:11], s34 offen offset:1024 sc1 lds
v_mfma_f32_16x16x32_bf16 v[96:99], a[184:187], a[216:219], v[96:99]
s_waitcnt lgkmcnt(2)
v_mfma_f32_16x16x32_bf16 v[96:99], a[188:191], a[236:239], v[96:99]
s_waitcnt lgkmcnt(0)
s_barrier
v_mfma_f32_16x16x32_bf16 v[100:103], a[192:195], a[200:203], v[100:103]
ds_read_b64_tr_b16 a[184:185], v237 offset:0
v_mfma_f32_16x16x32_bf16 v[100:103], a[196:199], a[220:223], v[100:103]
ds_read_b64_tr_b16 a[186:187], v237 offset:1024
s_add_u32 m0, s48, 114688
s_xor_b32 s35, s43, 2097280
v_mfma_f32_16x16x32_bf16 v[104:107], a[196:199], a[224:227], v[104:107]
buffer_load_dwordx4 v248, s[12:15], s35 offen offset:0 lds
v_mfma_f32_16x16x32_bf16 v[104:107], a[192:195], a[204:207], v[104:107]
ds_read_b64_tr_b16 a[188:189], v239 offset:0
v_mfma_f32_16x16x32_bf16 v[108:111], a[192:195], a[208:211], v[108:111]
ds_read_b64_tr_b16 a[190:191], v239 offset:1024
v_mfma_f32_16x16x32_bf16 v[108:111], a[196:199], a[228:231], v[108:111]
v_mfma_f32_16x16x32_bf16 v[112:115], a[196:199], a[232:235], v[112:115]
s_add_u32 m0, s39, 0
v_mfma_f32_16x16x32_bf16 v[112:115], a[192:195], a[212:215], v[112:115]
buffer_load_dwordx4 v243, s[8:11], s34 offen offset:2048 sc1 lds
v_mfma_f32_16x16x32_bf16 v[116:119], a[192:195], a[216:219], v[116:119]
v_mfma_f32_16x16x32_bf16 v[116:119], a[196:199], a[236:239], v[116:119]
v_mfma_f32_16x16x32_bf16 v[60:63], a[240:243], a[200:203], v[60:63]
ds_read_b64_tr_b16 a[192:193], v237 offset:8
v_mfma_f32_16x16x32_bf16 v[60:63], a[244:247], a[220:223], v[60:63]
ds_read_b64_tr_b16 a[194:195], v237 offset:1032
s_add_u32 m0, s48, 114688
v_mfma_f32_16x16x32_bf16 v[64:67], a[244:247], a[224:227], v[64:67]
buffer_load_dwordx4 v249, s[12:15], s35 offen offset:1024 lds
v_mfma_f32_16x16x32_bf16 v[64:67], a[240:243], a[204:207], v[64:67]
ds_read_b64_tr_b16 a[196:197], v239 offset:8
v_mfma_f32_16x16x32_bf16 v[68:71], a[240:243], a[208:211], v[68:71]
ds_read_b64_tr_b16 a[198:199], v239 offset:1032
v_mfma_f32_16x16x32_bf16 v[68:71], a[244:247], a[228:231], v[68:71]
v_mfma_f32_16x16x32_bf16 v[72:75], a[244:247], a[232:235], v[72:75]
s_add_u32 m0, s48, 114688
v_mfma_f32_16x16x32_bf16 v[72:75], a[240:243], a[212:215], v[72:75]
buffer_load_dwordx4 v250, s[12:15], s35 offen offset:2048 lds
v_mfma_f32_16x16x32_bf16 v[76:79], a[240:243], a[216:219], v[76:79]
v_mfma_f32_16x16x32_bf16 v[76:79], a[244:247], a[236:239], v[76:79]
v_mfma_f32_16x16x32_bf16 v[120:123], a[248:251], a[200:203], v[120:123]
ds_read_b64_tr_b16 a[240:241], v238 offset:0
v_mfma_f32_16x16x32_bf16 v[120:123], a[252:255], a[220:223], v[120:123]
ds_read_b64_tr_b16 a[242:243], v238 offset:1024
s_add_u32 m0, s39, 0
v_mfma_f32_16x16x32_bf16 v[124:127], a[252:255], a[224:227], v[124:127]
buffer_load_dwordx4 v243, s[8:11], s34 offen offset:3072 sc1 lds
v_mfma_f32_16x16x32_bf16 v[124:127], a[248:251], a[204:207], v[124:127]
ds_read_b64_tr_b16 a[244:245], v240 offset:0
v_mfma_f32_16x16x32_bf16 v[128:131], a[248:251], a[208:211], v[128:131]
ds_read_b64_tr_b16 a[246:247], v240 offset:1024
v_mfma_f32_16x16x32_bf16 v[128:131], a[252:255], a[228:231], v[128:131]
v_mfma_f32_16x16x32_bf16 v[132:135], a[252:255], a[232:235], v[132:135]
s_add_u32 m0, s48, 114688
v_mfma_f32_16x16x32_bf16 v[132:135], a[248:251], a[212:215], v[132:135]
buffer_load_dwordx4 v251, s[12:15], s35 offen offset:3072 lds
v_mfma_f32_16x16x32_bf16 v[136:139], a[248:251], a[216:219], v[136:139]
v_mfma_f32_16x16x32_bf16 v[136:139], a[252:255], a[236:239], v[136:139]
s_waitcnt lgkmcnt(4)
v_mfma_f32_16x16x32_bf16 v[140:143], a[184:187], a[200:203], v[140:143]
ds_read_b64_tr_b16 a[248:249], v238 offset:8
v_mfma_f32_16x16x32_bf16 v[140:143], a[188:191], a[220:223], v[140:143]
ds_read_b64_tr_b16 a[250:251], v238 offset:1032
s_add_u32 m0, s39, 4096
v_mfma_f32_16x16x32_bf16 v[144:147], a[188:191], a[224:227], v[144:147]
ds_read_b64_tr_b16 a[252:253], v240 offset:8
buffer_load_dwordx4 v247, s[8:11], s34 offen sc1 lds
v_mfma_f32_16x16x32_bf16 v[144:147], a[184:187], a[204:207], v[144:147]
ds_read_b64_tr_b16 a[254:255], v240 offset:1032
v_mfma_f32_16x16x32_bf16 v[148:151], a[184:187], a[208:211], v[148:151]
v_mfma_f32_16x16x32_bf16 v[148:151], a[188:191], a[228:231], v[148:151]
v_mfma_f32_16x16x32_bf16 v[152:155], a[188:191], a[232:235], v[152:155]
v_mfma_f32_16x16x32_bf16 v[152:155], a[184:187], a[212:215], v[152:155]
v_mfma_f32_16x16x32_bf16 v[156:159], a[184:187], a[216:219], v[156:159]
v_mfma_f32_16x16x32_bf16 v[156:159], a[188:191], a[236:239], v[156:159]
s_waitcnt lgkmcnt(0)
s_barrier
v_mfma_f32_16x16x32_bf16 v[160:163], a[192:195], a[200:203], v[160:163]
ds_read_b64_tr_b16 a[184:185], v237 offset:16384
v_mfma_f32_16x16x32_bf16 v[160:163], a[196:199], a[220:223], v[160:163]
ds_read_b64_tr_b16 a[186:187], v237 offset:17408
s_add_u32 m0, s48, 131072
s_xor_b32 s35, s43, 2162688
v_mfma_f32_16x16x32_bf16 v[164:167], a[196:199], a[224:227], v[164:167]
buffer_load_dwordx4 v248, s[12:15], s35 offen offset:0 lds
v_mfma_f32_16x16x32_bf16 v[164:167], a[192:195], a[204:207], v[164:167]
ds_read_b64_tr_b16 a[188:189], v239 offset:16384
v_mfma_f32_16x16x32_bf16 v[168:171], a[192:195], a[208:211], v[168:171]
ds_read_b64_tr_b16 a[190:191], v239 offset:17408
v_mfma_f32_16x16x32_bf16 v[168:171], a[196:199], a[228:231], v[168:171]
ds_read_b128 a[120:123], v242 offset:20480
v_mfma_f32_16x16x32_bf16 v[172:175], a[196:199], a[232:235], v[172:175]
ds_read_b128 a[140:143], v242 offset:21504
v_mfma_f32_16x16x32_bf16 v[172:175], a[192:195], a[212:215], v[172:175]
v_mfma_f32_16x16x32_bf16 v[176:179], a[192:195], a[216:219], v[176:179]
ds_read_b128 a[124:127], v242 offset:22528
v_mfma_f32_16x16x32_bf16 v[176:179], a[196:199], a[236:239], v[176:179]
ds_read_b128 a[144:147], v242 offset:23552
v_mfma_f32_16x16x32_bf16 v[180:183], a[240:243], a[200:203], v[180:183]
ds_read_b64_tr_b16 a[192:193], v237 offset:16392
v_mfma_f32_16x16x32_bf16 v[180:183], a[244:247], a[220:223], v[180:183]
ds_read_b64_tr_b16 a[194:195], v237 offset:17416
s_add_u32 m0, s48, 131072
v_mfma_f32_16x16x32_bf16 v[184:187], a[244:247], a[224:227], v[184:187]
buffer_load_dwordx4 v249, s[12:15], s35 offen offset:1024 lds
v_mfma_f32_16x16x32_bf16 v[184:187], a[240:243], a[204:207], v[184:187]
ds_read_b64_tr_b16 a[196:197], v239 offset:16392
v_mfma_f32_16x16x32_bf16 v[188:191], a[240:243], a[208:211], v[188:191]
ds_read_b64_tr_b16 a[198:199], v239 offset:17416
v_mfma_f32_16x16x32_bf16 v[188:191], a[244:247], a[228:231], v[188:191]
ds_read_b128 a[128:131], v242 offset:24576
v_mfma_f32_16x16x32_bf16 v[192:195], a[244:247], a[232:235], v[192:195]
ds_read_b128 a[148:151], v242 offset:25600
s_add_u32 m0, s48, 131072
v_mfma_f32_16x16x32_bf16 v[192:195], a[240:243], a[212:215], v[192:195]
buffer_load_dwordx4 v250, s[12:15], s35 offen offset:2048 lds
v_mfma_f32_16x16x32_bf16 v[196:199], a[240:243], a[216:219], v[196:199]
ds_read_b128 a[132:135], v242 offset:26624
v_mfma_f32_16x16x32_bf16 v[196:199], a[244:247], a[236:239], v[196:199]
ds_read_b128 a[152:155], v242 offset:27648
v_mfma_f32_16x16x32_bf16 v[200:203], a[248:251], a[200:203], v[200:203]
ds_read_b64_tr_b16 a[240:241], v238 offset:16384
v_mfma_f32_16x16x32_bf16 v[200:203], a[252:255], a[220:223], v[200:203]
ds_read_b64_tr_b16 a[242:243], v238 offset:17408
v_mfma_f32_16x16x32_bf16 v[204:207], a[252:255], a[224:227], v[204:207]
ds_read_b128 a[136:139], v242 offset:28672
v_mfma_f32_16x16x32_bf16 v[204:207], a[248:251], a[204:207], v[204:207]
ds_read_b64_tr_b16 a[244:245], v240 offset:16384
v_mfma_f32_16x16x32_bf16 v[208:211], a[248:251], a[208:211], v[208:211]
ds_read_b64_tr_b16 a[246:247], v240 offset:17408
v_mfma_f32_16x16x32_bf16 v[208:211], a[252:255], a[228:231], v[208:211]
ds_read_b128 a[156:159], v242 offset:29696
v_mfma_f32_16x16x32_bf16 v[212:215], a[252:255], a[232:235], v[212:215]
s_add_u32 m0, s48, 131072
v_mfma_f32_16x16x32_bf16 v[212:215], a[248:251], a[212:215], v[212:215]
buffer_load_dwordx4 v251, s[12:15], s35 offen offset:3072 lds
v_mfma_f32_16x16x32_bf16 v[216:219], a[248:251], a[216:219], v[216:219]
v_mfma_f32_16x16x32_bf16 v[216:219], a[252:255], a[236:239], v[216:219]
s_waitcnt lgkmcnt(1)
v_mfma_f32_16x16x32_bf16 v[80:83], a[184:187], a[120:123], v[80:83]
ds_read_b64_tr_b16 a[248:249], v238 offset:16392
s_add_u32 s24, s90, 33554432
s_addc_u32 s25, s91, 0
v_mfma_f32_16x16x32_bf16 v[80:83], a[188:191], a[140:143], v[80:83]
ds_read_b64_tr_b16 a[250:251], v238 offset:17416
s_add_u32 m0, s39, 20480
s_add_u32 s34, s40, 20480
v_mfma_f32_16x16x32_bf16 v[84:87], a[188:191], a[144:147], v[84:87]
ds_read_b64_tr_b16 a[252:253], v240 offset:16392
buffer_load_dwordx4 v243, s[8:11], s34 offen offset:0 sc1 lds
s_and_b32 s25, s25, 0xffff
v_mfma_f32_16x16x32_bf16 v[84:87], a[184:187], a[124:127], v[84:87]
ds_read_b64_tr_b16 a[254:255], v240 offset:17416
s_mov_b32 s26, 15728640
s_mov_b32 s27, 0x20000
v_mfma_f32_16x16x32_bf16 v[88:91], a[184:187], a[128:131], v[88:91]
s_add_u32 s16, s4, 0
s_addc_u32 s17, s5, 0
s_and_b32 s17, s17, 0xffff
v_mfma_f32_16x16x32_bf16 v[88:91], a[188:191], a[148:151], v[88:91]
s_mov_b32 s18, 5242880
s_mov_b32 s19, 0x20000
s_mul_i32 s59, s2, 61440
v_mfma_f32_16x16x32_bf16 v[92:95], a[188:191], a[152:155], v[92:95]
s_add_u32 m0, s39, 20480
s_add_u32 s60, s59, 20480
s_add_u32 s61, s59, 40960
v_mfma_f32_16x16x32_bf16 v[92:95], a[184:187], a[132:135], v[92:95]
buffer_load_dwordx4 v243, s[8:11], s34 offen offset:1024 sc1 lds
s_mov_b32 s62, 0x3f80
s_mov_b32 s63, 0x3f800000
v_mfma_f32_16x16x32_bf16 v[96:99], a[184:187], a[136:139], v[96:99]
s_xor_b32 s56, s2, 1
s_mul_i32 s56, s56, 61440
s_add_u32 s56, s56, 0
s_waitcnt lgkmcnt(0)
v_mfma_f32_16x16x32_bf16 v[96:99], a[188:191], a[156:159], v[96:99]
s_barrier
s_xor_b32 s57, s2, 2
v_mfma_f32_16x16x32_bf16 v[100:103], a[192:195], a[120:123], v[100:103]
ds_read_b64_tr_b16 a[184:185], v233 offset:0
s_mul_i32 s57, s57, 61440
s_add_u32 s57, s57, 20480
v_mfma_f32_16x16x32_bf16 v[100:103], a[196:199], a[140:143], v[100:103]
ds_read_b64_tr_b16 a[186:187], v233 offset:1024
s_add_u32 m0, s48, 147456
s_xor_b32 s35, s43, 2162816
v_mfma_f32_16x16x32_bf16 v[104:107], a[196:199], a[144:147], v[104:107]
buffer_load_dwordx4 v248, s[12:15], s35 offen offset:0 lds
s_xor_b32 s58, s2, 3
s_mul_i32 s58, s58, 61440
v_mfma_f32_16x16x32_bf16 v[104:107], a[192:195], a[124:127], v[104:107]
ds_read_b64_tr_b16 a[188:189], v235 offset:0
s_add_u32 s58, s58, 40960
s_mul_i32 s51, s32, 655360
v_mfma_f32_16x16x32_bf16 v[108:111], a[192:195], a[128:131], v[108:111]
ds_read_b64_tr_b16 a[190:191], v235 offset:1024
s_mul_i32 s50, s30, 327680
s_add_u32 s51, s51, s50
v_mfma_f32_16x16x32_bf16 v[108:111], a[196:199], a[148:151], v[108:111]
s_lshl_b32 s50, s31, 11
s_add_u32 s51, s51, s50
s_add_u32 s51, s51, s67
v_mfma_f32_16x16x32_bf16 v[112:115], a[196:199], a[152:155], v[112:115]
s_add_u32 m0, s39, 20480
s_lshl_b32 s50, s29, 8
s_add_u32 s51, s51, s50
v_mfma_f32_16x16x32_bf16 v[112:115], a[192:195], a[132:135], v[112:115]
buffer_load_dwordx4 v243, s[8:11], s34 offen offset:2048 sc1 lds
s_and_b32 s50, s2, 3
s_lshl_b32 s50, s50, 6
v_mfma_f32_16x16x32_bf16 v[116:119], a[192:195], a[136:139], v[116:119]
s_add_u32 s51, s51, s50
v_lshlrev_b32 v231, 12, v228
v_lshl_add_u32 v231, v227, 4, v231
v_mfma_f32_16x16x32_bf16 v[116:119], a[196:199], a[156:159], v[116:119]
v_add_u32 v231, s51, v231
v_mfma_f32_16x16x32_bf16 v[60:63], a[240:243], a[120:123], v[60:63]
ds_read_b64_tr_b16 a[192:193], v233 offset:8
v_mfma_f32_16x16x32_bf16 v[60:63], a[244:247], a[140:143], v[60:63]
ds_read_b64_tr_b16 a[194:195], v233 offset:1032
s_add_u32 m0, s48, 147456
v_mfma_f32_16x16x32_bf16 v[64:67], a[244:247], a[144:147], v[64:67]
buffer_load_dwordx4 v249, s[12:15], s35 offen offset:1024 lds
v_mfma_f32_16x16x32_bf16 v[64:67], a[240:243], a[124:127], v[64:67]
ds_read_b64_tr_b16 a[196:197], v235 offset:8
v_mfma_f32_16x16x32_bf16 v[68:71], a[240:243], a[128:131], v[68:71]
ds_read_b64_tr_b16 a[198:199], v235 offset:1032
v_mfma_f32_16x16x32_bf16 v[68:71], a[244:247], a[148:151], v[68:71]
v_mfma_f32_16x16x32_bf16 v[72:75], a[244:247], a[152:155], v[72:75]
s_add_u32 m0, s48, 147456
v_mfma_f32_16x16x32_bf16 v[72:75], a[240:243], a[132:135], v[72:75]
buffer_load_dwordx4 v250, s[12:15], s35 offen offset:2048 lds
v_mfma_f32_16x16x32_bf16 v[76:79], a[240:243], a[136:139], v[76:79]
v_mfma_f32_16x16x32_bf16 v[76:79], a[244:247], a[156:159], v[76:79]
buffer_load_dword v253, v252, s[92:95], 0 offen sc1
v_mfma_f32_16x16x32_bf16 v[120:123], a[248:251], a[120:123], v[120:123]
ds_read_b64_tr_b16 a[240:241], v234 offset:0
v_mfma_f32_16x16x32_bf16 v[120:123], a[252:255], a[140:143], v[120:123]
ds_read_b64_tr_b16 a[242:243], v234 offset:1024
s_add_u32 m0, s39, 20480
v_mfma_f32_16x16x32_bf16 v[124:127], a[252:255], a[144:147], v[124:127]
buffer_load_dwordx4 v243, s[8:11], s34 offen offset:3072 sc1 lds
v_mfma_f32_16x16x32_bf16 v[124:127], a[248:251], a[124:127], v[124:127]
ds_read_b64_tr_b16 a[244:245], v236 offset:0
v_mfma_f32_16x16x32_bf16 v[128:131], a[248:251], a[128:131], v[128:131]
ds_read_b64_tr_b16 a[246:247], v236 offset:1024
v_mfma_f32_16x16x32_bf16 v[128:131], a[252:255], a[148:151], v[128:131]
v_mfma_f32_16x16x32_bf16 v[132:135], a[252:255], a[152:155], v[132:135]
s_add_u32 m0, s48, 147456
v_mfma_f32_16x16x32_bf16 v[132:135], a[248:251], a[132:135], v[132:135]
buffer_load_dwordx4 v251, s[12:15], s35 offen offset:3072 lds
v_mfma_f32_16x16x32_bf16 v[136:139], a[248:251], a[136:139], v[136:139]
v_mfma_f32_16x16x32_bf16 v[136:139], a[252:255], a[156:159], v[136:139]
s_waitcnt lgkmcnt(4)
v_mfma_f32_16x16x32_bf16 v[140:143], a[184:187], a[120:123], v[140:143]
ds_read_b64_tr_b16 a[248:249], v234 offset:8
v_mfma_f32_16x16x32_bf16 v[140:143], a[188:191], a[140:143], v[140:143]
ds_read_b64_tr_b16 a[250:251], v234 offset:1032
s_add_u32 m0, s39, 24576
v_mfma_f32_16x16x32_bf16 v[144:147], a[188:191], a[144:147], v[144:147]
ds_read_b64_tr_b16 a[252:253], v236 offset:8
buffer_load_dwordx4 v247, s[8:11], s34 offen sc1 lds
v_mfma_f32_16x16x32_bf16 v[144:147], a[184:187], a[124:127], v[144:147]
ds_read_b64_tr_b16 a[254:255], v236 offset:1032
v_mfma_f32_16x16x32_bf16 v[148:151], a[184:187], a[128:131], v[148:151]
v_mfma_f32_16x16x32_bf16 v[148:151], a[188:191], a[148:151], v[148:151]
v_mfma_f32_16x16x32_bf16 v[152:155], a[188:191], a[152:155], v[152:155]
v_mfma_f32_16x16x32_bf16 v[152:155], a[184:187], a[132:135], v[152:155]
v_mfma_f32_16x16x32_bf16 v[156:159], a[184:187], a[136:139], v[156:159]
v_mfma_f32_16x16x32_bf16 v[156:159], a[188:191], a[156:159], v[156:159]
s_waitcnt vmcnt(14) lgkmcnt(0)
s_barrier
v_mfma_f32_16x16x32_bf16 v[160:163], a[192:195], a[120:123], v[160:163]
ds_read_b64_tr_b16 a[184:185], v233 offset:16384
v_mfma_f32_16x16x32_bf16 v[160:163], a[196:199], a[140:143], v[160:163]
ds_read_b64_tr_b16 a[186:187], v233 offset:17408
s_add_u32 m0, s48, 81920
s_xor_b32 s35, s43, 2228224
v_mfma_f32_16x16x32_bf16 v[164:167], a[196:199], a[144:147], v[164:167]
buffer_load_dwordx4 v248, s[12:15], s35 offen offset:0 lds
v_mfma_f32_16x16x32_bf16 v[164:167], a[192:195], a[124:127], v[164:167]
ds_read_b64_tr_b16 a[188:189], v235 offset:16384
v_mfma_f32_16x16x32_bf16 v[168:171], a[192:195], a[128:131], v[168:171]
ds_read_b64_tr_b16 a[190:191], v235 offset:17408
v_mfma_f32_16x16x32_bf16 v[168:171], a[196:199], a[148:151], v[168:171]
ds_read_b128 a[200:203], v241 offset:0
v_mfma_f32_16x16x32_bf16 v[172:175], a[196:199], a[152:155], v[172:175]
ds_read_b128 a[220:223], v241 offset:1024
v_mfma_f32_16x16x32_bf16 v[172:175], a[192:195], a[132:135], v[172:175]
v_mfma_f32_16x16x32_bf16 v[176:179], a[192:195], a[136:139], v[176:179]
ds_read_b128 a[204:207], v241 offset:2048
v_mfma_f32_16x16x32_bf16 v[176:179], a[196:199], a[156:159], v[176:179]
ds_read_b128 a[224:227], v241 offset:3072
v_mfma_f32_16x16x32_bf16 v[180:183], a[240:243], a[120:123], v[180:183]
ds_read_b64_tr_b16 a[192:193], v233 offset:16392
v_mfma_f32_16x16x32_bf16 v[180:183], a[244:247], a[140:143], v[180:183]
ds_read_b64_tr_b16 a[194:195], v233 offset:17416
s_add_u32 m0, s48, 81920
v_mfma_f32_16x16x32_bf16 v[184:187], a[244:247], a[144:147], v[184:187]
buffer_load_dwordx4 v249, s[12:15], s35 offen offset:1024 lds
v_mfma_f32_16x16x32_bf16 v[184:187], a[240:243], a[124:127], v[184:187]
ds_read_b64_tr_b16 a[196:197], v235 offset:16392
v_mfma_f32_16x16x32_bf16 v[188:191], a[240:243], a[128:131], v[188:191]
ds_read_b64_tr_b16 a[198:199], v235 offset:17416
v_mfma_f32_16x16x32_bf16 v[188:191], a[244:247], a[148:151], v[188:191]
ds_read_b128 a[208:211], v241 offset:4096
v_mfma_f32_16x16x32_bf16 v[192:195], a[244:247], a[152:155], v[192:195]
ds_read_b128 a[228:231], v241 offset:5120
s_add_u32 m0, s48, 81920
v_mfma_f32_16x16x32_bf16 v[192:195], a[240:243], a[132:135], v[192:195]
buffer_load_dwordx4 v250, s[12:15], s35 offen offset:2048 lds
v_mfma_f32_16x16x32_bf16 v[196:199], a[240:243], a[136:139], v[196:199]
ds_read_b128 a[212:215], v241 offset:6144
v_mfma_f32_16x16x32_bf16 v[196:199], a[244:247], a[156:159], v[196:199]
ds_read_b128 a[232:235], v241 offset:7168
v_mfma_f32_16x16x32_bf16 v[200:203], a[248:251], a[120:123], v[200:203]
ds_read_b64_tr_b16 a[240:241], v234 offset:16384
s_mov_b32 s36, 2
v_mfma_f32_16x16x32_bf16 v[200:203], a[252:255], a[140:143], v[200:203]
ds_read_b64_tr_b16 a[242:243], v234 offset:17408
v_mfma_f32_16x16x32_bf16 v[204:207], a[252:255], a[144:147], v[204:207]
ds_read_b128 a[216:219], v241 offset:8192
s_waitcnt vmcnt(6)
v_cmp_gt_u32 vcc, 2, v253
v_mfma_f32_16x16x32_bf16 v[204:207], a[248:251], a[124:127], v[204:207]
ds_read_b64_tr_b16 a[244:245], v236 offset:16384
v_mfma_f32_16x16x32_bf16 v[208:211], a[248:251], a[128:131], v[208:211]
ds_read_b64_tr_b16 a[246:247], v236 offset:17408
s_and_b32 s3, vcc_lo, 0xfff
v_mfma_f32_16x16x32_bf16 v[208:211], a[252:255], a[148:151], v[208:211]
ds_read_b128 a[236:239], v241 offset:9216
s_and_b32 s49, s3, s100
s_cbranch_scc1 L_slow_c
L_back_c:
v_mfma_f32_16x16x32_bf16 v[212:215], a[252:255], a[152:155], v[212:215]
s_add_u32 m0, s48, 81920
v_mfma_f32_16x16x32_bf16 v[212:215], a[248:251], a[132:135], v[212:215]
buffer_load_dwordx4 v251, s[12:15], s35 offen offset:3072 lds
v_mfma_f32_16x16x32_bf16 v[216:219], a[248:251], a[136:139], v[216:219]
v_mfma_f32_16x16x32_bf16 v[216:219], a[252:255], a[156:159], v[216:219]
s_waitcnt lgkmcnt(1)
v_mfma_f32_16x16x32_bf16 v[80:83], a[184:187], a[200:203], v[80:83]
ds_read_b64_tr_b16 a[248:249], v234 offset:16392
s_and_b32 s50, s2, 1
v_lshlrev_b32 v229, 1, v227
v_mfma_f32_16x16x32_bf16 v[80:83], a[188:191], a[220:223], v[80:83]
ds_read_b64_tr_b16 a[250:251], v234 offset:17416
s_add_u32 m0, s39, 40960
s_add_u32 s34, s40, 40960
v_mfma_f32_16x16x32_bf16 v[84:87], a[188:191], a[224:227], v[84:87]
ds_read_b64_tr_b16 a[252:253], v236 offset:16392
buffer_load_dwordx4 v243, s[8:11], s34 offen offset:0 sc1 lds
v_xor_b32 v229, v229, v228
v_mfma_f32_16x16x32_bf16 v[84:87], a[184:187], a[204:207], v[84:87]
ds_read_b64_tr_b16 a[254:255], v236 offset:17416
v_lshrrev_b32 v230, 2, v229
v_xor_b32 v230, s50, v230
v_mfma_f32_16x16x32_bf16 v[88:91], a[184:187], a[208:211], v[88:91]
v_and_b32 v229, 3, v229
v_lshlrev_b32 v229, 4, v229
v_mfma_f32_16x16x32_bf16 v[88:91], a[188:191], a[228:231], v[88:91]
v_lshl_add_u32 v229, v227, 11, v229
s_lshl_b32 s50, s30, 14
v_add_u32 v229, s50, v229
v_mfma_f32_16x16x32_bf16 v[92:95], a[188:191], a[232:235], v[92:95]
s_add_u32 m0, s39, 40960
v_and_b32 v221, 1, v230
v_lshl_add_u32 v229, v221, 16, v229
v_mfma_f32_16x16x32_bf16 v[92:95], a[184:187], a[212:215], v[92:95]
buffer_load_dwordx4 v243, s[8:11], s34 offen offset:1024 sc1 lds
v_lshrrev_b32 v230, 1, v230
v_lshl_add_u32 v220, v230, 18, v229
v_mfma_f32_16x16x32_bf16 v[96:99], a[184:187], a[216:219], v[96:99]
v_add_u32 v221, 31744, v220
v_xor_b32 v229, 0x40000, v220
s_waitcnt lgkmcnt(0)
v_mfma_f32_16x16x32_bf16 v[96:99], a[188:191], a[236:239], v[96:99]
s_barrier
v_add_u32 v222, 6144, v229
v_mfma_f32_16x16x32_bf16 v[100:103], a[192:195], a[200:203], v[100:103]
ds_read_b64_tr_b16 a[184:185], v233 offset:32768
v_add_u32 v223, 37888, v229
v_mfma_f32_16x16x32_bf16 v[100:103], a[196:199], a[220:223], v[100:103]
ds_read_b64_tr_b16 a[186:187], v233 offset:33792
s_add_u32 m0, s48, 98304
s_xor_b32 s35, s43, 2228352
v_mfma_f32_16x16x32_bf16 v[104:107], a[196:199], a[224:227], v[104:107]
buffer_load_dwordx4 v248, s[12:15], s35 offen offset:0 lds
v_mfma_f32_16x16x32_bf16 v[104:107], a[192:195], a[204:207], v[104:107]
ds_read_b64_tr_b16 a[188:189], v235 offset:32768
v_mfma_f32_16x16x32_bf16 v[108:111], a[192:195], a[208:211], v[108:111]
ds_read_b64_tr_b16 a[190:191], v235 offset:33792
v_mfma_f32_16x16x32_bf16 v[108:111], a[196:199], a[228:231], v[108:111]
v_mfma_f32_16x16x32_bf16 v[112:115], a[196:199], a[232:235], v[112:115]
s_add_u32 m0, s39, 40960
v_mfma_f32_16x16x32_bf16 v[112:115], a[192:195], a[212:215], v[112:115]
buffer_load_dwordx4 v243, s[8:11], s34 offen offset:2048 sc1 lds
v_mfma_f32_16x16x32_bf16 v[116:119], a[192:195], a[216:219], v[116:119]
v_mfma_f32_16x16x32_bf16 v[116:119], a[196:199], a[236:239], v[116:119]
v_mfma_f32_16x16x32_bf16 v[60:63], a[240:243], a[200:203], v[60:63]
ds_read_b64_tr_b16 a[192:193], v233 offset:32776
v_mfma_f32_16x16x32_bf16 v[60:63], a[244:247], a[220:223], v[60:63]
ds_read_b64_tr_b16 a[194:195], v233 offset:33800
s_add_u32 m0, s48, 98304
v_mfma_f32_16x16x32_bf16 v[64:67], a[244:247], a[224:227], v[64:67]
buffer_load_dwordx4 v249, s[12:15], s35 offen offset:1024 lds
v_mfma_f32_16x16x32_bf16 v[64:67], a[240:243], a[204:207], v[64:67]
ds_read_b64_tr_b16 a[196:197], v235 offset:32776
v_mfma_f32_16x16x32_bf16 v[68:71], a[240:243], a[208:211], v[68:71]
ds_read_b64_tr_b16 a[198:199], v235 offset:33800
v_mfma_f32_16x16x32_bf16 v[68:71], a[244:247], a[228:231], v[68:71]
v_mfma_f32_16x16x32_bf16 v[72:75], a[244:247], a[232:235], v[72:75]
s_add_u32 m0, s48, 98304
v_mfma_f32_16x16x32_bf16 v[72:75], a[240:243], a[212:215], v[72:75]
buffer_load_dwordx4 v250, s[12:15], s35 offen offset:2048 lds
v_mfma_f32_16x16x32_bf16 v[76:79], a[240:243], a[216:219], v[76:79]
v_mfma_f32_16x16x32_bf16 v[76:79], a[244:247], a[236:239], v[76:79]
v_mfma_f32_16x16x32_bf16 v[120:123], a[248:251], a[200:203], v[120:123]
ds_read_b64_tr_b16 a[240:241], v234 offset:32768
v_mfma_f32_16x16x32_bf16 v[120:123], a[252:255], a[220:223], v[120:123]
ds_read_b64_tr_b16 a[242:243], v234 offset:33792
s_add_u32 m0, s39, 40960
v_mfma_f32_16x16x32_bf16 v[124:127], a[252:255], a[224:227], v[124:127]
buffer_load_dwordx4 v243, s[8:11], s34 offen offset:3072 sc1 lds
v_mfma_f32_16x16x32_bf16 v[124:127], a[248:251], a[204:207], v[124:127]
ds_read_b64_tr_b16 a[244:245], v236 offset:32768
v_mfma_f32_16x16x32_bf16 v[128:131], a[248:251], a[208:211], v[128:131]
ds_read_b64_tr_b16 a[246:247], v236 offset:33792
v_mfma_f32_16x16x32_bf16 v[128:131], a[252:255], a[228:231], v[128:131]
v_mfma_f32_16x16x32_bf16 v[132:135], a[252:255], a[232:235], v[132:135]
s_add_u32 m0, s48, 98304
v_mfma_f32_16x16x32_bf16 v[132:135], a[248:251], a[212:215], v[132:135]
buffer_load_dwordx4 v251, s[12:15], s35 offen offset:3072 lds
v_mfma_f32_16x16x32_bf16 v[136:139], a[248:251], a[216:219], v[136:139]
v_mfma_f32_16x16x32_bf16 v[136:139], a[252:255], a[236:239], v[136:139]
s_waitcnt lgkmcnt(4)
v_mfma_f32_16x16x32_bf16 v[140:143], a[184:187], a[200:203], v[140:143]
ds_read_b64_tr_b16 a[248:249], v234 offset:32776
v_mfma_f32_16x16x32_bf16 v[140:143], a[188:191], a[220:223], v[140:143]
ds_read_b64_tr_b16 a[250:251], v234 offset:33800
s_add_u32 m0, s39, 45056
v_mfma_f32_16x16x32_bf16 v[144:147], a[188:191], a[224:227], v[144:147]
ds_read_b64_tr_b16 a[252:253], v236 offset:32776
buffer_load_dwordx4 v247, s[8:11], s34 offen sc1 lds
v_mfma_f32_16x16x32_bf16 v[144:147], a[184:187], a[204:207], v[144:147]
ds_read_b64_tr_b16 a[254:255], v236 offset:33800
v_mfma_f32_16x16x32_bf16 v[148:151], a[184:187], a[208:211], v[148:151]
v_mfma_f32_16x16x32_bf16 v[148:151], a[188:191], a[228:231], v[148:151]
v_mfma_f32_16x16x32_bf16 v[152:155], a[188:191], a[232:235], v[152:155]
v_mfma_f32_16x16x32_bf16 v[152:155], a[184:187], a[212:215], v[152:155]
v_mfma_f32_16x16x32_bf16 v[156:159], a[184:187], a[216:219], v[156:159]
v_mfma_f32_16x16x32_bf16 v[156:159], a[188:191], a[236:239], v[156:159]
s_waitcnt vmcnt(13) lgkmcnt(0)
s_barrier
v_mfma_f32_16x16x32_bf16 v[160:163], a[192:195], a[200:203], v[160:163]
ds_read_b64_tr_b16 a[184:185], v237 offset:0
v_mfma_f32_16x16x32_bf16 v[160:163], a[196:199], a[220:223], v[160:163]
ds_read_b64_tr_b16 a[186:187], v237 offset:1024
s_add_u32 m0, s48, 114688
s_xor_b32 s35, s43, 2293760
v_mfma_f32_16x16x32_bf16 v[164:167], a[196:199], a[224:227], v[164:167]
buffer_load_dwordx4 v248, s[12:15], s35 offen offset:0 lds
v_mfma_f32_16x16x32_bf16 v[164:167], a[192:195], a[204:207], v[164:167]
ds_read_b64_tr_b16 a[188:189], v239 offset:0
v_mfma_f32_16x16x32_bf16 v[168:171], a[192:195], a[208:211], v[168:171]
ds_read_b64_tr_b16 a[190:191], v239 offset:1024
v_mfma_f32_16x16x32_bf16 v[168:171], a[196:199], a[228:231], v[168:171]
ds_read_b128 a[120:123], v241 offset:20480
v_mfma_f32_16x16x32_bf16 v[172:175], a[196:199], a[232:235], v[172:175]
ds_read_b128 a[140:143], v241 offset:21504
s_add_u32 m0, s39, 61440
s_add_u32 s34, s40, 61440
v_mfma_f32_16x16x32_bf16 v[172:175], a[192:195], a[212:215], v[172:175]
buffer_load_dwordx4 v243, s[8:11], s34 offen offset:0 sc1 lds
v_mfma_f32_16x16x32_bf16 v[176:179], a[192:195], a[216:219], v[176:179]
ds_read_b128 a[124:127], v241 offset:22528
v_mfma_f32_16x16x32_bf16 v[176:179], a[196:199], a[236:239], v[176:179]
ds_read_b128 a[144:147], v241 offset:23552
v_mfma_f32_16x16x32_bf16 v[180:183], a[240:243], a[200:203], v[180:183]
ds_read_b64_tr_b16 a[192:193], v237 offset:8
v_mfma_f32_16x16x32_bf16 v[180:183], a[244:247], a[220:223], v[180:183]
ds_read_b64_tr_b16 a[194:195], v237 offset:1032
s_add_u32 m0, s48, 114688
v_mfma_f32_16x16x32_bf16 v[184:187], a[244:247], a[224:227], v[184:187]
buffer_load_dwordx4 v249, s[12:15], s35 offen offset:1024 lds
v_mfma_f32_16x16x32_bf16 v[184:187], a[240:243], a[204:207], v[184:187]
ds_read_b64_tr_b16 a[196:197], v239 offset:8
v_mfma_f32_16x16x32_bf16 v[188:191], a[240:243], a[208:211], v[188:191]
ds_read_b64_tr_b16 a[198:199], v239 offset:1032
v_mfma_f32_16x16x32_bf16 v[188:191], a[244:247], a[228:231], v[188:191]
ds_read_b128 a[128:131], v241 offset:24576
v_mfma_f32_16x16x32_bf16 v[192:195], a[244:247], a[232:235], v[192:195]
ds_read_b128 a[148:151], v241 offset:25600
s_add_u32 m0, s48, 114688
v_mfma_f32_16x16x32_bf16 v[192:195], a[240:243], a[212:215], v[192:195]
buffer_load_dwordx4 v250, s[12:15], s35 offen offset:2048 lds
v_mfma_f32_16x16x32_bf16 v[196:199], a[240:243], a[216:219], v[196:199]
ds_read_b128 a[132:135], v241 offset:26624
v_mfma_f32_16x16x32_bf16 v[196:199], a[244:247], a[236:239], v[196:199]
ds_read_b128 a[152:155], v241 offset:27648
v_mfma_f32_16x16x32_bf16 v[200:203], a[248:251], a[200:203], v[200:203]
ds_read_b64_tr_b16 a[240:241], v238 offset:0
v_mfma_f32_16x16x32_bf16 v[200:203], a[252:255], a[220:223], v[200:203]
ds_read_b64_tr_b16 a[242:243], v238 offset:1024
s_add_u32 m0, s39, 61440
v_mfma_f32_16x16x32_bf16 v[204:207], a[252:255], a[224:227], v[204:207]
ds_read_b128 a[136:139], v241 offset:28672
buffer_load_dwordx4 v243, s[8:11], s34 offen offset:1024 sc1 lds
v_mfma_f32_16x16x32_bf16 v[204:207], a[248:251], a[204:207], v[204:207]
ds_read_b64_tr_b16 a[244:245], v240 offset:0
v_mfma_f32_16x16x32_bf16 v[208:211], a[248:251], a[208:211], v[208:211]
ds_read_b64_tr_b16 a[246:247], v240 offset:1024
s_movk_i32 s100, 240
v_mfma_f32_16x16x32_bf16 v[208:211], a[252:255], a[228:231], v[208:211]
ds_read_b128 a[156:159], v241 offset:29696
s_and_b32 s49, s3, s100
s_cbranch_scc1 L_slow_b
L_back_b:
v_mfma_f32_16x16x32_bf16 v[212:215], a[252:255], a[232:235], v[212:215]
s_add_u32 m0, s48, 114688
v_mfma_f32_16x16x32_bf16 v[212:215], a[248:251], a[212:215], v[212:215]
buffer_load_dwordx4 v251, s[12:15], s35 offen offset:3072 lds
v_mfma_f32_16x16x32_bf16 v[216:219], a[248:251], a[216:219], v[216:219]
v_mfma_f32_16x16x32_bf16 v[216:219], a[252:255], a[236:239], v[216:219]
s_waitcnt lgkmcnt(1)
v_mfma_f32_16x16x32_bf16 v[80:83], a[184:187], a[120:123], v[80:83]
ds_read_b64_tr_b16 a[248:249], v238 offset:8
v_mfma_f32_16x16x32_bf16 v[80:83], a[188:191], a[140:143], v[80:83]
ds_read_b64_tr_b16 a[250:251], v238 offset:1032
s_add_u32 m0, s39, 61440
v_mfma_f32_16x16x32_bf16 v[84:87], a[188:191], a[144:147], v[84:87]
ds_read_b64_tr_b16 a[252:253], v240 offset:8
buffer_load_dwordx4 v243, s[8:11], s34 offen offset:2048 sc1 lds
v_mfma_f32_16x16x32_bf16 v[84:87], a[184:187], a[124:127], v[84:87]
ds_read_b64_tr_b16 a[254:255], v240 offset:1032
v_mfma_f32_16x16x32_bf16 v[88:91], a[184:187], a[128:131], v[88:91]
v_mfma_f32_16x16x32_bf16 v[88:91], a[188:191], a[148:151], v[88:91]
v_mfma_f32_16x16x32_bf16 v[92:95], a[188:191], a[152:155], v[92:95]
s_add_u32 m0, s39, 61440
v_mfma_f32_16x16x32_bf16 v[92:95], a[184:187], a[132:135], v[92:95]
buffer_load_dwordx4 v243, s[8:11], s34 offen offset:3072 sc1 lds
v_mfma_f32_16x16x32_bf16 v[96:99], a[184:187], a[136:139], v[96:99]
s_waitcnt lgkmcnt(2)
v_mfma_f32_16x16x32_bf16 v[96:99], a[188:191], a[156:159], v[96:99]
s_waitcnt lgkmcnt(0)
s_barrier
v_mfma_f32_16x16x32_bf16 v[100:103], a[192:195], a[120:123], v[100:103]
ds_read_b64_tr_b16 a[184:185], v237 offset:16384
v_mfma_f32_16x16x32_bf16 v[100:103], a[196:199], a[140:143], v[100:103]
ds_read_b64_tr_b16 a[186:187], v237 offset:17408
s_add_u32 m0, s48, 131072
s_xor_b32 s35, s43, 2293888
v_mfma_f32_16x16x32_bf16 v[104:107], a[196:199], a[144:147], v[104:107]
buffer_load_dwordx4 v248, s[12:15], s35 offen offset:0 lds
v_mfma_f32_16x16x32_bf16 v[104:107], a[192:195], a[124:127], v[104:107]
ds_read_b64_tr_b16 a[188:189], v239 offset:16384
v_mfma_f32_16x16x32_bf16 v[108:111], a[192:195], a[128:131], v[108:111]
ds_read_b64_tr_b16 a[190:191], v239 offset:17408
v_mfma_f32_16x16x32_bf16 v[108:111], a[196:199], a[148:151], v[108:111]
v_mfma_f32_16x16x32_bf16 v[112:115], a[196:199], a[152:155], v[112:115]
s_add_u32 m0, s39, 65536
v_mfma_f32_16x16x32_bf16 v[112:115], a[192:195], a[132:135], v[112:115]
buffer_load_dwordx4 v247, s[8:11], s34 offen sc1 lds
v_mfma_f32_16x16x32_bf16 v[116:119], a[192:195], a[136:139], v[116:119]
v_mfma_f32_16x16x32_bf16 v[116:119], a[196:199], a[156:159], v[116:119]
v_mfma_f32_16x16x32_bf16 v[60:63], a[240:243], a[120:123], v[60:63]
ds_read_b64_tr_b16 a[192:193], v237 offset:16392
v_mfma_f32_16x16x32_bf16 v[60:63], a[244:247], a[140:143], v[60:63]
ds_read_b64_tr_b16 a[194:195], v237 offset:17416
s_add_u32 m0, s48, 131072
v_mfma_f32_16x16x32_bf16 v[64:67], a[244:247], a[144:147], v[64:67]
buffer_load_dwordx4 v249, s[12:15], s35 offen offset:1024 lds
v_mfma_f32_16x16x32_bf16 v[64:67], a[240:243], a[124:127], v[64:67]
ds_read_b64_tr_b16 a[196:197], v239 offset:16392
v_mfma_f32_16x16x32_bf16 v[68:71], a[240:243], a[128:131], v[68:71]
ds_read_b64_tr_b16 a[198:199], v239 offset:17416
v_mfma_f32_16x16x32_bf16 v[68:71], a[244:247], a[148:151], v[68:71]
v_mfma_f32_16x16x32_bf16 v[72:75], a[244:247], a[152:155], v[72:75]
s_add_u32 m0, s48, 131072
v_mfma_f32_16x16x32_bf16 v[72:75], a[240:243], a[132:135], v[72:75]
buffer_load_dwordx4 v250, s[12:15], s35 offen offset:2048 lds
v_mfma_f32_16x16x32_bf16 v[76:79], a[240:243], a[136:139], v[76:79]
v_mfma_f32_16x16x32_bf16 v[76:79], a[244:247], a[156:159], v[76:79]
v_mfma_f32_16x16x32_bf16 v[120:123], a[248:251], a[120:123], v[120:123]
ds_read_b64_tr_b16 a[240:241], v238 offset:16384
v_mfma_f32_16x16x32_bf16 v[120:123], a[252:255], a[140:143], v[120:123]
ds_read_b64_tr_b16 a[242:243], v238 offset:17408
v_mfma_f32_16x16x32_bf16 v[124:127], a[252:255], a[144:147], v[124:127]
v_mfma_f32_16x16x32_bf16 v[124:127], a[248:251], a[124:127], v[124:127]
ds_read_b64_tr_b16 a[244:245], v240 offset:16384
v_mfma_f32_16x16x32_bf16 v[128:131], a[248:251], a[128:131], v[128:131]
ds_read_b64_tr_b16 a[246:247], v240 offset:17408
v_mfma_f32_16x16x32_bf16 v[128:131], a[252:255], a[148:151], v[128:131]
v_mfma_f32_16x16x32_bf16 v[132:135], a[252:255], a[152:155], v[132:135]
s_add_u32 m0, s48, 131072
v_mfma_f32_16x16x32_bf16 v[132:135], a[248:251], a[132:135], v[132:135]
buffer_load_dwordx4 v251, s[12:15], s35 offen offset:3072 lds
v_mfma_f32_16x16x32_bf16 v[136:139], a[248:251], a[136:139], v[136:139]
v_mfma_f32_16x16x32_bf16 v[136:139], a[252:255], a[156:159], v[136:139]
s_waitcnt lgkmcnt(4)
v_mfma_f32_16x16x32_bf16 v[140:143], a[184:187], a[120:123], v[140:143]
ds_read_b64_tr_b16 a[248:249], v238 offset:16392
v_mfma_f32_16x16x32_bf16 v[140:143], a[188:191], a[140:143], v[140:143]
ds_read_b64_tr_b16 a[250:251], v238 offset:17416
v_mfma_f32_16x16x32_bf16 v[144:147], a[188:191], a[144:147], v[144:147]
ds_read_b64_tr_b16 a[252:253], v240 offset:16392
v_mfma_f32_16x16x32_bf16 v[144:147], a[184:187], a[124:127], v[144:147]
ds_read_b64_tr_b16 a[254:255], v240 offset:17416
v_mfma_f32_16x16x32_bf16 v[148:151], a[184:187], a[128:131], v[148:151]
v_mfma_f32_16x16x32_bf16 v[148:151], a[188:191], a[148:151], v[148:151]
v_mfma_f32_16x16x32_bf16 v[152:155], a[188:191], a[152:155], v[152:155]
v_mfma_f32_16x16x32_bf16 v[152:155], a[184:187], a[132:135], v[152:155]
v_mfma_f32_16x16x32_bf16 v[156:159], a[184:187], a[136:139], v[156:159]
v_mfma_f32_16x16x32_bf16 v[156:159], a[188:191], a[156:159], v[156:159]
s_waitcnt vmcnt(13) lgkmcnt(0)
s_barrier
v_mfma_f32_16x16x32_bf16 v[160:163], a[192:195], a[120:123], v[160:163]
ds_read_b64_tr_b16 a[184:185], v233 offset:0
v_mfma_f32_16x16x32_bf16 v[160:163], a[196:199], a[140:143], v[160:163]
ds_read_b64_tr_b16 a[186:187], v233 offset:1024
s_add_u32 m0, s48, 147456
s_xor_b32 s35, s43, 4194304
v_mfma_f32_16x16x32_bf16 v[164:167], a[196:199], a[144:147], v[164:167]
buffer_load_dwordx4 v248, s[12:15], s35 offen offset:0 lds
v_mfma_f32_16x16x32_bf16 v[164:167], a[192:195], a[124:127], v[164:167]
ds_read_b64_tr_b16 a[188:189], v235 offset:0
v_mfma_f32_16x16x32_bf16 v[168:171], a[192:195], a[128:131], v[168:171]
ds_read_b64_tr_b16 a[190:191], v235 offset:1024
v_mfma_f32_16x16x32_bf16 v[168:171], a[196:199], a[148:151], v[168:171]
ds_read_b128 a[200:203], v242 offset:0
v_mfma_f32_16x16x32_bf16 v[172:175], a[196:199], a[152:155], v[172:175]
ds_read_b128 a[220:223], v242 offset:1024
s_add_u32 m0, s39, 0
s_add_u32 s34, s41, 0
v_mfma_f32_16x16x32_bf16 v[172:175], a[192:195], a[132:135], v[172:175]
buffer_load_dwordx4 v243, s[8:11], s34 offen offset:0 sc1 lds
v_mfma_f32_16x16x32_bf16 v[176:179], a[192:195], a[136:139], v[176:179]
ds_read_b128 a[204:207], v242 offset:2048
v_mfma_f32_16x16x32_bf16 v[176:179], a[196:199], a[156:159], v[176:179]
ds_read_b128 a[224:227], v242 offset:3072
v_mfma_f32_16x16x32_bf16 v[180:183], a[240:243], a[120:123], v[180:183]
ds_read_b64_tr_b16 a[192:193], v233 offset:8
v_mfma_f32_16x16x32_bf16 v[180:183], a[244:247], a[140:143], v[180:183]
ds_read_b64_tr_b16 a[194:195], v233 offset:1032
s_add_u32 m0, s48, 147456
v_mfma_f32_16x16x32_bf16 v[184:187], a[244:247], a[144:147], v[184:187]
buffer_load_dwordx4 v249, s[12:15], s35 offen offset:1024 lds
v_mfma_f32_16x16x32_bf16 v[184:187], a[240:243], a[124:127], v[184:187]
ds_read_b64_tr_b16 a[196:197], v235 offset:8
v_mfma_f32_16x16x32_bf16 v[188:191], a[240:243], a[128:131], v[188:191]
ds_read_b64_tr_b16 a[198:199], v235 offset:1032
v_mfma_f32_16x16x32_bf16 v[188:191], a[244:247], a[148:151], v[188:191]
ds_read_b128 a[208:211], v242 offset:4096
v_mfma_f32_16x16x32_bf16 v[192:195], a[244:247], a[152:155], v[192:195]
ds_read_b128 a[228:231], v242 offset:5120
s_add_u32 m0, s48, 147456
v_mfma_f32_16x16x32_bf16 v[192:195], a[240:243], a[132:135], v[192:195]
buffer_load_dwordx4 v250, s[12:15], s35 offen offset:2048 lds
v_mfma_f32_16x16x32_bf16 v[196:199], a[240:243], a[136:139], v[196:199]
ds_read_b128 a[212:215], v242 offset:6144
v_mfma_f32_16x16x32_bf16 v[196:199], a[244:247], a[156:159], v[196:199]
ds_read_b128 a[232:235], v242 offset:7168
v_mfma_f32_16x16x32_bf16 v[200:203], a[248:251], a[120:123], v[200:203]
ds_read_b64_tr_b16 a[240:241], v234 offset:0
v_mfma_f32_16x16x32_bf16 v[200:203], a[252:255], a[140:143], v[200:203]
ds_read_b64_tr_b16 a[242:243], v234 offset:1024
s_add_u32 m0, s39, 0
v_mfma_f32_16x16x32_bf16 v[204:207], a[252:255], a[144:147], v[204:207]
ds_read_b128 a[216:219], v242 offset:8192
buffer_load_dwordx4 v243, s[8:11], s34 offen offset:1024 sc1 lds
v_mfma_f32_16x16x32_bf16 v[204:207], a[248:251], a[124:127], v[204:207]
ds_read_b64_tr_b16 a[244:245], v236 offset:0
v_mfma_f32_16x16x32_bf16 v[208:211], a[248:251], a[128:131], v[208:211]
ds_read_b64_tr_b16 a[246:247], v236 offset:1024
v_mfma_f32_16x16x32_bf16 v[208:211], a[252:255], a[148:151], v[208:211]
ds_read_b128 a[236:239], v242 offset:9216
v_mfma_f32_16x16x32_bf16 v[212:215], a[252:255], a[152:155], v[212:215]
s_add_u32 m0, s48, 147456
v_mfma_f32_16x16x32_bf16 v[212:215], a[248:251], a[132:135], v[212:215]
buffer_load_dwordx4 v251, s[12:15], s35 offen offset:3072 lds
v_mfma_f32_16x16x32_bf16 v[216:219], a[248:251], a[136:139], v[216:219]
v_mfma_f32_16x16x32_bf16 v[216:219], a[252:255], a[156:159], v[216:219]
s_waitcnt lgkmcnt(1)
v_mfma_f32_16x16x32_bf16 v[80:83], a[184:187], a[200:203], v[80:83]
ds_read_b64_tr_b16 a[248:249], v234 offset:8
v_mfma_f32_16x16x32_bf16 v[80:83], a[188:191], a[220:223], v[80:83]
ds_read_b64_tr_b16 a[250:251], v234 offset:1032
s_add_u32 m0, s39, 0
v_mfma_f32_16x16x32_bf16 v[84:87], a[188:191], a[224:227], v[84:87]
ds_read_b64_tr_b16 a[252:253], v236 offset:8
buffer_load_dwordx4 v243, s[8:11], s34 offen offset:2048 sc1 lds
v_mfma_f32_16x16x32_bf16 v[84:87], a[184:187], a[204:207], v[84:87]
ds_read_b64_tr_b16 a[254:255], v236 offset:1032
v_mfma_f32_16x16x32_bf16 v[88:91], a[184:187], a[208:211], v[88:91]
v_mfma_f32_16x16x32_bf16 v[88:91], a[188:191], a[228:231], v[88:91]
v_mfma_f32_16x16x32_bf16 v[92:95], a[188:191], a[232:235], v[92:95]
s_add_u32 m0, s39, 0
v_mfma_f32_16x16x32_bf16 v[92:95], a[184:187], a[212:215], v[92:95]
buffer_load_dwordx4 v243, s[8:11], s34 offen offset:3072 sc1 lds
v_mfma_f32_16x16x32_bf16 v[96:99], a[184:187], a[216:219], v[96:99]
s_waitcnt lgkmcnt(2)
v_mfma_f32_16x16x32_bf16 v[96:99], a[188:191], a[236:239], v[96:99]
s_waitcnt lgkmcnt(0)
s_barrier
v_mfma_f32_16x16x32_bf16 v[100:103], a[192:195], a[200:203], v[100:103]
ds_read_b64_tr_b16 a[184:185], v233 offset:16384
v_mfma_f32_16x16x32_bf16 v[100:103], a[196:199], a[220:223], v[100:103]
ds_read_b64_tr_b16 a[186:187], v233 offset:17408
s_add_u32 m0, s48, 81920
s_xor_b32 s35, s43, 4194432
v_mfma_f32_16x16x32_bf16 v[104:107], a[196:199], a[224:227], v[104:107]
buffer_load_dwordx4 v248, s[12:15], s35 offen offset:0 lds
v_mfma_f32_16x16x32_bf16 v[104:107], a[192:195], a[204:207], v[104:107]
ds_read_b64_tr_b16 a[188:189], v235 offset:16384
v_mfma_f32_16x16x32_bf16 v[108:111], a[192:195], a[208:211], v[108:111]
ds_read_b64_tr_b16 a[190:191], v235 offset:17408
v_mfma_f32_16x16x32_bf16 v[108:111], a[196:199], a[228:231], v[108:111]
v_mfma_f32_16x16x32_bf16 v[112:115], a[196:199], a[232:235], v[112:115]
s_add_u32 m0, s39, 4096
v_mfma_f32_16x16x32_bf16 v[112:115], a[192:195], a[212:215], v[112:115]
buffer_load_dwordx4 v247, s[8:11], s34 offen sc1 lds
v_mfma_f32_16x16x32_bf16 v[116:119], a[192:195], a[216:219], v[116:119]
v_mfma_f32_16x16x32_bf16 v[116:119], a[196:199], a[236:239], v[116:119]
v_mfma_f32_16x16x32_bf16 v[60:63], a[240:243], a[200:203], v[60:63]
ds_read_b64_tr_b16 a[192:193], v233 offset:16392
v_mfma_f32_16x16x32_bf16 v[60:63], a[244:247], a[220:223], v[60:63]
ds_read_b64_tr_b16 a[194:195], v233 offset:17416
s_add_u32 m0, s48, 81920
v_mfma_f32_16x16x32_bf16 v[64:67], a[244:247], a[224:227], v[64:67]
buffer_load_dwordx4 v249, s[12:15], s35 offen offset:1024 lds
v_mfma_f32_16x16x32_bf16 v[64:67], a[240:243], a[204:207], v[64:67]
ds_read_b64_tr_b16 a[196:197], v235 offset:16392
v_mfma_f32_16x16x32_bf16 v[68:71], a[240:243], a[208:211], v[68:71]
ds_read_b64_tr_b16 a[198:199], v235 offset:17416
v_mfma_f32_16x16x32_bf16 v[68:71], a[244:247], a[228:231], v[68:71]
v_mfma_f32_16x16x32_bf16 v[72:75], a[244:247], a[232:235], v[72:75]
s_add_u32 m0, s48, 81920
v_mfma_f32_16x16x32_bf16 v[72:75], a[240:243], a[212:215], v[72:75]
buffer_load_dwordx4 v250, s[12:15], s35 offen offset:2048 lds
v_mfma_f32_16x16x32_bf16 v[76:79], a[240:243], a[216:219], v[76:79]
v_mfma_f32_16x16x32_bf16 v[76:79], a[244:247], a[236:239], v[76:79]
v_mfma_f32_16x16x32_bf16 v[120:123], a[248:251], a[200:203], v[120:123]
ds_read_b64_tr_b16 a[240:241], v234 offset:16384
v_mfma_f32_16x16x32_bf16 v[120:123], a[252:255], a[220:223], v[120:123]
ds_read_b64_tr_b16 a[242:243], v234 offset:17408
v_mfma_f32_16x16x32_bf16 v[124:127], a[252:255], a[224:227], v[124:127]
v_mfma_f32_16x16x32_bf16 v[124:127], a[248:251], a[204:207], v[124:127]
ds_read_b64_tr_b16 a[244:245], v236 offset:16384
v_mfma_f32_16x16x32_bf16 v[128:131], a[248:251], a[208:211], v[128:131]
ds_read_b64_tr_b16 a[246:247], v236 offset:17408
v_mfma_f32_16x16x32_bf16 v[128:131], a[252:255], a[228:231], v[128:131]
v_mfma_f32_16x16x32_bf16 v[132:135], a[252:255], a[232:235], v[132:135]
s_add_u32 m0, s48, 81920
v_mfma_f32_16x16x32_bf16 v[132:135], a[248:251], a[212:215], v[132:135]
buffer_load_dwordx4 v251, s[12:15], s35 offen offset:3072 lds
v_mfma_f32_16x16x32_bf16 v[136:139], a[248:251], a[216:219], v[136:139]
v_mfma_f32_16x16x32_bf16 v[136:139], a[252:255], a[236:239], v[136:139]
s_waitcnt lgkmcnt(4)
v_mfma_f32_16x16x32_bf16 v[140:143], a[184:187], a[200:203], v[140:143]
ds_read_b64_tr_b16 a[248:249], v234 offset:16392
v_mfma_f32_16x16x32_bf16 v[140:143], a[188:191], a[220:223], v[140:143]
ds_read_b64_tr_b16 a[250:251], v234 offset:17416
v_mfma_f32_16x16x32_bf16 v[144:147], a[188:191], a[224:227], v[144:147]
ds_read_b64_tr_b16 a[252:253], v236 offset:16392
v_mfma_f32_16x16x32_bf16 v[144:147], a[184:187], a[204:207], v[144:147]
ds_read_b64_tr_b16 a[254:255], v236 offset:17416
v_mfma_f32_16x16x32_bf16 v[148:151], a[184:187], a[208:211], v[148:151]
v_mfma_f32_16x16x32_bf16 v[148:151], a[188:191], a[228:231], v[148:151]
v_mfma_f32_16x16x32_bf16 v[152:155], a[188:191], a[232:235], v[152:155]
v_mfma_f32_16x16x32_bf16 v[152:155], a[184:187], a[212:215], v[152:155]
v_mfma_f32_16x16x32_bf16 v[156:159], a[184:187], a[216:219], v[156:159]
v_mfma_f32_16x16x32_bf16 v[156:159], a[188:191], a[236:239], v[156:159]
s_waitcnt vmcnt(16) lgkmcnt(0)
s_barrier
v_mfma_f32_16x16x32_bf16 v[160:163], a[192:195], a[200:203], v[160:163]
ds_read_b64_tr_b16 a[184:185], v233 offset:32768
v_mfma_f32_16x16x32_bf16 v[160:163], a[196:199], a[220:223], v[160:163]
ds_read_b64_tr_b16 a[186:187], v233 offset:33792
s_add_u32 m0, s48, 98304
s_xor_b32 s35, s43, 4259840
v_mfma_f32_16x16x32_bf16 v[164:167], a[196:199], a[224:227], v[164:167]
buffer_load_dwordx4 v248, s[12:15], s35 offen offset:0 lds
v_mfma_f32_16x16x32_bf16 v[164:167], a[192:195], a[204:207], v[164:167]
ds_read_b64_tr_b16 a[188:189], v235 offset:32768
v_mfma_f32_16x16x32_bf16 v[168:171], a[192:195], a[208:211], v[168:171]
ds_read_b64_tr_b16 a[190:191], v235 offset:33792
v_mfma_f32_16x16x32_bf16 v[168:171], a[196:199], a[228:231], v[168:171]
ds_read_b128 a[120:123], v242 offset:20480
v_mfma_f32_16x16x32_bf16 v[172:175], a[196:199], a[232:235], v[172:175]
ds_read_b128 a[140:143], v242 offset:21504
s_add_u32 m0, s39, 20480
s_add_u32 s34, s41, 20480
v_mfma_f32_16x16x32_bf16 v[172:175], a[192:195], a[212:215], v[172:175]
buffer_load_dwordx4 v243, s[8:11], s34 offen offset:0 sc1 lds
v_mfma_f32_16x16x32_bf16 v[176:179], a[192:195], a[216:219], v[176:179]
ds_read_b128 a[124:127], v242 offset:22528
v_mfma_f32_16x16x32_bf16 v[176:179], a[196:199], a[236:239], v[176:179]
ds_read_b128 a[144:147], v242 offset:23552
v_mfma_f32_16x16x32_bf16 v[180:183], a[240:243], a[200:203], v[180:183]
ds_read_b64_tr_b16 a[192:193], v233 offset:32776
v_mfma_f32_16x16x32_bf16 v[180:183], a[244:247], a[220:223], v[180:183]
ds_read_b64_tr_b16 a[194:195], v233 offset:33800
s_add_u32 m0, s48, 98304
v_mfma_f32_16x16x32_bf16 v[184:187], a[244:247], a[224:227], v[184:187]
buffer_load_dwordx4 v249, s[12:15], s35 offen offset:1024 lds
v_mfma_f32_16x16x32_bf16 v[184:187], a[240:243], a[204:207], v[184:187]
ds_read_b64_tr_b16 a[196:197], v235 offset:32776
v_mfma_f32_16x16x32_bf16 v[188:191], a[240:243], a[208:211], v[188:191]
ds_read_b64_tr_b16 a[198:199], v235 offset:33800
v_mfma_f32_16x16x32_bf16 v[188:191], a[244:247], a[228:231], v[188:191]
ds_read_b128 a[128:131], v242 offset:24576
v_mfma_f32_16x16x32_bf16 v[192:195], a[244:247], a[232:235], v[192:195]
ds_read_b128 a[148:151], v242 offset:25600
s_add_u32 m0, s48, 98304
v_mfma_f32_16x16x32_bf16 v[192:195], a[240:243], a[212:215], v[192:195]
buffer_load_dwordx4 v250, s[12:15], s35 offen offset:2048 lds
v_mfma_f32_16x16x32_bf16 v[196:199], a[240:243], a[216:219], v[196:199]
ds_read_b128 a[132:135], v242 offset:26624
v_mfma_f32_16x16x32_bf16 v[196:199], a[244:247], a[236:239], v[196:199]
ds_read_b128 a[152:155], v242 offset:27648
v_mfma_f32_16x16x32_bf16 v[200:203], a[248:251], a[200:203], v[200:203]
ds_read_b64_tr_b16 a[240:241], v234 offset:32768
v_mfma_f32_16x16x32_bf16 v[200:203], a[252:255], a[220:223], v[200:203]
ds_read_b64_tr_b16 a[242:243], v234 offset:33792
s_add_u32 m0, s39, 20480
v_mfma_f32_16x16x32_bf16 v[204:207], a[252:255], a[224:227], v[204:207]
ds_read_b128 a[136:139], v242 offset:28672
buffer_load_dwordx4 v243, s[8:11], s34 offen offset:1024 sc1 lds
v_mfma_f32_16x16x32_bf16 v[204:207], a[248:251], a[204:207], v[204:207]
ds_read_b64_tr_b16 a[244:245], v236 offset:32768
v_mfma_f32_16x16x32_bf16 v[208:211], a[248:251], a[208:211], v[208:211]
ds_read_b64_tr_b16 a[246:247], v236 offset:33792
v_mfma_f32_16x16x32_bf16 v[208:211], a[252:255], a[228:231], v[208:211]
ds_read_b128 a[156:159], v242 offset:29696
v_mfma_f32_16x16x32_bf16 v[212:215], a[252:255], a[232:235], v[212:215]
s_add_u32 m0, s48, 98304
v_mfma_f32_16x16x32_bf16 v[212:215], a[248:251], a[212:215], v[212:215]
buffer_load_dwordx4 v251, s[12:15], s35 offen offset:3072 lds
v_mfma_f32_16x16x32_bf16 v[216:219], a[248:251], a[216:219], v[216:219]
v_mfma_f32_16x16x32_bf16 v[216:219], a[252:255], a[236:239], v[216:219]
s_waitcnt lgkmcnt(1)
v_mfma_f32_16x16x32_bf16 v[80:83], a[184:187], a[120:123], v[80:83]
ds_read_b64_tr_b16 a[248:249], v234 offset:32776
v_mfma_f32_16x16x32_bf16 v[80:83], a[188:191], a[140:143], v[80:83]
ds_read_b64_tr_b16 a[250:251], v234 offset:33800
s_add_u32 m0, s39, 20480
v_mfma_f32_16x16x32_bf16 v[84:87], a[188:191], a[144:147], v[84:87]
ds_read_b64_tr_b16 a[252:253], v236 offset:32776
buffer_load_dwordx4 v243, s[8:11], s34 offen offset:2048 sc1 lds
v_mfma_f32_16x16x32_bf16 v[84:87], a[184:187], a[124:127], v[84:87]
ds_read_b64_tr_b16 a[254:255], v236 offset:33800
v_mfma_f32_16x16x32_bf16 v[88:91], a[184:187], a[128:131], v[88:91]
v_mfma_f32_16x16x32_bf16 v[88:91], a[188:191], a[148:151], v[88:91]
v_mfma_f32_16x16x32_bf16 v[92:95], a[188:191], a[152:155], v[92:95]
s_add_u32 m0, s39, 20480
v_mfma_f32_16x16x32_bf16 v[92:95], a[184:187], a[132:135], v[92:95]
buffer_load_dwordx4 v243, s[8:11], s34 offen offset:3072 sc1 lds
v_mfma_f32_16x16x32_bf16 v[96:99], a[184:187], a[136:139], v[96:99]
s_waitcnt lgkmcnt(2)
v_mfma_f32_16x16x32_bf16 v[96:99], a[188:191], a[156:159], v[96:99]
s_waitcnt vmcnt(21) lgkmcnt(0)
s_barrier
v_mfma_f32_16x16x32_bf16 v[100:103], a[192:195], a[120:123], v[100:103]
ds_read_b64_tr_b16 a[184:185], v237 offset:0
v_mfma_f32_16x16x32_bf16 v[100:103], a[196:199], a[140:143], v[100:103]
ds_read_b64_tr_b16 a[186:187], v237 offset:1024
s_add_u32 m0, s48, 114688
s_xor_b32 s35, s43, 4259968
v_mfma_f32_16x16x32_bf16 v[104:107], a[196:199], a[144:147], v[104:107]
buffer_load_dwordx4 v248, s[12:15], s35 offen offset:0 lds
v_mfma_f32_16x16x32_bf16 v[104:107], a[192:195], a[124:127], v[104:107]
ds_read_b64_tr_b16 a[188:189], v239 offset:0
v_mfma_f32_16x16x32_bf16 v[108:111], a[192:195], a[128:131], v[108:111]
ds_read_b64_tr_b16 a[190:191], v239 offset:1024
v_mfma_f32_16x16x32_bf16 v[108:111], a[196:199], a[148:151], v[108:111]
v_mfma_f32_16x16x32_bf16 v[112:115], a[196:199], a[152:155], v[112:115]
s_add_u32 m0, s39, 24576
v_mfma_f32_16x16x32_bf16 v[112:115], a[192:195], a[132:135], v[112:115]
buffer_load_dwordx4 v247, s[8:11], s34 offen sc1 lds
v_mfma_f32_16x16x32_bf16 v[116:119], a[192:195], a[136:139], v[116:119]
v_mfma_f32_16x16x32_bf16 v[116:119], a[196:199], a[156:159], v[116:119]
v_mfma_f32_16x16x32_bf16 v[60:63], a[240:243], a[120:123], v[60:63]
ds_read_b64_tr_b16 a[192:193], v237 offset:8
v_mfma_f32_16x16x32_bf16 v[60:63], a[244:247], a[140:143], v[60:63]
ds_read_b64_tr_b16 a[194:195], v237 offset:1032
s_add_u32 m0, s48, 114688
v_mfma_f32_16x16x32_bf16 v[64:67], a[244:247], a[144:147], v[64:67]
buffer_load_dwordx4 v249, s[12:15], s35 offen offset:1024 lds
v_mfma_f32_16x16x32_bf16 v[64:67], a[240:243], a[124:127], v[64:67]
ds_read_b64_tr_b16 a[196:197], v239 offset:8
v_mfma_f32_16x16x32_bf16 v[68:71], a[240:243], a[128:131], v[68:71]
ds_read_b64_tr_b16 a[198:199], v239 offset:1032
v_mfma_f32_16x16x32_bf16 v[68:71], a[244:247], a[148:151], v[68:71]
v_mfma_f32_16x16x32_bf16 v[72:75], a[244:247], a[152:155], v[72:75]
s_add_u32 m0, s48, 114688
v_mfma_f32_16x16x32_bf16 v[72:75], a[240:243], a[132:135], v[72:75]
buffer_load_dwordx4 v250, s[12:15], s35 offen offset:2048 lds
v_mfma_f32_16x16x32_bf16 v[76:79], a[240:243], a[136:139], v[76:79]
v_mfma_f32_16x16x32_bf16 v[76:79], a[244:247], a[156:159], v[76:79]
v_mfma_f32_16x16x32_bf16 v[120:123], a[248:251], a[120:123], v[120:123]
ds_read_b64_tr_b16 a[240:241], v238 offset:0
v_mfma_f32_16x16x32_bf16 v[120:123], a[252:255], a[140:143], v[120:123]
ds_read_b64_tr_b16 a[242:243], v238 offset:1024
s_add_u32 m0, s39, 40960
s_add_u32 s34, s41, 40960
v_mfma_f32_16x16x32_bf16 v[124:127], a[252:255], a[144:147], v[124:127]
buffer_load_dwordx4 v243, s[8:11], s34 offen offset:0 sc1 lds
v_mfma_f32_16x16x32_bf16 v[124:127], a[248:251], a[124:127], v[124:127]
ds_read_b64_tr_b16 a[244:245], v240 offset:0
v_mfma_f32_16x16x32_bf16 v[128:131], a[248:251], a[128:131], v[128:131]
ds_read_b64_tr_b16 a[246:247], v240 offset:1024
v_mfma_f32_16x16x32_bf16 v[128:131], a[252:255], a[148:151], v[128:131]
v_mfma_f32_16x16x32_bf16 v[132:135], a[252:255], a[152:155], v[132:135]
s_add_u32 m0, s48, 114688
v_mfma_f32_16x16x32_bf16 v[132:135], a[248:251], a[132:135], v[132:135]
buffer_load_dwordx4 v251, s[12:15], s35 offen offset:3072 lds
v_mfma_f32_16x16x32_bf16 v[136:139], a[248:251], a[136:139], v[136:139]
v_mfma_f32_16x16x32_bf16 v[136:139], a[252:255], a[156:159], v[136:139]
s_waitcnt lgkmcnt(4)
v_mfma_f32_16x16x32_bf16 v[140:143], a[184:187], a[120:123], v[140:143]
ds_read_b64_tr_b16 a[248:249], v238 offset:8
v_mfma_f32_16x16x32_bf16 v[140:143], a[188:191], a[140:143], v[140:143]
ds_read_b64_tr_b16 a[250:251], v238 offset:1032
s_add_u32 m0, s39, 40960
v_mfma_f32_16x16x32_bf16 v[144:147], a[188:191], a[144:147], v[144:147]
ds_read_b64_tr_b16 a[252:253], v240 offset:8
buffer_load_dwordx4 v243, s[8:11], s34 offen offset:1024 sc1 lds
v_mfma_f32_16x16x32_bf16 v[144:147], a[184:187], a[124:127], v[144:147]
ds_read_b64_tr_b16 a[254:255], v240 offset:1032
v_mfma_f32_16x16x32_bf16 v[148:151], a[184:187], a[128:131], v[148:151]
v_mfma_f32_16x16x32_bf16 v[148:151], a[188:191], a[148:151], v[148:151]
v_mfma_f32_16x16x32_bf16 v[152:155], a[188:191], a[152:155], v[152:155]
s_add_u32 m0, s39, 40960
v_mfma_f32_16x16x32_bf16 v[152:155], a[184:187], a[132:135], v[152:155]
buffer_load_dwordx4 v243, s[8:11], s34 offen offset:2048 sc1 lds
v_mfma_f32_16x16x32_bf16 v[156:159], a[184:187], a[136:139], v[156:159]
v_mfma_f32_16x16x32_bf16 v[156:159], a[188:191], a[156:159], v[156:159]
s_waitcnt vmcnt(19) lgkmcnt(0)
s_barrier
v_mfma_f32_16x16x32_bf16 v[160:163], a[192:195], a[120:123], v[160:163]
ds_read_b64_tr_b16 a[184:185], v237 offset:16384
v_mfma_f32_16x16x32_bf16 v[160:163], a[196:199], a[140:143], v[160:163]
ds_read_b64_tr_b16 a[186:187], v237 offset:17408
s_add_u32 m0, s48, 131072
s_xor_b32 s35, s43, 4325504
v_mfma_f32_16x16x32_bf16 v[164:167], a[196:199], a[144:147], v[164:167]
buffer_load_dwordx4 v248, s[12:15], s35 offen offset:0 lds
v_mfma_f32_16x16x32_bf16 v[164:167], a[192:195], a[124:127], v[164:167]
ds_read_b64_tr_b16 a[188:189], v239 offset:16384
v_mfma_f32_16x16x32_bf16 v[168:171], a[192:195], a[128:131], v[168:171]
ds_read_b64_tr_b16 a[190:191], v239 offset:17408
v_mfma_f32_16x16x32_bf16 v[168:171], a[196:199], a[148:151], v[168:171]
ds_read_b128 a[200:203], v241 offset:0
v_mfma_f32_16x16x32_bf16 v[172:175], a[196:199], a[152:155], v[172:175]
ds_read_b128 a[220:223], v241 offset:1024
s_add_u32 m0, s39, 40960
v_mfma_f32_16x16x32_bf16 v[172:175], a[192:195], a[132:135], v[172:175]
buffer_load_dwordx4 v243, s[8:11], s34 offen offset:3072 sc1 lds
v_mfma_f32_16x16x32_bf16 v[176:179], a[192:195], a[136:139], v[176:179]
ds_read_b128 a[204:207], v241 offset:2048
v_mfma_f32_16x16x32_bf16 v[176:179], a[196:199], a[156:159], v[176:179]
ds_read_b128 a[224:227], v241 offset:3072
v_mfma_f32_16x16x32_bf16 v[180:183], a[240:243], a[120:123], v[180:183]
ds_read_b64_tr_b16 a[192:193], v237 offset:16392
v_mfma_f32_16x16x32_bf16 v[180:183], a[244:247], a[140:143], v[180:183]
ds_read_b64_tr_b16 a[194:195], v237 offset:17416
s_add_u32 m0, s48, 131072
v_mfma_f32_16x16x32_bf16 v[184:187], a[244:247], a[144:147], v[184:187]
buffer_load_dwordx4 v249, s[12:15], s35 offen offset:1024 lds
v_mfma_f32_16x16x32_bf16 v[184:187], a[240:243], a[124:127], v[184:187]
ds_read_b64_tr_b16 a[196:197], v239 offset:16392
v_mfma_f32_16x16x32_bf16 v[188:191], a[240:243], a[128:131], v[188:191]
ds_read_b64_tr_b16 a[198:199], v239 offset:17416
v_mfma_f32_16x16x32_bf16 v[188:191], a[244:247], a[148:151], v[188:191]
ds_read_b128 a[208:211], v241 offset:4096
v_mfma_f32_16x16x32_bf16 v[192:195], a[244:247], a[152:155], v[192:195]
ds_read_b128 a[228:231], v241 offset:5120
s_add_u32 m0, s48, 131072
v_mfma_f32_16x16x32_bf16 v[192:195], a[240:243], a[132:135], v[192:195]
buffer_load_dwordx4 v250, s[12:15], s35 offen offset:2048 lds
v_mfma_f32_16x16x32_bf16 v[196:199], a[240:243], a[136:139], v[196:199]
ds_read_b128 a[212:215], v241 offset:6144
v_mfma_f32_16x16x32_bf16 v[196:199], a[244:247], a[156:159], v[196:199]
ds_read_b128 a[232:235], v241 offset:7168
v_mfma_f32_16x16x32_bf16 v[200:203], a[248:251], a[120:123], v[200:203]
ds_read_b64_tr_b16 a[240:241], v238 offset:16384
v_mfma_f32_16x16x32_bf16 v[200:203], a[252:255], a[140:143], v[200:203]
ds_read_b64_tr_b16 a[242:243], v238 offset:17408
s_add_u32 m0, s39, 45056
v_mfma_f32_16x16x32_bf16 v[204:207], a[252:255], a[144:147], v[204:207]
ds_read_b128 a[216:219], v241 offset:8192
buffer_load_dwordx4 v247, s[8:11], s34 offen sc1 lds
v_mfma_f32_16x16x32_bf16 v[204:207], a[248:251], a[124:127], v[204:207]
ds_read_b64_tr_b16 a[244:245], v240 offset:16384
v_mfma_f32_16x16x32_bf16 v[208:211], a[248:251], a[128:131], v[208:211]
ds_read_b64_tr_b16 a[246:247], v240 offset:17408
s_movk_i32 s100, 3840
v_mfma_f32_16x16x32_bf16 v[208:211], a[252:255], a[148:151], v[208:211]
ds_read_b128 a[236:239], v241 offset:9216
s_and_b32 s49, s3, s100
s_cbranch_scc1 L_slow_d
L_back_d:
v_mfma_f32_16x16x32_bf16 v[212:215], a[252:255], a[152:155], v[212:215]
s_add_u32 m0, s48, 131072
v_mfma_f32_16x16x32_bf16 v[212:215], a[248:251], a[132:135], v[212:215]
buffer_load_dwordx4 v251, s[12:15], s35 offen offset:3072 lds
v_mfma_f32_16x16x32_bf16 v[216:219], a[248:251], a[136:139], v[216:219]
v_mfma_f32_16x16x32_bf16 v[216:219], a[252:255], a[156:159], v[216:219]
s_waitcnt lgkmcnt(1)
v_mfma_f32_16x16x32_bf16 v[80:83], a[184:187], a[200:203], v[80:83]
ds_read_b64_tr_b16 a[248:249], v238 offset:16392
v_add_u32 v229, 1, v226
v_xor_b32 v229, s2, v229
v_mfma_f32_16x16x32_bf16 v[80:83], a[188:191], a[220:223], v[80:83]
ds_read_b64_tr_b16 a[250:251], v238 offset:17416
s_add_u32 m0, s39, 61440
s_add_u32 s34, s41, 61440
v_mfma_f32_16x16x32_bf16 v[84:87], a[188:191], a[224:227], v[84:87]
ds_read_b64_tr_b16 a[252:253], v240 offset:16392
buffer_load_dwordx4 v243, s[8:11], s34 offen offset:0 sc1 lds
s_lshl_b32 s50, s28, 2
v_mfma_f32_16x16x32_bf16 v[84:87], a[184:187], a[204:207], v[84:87]
ds_read_b64_tr_b16 a[254:255], v240 offset:17416
s_add_u32 s50, s50, 16
v_lshl_add_u32 v252, v229, 7, s50
v_mfma_f32_16x16x32_bf16 v[88:91], a[184:187], a[208:211], v[88:91]
v_cmp_lt_u32 vcc, 2, v226
v_mov_b32 v229, 0x100000
v_mfma_f32_16x16x32_bf16 v[88:91], a[188:191], a[228:231], v[88:91]
s_nop 0
v_cndmask_b32 v252, v252, v229, vcc
v_mfma_f32_16x16x32_bf16 v[92:95], a[188:191], a[232:235], v[92:95]
s_add_u32 m0, s39, 61440
v_mfma_f32_16x16x32_bf16 v[92:95], a[184:187], a[212:215], v[92:95]
buffer_load_dwordx4 v243, s[8:11], s34 offen offset:1024 sc1 lds
v_mfma_f32_16x16x32_bf16 v[96:99], a[184:187], a[216:219], v[96:99]
s_waitcnt lgkmcnt(0)
v_mfma_f32_16x16x32_bf16 v[96:99], a[188:191], a[236:239], v[96:99]
s_waitcnt vmcnt(24)
s_barrier
v_mfma_f32_16x16x32_bf16 v[100:103], a[192:195], a[200:203], v[100:103]
ds_read_b64_tr_b16 a[184:185], v233 offset:0
v_mfma_f32_16x16x32_bf16 v[100:103], a[196:199], a[220:223], v[100:103]
ds_read_b64_tr_b16 a[186:187], v233 offset:1024
s_add_u32 m0, s48, 147456
s_xor_b32 s35, s44, 4325440
v_mfma_f32_16x16x32_bf16 v[104:107], a[196:199], a[224:227], v[104:107]
buffer_load_dwordx4 v220, s[12:15], s35 offen offset:0 lds
v_mfma_f32_16x16x32_bf16 v[104:107], a[192:195], a[204:207], v[104:107]
ds_read_b64_tr_b16 a[188:189], v235 offset:0
v_mfma_f32_16x16x32_bf16 v[108:111], a[192:195], a[208:211], v[108:111]
ds_read_b64_tr_b16 a[190:191], v235 offset:1024
v_mfma_f32_16x16x32_bf16 v[108:111], a[196:199], a[228:231], v[108:111]
v_mfma_f32_16x16x32_bf16 v[112:115], a[196:199], a[232:235], v[112:115]
s_add_u32 m0, s39, 61440
v_mfma_f32_16x16x32_bf16 v[112:115], a[192:195], a[212:215], v[112:115]
buffer_load_dwordx4 v243, s[8:11], s34 offen offset:2048 sc1 lds
v_mfma_f32_16x16x32_bf16 v[116:119], a[192:195], a[216:219], v[116:119]
v_mfma_f32_16x16x32_bf16 v[116:119], a[196:199], a[236:239], v[116:119]
v_mfma_f32_16x16x32_bf16 v[60:63], a[240:243], a[200:203], v[60:63]
ds_read_b64_tr_b16 a[192:193], v233 offset:8
v_mfma_f32_16x16x32_bf16 v[60:63], a[244:247], a[220:223], v[60:63]
ds_read_b64_tr_b16 a[194:195], v233 offset:1032
s_add_u32 m0, s48, 147456
v_mfma_f32_16x16x32_bf16 v[64:67], a[244:247], a[224:227], v[64:67]
buffer_load_dwordx4 v221, s[12:15], s35 offen offset:1024 lds
v_mfma_f32_16x16x32_bf16 v[64:67], a[240:243], a[204:207], v[64:67]
ds_read_b64_tr_b16 a[196:197], v235 offset:8
v_mfma_f32_16x16x32_bf16 v[68:71], a[240:243], a[208:211], v[68:71]
ds_read_b64_tr_b16 a[198:199], v235 offset:1032
v_mfma_f32_16x16x32_bf16 v[68:71], a[244:247], a[228:231], v[68:71]
v_mfma_f32_16x16x32_bf16 v[72:75], a[244:247], a[232:235], v[72:75]
s_add_u32 m0, s48, 147456
v_mfma_f32_16x16x32_bf16 v[72:75], a[240:243], a[212:215], v[72:75]
buffer_load_dwordx4 v222, s[12:15], s35 offen offset:2048 lds
v_mfma_f32_16x16x32_bf16 v[76:79], a[240:243], a[216:219], v[76:79]
v_mfma_f32_16x16x32_bf16 v[76:79], a[244:247], a[236:239], v[76:79]
v_mfma_f32_16x16x32_bf16 v[120:123], a[248:251], a[200:203], v[120:123]
ds_read_b64_tr_b16 a[240:241], v234 offset:0
v_mfma_f32_16x16x32_bf16 v[120:123], a[252:255], a[220:223], v[120:123]
ds_read_b64_tr_b16 a[242:243], v234 offset:1024
s_add_u32 m0, s39, 61440
v_mfma_f32_16x16x32_bf16 v[124:127], a[252:255], a[224:227], v[124:127]
buffer_load_dwordx4 v243, s[8:11], s34 offen offset:3072 sc1 lds
v_mfma_f32_16x16x32_bf16 v[124:127], a[248:251], a[204:207], v[124:127]
ds_read_b64_tr_b16 a[244:245], v236 offset:0
v_mfma_f32_16x16x32_bf16 v[128:131], a[248:251], a[208:211], v[128:131]
ds_read_b64_tr_b16 a[246:247], v236 offset:1024
v_mfma_f32_16x16x32_bf16 v[128:131], a[252:255], a[228:231], v[128:131]
v_mfma_f32_16x16x32_bf16 v[132:135], a[252:255], a[232:235], v[132:135]
s_add_u32 m0, s48, 147456
v_mfma_f32_16x16x32_bf16 v[132:135], a[248:251], a[212:215], v[132:135]
buffer_load_dwordx4 v223, s[12:15], s35 offen offset:3072 lds
v_mfma_f32_16x16x32_bf16 v[136:139], a[248:251], a[216:219], v[136:139]
v_mfma_f32_16x16x32_bf16 v[136:139], a[252:255], a[236:239], v[136:139]
s_waitcnt lgkmcnt(4)
v_mfma_f32_16x16x32_bf16 v[140:143], a[184:187], a[200:203], v[140:143]
ds_read_b64_tr_b16 a[248:249], v234 offset:8
v_mfma_f32_16x16x32_bf16 v[140:143], a[188:191], a[220:223], v[140:143]
ds_read_b64_tr_b16 a[250:251], v234 offset:1032
s_add_u32 m0, s39, 65536
v_mfma_f32_16x16x32_bf16 v[144:147], a[188:191], a[224:227], v[144:147]
ds_read_b64_tr_b16 a[252:253], v236 offset:8
buffer_load_dwordx4 v247, s[8:11], s34 offen sc1 lds
v_mfma_f32_16x16x32_bf16 v[144:147], a[184:187], a[204:207], v[144:147]
ds_read_b64_tr_b16 a[254:255], v236 offset:1032
v_mfma_f32_16x16x32_bf16 v[148:151], a[184:187], a[208:211], v[148:151]
v_mfma_f32_16x16x32_bf16 v[148:151], a[188:191], a[228:231], v[148:151]
v_mfma_f32_16x16x32_bf16 v[152:155], a[188:191], a[232:235], v[152:155]
s_add_u32 m0, s39, 0
s_add_u32 s34, s42, 0
v_mfma_f32_16x16x32_bf16 v[152:155], a[184:187], a[212:215], v[152:155]
buffer_load_dwordx4 v243, s[8:11], s34 offen offset:0 sc1 lds
v_mfma_f32_16x16x32_bf16 v[156:159], a[184:187], a[216:219], v[156:159]
v_mfma_f32_16x16x32_bf16 v[156:159], a[188:191], a[236:239], v[156:159]
s_waitcnt vmcnt(22) lgkmcnt(0)
s_barrier
v_mfma_f32_16x16x32_bf16 v[160:163], a[192:195], a[200:203], v[160:163]
ds_read_b64_tr_b16 a[184:185], v233 offset:16384
v_mfma_f32_16x16x32_bf16 v[160:163], a[196:199], a[220:223], v[160:163]
ds_read_b64_tr_b16 a[186:187], v233 offset:17408
s_add_u32 m0, s48, 81920
s_xor_b32 s35, s43, 4391040
v_mfma_f32_16x16x32_bf16 v[164:167], a[196:199], a[224:227], v[164:167]
buffer_load_dwordx4 v248, s[12:15], s35 offen offset:0 lds
v_mfma_f32_16x16x32_bf16 v[164:167], a[192:195], a[204:207], v[164:167]
ds_read_b64_tr_b16 a[188:189], v235 offset:16384
v_mfma_f32_16x16x32_bf16 v[168:171], a[192:195], a[208:211], v[168:171]
ds_read_b64_tr_b16 a[190:191], v235 offset:17408
v_mfma_f32_16x16x32_bf16 v[168:171], a[196:199], a[228:231], v[168:171]
ds_read_b128 a[120:123], v241 offset:20480
v_mfma_f32_16x16x32_bf16 v[172:175], a[196:199], a[232:235], v[172:175]
ds_read_b128 a[140:143], v241 offset:21504
s_add_u32 m0, s39, 0
v_mfma_f32_16x16x32_bf16 v[172:175], a[192:195], a[212:215], v[172:175]
buffer_load_dwordx4 v243, s[8:11], s34 offen offset:1024 sc1 lds
v_mfma_f32_16x16x32_bf16 v[176:179], a[192:195], a[216:219], v[176:179]
ds_read_b128 a[124:127], v241 offset:22528
v_mfma_f32_16x16x32_bf16 v[176:179], a[196:199], a[236:239], v[176:179]
ds_read_b128 a[144:147], v241 offset:23552
v_mfma_f32_16x16x32_bf16 v[180:183], a[240:243], a[200:203], v[180:183]
ds_read_b64_tr_b16 a[192:193], v233 offset:16392
v_mfma_f32_16x16x32_bf16 v[180:183], a[244:247], a[220:223], v[180:183]
ds_read_b64_tr_b16 a[194:195], v233 offset:17416
s_add_u32 m0, s48, 81920
v_mfma_f32_16x16x32_bf16 v[184:187], a[244:247], a[224:227], v[184:187]
buffer_load_dwordx4 v249, s[12:15], s35 offen offset:1024 lds
v_mfma_f32_16x16x32_bf16 v[184:187], a[240:243], a[204:207], v[184:187]
ds_read_b64_tr_b16 a[196:197], v235 offset:16392
v_mfma_f32_16x16x32_bf16 v[188:191], a[240:243], a[208:211], v[188:191]
ds_read_b64_tr_b16 a[198:199], v235 offset:17416
v_mfma_f32_16x16x32_bf16 v[188:191], a[244:247], a[228:231], v[188:191]
ds_read_b128 a[128:131], v241 offset:24576
v_mfma_f32_16x16x32_bf16 v[192:195], a[244:247], a[232:235], v[192:195]
ds_read_b128 a[148:151], v241 offset:25600
s_add_u32 m0, s48, 81920
v_mfma_f32_16x16x32_bf16 v[192:195], a[240:243], a[212:215], v[192:195]
buffer_load_dwordx4 v250, s[12:15], s35 offen offset:2048 lds
v_mfma_f32_16x16x32_bf16 v[196:199], a[240:243], a[216:219], v[196:199]
ds_read_b128 a[132:135], v241 offset:26624
v_mfma_f32_16x16x32_bf16 v[196:199], a[244:247], a[236:239], v[196:199]
ds_read_b128 a[152:155], v241 offset:27648
v_mfma_f32_16x16x32_bf16 v[200:203], a[248:251], a[200:203], v[200:203]
ds_read_b64_tr_b16 a[240:241], v234 offset:16384
v_mfma_f32_16x16x32_bf16 v[200:203], a[252:255], a[220:223], v[200:203]
ds_read_b64_tr_b16 a[242:243], v234 offset:17408
s_add_u32 m0, s39, 0
v_mfma_f32_16x16x32_bf16 v[204:207], a[252:255], a[224:227], v[204:207]
ds_read_b128 a[136:139], v241 offset:28672
buffer_load_dwordx4 v243, s[8:11], s34 offen offset:2048 sc1 lds
v_mfma_f32_16x16x32_bf16 v[204:207], a[248:251], a[204:207], v[204:207]
ds_read_b64_tr_b16 a[244:245], v236 offset:16384
v_mfma_f32_16x16x32_bf16 v[208:211], a[248:251], a[208:211], v[208:211]
ds_read_b64_tr_b16 a[246:247], v236 offset:17408
v_mfma_f32_16x16x32_bf16 v[208:211], a[252:255], a[228:231], v[208:211]
ds_read_b128 a[156:159], v241 offset:29696
v_mfma_f32_16x16x32_bf16 v[212:215], a[252:255], a[232:235], v[212:215]
s_add_u32 m0, s48, 81920
v_mfma_f32_16x16x32_bf16 v[212:215], a[248:251], a[212:215], v[212:215]
buffer_load_dwordx4 v251, s[12:15], s35 offen offset:3072 lds
v_mfma_f32_16x16x32_bf16 v[216:219], a[248:251], a[216:219], v[216:219]
v_mfma_f32_16x16x32_bf16 v[216:219], a[252:255], a[236:239], v[216:219]
s_waitcnt lgkmcnt(1)
v_mfma_f32_16x16x32_bf16 v[80:83], a[184:187], a[120:123], v[80:83]
ds_read_b64_tr_b16 a[248:249], v234 offset:16392
v_mfma_f32_16x16x32_bf16 v[80:83], a[188:191], a[140:143], v[80:83]
ds_read_b64_tr_b16 a[250:251], v234 offset:17416
s_add_u32 m0, s39, 0
v_mfma_f32_16x16x32_bf16 v[84:87], a[188:191], a[144:147], v[84:87]
ds_read_b64_tr_b16 a[252:253], v236 offset:16392
buffer_load_dwordx4 v243, s[8:11], s34 offen offset:3072 sc1 lds
v_mfma_f32_16x16x32_bf16 v[84:87], a[184:187], a[124:127], v[84:87]
ds_read_b64_tr_b16 a[254:255], v236 offset:17416
v_mfma_f32_16x16x32_bf16 v[88:91], a[184:187], a[128:131], v[88:91]
v_mfma_f32_16x16x32_bf16 v[88:91], a[188:191], a[148:151], v[88:91]
v_mfma_f32_16x16x32_bf16 v[92:95], a[188:191], a[152:155], v[92:95]
s_add_u32 m0, s39, 4096
v_mfma_f32_16x16x32_bf16 v[92:95], a[184:187], a[132:135], v[92:95]
buffer_load_dwordx4 v247, s[8:11], s34 offen sc1 lds
v_mfma_f32_16x16x32_bf16 v[96:99], a[184:187], a[136:139], v[96:99]
s_waitcnt lgkmcnt(2)
v_mfma_f32_16x16x32_bf16 v[96:99], a[188:191], a[156:159], v[96:99]
s_waitcnt vmcnt(26) lgkmcnt(0)
s_barrier
v_mfma_f32_16x16x32_bf16 v[100:103], a[192:195], a[120:123], v[100:103]
ds_read_b64_tr_b16 a[184:185], v233 offset:32768
v_mfma_f32_16x16x32_bf16 v[100:103], a[196:199], a[140:143], v[100:103]
ds_read_b64_tr_b16 a[186:187], v233 offset:33792
s_add_u32 m0, s48, 98304
s_xor_b32 s35, s44, 6291648
v_mfma_f32_16x16x32_bf16 v[104:107], a[196:199], a[144:147], v[104:107]
buffer_load_dwordx4 v220, s[12:15], s35 offen offset:0 lds
v_mfma_f32_16x16x32_bf16 v[104:107], a[192:195], a[124:127], v[104:107]
ds_read_b64_tr_b16 a[188:189], v235 offset:32768
v_mfma_f32_16x16x32_bf16 v[108:111], a[192:195], a[128:131], v[108:111]
ds_read_b64_tr_b16 a[190:191], v235 offset:33792
v_mfma_f32_16x16x32_bf16 v[108:111], a[196:199], a[148:151], v[108:111]
v_mfma_f32_16x16x32_bf16 v[112:115], a[196:199], a[152:155], v[112:115]
s_add_u32 m0, s39, 20480
s_add_u32 s34, s42, 20480
v_mfma_f32_16x16x32_bf16 v[112:115], a[192:195], a[132:135], v[112:115]
buffer_load_dwordx4 v243, s[8:11], s34 offen offset:0 sc1 lds
v_mfma_f32_16x16x32_bf16 v[116:119], a[192:195], a[136:139], v[116:119]
v_mfma_f32_16x16x32_bf16 v[116:119], a[196:199], a[156:159], v[116:119]
v_mfma_f32_16x16x32_bf16 v[60:63], a[240:243], a[120:123], v[60:63]
ds_read_b64_tr_b16 a[192:193], v233 offset:32776
v_mfma_f32_16x16x32_bf16 v[60:63], a[244:247], a[140:143], v[60:63]
ds_read_b64_tr_b16 a[194:195], v233 offset:33800
s_add_u32 m0, s48, 98304
v_mfma_f32_16x16x32_bf16 v[64:67], a[244:247], a[144:147], v[64:67]
buffer_load_dwordx4 v221, s[12:15], s35 offen offset:1024 lds
v_mfma_f32_16x16x32_bf16 v[64:67], a[240:243], a[124:127], v[64:67]
ds_read_b64_tr_b16 a[196:197], v235 offset:32776
v_mfma_f32_16x16x32_bf16 v[68:71], a[240:243], a[128:131], v[68:71]
ds_read_b64_tr_b16 a[198:199], v235 offset:33800
v_mfma_f32_16x16x32_bf16 v[68:71], a[244:247], a[148:151], v[68:71]
v_mfma_f32_16x16x32_bf16 v[72:75], a[244:247], a[152:155], v[72:75]
s_add_u32 m0, s48, 98304
v_mfma_f32_16x16x32_bf16 v[72:75], a[240:243], a[132:135], v[72:75]
buffer_load_dwordx4 v222, s[12:15], s35 offen offset:2048 lds
v_mfma_f32_16x16x32_bf16 v[76:79], a[240:243], a[136:139], v[76:79]
v_mfma_f32_16x16x32_bf16 v[76:79], a[244:247], a[156:159], v[76:79]
v_mfma_f32_16x16x32_bf16 v[120:123], a[248:251], a[120:123], v[120:123]
ds_read_b64_tr_b16 a[240:241], v234 offset:32768
v_mfma_f32_16x16x32_bf16 v[120:123], a[252:255], a[140:143], v[120:123]
ds_read_b64_tr_b16 a[242:243], v234 offset:33792
s_add_u32 m0, s39, 20480
v_mfma_f32_16x16x32_bf16 v[124:127], a[252:255], a[144:147], v[124:127]
buffer_load_dwordx4 v243, s[8:11], s34 offen offset:1024 sc1 lds
v_mfma_f32_16x16x32_bf16 v[124:127], a[248:251], a[124:127], v[124:127]
ds_read_b64_tr_b16 a[244:245], v236 offset:32768
v_mfma_f32_16x16x32_bf16 v[128:131], a[248:251], a[128:131], v[128:131]
ds_read_b64_tr_b16 a[246:247], v236 offset:33792
v_mfma_f32_16x16x32_bf16 v[128:131], a[252:255], a[148:151], v[128:131]
v_mfma_f32_16x16x32_bf16 v[132:135], a[252:255], a[152:155], v[132:135]
s_add_u32 m0, s48, 98304
v_mfma_f32_16x16x32_bf16 v[132:135], a[248:251], a[132:135], v[132:135]
buffer_load_dwordx4 v223, s[12:15], s35 offen offset:3072 lds
v_mfma_f32_16x16x32_bf16 v[136:139], a[248:251], a[136:139], v[136:139]
v_mfma_f32_16x16x32_bf16 v[136:139], a[252:255], a[156:159], v[136:139]
s_waitcnt lgkmcnt(4)
v_mfma_f32_16x16x32_bf16 v[140:143], a[184:187], a[120:123], v[140:143]
ds_read_b64_tr_b16 a[248:249], v234 offset:32776
v_mfma_f32_16x16x32_bf16 v[140:143], a[188:191], a[140:143], v[140:143]
ds_read_b64_tr_b16 a[250:251], v234 offset:33800
s_add_u32 m0, s39, 20480
v_mfma_f32_16x16x32_bf16 v[144:147], a[188:191], a[144:147], v[144:147]
ds_read_b64_tr_b16 a[252:253], v236 offset:32776
buffer_load_dwordx4 v243, s[8:11], s34 offen offset:2048 sc1 lds
v_mfma_f32_16x16x32_bf16 v[144:147], a[184:187], a[124:127], v[144:147]
ds_read_b64_tr_b16 a[254:255], v236 offset:33800
v_mfma_f32_16x16x32_bf16 v[148:151], a[184:187], a[128:131], v[148:151]
v_mfma_f32_16x16x32_bf16 v[148:151], a[188:191], a[148:151], v[148:151]
v_mfma_f32_16x16x32_bf16 v[152:155], a[188:191], a[152:155], v[152:155]
s_add_u32 m0, s39, 20480
v_mfma_f32_16x16x32_bf16 v[152:155], a[184:187], a[132:135], v[152:155]
buffer_load_dwordx4 v243, s[8:11], s34 offen offset:3072 sc1 lds
v_mfma_f32_16x16x32_bf16 v[156:159], a[184:187], a[136:139], v[156:159]
v_mfma_f32_16x16x32_bf16 v[156:159], a[188:191], a[156:159], v[156:159]
s_waitcnt vmcnt(26) lgkmcnt(0)
s_barrier
v_mfma_f32_16x16x32_bf16 v[160:163], a[192:195], a[120:123], v[160:163]
ds_read_b64_tr_b16 a[184:185], v237 offset:0
v_mfma_f32_16x16x32_bf16 v[160:163], a[196:199], a[140:143], v[160:163]
ds_read_b64_tr_b16 a[186:187], v237 offset:1024
s_add_u32 m0, s48, 114688
s_xor_b32 s35, s44, 6422720
v_mfma_f32_16x16x32_bf16 v[164:167], a[196:199], a[144:147], v[164:167]
buffer_load_dwordx4 v220, s[12:15], s35 offen offset:0 lds
v_mfma_f32_16x16x32_bf16 v[164:167], a[192:195], a[124:127], v[164:167]
ds_read_b64_tr_b16 a[188:189], v239 offset:0
v_mfma_f32_16x16x32_bf16 v[168:171], a[192:195], a[128:131], v[168:171]
ds_read_b64_tr_b16 a[190:191], v239 offset:1024
v_mfma_f32_16x16x32_bf16 v[168:171], a[196:199], a[148:151], v[168:171]
ds_read_b128 a[200:203], v242 offset:0
v_mfma_f32_16x16x32_bf16 v[172:175], a[196:199], a[152:155], v[172:175]
ds_read_b128 a[220:223], v242 offset:1024
s_add_u32 m0, s39, 24576
v_mfma_f32_16x16x32_bf16 v[172:175], a[192:195], a[132:135], v[172:175]
buffer_load_dwordx4 v247, s[8:11], s34 offen sc1 lds
v_mfma_f32_16x16x32_bf16 v[176:179], a[192:195], a[136:139], v[176:179]
ds_read_b128 a[204:207], v242 offset:2048
v_mfma_f32_16x16x32_bf16 v[176:179], a[196:199], a[156:159], v[176:179]
ds_read_b128 a[224:227], v242 offset:3072
v_mfma_f32_16x16x32_bf16 v[180:183], a[240:243], a[120:123], v[180:183]
ds_read_b64_tr_b16 a[192:193], v237 offset:8
v_mfma_f32_16x16x32_bf16 v[180:183], a[244:247], a[140:143], v[180:183]
ds_read_b64_tr_b16 a[194:195], v237 offset:1032
s_add_u32 m0, s48, 114688
v_mfma_f32_16x16x32_bf16 v[184:187], a[244:247], a[144:147], v[184:187]
buffer_load_dwordx4 v221, s[12:15], s35 offen offset:1024 lds
v_mfma_f32_16x16x32_bf16 v[184:187], a[240:243], a[124:127], v[184:187]
ds_read_b64_tr_b16 a[196:197], v239 offset:8
v_mfma_f32_16x16x32_bf16 v[188:191], a[240:243], a[128:131], v[188:191]
ds_read_b64_tr_b16 a[198:199], v239 offset:1032
v_mfma_f32_16x16x32_bf16 v[188:191], a[244:247], a[148:151], v[188:191]
ds_read_b128 a[208:211], v242 offset:4096
v_mfma_f32_16x16x32_bf16 v[192:195], a[244:247], a[152:155], v[192:195]
ds_read_b128 a[228:231], v242 offset:5120
s_add_u32 m0, s48, 114688
v_mfma_f32_16x16x32_bf16 v[192:195], a[240:243], a[132:135], v[192:195]
buffer_load_dwordx4 v222, s[12:15], s35 offen offset:2048 lds
v_mfma_f32_16x16x32_bf16 v[196:199], a[240:243], a[136:139], v[196:199]
ds_read_b128 a[212:215], v242 offset:6144
v_mfma_f32_16x16x32_bf16 v[196:199], a[244:247], a[156:159], v[196:199]
ds_read_b128 a[232:235], v242 offset:7168
v_mfma_f32_16x16x32_bf16 v[200:203], a[248:251], a[120:123], v[200:203]
ds_read_b64_tr_b16 a[240:241], v238 offset:0
v_mfma_f32_16x16x32_bf16 v[200:203], a[252:255], a[140:143], v[200:203]
ds_read_b64_tr_b16 a[242:243], v238 offset:1024
v_mfma_f32_16x16x32_bf16 v[204:207], a[252:255], a[144:147], v[204:207]
ds_read_b128 a[216:219], v242 offset:8192
v_mfma_f32_16x16x32_bf16 v[204:207], a[248:251], a[124:127], v[204:207]
ds_read_b64_tr_b16 a[244:245], v240 offset:0
v_mfma_f32_16x16x32_bf16 v[208:211], a[248:251], a[128:131], v[208:211]
ds_read_b64_tr_b16 a[246:247], v240 offset:1024
v_mfma_f32_16x16x32_bf16 v[208:211], a[252:255], a[148:151], v[208:211]
ds_read_b128 a[236:239], v242 offset:9216
v_mfma_f32_16x16x32_bf16 v[212:215], a[252:255], a[152:155], v[212:215]
s_add_u32 m0, s48, 114688
v_mfma_f32_16x16x32_bf16 v[212:215], a[248:251], a[132:135], v[212:215]
buffer_load_dwordx4 v223, s[12:15], s35 offen offset:3072 lds
v_mfma_f32_16x16x32_bf16 v[216:219], a[248:251], a[136:139], v[216:219]
v_mfma_f32_16x16x32_bf16 v[216:219], a[252:255], a[156:159], v[216:219]
s_waitcnt lgkmcnt(1)
v_mfma_f32_16x16x32_bf16 v[140:143], a[184:187], a[200:203], v[140:143]
ds_read_b64_tr_b16 a[248:249], v238 offset:8
v_mfma_f32_16x16x32_bf16 v[140:143], a[188:191], a[220:223], v[140:143]
ds_read_b64_tr_b16 a[250:251], v238 offset:1032
v_mfma_f32_16x16x32_bf16 v[144:147], a[188:191], a[224:227], v[144:147]
ds_read_b64_tr_b16 a[252:253], v240 offset:8
v_mfma_f32_16x16x32_bf16 v[144:147], a[184:187], a[204:207], v[144:147]
ds_read_b64_tr_b16 a[254:255], v240 offset:1032
v_mfma_f32_16x16x32_bf16 v[148:151], a[184:187], a[208:211], v[148:151]
v_mfma_f32_16x16x32_bf16 v[148:151], a[188:191], a[228:231], v[148:151]
v_mfma_f32_16x16x32_bf16 v[152:155], a[188:191], a[232:235], v[152:155]
v_mfma_f32_16x16x32_bf16 v[152:155], a[184:187], a[212:215], v[152:155]
v_mfma_f32_16x16x32_bf16 v[156:159], a[184:187], a[216:219], v[156:159]
s_waitcnt lgkmcnt(4)
v_mfma_f32_16x16x32_bf16 v[156:159], a[188:191], a[236:239], v[156:159]
s_waitcnt vmcnt(22) lgkmcnt(0)
s_barrier
v_mfma_f32_16x16x32_bf16 v[160:163], a[192:195], a[200:203], v[160:163]
ds_read_b64_tr_b16 a[184:185], v237 offset:16384
v_mfma_f32_16x16x32_bf16 v[160:163], a[196:199], a[220:223], v[160:163]
ds_read_b64_tr_b16 a[186:187], v237 offset:17408
s_add_u32 m0, s48, 131072
s_xor_b32 s35, s44, 6291584
v_mfma_f32_16x16x32_bf16 v[164:167], a[196:199], a[224:227], v[164:167]
buffer_load_dwordx4 v220, s[12:15], s35 offen offset:0 lds
v_mfma_f32_16x16x32_bf16 v[164:167], a[192:195], a[204:207], v[164:167]
ds_read_b64_tr_b16 a[188:189], v239 offset:16384
v_mfma_f32_16x16x32_bf16 v[168:171], a[192:195], a[208:211], v[168:171]
ds_read_b64_tr_b16 a[190:191], v239 offset:17408
v_mfma_f32_16x16x32_bf16 v[168:171], a[196:199], a[228:231], v[168:171]
ds_read_b128 a[120:123], v242 offset:20480
v_mfma_f32_16x16x32_bf16 v[172:175], a[196:199], a[232:235], v[172:175]
s_add_u32 m0, s39, 40960
s_add_u32 s34, s42, 40960
ds_read_b128 a[140:143], v242 offset:21504
v_mfma_f32_16x16x32_bf16 v[172:175], a[192:195], a[212:215], v[172:175]
buffer_load_dwordx4 v243, s[8:11], s34 offen offset:0 sc1 lds
v_mfma_f32_16x16x32_bf16 v[176:179], a[192:195], a[216:219], v[176:179]
ds_read_b128 a[124:127], v242 offset:22528
v_mfma_f32_16x16x32_bf16 v[176:179], a[196:199], a[236:239], v[176:179]
ds_read_b128 a[144:147], v242 offset:23552
v_mfma_f32_16x16x32_bf16 v[180:183], a[240:243], a[200:203], v[180:183]
ds_read_b64_tr_b16 a[192:193], v237 offset:16392
v_mfma_f32_16x16x32_bf16 v[180:183], a[244:247], a[220:223], v[180:183]
ds_read_b64_tr_b16 a[194:195], v237 offset:17416
s_add_u32 m0, s48, 131072
v_mfma_f32_16x16x32_bf16 v[184:187], a[244:247], a[224:227], v[184:187]
buffer_load_dwordx4 v221, s[12:15], s35 offen offset:1024 lds
v_mfma_f32_16x16x32_bf16 v[184:187], a[240:243], a[204:207], v[184:187]
ds_read_b64_tr_b16 a[196:197], v239 offset:16392
v_mfma_f32_16x16x32_bf16 v[188:191], a[240:243], a[208:211], v[188:191]
ds_read_b64_tr_b16 a[198:199], v239 offset:17416
v_mfma_f32_16x16x32_bf16 v[188:191], a[244:247], a[228:231], v[188:191]
ds_read_b128 a[128:131], v242 offset:24576
v_mfma_f32_16x16x32_bf16 v[192:195], a[244:247], a[232:235], v[192:195]
s_add_u32 m0, s48, 131072
ds_read_b128 a[148:151], v242 offset:25600
v_mfma_f32_16x16x32_bf16 v[192:195], a[240:243], a[212:215], v[192:195]
buffer_load_dwordx4 v222, s[12:15], s35 offen offset:2048 lds
v_mfma_f32_16x16x32_bf16 v[196:199], a[240:243], a[216:219], v[196:199]
ds_read_b128 a[132:135], v242 offset:26624
v_mfma_f32_16x16x32_bf16 v[196:199], a[244:247], a[236:239], v[196:199]
ds_read_b128 a[152:155], v242 offset:27648
v_mfma_f32_16x16x32_bf16 v[200:203], a[248:251], a[200:203], v[200:203]
ds_read_b64_tr_b16 a[240:241], v238 offset:16384
v_mfma_f32_16x16x32_bf16 v[200:203], a[252:255], a[220:223], v[200:203]
ds_read_b64_tr_b16 a[242:243], v238 offset:17408
s_add_u32 m0, s39, 40960
v_mfma_f32_16x16x32_bf16 v[204:207], a[252:255], a[224:227], v[204:207]
buffer_load_dwordx4 v243, s[8:11], s34 offen offset:1024 sc1 lds
ds_read_b128 a[136:139], v242 offset:28672
v_mfma_f32_16x16x32_bf16 v[204:207], a[248:251], a[204:207], v[204:207]
ds_read_b64_tr_b16 a[244:245], v240 offset:16384
v_mfma_f32_16x16x32_bf16 v[208:211], a[248:251], a[208:211], v[208:211]
ds_read_b64_tr_b16 a[246:247], v240 offset:17408
v_mfma_f32_16x16x32_bf16 v[208:211], a[252:255], a[228:231], v[208:211]
ds_read_b128 a[156:159], v242 offset:29696
v_mfma_f32_16x16x32_bf16 v[212:215], a[252:255], a[232:235], v[212:215]
s_add_u32 m0, s48, 131072
v_mfma_f32_16x16x32_bf16 v[212:215], a[248:251], a[212:215], v[212:215]
buffer_load_dwordx4 v223, s[12:15], s35 offen offset:3072 lds
v_mfma_f32_16x16x32_bf16 v[216:219], a[248:251], a[216:219], v[216:219]
v_mfma_f32_16x16x32_bf16 v[216:219], a[252:255], a[236:239], v[216:219]
s_waitcnt lgkmcnt(4)
v_mfma_f32_16x16x32_bf16 v[60:63], a[184:187], a[200:203], v[60:63]
ds_read_b64_tr_b16 a[248:249], v238 offset:16392
v_mfma_f32_16x16x32_bf16 v[60:63], a[188:191], a[220:223], v[60:63]
ds_read_b64_tr_b16 a[250:251], v238 offset:17416
s_add_u32 m0, s39, 40960
v_mfma_f32_16x16x32_bf16 v[64:67], a[188:191], a[224:227], v[64:67]
ds_read_b64_tr_b16 a[252:253], v240 offset:16392
buffer_load_dwordx4 v243, s[8:11], s34 offen offset:2048 sc1 lds
v_mfma_f32_16x16x32_bf16 v[64:67], a[184:187], a[204:207], v[64:67]
ds_read_b64_tr_b16 a[254:255], v240 offset:17416
v_mfma_f32_16x16x32_bf16 v[68:71], a[184:187], a[208:211], v[68:71]
v_mfma_f32_16x16x32_bf16 v[68:71], a[188:191], a[228:231], v[68:71]
v_mfma_f32_16x16x32_bf16 v[72:75], a[188:191], a[232:235], v[72:75]
s_add_u32 m0, s39, 40960
v_mfma_f32_16x16x32_bf16 v[72:75], a[184:187], a[212:215], v[72:75]
buffer_load_dwordx4 v243, s[8:11], s34 offen offset:3072 sc1 lds
v_mfma_f32_16x16x32_bf16 v[76:79], a[184:187], a[216:219], v[76:79]
v_mfma_f32_16x16x32_bf16 v[76:79], a[188:191], a[236:239], v[76:79]
s_waitcnt vmcnt(21) lgkmcnt(0)
s_barrier
v_mfma_f32_16x16x32_bf16 v[120:123], a[192:195], a[200:203], v[120:123]
ds_read_b64_tr_b16 a[184:185], v233 offset:0
v_mfma_f32_16x16x32_bf16 v[120:123], a[196:199], a[220:223], v[120:123]
ds_read_b64_tr_b16 a[186:187], v233 offset:1024
s_add_u32 m0, s48, 147456
s_xor_b32 s35, s44, 6422656
v_mfma_f32_16x16x32_bf16 v[124:127], a[196:199], a[224:227], v[124:127]
buffer_load_dwordx4 v220, s[12:15], s35 offen offset:0 lds
v_mfma_f32_16x16x32_bf16 v[124:127], a[192:195], a[204:207], v[124:127]
ds_read_b64_tr_b16 a[188:189], v235 offset:0
v_mfma_f32_16x16x32_bf16 v[128:131], a[192:195], a[208:211], v[128:131]
ds_read_b64_tr_b16 a[190:191], v235 offset:1024
v_mfma_f32_16x16x32_bf16 v[128:131], a[196:199], a[228:231], v[128:131]
ds_read_b128 a[0:3], v241 offset:0
v_mfma_f32_16x16x32_bf16 v[132:135], a[196:199], a[232:235], v[132:135]
s_add_u32 m0, s39, 45056
ds_read_b128 a[20:23], v241 offset:1024
v_mfma_f32_16x16x32_bf16 v[132:135], a[192:195], a[212:215], v[132:135]
buffer_load_dwordx4 v247, s[8:11], s34 offen sc1 lds
v_mfma_f32_16x16x32_bf16 v[136:139], a[192:195], a[216:219], v[136:139]
ds_read_b128 a[4:7], v241 offset:2048
v_mfma_f32_16x16x32_bf16 v[136:139], a[196:199], a[236:239], v[136:139]
ds_read_b128 a[24:27], v241 offset:3072
v_mfma_f32_16x16x32_bf16 v[60:63], a[240:243], a[120:123], v[60:63]
ds_read_b64_tr_b16 a[192:193], v233 offset:8
v_mfma_f32_16x16x32_bf16 v[60:63], a[244:247], a[140:143], v[60:63]
ds_read_b64_tr_b16 a[194:195], v233 offset:1032
s_add_u32 m0, s48, 147456
v_mfma_f32_16x16x32_bf16 v[64:67], a[244:247], a[144:147], v[64:67]
buffer_load_dwordx4 v221, s[12:15], s35 offen offset:1024 lds
v_mfma_f32_16x16x32_bf16 v[64:67], a[240:243], a[124:127], v[64:67]
ds_read_b64_tr_b16 a[196:197], v235 offset:8
v_mfma_f32_16x16x32_bf16 v[68:71], a[240:243], a[128:131], v[68:71]
ds_read_b64_tr_b16 a[198:199], v235 offset:1032
v_mfma_f32_16x16x32_bf16 v[68:71], a[244:247], a[148:151], v[68:71]
ds_read_b128 a[8:11], v241 offset:4096
v_mfma_f32_16x16x32_bf16 v[72:75], a[244:247], a[152:155], v[72:75]
s_add_u32 m0, s48, 147456
ds_read_b128 a[28:31], v241 offset:5120
v_mfma_f32_16x16x32_bf16 v[72:75], a[240:243], a[132:135], v[72:75]
buffer_load_dwordx4 v222, s[12:15], s35 offen offset:2048 lds
v_mfma_f32_16x16x32_bf16 v[76:79], a[240:243], a[136:139], v[76:79]
ds_read_b128 a[12:15], v241 offset:6144
v_mfma_f32_16x16x32_bf16 v[76:79], a[244:247], a[156:159], v[76:79]
ds_read_b128 a[32:35], v241 offset:7168
v_mfma_f32_16x16x32_bf16 v[120:123], a[248:251], a[120:123], v[120:123]
ds_read_b64_tr_b16 a[240:241], v234 offset:0
v_mfma_f32_16x16x32_bf16 v[120:123], a[252:255], a[140:143], v[120:123]
ds_read_b64_tr_b16 a[242:243], v234 offset:1024
s_add_u32 m0, s39, 61440
s_add_u32 s34, s42, 61440
v_mfma_f32_16x16x32_bf16 v[124:127], a[252:255], a[144:147], v[124:127]
buffer_load_dwordx4 v243, s[8:11], s34 offen offset:0 sc1 lds
ds_read_b128 a[16:19], v241 offset:8192
v_mfma_f32_16x16x32_bf16 v[124:127], a[248:251], a[124:127], v[124:127]
ds_read_b64_tr_b16 a[244:245], v236 offset:0
v_mfma_f32_16x16x32_bf16 v[128:131], a[248:251], a[128:131], v[128:131]
ds_read_b64_tr_b16 a[246:247], v236 offset:1024
v_mfma_f32_16x16x32_bf16 v[128:131], a[252:255], a[148:151], v[128:131]
ds_read_b128 a[36:39], v241 offset:9216
v_mfma_f32_16x16x32_bf16 v[132:135], a[252:255], a[152:155], v[132:135]
s_add_u32 m0, s48, 147456
v_mfma_f32_16x16x32_bf16 v[132:135], a[248:251], a[132:135], v[132:135]
buffer_load_dwordx4 v223, s[12:15], s35 offen offset:3072 lds
v_mfma_f32_16x16x32_bf16 v[136:139], a[248:251], a[136:139], v[136:139]
v_mfma_f32_16x16x32_bf16 v[136:139], a[252:255], a[156:159], v[136:139]
s_waitcnt lgkmcnt(4)
v_mfma_f32_16x16x32_bf16 v[140:143], a[184:187], a[120:123], v[140:143]
ds_read_b64_tr_b16 a[248:249], v234 offset:8
v_mfma_f32_16x16x32_bf16 v[140:143], a[188:191], a[140:143], v[140:143]
ds_read_b64_tr_b16 a[250:251], v234 offset:1032
s_add_u32 m0, s39, 61440
v_mfma_f32_16x16x32_bf16 v[144:147], a[188:191], a[144:147], v[144:147]
ds_read_b64_tr_b16 a[252:253], v236 offset:8
buffer_load_dwordx4 v243, s[8:11], s34 offen offset:1024 sc1 lds
v_mfma_f32_16x16x32_bf16 v[144:147], a[184:187], a[124:127], v[144:147]
ds_read_b64_tr_b16 a[254:255], v236 offset:1032
v_mfma_f32_16x16x32_bf16 v[148:151], a[184:187], a[128:131], v[148:151]
v_mfma_f32_16x16x32_bf16 v[148:151], a[188:191], a[148:151], v[148:151]
v_mfma_f32_16x16x32_bf16 v[152:155], a[188:191], a[152:155], v[152:155]
s_add_u32 m0, s39, 61440
v_mfma_f32_16x16x32_bf16 v[152:155], a[184:187], a[132:135], v[152:155]
buffer_load_dwordx4 v243, s[8:11], s34 offen offset:2048 sc1 lds
v_mfma_f32_16x16x32_bf16 v[156:159], a[184:187], a[136:139], v[156:159]
v_mfma_f32_16x16x32_bf16 v[156:159], a[188:191], a[156:159], v[156:159]
s_waitcnt vmcnt(19) lgkmcnt(0)
s_barrier
v_mfma_f32_16x16x32_bf16 v[160:163], a[192:195], a[120:123], v[160:163]
ds_read_b64_tr_b16 a[184:185], v233 offset:16384
v_mfma_f32_16x16x32_bf16 v[160:163], a[196:199], a[140:143], v[160:163]
ds_read_b64_tr_b16 a[186:187], v233 offset:17408
s_add_u32 m0, s48, 81920
s_xor_b32 s35, s44, 6291520
v_mfma_f32_16x16x32_bf16 v[164:167], a[196:199], a[144:147], v[164:167]
buffer_load_dwordx4 v220, s[12:15], s35 offen offset:0 lds
v_mfma_f32_16x16x32_bf16 v[164:167], a[192:195], a[124:127], v[164:167]
ds_read_b64_tr_b16 a[188:189], v235 offset:16384
v_mfma_f32_16x16x32_bf16 v[168:171], a[192:195], a[128:131], v[168:171]
ds_read_b64_tr_b16 a[190:191], v235 offset:17408
v_mfma_f32_16x16x32_bf16 v[168:171], a[196:199], a[148:151], v[168:171]
ds_read_b128 a[40:43], v241 offset:20480
v_mfma_f32_16x16x32_bf16 v[172:175], a[196:199], a[152:155], v[172:175]
s_add_u32 m0, s39, 61440
ds_read_b128 a[60:63], v241 offset:21504
v_mfma_f32_16x16x32_bf16 v[172:175], a[192:195], a[132:135], v[172:175]
buffer_load_dwordx4 v243, s[8:11], s34 offen offset:3072 sc1 lds
v_mfma_f32_16x16x32_bf16 v[176:179], a[192:195], a[136:139], v[176:179]
ds_read_b128 a[44:47], v241 offset:22528
v_mfma_f32_16x16x32_bf16 v[176:179], a[196:199], a[156:159], v[176:179]
ds_read_b128 a[64:67], v241 offset:23552
v_mfma_f32_16x16x32_bf16 v[180:183], a[240:243], a[120:123], v[180:183]
ds_read_b64_tr_b16 a[192:193], v233 offset:16392
v_mfma_f32_16x16x32_bf16 v[180:183], a[244:247], a[140:143], v[180:183]
ds_read_b64_tr_b16 a[194:195], v233 offset:17416
s_add_u32 m0, s48, 81920
v_mfma_f32_16x16x32_bf16 v[184:187], a[244:247], a[144:147], v[184:187]
buffer_load_dwordx4 v221, s[12:15], s35 offen offset:1024 lds
v_mfma_f32_16x16x32_bf16 v[184:187], a[240:243], a[124:127], v[184:187]
ds_read_b64_tr_b16 a[196:197], v235 offset:16392
v_mfma_f32_16x16x32_bf16 v[188:191], a[240:243], a[128:131], v[188:191]
ds_read_b64_tr_b16 a[198:199], v235 offset:17416
v_mfma_f32_16x16x32_bf16 v[188:191], a[244:247], a[148:151], v[188:191]
ds_read_b128 a[48:51], v241 offset:24576
v_mfma_f32_16x16x32_bf16 v[192:195], a[244:247], a[152:155], v[192:195]
s_add_u32 m0, s48, 81920
ds_read_b128 a[68:71], v241 offset:25600
v_mfma_f32_16x16x32_bf16 v[192:195], a[240:243], a[132:135], v[192:195]
buffer_load_dwordx4 v222, s[12:15], s35 offen offset:2048 lds
v_mfma_f32_16x16x32_bf16 v[196:199], a[240:243], a[136:139], v[196:199]
ds_read_b128 a[52:55], v241 offset:26624
v_mfma_f32_16x16x32_bf16 v[196:199], a[244:247], a[156:159], v[196:199]
ds_read_b128 a[72:75], v241 offset:27648
v_mfma_f32_16x16x32_bf16 v[200:203], a[248:251], a[120:123], v[200:203]
ds_read_b64_tr_b16 a[240:241], v234 offset:16384
v_mfma_f32_16x16x32_bf16 v[200:203], a[252:255], a[140:143], v[200:203]
ds_read_b64_tr_b16 a[242:243], v234 offset:17408
s_add_u32 m0, s39, 65536
v_mfma_f32_16x16x32_bf16 v[204:207], a[252:255], a[144:147], v[204:207]
buffer_load_dwordx4 v247, s[8:11], s34 offen sc1 lds
ds_read_b128 a[56:59], v241 offset:28672
v_mfma_f32_16x16x32_bf16 v[204:207], a[248:251], a[124:127], v[204:207]
ds_read_b64_tr_b16 a[244:245], v236 offset:16384
v_mfma_f32_16x16x32_bf16 v[208:211], a[248:251], a[128:131], v[208:211]
ds_read_b64_tr_b16 a[246:247], v236 offset:17408
v_mfma_f32_16x16x32_bf16 v[208:211], a[252:255], a[148:151], v[208:211]
ds_read_b128 a[76:79], v241 offset:29696
v_mfma_f32_16x16x32_bf16 v[212:215], a[252:255], a[152:155], v[212:215]
s_add_u32 m0, s48, 81920
v_mfma_f32_16x16x32_bf16 v[212:215], a[248:251], a[132:135], v[212:215]
buffer_load_dwordx4 v223, s[12:15], s35 offen offset:3072 lds
v_mfma_f32_16x16x32_bf16 v[216:219], a[248:251], a[136:139], v[216:219]
v_mfma_f32_16x16x32_bf16 v[216:219], a[252:255], a[156:159], v[216:219]
s_waitcnt lgkmcnt(4)
v_mfma_f32_16x16x32_bf16 v[180:183], a[184:187], a[0:3], v[180:183]
ds_read_b64_tr_b16 a[248:249], v234 offset:16392
v_mfma_f32_16x16x32_bf16 v[180:183], a[188:191], a[20:23], v[180:183]
ds_read_b64_tr_b16 a[250:251], v234 offset:17416
v_mfma_f32_16x16x32_bf16 v[184:187], a[188:191], a[24:27], v[184:187]
ds_read_b64_tr_b16 a[252:253], v236 offset:16392
v_mfma_f32_16x16x32_bf16 v[184:187], a[184:187], a[4:7], v[184:187]
ds_read_b64_tr_b16 a[254:255], v236 offset:17416
v_mfma_f32_16x16x32_bf16 v[188:191], a[184:187], a[8:11], v[188:191]
v_mfma_f32_16x16x32_bf16 v[188:191], a[188:191], a[28:31], v[188:191]
v_mfma_f32_16x16x32_bf16 v[192:195], a[188:191], a[32:35], v[192:195]
v_mfma_f32_16x16x32_bf16 v[192:195], a[184:187], a[12:15], v[192:195]
v_mfma_f32_16x16x32_bf16 v[196:199], a[184:187], a[16:19], v[196:199]
v_mfma_f32_16x16x32_bf16 v[196:199], a[188:191], a[36:39], v[196:199]
s_waitcnt vmcnt(12) lgkmcnt(0)
s_barrier
v_mfma_f32_16x16x32_bf16 v[200:203], a[192:195], a[0:3], v[200:203]
ds_read_b64_tr_b16 a[184:185], v233 offset:32768
v_mfma_f32_16x16x32_bf16 v[200:203], a[196:199], a[20:23], v[200:203]
ds_read_b64_tr_b16 a[186:187], v233 offset:33792
s_add_u32 m0, s48, 98304
s_xor_b32 s35, s44, 6422592
v_mfma_f32_16x16x32_bf16 v[204:207], a[196:199], a[24:27], v[204:207]
buffer_load_dwordx4 v220, s[12:15], s35 offen offset:0 lds
v_mfma_f32_16x16x32_bf16 v[204:207], a[192:195], a[4:7], v[204:207]
ds_read_b64_tr_b16 a[188:189], v235 offset:32768
v_mfma_f32_16x16x32_bf16 v[208:211], a[192:195], a[8:11], v[208:211]
ds_read_b64_tr_b16 a[190:191], v235 offset:33792
v_mfma_f32_16x16x32_bf16 v[208:211], a[196:199], a[28:31], v[208:211]
ds_read_b128 a[80:83], v242 offset:0
v_mfma_f32_16x16x32_bf16 v[212:215], a[196:199], a[32:35], v[212:215]
ds_read_b128 a[100:103], v242 offset:1024
v_mfma_f32_16x16x32_bf16 v[212:215], a[192:195], a[12:15], v[212:215]
v_mfma_f32_16x16x32_bf16 v[216:219], a[192:195], a[16:19], v[216:219]
ds_read_b128 a[84:87], v242 offset:2048
v_mfma_f32_16x16x32_bf16 v[216:219], a[196:199], a[36:39], v[216:219]
ds_read_b128 a[104:107], v242 offset:3072
v_mfma_f32_16x16x32_bf16 v[180:183], a[240:243], a[40:43], v[180:183]
ds_read_b64_tr_b16 a[192:193], v233 offset:32776
v_mfma_f32_16x16x32_bf16 v[180:183], a[244:247], a[60:63], v[180:183]
ds_read_b64_tr_b16 a[194:195], v233 offset:33800
s_add_u32 m0, s48, 98304
v_mfma_f32_16x16x32_bf16 v[184:187], a[244:247], a[64:67], v[184:187]
buffer_load_dwordx4 v221, s[12:15], s35 offen offset:1024 lds
v_mfma_f32_16x16x32_bf16 v[184:187], a[240:243], a[44:47], v[184:187]
ds_read_b64_tr_b16 a[196:197], v235 offset:32776
v_mfma_f32_16x16x32_bf16 v[188:191], a[240:243], a[48:51], v[188:191]
ds_read_b64_tr_b16 a[198:199], v235 offset:33800
v_mfma_f32_16x16x32_bf16 v[188:191], a[244:247], a[68:71], v[188:191]
ds_read_b128 a[88:91], v242 offset:4096
v_mfma_f32_16x16x32_bf16 v[192:195], a[244:247], a[72:75], v[192:195]
s_add_u32 m0, s48, 98304
ds_read_b128 a[108:111], v242 offset:5120
v_mfma_f32_16x16x32_bf16 v[192:195], a[240:243], a[52:55], v[192:195]
buffer_load_dwordx4 v222, s[12:15], s35 offen offset:2048 lds
v_mfma_f32_16x16x32_bf16 v[196:199], a[240:243], a[56:59], v[196:199]
ds_read_b128 a[92:95], v242 offset:6144
v_mfma_f32_16x16x32_bf16 v[196:199], a[244:247], a[76:79], v[196:199]
ds_read_b128 a[112:115], v242 offset:7168
v_mfma_f32_16x16x32_bf16 v[200:203], a[248:251], a[40:43], v[200:203]
ds_read_b64_tr_b16 a[240:241], v234 offset:32768
v_mfma_f32_16x16x32_bf16 v[200:203], a[252:255], a[60:63], v[200:203]
ds_read_b64_tr_b16 a[242:243], v234 offset:33792
v_mfma_f32_16x16x32_bf16 v[204:207], a[252:255], a[64:67], v[204:207]
ds_read_b128 a[96:99], v242 offset:8192
v_mfma_f32_16x16x32_bf16 v[204:207], a[248:251], a[44:47], v[204:207]
ds_read_b64_tr_b16 a[244:245], v236 offset:32768
v_mfma_f32_16x16x32_bf16 v[208:211], a[248:251], a[48:51], v[208:211]
ds_read_b64_tr_b16 a[246:247], v236 offset:33792
v_mfma_f32_16x16x32_bf16 v[208:211], a[252:255], a[68:71], v[208:211]
ds_read_b128 a[116:119], v242 offset:9216
v_mfma_f32_16x16x32_bf16 v[212:215], a[252:255], a[72:75], v[212:215]
s_add_u32 m0, s48, 98304
v_mfma_f32_16x16x32_bf16 v[212:215], a[248:251], a[52:55], v[212:215]
buffer_load_dwordx4 v223, s[12:15], s35 offen offset:3072 lds
v_mfma_f32_16x16x32_bf16 v[216:219], a[248:251], a[56:59], v[216:219]
v_mfma_f32_16x16x32_bf16 v[216:219], a[252:255], a[76:79], v[216:219]
s_waitcnt lgkmcnt(4)
v_mfma_f32_16x16x32_bf16 v[180:183], a[184:187], a[80:83], v[180:183]
ds_read_b64_tr_b16 a[248:249], v234 offset:32776
v_mfma_f32_16x16x32_bf16 v[180:183], a[188:191], a[100:103], v[180:183]
ds_read_b64_tr_b16 a[250:251], v234 offset:33800
v_mfma_f32_16x16x32_bf16 v[184:187], a[188:191], a[104:107], v[184:187]
ds_read_b64_tr_b16 a[252:253], v236 offset:32776
v_mfma_f32_16x16x32_bf16 v[184:187], a[184:187], a[84:87], v[184:187]
ds_read_b64_tr_b16 a[254:255], v236 offset:33800
v_mfma_f32_16x16x32_bf16 v[188:191], a[184:187], a[88:91], v[188:191]
v_mfma_f32_16x16x32_bf16 v[188:191], a[188:191], a[108:111], v[188:191]
v_mfma_f32_16x16x32_bf16 v[192:195], a[188:191], a[112:115], v[192:195]
v_mfma_f32_16x16x32_bf16 v[192:195], a[184:187], a[92:95], v[192:195]
s_waitcnt lgkmcnt(4)
v_mfma_f32_16x16x32_bf16 v[196:199], a[184:187], a[96:99], v[196:199]
v_mfma_f32_16x16x32_bf16 v[196:199], a[188:191], a[116:119], v[196:199]
s_waitcnt vmcnt(5) lgkmcnt(0)
s_barrier
v_mfma_f32_16x16x32_bf16 v[200:203], a[192:195], a[80:83], v[200:203]
ds_read_b64_tr_b16 a[184:185], v237 offset:0
ds_read_b128 v[0:3], v242 offset:20480
v_mfma_f32_16x16x32_bf16 v[200:203], a[196:199], a[100:103], v[200:203]
ds_read_b64_tr_b16 a[186:187], v237 offset:1024
s_add_u32 m0, s48, 114688
s_xor_b32 s35, s44, 6291456
ds_read_b128 v[20:23], v242 offset:21504
v_mfma_f32_16x16x32_bf16 v[204:207], a[196:199], a[104:107], v[204:207]
buffer_load_dwordx4 v220, s[12:15], s35 offen offset:0 lds
ds_read_b128 v[4:7], v242 offset:22528
v_mfma_f32_16x16x32_bf16 v[204:207], a[192:195], a[84:87], v[204:207]
ds_read_b64_tr_b16 a[188:189], v239 offset:0
ds_read_b128 v[24:27], v242 offset:23552
v_mfma_f32_16x16x32_bf16 v[208:211], a[192:195], a[88:91], v[208:211]
ds_read_b64_tr_b16 a[190:191], v239 offset:1024
ds_read_b128 v[8:11], v242 offset:24576
v_mfma_f32_16x16x32_bf16 v[208:211], a[196:199], a[108:111], v[208:211]
ds_read_b128 v[28:31], v242 offset:25600
v_mfma_f32_16x16x32_bf16 v[212:215], a[196:199], a[112:115], v[212:215]
ds_read_b128 v[12:15], v242 offset:26624
v_mfma_f32_16x16x32_bf16 v[212:215], a[192:195], a[92:95], v[212:215]
ds_read_b128 v[32:35], v242 offset:27648
v_mfma_f32_16x16x32_bf16 v[216:219], a[192:195], a[96:99], v[216:219]
ds_read_b128 v[16:19], v242 offset:28672
v_mfma_f32_16x16x32_bf16 v[216:219], a[196:199], a[116:119], v[216:219]
ds_read_b128 v[36:39], v242 offset:29696
s_waitcnt lgkmcnt(7)
v_mfma_f32_16x16x32_bf16 v[180:183], a[240:243], v[0:3], v[180:183]
ds_read_b64_tr_b16 a[192:193], v237 offset:8
v_mfma_f32_16x16x32_bf16 v[180:183], a[244:247], v[20:23], v[180:183]
ds_read_b64_tr_b16 a[194:195], v237 offset:1032
s_add_u32 m0, s48, 114688
v_mfma_f32_16x16x32_bf16 v[184:187], a[244:247], v[24:27], v[184:187]
buffer_load_dwordx4 v221, s[12:15], s35 offen offset:1024 lds
v_mfma_f32_16x16x32_bf16 v[184:187], a[240:243], v[4:7], v[184:187]
ds_read_b64_tr_b16 a[196:197], v239 offset:8
s_waitcnt lgkmcnt(5)
v_mfma_f32_16x16x32_bf16 v[188:191], a[240:243], v[8:11], v[188:191]
ds_read_b64_tr_b16 a[198:199], v239 offset:1032
v_mfma_f32_16x16x32_bf16 v[188:191], a[244:247], v[28:31], v[188:191]
v_mfma_f32_16x16x32_bf16 v[192:195], a[244:247], v[32:35], v[192:195]
s_add_u32 m0, s48, 114688
v_mfma_f32_16x16x32_bf16 v[192:195], a[240:243], v[12:15], v[192:195]
buffer_load_dwordx4 v222, s[12:15], s35 offen offset:2048 lds
s_waitcnt lgkmcnt(2)
v_mfma_f32_16x16x32_bf16 v[196:199], a[240:243], v[16:19], v[196:199]
v_mfma_f32_16x16x32_bf16 v[196:199], a[244:247], v[36:39], v[196:199]
v_mfma_f32_16x16x32_bf16 v[200:203], a[248:251], v[0:3], v[200:203]
ds_read_b64_tr_b16 a[240:241], v238 offset:0
v_mfma_f32_16x16x32_bf16 v[200:203], a[252:255], v[20:23], v[200:203]
ds_read_b64_tr_b16 a[242:243], v238 offset:1024
v_mfma_f32_16x16x32_bf16 v[204:207], a[252:255], v[24:27], v[204:207]
v_mfma_f32_16x16x32_bf16 v[204:207], a[248:251], v[4:7], v[204:207]
ds_read_b64_tr_b16 a[244:245], v240 offset:0
v_mfma_f32_16x16x32_bf16 v[208:211], a[248:251], v[8:11], v[208:211]
ds_read_b64_tr_b16 a[246:247], v240 offset:1024
v_mfma_f32_16x16x32_bf16 v[208:211], a[252:255], v[28:31], v[208:211]
v_mfma_f32_16x16x32_bf16 v[212:215], a[252:255], v[32:35], v[212:215]
s_add_u32 m0, s48, 114688
v_mfma_f32_16x16x32_bf16 v[212:215], a[248:251], v[12:15], v[212:215]
buffer_load_dwordx4 v223, s[12:15], s35 offen offset:3072 lds
v_mfma_f32_16x16x32_bf16 v[216:219], a[248:251], v[16:19], v[216:219]
v_mfma_f32_16x16x32_bf16 v[216:219], a[252:255], v[36:39], v[216:219]
s_waitcnt lgkmcnt(4)
v_mfma_f32_16x16x32_bf16 v[140:143], a[184:187], a[0:3], v[140:143]
ds_read_b64_tr_b16 a[248:249], v238 offset:8
v_mfma_f32_16x16x32_bf16 v[140:143], a[188:191], a[20:23], v[140:143]
ds_read_b64_tr_b16 a[250:251], v238 offset:1032
v_mfma_f32_16x16x32_bf16 v[144:147], a[188:191], a[24:27], v[144:147]
ds_read_b64_tr_b16 a[252:253], v240 offset:8
v_mfma_f32_16x16x32_bf16 v[144:147], a[184:187], a[4:7], v[144:147]
ds_read_b64_tr_b16 a[254:255], v240 offset:1032
v_mfma_f32_16x16x32_bf16 v[148:151], a[184:187], a[8:11], v[148:151]
v_mfma_f32_16x16x32_bf16 v[148:151], a[188:191], a[28:31], v[148:151]
v_mfma_f32_16x16x32_bf16 v[152:155], a[188:191], a[32:35], v[152:155]
v_mfma_f32_16x16x32_bf16 v[152:155], a[184:187], a[12:15], v[152:155]
v_mfma_f32_16x16x32_bf16 v[156:159], a[184:187], a[16:19], v[156:159]
v_mfma_f32_16x16x32_bf16 v[156:159], a[188:191], a[36:39], v[156:159]
s_waitcnt lgkmcnt(0)
s_barrier
v_mfma_f32_16x16x32_bf16 v[160:163], a[192:195], a[0:3], v[160:163]
ds_read_b64_tr_b16 a[184:185], v237 offset:16384
v_mfma_f32_16x16x32_bf16 v[160:163], a[196:199], a[20:23], v[160:163]
ds_read_b64_tr_b16 a[186:187], v237 offset:17408
s_add_u32 m0, s48, 131072
s_xor_b32 s35, s44, 6422528
v_mfma_f32_16x16x32_bf16 v[164:167], a[196:199], a[24:27], v[164:167]
buffer_load_dwordx4 v220, s[12:15], s35 offen offset:0 lds
v_mfma_f32_16x16x32_bf16 v[164:167], a[192:195], a[4:7], v[164:167]
ds_read_b64_tr_b16 a[188:189], v239 offset:16384
v_mfma_f32_16x16x32_bf16 v[168:171], a[192:195], a[8:11], v[168:171]
ds_read_b64_tr_b16 a[190:191], v239 offset:17408
v_mfma_f32_16x16x32_bf16 v[168:171], a[196:199], a[28:31], v[168:171]
s_add_u32 m0, s48, 131072
v_mfma_f32_16x16x32_bf16 v[172:175], a[196:199], a[32:35], v[172:175]
buffer_load_dwordx4 v221, s[12:15], s35 offen offset:1024 lds
v_mfma_f32_16x16x32_bf16 v[172:175], a[192:195], a[12:15], v[172:175]
v_mfma_f32_16x16x32_bf16 v[176:179], a[192:195], a[16:19], v[176:179]
v_mfma_f32_16x16x32_bf16 v[176:179], a[196:199], a[36:39], v[176:179]
v_mfma_f32_16x16x32_bf16 v[140:143], a[240:243], a[40:43], v[140:143]
ds_read_b64_tr_b16 a[192:193], v237 offset:16392
v_mfma_f32_16x16x32_bf16 v[140:143], a[244:247], a[60:63], v[140:143]
ds_read_b64_tr_b16 a[194:195], v237 offset:17416
s_add_u32 m0, s48, 131072
v_mfma_f32_16x16x32_bf16 v[144:147], a[244:247], a[64:67], v[144:147]
buffer_load_dwordx4 v222, s[12:15], s35 offen offset:2048 lds
v_mfma_f32_16x16x32_bf16 v[144:147], a[240:243], a[44:47], v[144:147]
ds_read_b64_tr_b16 a[196:197], v239 offset:16392
v_mfma_f32_16x16x32_bf16 v[148:151], a[240:243], a[48:51], v[148:151]
ds_read_b64_tr_b16 a[198:199], v239 offset:17416
v_mfma_f32_16x16x32_bf16 v[148:151], a[244:247], a[68:71], v[148:151]
s_add_u32 m0, s48, 131072
v_mfma_f32_16x16x32_bf16 v[152:155], a[244:247], a[72:75], v[152:155]
buffer_load_dwordx4 v223, s[12:15], s35 offen offset:3072 lds
v_mfma_f32_16x16x32_bf16 v[152:155], a[240:243], a[52:55], v[152:155]
v_mfma_f32_16x16x32_bf16 v[156:159], a[240:243], a[56:59], v[156:159]
v_mfma_f32_16x16x32_bf16 v[156:159], a[244:247], a[76:79], v[156:159]
v_mfma_f32_16x16x32_bf16 v[160:163], a[248:251], a[40:43], v[160:163]
ds_read_b64_tr_b16 a[240:241], v238 offset:16384
v_cvt_pk_bf16_f32 v40, v180, v181
v_cvt_pk_bf16_f32 v41, v182, v183
v_mfma_f32_16x16x32_bf16 v[160:163], a[252:255], a[60:63], v[160:163]
ds_read_b64_tr_b16 a[242:243], v238 offset:17408
v_cvt_pk_bf16_f32 v42, v200, v201
v_cvt_pk_bf16_f32 v43, v202, v203
v_mfma_f32_16x16x32_bf16 v[164:167], a[252:255], a[64:67], v[164:167]
buffer_store_dwordx4 v[40:43], v243, s[24:27], s58 offen offset:0 sc1
v_mfma_f32_16x16x32_bf16 v[164:167], a[248:251], a[44:47], v[164:167]
ds_read_b64_tr_b16 a[244:245], v240 offset:16384
v_mfma_f32_16x16x32_bf16 v[168:171], a[248:251], a[48:51], v[168:171]
ds_read_b64_tr_b16 a[246:247], v240 offset:17408
v_mfma_f32_16x16x32_bf16 v[168:171], a[252:255], a[68:71], v[168:171]
v_cvt_pk_bf16_f32 v44, v184, v185
v_cvt_pk_bf16_f32 v45, v186, v187
v_mfma_f32_16x16x32_bf16 v[172:175], a[252:255], a[72:75], v[172:175]
v_cvt_pk_bf16_f32 v46, v204, v205
v_cvt_pk_bf16_f32 v47, v206, v207
v_mfma_f32_16x16x32_bf16 v[172:175], a[248:251], a[52:55], v[172:175]
buffer_store_dwordx4 v[44:47], v243, s[24:27], s58 offen offset:1024 sc1
v_mfma_f32_16x16x32_bf16 v[176:179], a[248:251], a[56:59], v[176:179]
v_mfma_f32_16x16x32_bf16 v[176:179], a[252:255], a[76:79], v[176:179]
s_waitcnt lgkmcnt(4)
v_mfma_f32_16x16x32_bf16 v[140:143], a[184:187], a[80:83], v[140:143]
ds_read_b64_tr_b16 a[248:249], v238 offset:16392
v_mfma_f32_16x16x32_bf16 v[140:143], a[188:191], a[100:103], v[140:143]
ds_read_b64_tr_b16 a[250:251], v238 offset:17416
v_mfma_f32_16x16x32_bf16 v[144:147], a[188:191], a[104:107], v[144:147]
ds_read_b64_tr_b16 a[252:253], v240 offset:16392
v_mfma_f32_16x16x32_bf16 v[144:147], a[184:187], a[84:87], v[144:147]
ds_read_b64_tr_b16 a[254:255], v240 offset:17416
v_mfma_f32_16x16x32_bf16 v[148:151], a[184:187], a[88:91], v[148:151]
v_cvt_pk_bf16_f32 v48, v188, v189
v_cvt_pk_bf16_f32 v49, v190, v191
v_mfma_f32_16x16x32_bf16 v[148:151], a[188:191], a[108:111], v[148:151]
v_cvt_pk_bf16_f32 v50, v208, v209
v_cvt_pk_bf16_f32 v51, v210, v211
v_mfma_f32_16x16x32_bf16 v[152:155], a[188:191], a[112:115], v[152:155]
buffer_store_dwordx4 v[48:51], v243, s[24:27], s58 offen offset:2048 sc1
v_mfma_f32_16x16x32_bf16 v[152:155], a[184:187], a[92:95], v[152:155]
v_mfma_f32_16x16x32_bf16 v[156:159], a[184:187], a[96:99], v[156:159]
v_mfma_f32_16x16x32_bf16 v[156:159], a[188:191], a[116:119], v[156:159]
s_waitcnt vmcnt(15) lgkmcnt(0)
s_barrier
v_mfma_f32_16x16x32_bf16 v[160:163], a[192:195], a[80:83], v[160:163]
ds_read_b64_tr_b16 a[184:185], v233 offset:0
v_mfma_f32_16x16x32_bf16 v[160:163], a[196:199], a[100:103], v[160:163]
ds_read_b64_tr_b16 a[186:187], v233 offset:1024
s_add_u32 m0, s48, 147456
s_xor_b32 s35, s44, 4325376
v_mfma_f32_16x16x32_bf16 v[164:167], a[196:199], a[104:107], v[164:167]
buffer_load_dwordx4 v220, s[12:15], s35 offen offset:0 lds
v_mfma_f32_16x16x32_bf16 v[164:167], a[192:195], a[84:87], v[164:167]
ds_read_b64_tr_b16 a[188:189], v235 offset:0
v_mfma_f32_16x16x32_bf16 v[168:171], a[192:195], a[88:91], v[168:171]
ds_read_b64_tr_b16 a[190:191], v235 offset:1024
v_mfma_f32_16x16x32_bf16 v[168:171], a[196:199], a[108:111], v[168:171]
s_add_u32 m0, s48, 147456
v_mfma_f32_16x16x32_bf16 v[172:175], a[196:199], a[112:115], v[172:175]
buffer_load_dwordx4 v221, s[12:15], s35 offen offset:1024 lds
v_mfma_f32_16x16x32_bf16 v[172:175], a[192:195], a[92:95], v[172:175]
v_mfma_f32_16x16x32_bf16 v[176:179], a[192:195], a[96:99], v[176:179]
v_mfma_f32_16x16x32_bf16 v[176:179], a[196:199], a[116:119], v[176:179]
v_mfma_f32_16x16x32_bf16 v[140:143], a[240:243], v[0:3], v[140:143]
ds_read_b64_tr_b16 a[192:193], v233 offset:8
v_mfma_f32_16x16x32_bf16 v[140:143], a[244:247], v[20:23], v[140:143]
ds_read_b64_tr_b16 a[194:195], v233 offset:1032
s_add_u32 m0, s48, 147456
v_mfma_f32_16x16x32_bf16 v[144:147], a[244:247], v[24:27], v[144:147]
buffer_load_dwordx4 v222, s[12:15], s35 offen offset:2048 lds
v_mfma_f32_16x16x32_bf16 v[144:147], a[240:243], v[4:7], v[144:147]
ds_read_b64_tr_b16 a[196:197], v235 offset:8
v_mfma_f32_16x16x32_bf16 v[148:151], a[240:243], v[8:11], v[148:151]
ds_read_b64_tr_b16 a[198:199], v235 offset:1032
v_mfma_f32_16x16x32_bf16 v[148:151], a[244:247], v[28:31], v[148:151]
s_add_u32 m0, s48, 147456
v_mfma_f32_16x16x32_bf16 v[152:155], a[244:247], v[32:35], v[152:155]
buffer_load_dwordx4 v223, s[12:15], s35 offen offset:3072 lds
v_mfma_f32_16x16x32_bf16 v[152:155], a[240:243], v[12:15], v[152:155]
v_mfma_f32_16x16x32_bf16 v[156:159], a[240:243], v[16:19], v[156:159]
v_mfma_f32_16x16x32_bf16 v[156:159], a[244:247], v[36:39], v[156:159]
v_mfma_f32_16x16x32_bf16 v[160:163], a[248:251], v[0:3], v[160:163]
ds_read_b64_tr_b16 a[240:241], v234 offset:0
v_cvt_pk_bf16_f32 v52, v192, v193
v_cvt_pk_bf16_f32 v53, v194, v195
v_mfma_f32_16x16x32_bf16 v[160:163], a[252:255], v[20:23], v[160:163]
ds_read_b64_tr_b16 a[242:243], v234 offset:1024
v_cvt_pk_bf16_f32 v54, v212, v213
v_cvt_pk_bf16_f32 v55, v214, v215
v_mfma_f32_16x16x32_bf16 v[164:167], a[252:255], v[24:27], v[164:167]
buffer_store_dwordx4 v[52:55], v243, s[24:27], s58 offen offset:3072 sc1
v_mfma_f32_16x16x32_bf16 v[164:167], a[248:251], v[4:7], v[164:167]
ds_read_b64_tr_b16 a[244:245], v236 offset:0
v_mfma_f32_16x16x32_bf16 v[168:171], a[248:251], v[8:11], v[168:171]
ds_read_b64_tr_b16 a[246:247], v236 offset:1024
v_mfma_f32_16x16x32_bf16 v[168:171], a[252:255], v[28:31], v[168:171]
v_cvt_pk_bf16_f32 v56, v196, v197
v_cvt_pk_bf16_f32 v57, v198, v199
v_mfma_f32_16x16x32_bf16 v[172:175], a[252:255], v[32:35], v[172:175]
v_cvt_pk_bf16_f32 v58, v216, v217
v_cvt_pk_bf16_f32 v59, v218, v219
v_mfma_f32_16x16x32_bf16 v[172:175], a[248:251], v[12:15], v[172:175]
buffer_store_dwordx4 v[56:59], v247, s[24:27], s58 offen sc1
v_mfma_f32_16x16x32_bf16 v[176:179], a[248:251], v[16:19], v[176:179]
v_mfma_f32_16x16x32_bf16 v[176:179], a[252:255], v[36:39], v[176:179]
s_waitcnt lgkmcnt(4)
v_mfma_f32_16x16x32_bf16 v[60:63], a[184:187], a[0:3], v[60:63]
ds_read_b64_tr_b16 a[248:249], v234 offset:8
v_mfma_f32_16x16x32_bf16 v[60:63], a[188:191], a[20:23], v[60:63]
ds_read_b64_tr_b16 a[250:251], v234 offset:1032
v_mfma_f32_16x16x32_bf16 v[64:67], a[188:191], a[24:27], v[64:67]
ds_read_b64_tr_b16 a[252:253], v236 offset:8
v_mfma_f32_16x16x32_bf16 v[64:67], a[184:187], a[4:7], v[64:67]
ds_read_b64_tr_b16 a[254:255], v236 offset:1032
v_mfma_f32_16x16x32_bf16 v[68:71], a[184:187], a[8:11], v[68:71]
v_mfma_f32_16x16x32_bf16 v[68:71], a[188:191], a[28:31], v[68:71]
v_mfma_f32_16x16x32_bf16 v[72:75], a[188:191], a[32:35], v[72:75]
v_mfma_f32_16x16x32_bf16 v[72:75], a[184:187], a[12:15], v[72:75]
v_mfma_f32_16x16x32_bf16 v[76:79], a[184:187], a[16:19], v[76:79]
v_mfma_f32_16x16x32_bf16 v[76:79], a[188:191], a[36:39], v[76:79]
s_waitcnt vmcnt(17) lgkmcnt(0)
s_barrier
v_mfma_f32_16x16x32_bf16 v[120:123], a[192:195], a[0:3], v[120:123]
ds_read_b64_tr_b16 a[184:185], v233 offset:16384
v_cvt_pk_bf16_f32 v40, v140, v141
v_cvt_pk_bf16_f32 v41, v142, v143
v_mfma_f32_16x16x32_bf16 v[120:123], a[196:199], a[20:23], v[120:123]
ds_read_b64_tr_b16 a[186:187], v233 offset:17408
v_cvt_pk_bf16_f32 v42, v160, v161
v_cvt_pk_bf16_f32 v43, v162, v163
v_mfma_f32_16x16x32_bf16 v[124:127], a[196:199], a[24:27], v[124:127]
buffer_store_dwordx4 v[40:43], v243, s[24:27], s57 offen offset:0 sc1
v_mfma_f32_16x16x32_bf16 v[124:127], a[192:195], a[4:7], v[124:127]
ds_read_b64_tr_b16 a[188:189], v235 offset:16384
v_mfma_f32_16x16x32_bf16 v[128:131], a[192:195], a[8:11], v[128:131]
ds_read_b64_tr_b16 a[190:191], v235 offset:17408
v_mfma_f32_16x16x32_bf16 v[128:131], a[196:199], a[28:31], v[128:131]
v_mfma_f32_16x16x32_bf16 v[132:135], a[196:199], a[32:35], v[132:135]
v_mfma_f32_16x16x32_bf16 v[132:135], a[192:195], a[12:15], v[132:135]
v_mfma_f32_16x16x32_bf16 v[136:139], a[192:195], a[16:19], v[136:139]
v_mfma_f32_16x16x32_bf16 v[136:139], a[196:199], a[36:39], v[136:139]
v_mfma_f32_16x16x32_bf16 v[60:63], a[240:243], a[40:43], v[60:63]
ds_read_b64_tr_b16 a[192:193], v233 offset:16392
v_cvt_pk_bf16_f32 v44, v144, v145
v_cvt_pk_bf16_f32 v45, v146, v147
v_mfma_f32_16x16x32_bf16 v[60:63], a[244:247], a[60:63], v[60:63]
ds_read_b64_tr_b16 a[194:195], v233 offset:17416
v_cvt_pk_bf16_f32 v46, v164, v165
v_cvt_pk_bf16_f32 v47, v166, v167
v_mfma_f32_16x16x32_bf16 v[64:67], a[244:247], a[64:67], v[64:67]
buffer_store_dwordx4 v[44:47], v243, s[24:27], s57 offen offset:1024 sc1
v_mfma_f32_16x16x32_bf16 v[64:67], a[240:243], a[44:47], v[64:67]
ds_read_b64_tr_b16 a[196:197], v235 offset:16392
v_mfma_f32_16x16x32_bf16 v[68:71], a[240:243], a[48:51], v[68:71]
ds_read_b64_tr_b16 a[198:199], v235 offset:17416
v_mfma_f32_16x16x32_bf16 v[68:71], a[244:247], a[68:71], v[68:71]
v_mfma_f32_16x16x32_bf16 v[72:75], a[244:247], a[72:75], v[72:75]
v_mfma_f32_16x16x32_bf16 v[72:75], a[240:243], a[52:55], v[72:75]
v_mfma_f32_16x16x32_bf16 v[76:79], a[240:243], a[56:59], v[76:79]
v_mfma_f32_16x16x32_bf16 v[76:79], a[244:247], a[76:79], v[76:79]
v_mfma_f32_16x16x32_bf16 v[120:123], a[248:251], a[40:43], v[120:123]
ds_read_b64_tr_b16 a[240:241], v234 offset:16384
v_cvt_pk_bf16_f32 v48, v148, v149
v_cvt_pk_bf16_f32 v49, v150, v151
v_mfma_f32_16x16x32_bf16 v[120:123], a[252:255], a[60:63], v[120:123]
ds_read_b64_tr_b16 a[242:243], v234 offset:17408
v_cvt_pk_bf16_f32 v50, v168, v169
v_cvt_pk_bf16_f32 v51, v170, v171
v_mfma_f32_16x16x32_bf16 v[124:127], a[252:255], a[64:67], v[124:127]
buffer_store_dwordx4 v[48:51], v243, s[24:27], s57 offen offset:2048 sc1
v_mfma_f32_16x16x32_bf16 v[124:127], a[248:251], a[44:47], v[124:127]
ds_read_b64_tr_b16 a[244:245], v236 offset:16384
v_mfma_f32_16x16x32_bf16 v[128:131], a[248:251], a[48:51], v[128:131]
ds_read_b64_tr_b16 a[246:247], v236 offset:17408
v_mfma_f32_16x16x32_bf16 v[128:131], a[252:255], a[68:71], v[128:131]
v_mfma_f32_16x16x32_bf16 v[132:135], a[252:255], a[72:75], v[132:135]
v_mfma_f32_16x16x32_bf16 v[132:135], a[248:251], a[52:55], v[132:135]
v_mfma_f32_16x16x32_bf16 v[136:139], a[248:251], a[56:59], v[136:139]
v_mfma_f32_16x16x32_bf16 v[136:139], a[252:255], a[76:79], v[136:139]
s_waitcnt lgkmcnt(4)
v_mfma_f32_16x16x32_bf16 v[60:63], a[184:187], a[80:83], v[60:63]
ds_read_b64_tr_b16 a[248:249], v234 offset:16392
v_mfma_f32_16x16x32_bf16 v[60:63], a[188:191], a[100:103], v[60:63]
ds_read_b64_tr_b16 a[250:251], v234 offset:17416
v_mfma_f32_16x16x32_bf16 v[64:67], a[188:191], a[104:107], v[64:67]
ds_read_b64_tr_b16 a[252:253], v236 offset:16392
v_mfma_f32_16x16x32_bf16 v[64:67], a[184:187], a[84:87], v[64:67]
ds_read_b64_tr_b16 a[254:255], v236 offset:17416
v_mfma_f32_16x16x32_bf16 v[68:71], a[184:187], a[88:91], v[68:71]
v_cvt_pk_bf16_f32 v52, v152, v153
v_cvt_pk_bf16_f32 v53, v154, v155
v_mfma_f32_16x16x32_bf16 v[68:71], a[188:191], a[108:111], v[68:71]
v_cvt_pk_bf16_f32 v54, v172, v173
v_cvt_pk_bf16_f32 v55, v174, v175
v_mfma_f32_16x16x32_bf16 v[72:75], a[188:191], a[112:115], v[72:75]
buffer_store_dwordx4 v[52:55], v243, s[24:27], s57 offen offset:3072 sc1
v_mfma_f32_16x16x32_bf16 v[72:75], a[184:187], a[92:95], v[72:75]
v_mfma_f32_16x16x32_bf16 v[76:79], a[184:187], a[96:99], v[76:79]
v_mfma_f32_16x16x32_bf16 v[76:79], a[188:191], a[116:119], v[76:79]
s_waitcnt vmcnt(17) lgkmcnt(0)
s_barrier
v_mfma_f32_16x16x32_bf16 v[120:123], a[192:195], a[80:83], v[120:123]
ds_read_b64_tr_b16 a[184:185], v233 offset:32768
v_mfma_f32_16x16x32_bf16 v[120:123], a[196:199], a[100:103], v[120:123]
ds_read_b64_tr_b16 a[186:187], v233 offset:33792
v_mfma_f32_16x16x32_bf16 v[124:127], a[196:199], a[104:107], v[124:127]
v_mfma_f32_16x16x32_bf16 v[124:127], a[192:195], a[84:87], v[124:127]
ds_read_b64_tr_b16 a[188:189], v235 offset:32768
v_mfma_f32_16x16x32_bf16 v[128:131], a[192:195], a[88:91], v[128:131]
ds_read_b64_tr_b16 a[190:191], v235 offset:33792
v_mfma_f32_16x16x32_bf16 v[128:131], a[196:199], a[108:111], v[128:131]
v_cvt_pk_bf16_f32 v56, v156, v157
v_cvt_pk_bf16_f32 v57, v158, v159
v_mfma_f32_16x16x32_bf16 v[132:135], a[196:199], a[112:115], v[132:135]
v_cvt_pk_bf16_f32 v58, v176, v177
v_cvt_pk_bf16_f32 v59, v178, v179
v_mfma_f32_16x16x32_bf16 v[132:135], a[192:195], a[92:95], v[132:135]
buffer_store_dwordx4 v[56:59], v247, s[24:27], s57 offen sc1
v_mfma_f32_16x16x32_bf16 v[136:139], a[192:195], a[96:99], v[136:139]
v_mfma_f32_16x16x32_bf16 v[136:139], a[196:199], a[116:119], v[136:139]
v_mfma_f32_16x16x32_bf16 v[60:63], a[240:243], v[0:3], v[60:63]
ds_read_b64_tr_b16 a[192:193], v233 offset:32776
v_mfma_f32_16x16x32_bf16 v[60:63], a[244:247], v[20:23], v[60:63]
ds_read_b64_tr_b16 a[194:195], v233 offset:33800
v_mfma_f32_16x16x32_bf16 v[64:67], a[244:247], v[24:27], v[64:67]
v_mfma_f32_16x16x32_bf16 v[64:67], a[240:243], v[4:7], v[64:67]
ds_read_b64_tr_b16 a[196:197], v235 offset:32776
v_mfma_f32_16x16x32_bf16 v[68:71], a[240:243], v[8:11], v[68:71]
ds_read_b64_tr_b16 a[198:199], v235 offset:33800
v_mfma_f32_16x16x32_bf16 v[68:71], a[244:247], v[28:31], v[68:71]
v_mfma_f32_16x16x32_bf16 v[72:75], a[244:247], v[32:35], v[72:75]
v_mfma_f32_16x16x32_bf16 v[72:75], a[240:243], v[12:15], v[72:75]
v_mfma_f32_16x16x32_bf16 v[76:79], a[240:243], v[16:19], v[76:79]
v_mfma_f32_16x16x32_bf16 v[76:79], a[244:247], v[36:39], v[76:79]
v_mfma_f32_16x16x32_bf16 v[120:123], a[248:251], v[0:3], v[120:123]
ds_read_b64_tr_b16 a[240:241], v234 offset:32768
v_mfma_f32_16x16x32_bf16 v[120:123], a[252:255], v[20:23], v[120:123]
ds_read_b64_tr_b16 a[242:243], v234 offset:33792
v_mfma_f32_16x16x32_bf16 v[124:127], a[252:255], v[24:27], v[124:127]
v_mfma_f32_16x16x32_bf16 v[124:127], a[248:251], v[4:7], v[124:127]
ds_read_b64_tr_b16 a[244:245], v236 offset:32768
v_mfma_f32_16x16x32_bf16 v[128:131], a[248:251], v[8:11], v[128:131]
ds_read_b64_tr_b16 a[246:247], v236 offset:33792
v_mfma_f32_16x16x32_bf16 v[128:131], a[252:255], v[28:31], v[128:131]
v_mfma_f32_16x16x32_bf16 v[132:135], a[252:255], v[32:35], v[132:135]
v_mfma_f32_16x16x32_bf16 v[132:135], a[248:251], v[12:15], v[132:135]
v_mfma_f32_16x16x32_bf16 v[136:139], a[248:251], v[16:19], v[136:139]
v_mfma_f32_16x16x32_bf16 v[136:139], a[252:255], v[36:39], v[136:139]
s_waitcnt lgkmcnt(4)
v_mfma_f32_16x16x32_bf16 v[80:83], a[184:187], a[0:3], v[80:83]
ds_read_b64_tr_b16 a[248:249], v234 offset:32776
v_mfma_f32_16x16x32_bf16 v[80:83], a[188:191], a[20:23], v[80:83]
ds_read_b64_tr_b16 a[250:251], v234 offset:33800
v_mfma_f32_16x16x32_bf16 v[84:87], a[188:191], a[24:27], v[84:87]
ds_read_b64_tr_b16 a[252:253], v236 offset:32776
v_mfma_f32_16x16x32_bf16 v[84:87], a[184:187], a[4:7], v[84:87]
ds_read_b64_tr_b16 a[254:255], v236 offset:33800
v_mfma_f32_16x16x32_bf16 v[88:91], a[184:187], a[8:11], v[88:91]
v_mov_b32 v246, 2
v_mfma_f32_16x16x32_bf16 v[88:91], a[188:191], a[28:31], v[88:91]
s_waitcnt vmcnt(0)
buffer_store_dword v246, v255, s[92:95], 0 offen offset:16 sc1
v_mfma_f32_16x16x32_bf16 v[92:95], a[188:191], a[32:35], v[92:95]
v_mfma_f32_16x16x32_bf16 v[92:95], a[184:187], a[12:15], v[92:95]
v_mfma_f32_16x16x32_bf16 v[96:99], a[184:187], a[16:19], v[96:99]
v_mfma_f32_16x16x32_bf16 v[96:99], a[188:191], a[36:39], v[96:99]
s_waitcnt lgkmcnt(0)
s_barrier
v_mfma_f32_16x16x32_bf16 v[100:103], a[192:195], a[0:3], v[100:103]
ds_read_b64_tr_b16 a[184:185], v237 offset:0
v_cvt_pk_bf16_f32 v40, v60, v61
v_cvt_pk_bf16_f32 v41, v62, v63
v_mfma_f32_16x16x32_bf16 v[100:103], a[196:199], a[20:23], v[100:103]
ds_read_b64_tr_b16 a[186:187], v237 offset:1024
v_cvt_pk_bf16_f32 v42, v120, v121
v_cvt_pk_bf16_f32 v43, v122, v123
v_mfma_f32_16x16x32_bf16 v[104:107], a[196:199], a[24:27], v[104:107]
buffer_store_dwordx4 v[40:43], v243, s[24:27], s56 offen offset:0 sc1
v_mfma_f32_16x16x32_bf16 v[104:107], a[192:195], a[4:7], v[104:107]
ds_read_b64_tr_b16 a[188:189], v239 offset:0
v_mfma_f32_16x16x32_bf16 v[108:111], a[192:195], a[8:11], v[108:111]
ds_read_b64_tr_b16 a[190:191], v239 offset:1024
v_mfma_f32_16x16x32_bf16 v[108:111], a[196:199], a[28:31], v[108:111]
v_cvt_pk_bf16_f32 v44, v64, v65
v_cvt_pk_bf16_f32 v45, v66, v67
v_mfma_f32_16x16x32_bf16 v[112:115], a[196:199], a[32:35], v[112:115]
v_cvt_pk_bf16_f32 v46, v124, v125
v_cvt_pk_bf16_f32 v47, v126, v127
v_mfma_f32_16x16x32_bf16 v[112:115], a[192:195], a[12:15], v[112:115]
buffer_store_dwordx4 v[44:47], v243, s[24:27], s56 offen offset:1024 sc1
v_mfma_f32_16x16x32_bf16 v[116:119], a[192:195], a[16:19], v[116:119]
v_mfma_f32_16x16x32_bf16 v[116:119], a[196:199], a[36:39], v[116:119]
v_mfma_f32_16x16x32_bf16 v[80:83], a[240:243], a[40:43], v[80:83]
ds_read_b64_tr_b16 a[192:193], v237 offset:8
v_cvt_pk_bf16_f32 v48, v68, v69
v_cvt_pk_bf16_f32 v49, v70, v71
v_mfma_f32_16x16x32_bf16 v[80:83], a[244:247], a[60:63], v[80:83]
ds_read_b64_tr_b16 a[194:195], v237 offset:1032
v_cvt_pk_bf16_f32 v50, v128, v129
v_cvt_pk_bf16_f32 v51, v130, v131
v_mfma_f32_16x16x32_bf16 v[84:87], a[244:247], a[64:67], v[84:87]
buffer_store_dwordx4 v[48:51], v243, s[24:27], s56 offen offset:2048 sc1
v_mfma_f32_16x16x32_bf16 v[84:87], a[240:243], a[44:47], v[84:87]
ds_read_b64_tr_b16 a[196:197], v239 offset:8
v_mfma_f32_16x16x32_bf16 v[88:91], a[240:243], a[48:51], v[88:91]
ds_read_b64_tr_b16 a[198:199], v239 offset:1032
v_mfma_f32_16x16x32_bf16 v[88:91], a[244:247], a[68:71], v[88:91]
v_cvt_pk_bf16_f32 v52, v72, v73
v_cvt_pk_bf16_f32 v53, v74, v75
v_mfma_f32_16x16x32_bf16 v[92:95], a[244:247], a[72:75], v[92:95]
v_cvt_pk_bf16_f32 v54, v132, v133
v_cvt_pk_bf16_f32 v55, v134, v135
v_mfma_f32_16x16x32_bf16 v[92:95], a[240:243], a[52:55], v[92:95]
buffer_store_dwordx4 v[52:55], v243, s[24:27], s56 offen offset:3072 sc1
v_mfma_f32_16x16x32_bf16 v[96:99], a[240:243], a[56:59], v[96:99]
v_mfma_f32_16x16x32_bf16 v[96:99], a[244:247], a[76:79], v[96:99]
v_mfma_f32_16x16x32_bf16 v[100:103], a[248:251], a[40:43], v[100:103]
ds_read_b64_tr_b16 a[240:241], v238 offset:0
v_cvt_pk_bf16_f32 v56, v76, v77
v_cvt_pk_bf16_f32 v57, v78, v79
v_mfma_f32_16x16x32_bf16 v[100:103], a[252:255], a[60:63], v[100:103]
ds_read_b64_tr_b16 a[242:243], v238 offset:1024
v_cvt_pk_bf16_f32 v58, v136, v137
v_cvt_pk_bf16_f32 v59, v138, v139
v_mfma_f32_16x16x32_bf16 v[104:107], a[252:255], a[64:67], v[104:107]
buffer_store_dwordx4 v[56:59], v247, s[24:27], s56 offen sc1
v_mfma_f32_16x16x32_bf16 v[104:107], a[248:251], a[44:47], v[104:107]
ds_read_b64_tr_b16 a[244:245], v240 offset:0
v_mfma_f32_16x16x32_bf16 v[108:111], a[248:251], a[48:51], v[108:111]
ds_read_b64_tr_b16 a[246:247], v240 offset:1024
v_mfma_f32_16x16x32_bf16 v[108:111], a[252:255], a[68:71], v[108:111]
v_mfma_f32_16x16x32_bf16 v[112:115], a[252:255], a[72:75], v[112:115]
v_mfma_f32_16x16x32_bf16 v[112:115], a[248:251], a[52:55], v[112:115]
v_mfma_f32_16x16x32_bf16 v[116:119], a[248:251], a[56:59], v[116:119]
v_mfma_f32_16x16x32_bf16 v[116:119], a[252:255], a[76:79], v[116:119]
s_waitcnt lgkmcnt(4)
v_mfma_f32_16x16x32_bf16 v[80:83], a[184:187], a[80:83], v[80:83]
ds_read_b64_tr_b16 a[248:249], v238 offset:8
v_mfma_f32_16x16x32_bf16 v[80:83], a[188:191], a[100:103], v[80:83]
ds_read_b64_tr_b16 a[250:251], v238 offset:1032
v_mfma_f32_16x16x32_bf16 v[84:87], a[188:191], a[104:107], v[84:87]
ds_read_b64_tr_b16 a[252:253], v240 offset:8
v_mfma_f32_16x16x32_bf16 v[84:87], a[184:187], a[84:87], v[84:87]
ds_read_b64_tr_b16 a[254:255], v240 offset:1032
v_mfma_f32_16x16x32_bf16 v[88:91], a[184:187], a[88:91], v[88:91]
v_mfma_f32_16x16x32_bf16 v[88:91], a[188:191], a[108:111], v[88:91]
buffer_load_dword v253, v252, s[92:95], 0 offen sc1
v_mfma_f32_16x16x32_bf16 v[92:95], a[188:191], a[112:115], v[92:95]
v_mfma_f32_16x16x32_bf16 v[92:95], a[184:187], a[92:95], v[92:95]
v_mfma_f32_16x16x32_bf16 v[96:99], a[184:187], a[96:99], v[96:99]
v_mfma_f32_16x16x32_bf16 v[96:99], a[188:191], a[116:119], v[96:99]
s_waitcnt lgkmcnt(0)
s_barrier
v_mfma_f32_16x16x32_bf16 v[100:103], a[192:195], a[80:83], v[100:103]
ds_read_b64_tr_b16 a[184:185], v237 offset:16384
v_mfma_f32_16x16x32_bf16 v[100:103], a[196:199], a[100:103], v[100:103]
ds_read_b64_tr_b16 a[186:187], v237 offset:17408
v_mfma_f32_16x16x32_bf16 v[104:107], a[196:199], a[104:107], v[104:107]
v_mfma_f32_16x16x32_bf16 v[104:107], a[192:195], a[84:87], v[104:107]
ds_read_b64_tr_b16 a[188:189], v239 offset:16384
v_mfma_f32_16x16x32_bf16 v[108:111], a[192:195], a[88:91], v[108:111]
ds_read_b64_tr_b16 a[190:191], v239 offset:17408
v_mfma_f32_16x16x32_bf16 v[108:111], a[196:199], a[108:111], v[108:111]
v_mfma_f32_16x16x32_bf16 v[112:115], a[196:199], a[112:115], v[112:115]
v_mfma_f32_16x16x32_bf16 v[112:115], a[192:195], a[92:95], v[112:115]
v_mfma_f32_16x16x32_bf16 v[116:119], a[192:195], a[96:99], v[116:119]
v_mfma_f32_16x16x32_bf16 v[116:119], a[196:199], a[116:119], v[116:119]
v_mfma_f32_16x16x32_bf16 v[80:83], a[240:243], v[0:3], v[80:83]
ds_read_b64_tr_b16 a[192:193], v237 offset:16392
v_mfma_f32_16x16x32_bf16 v[80:83], a[244:247], v[20:23], v[80:83]
ds_read_b64_tr_b16 a[194:195], v237 offset:17416
v_mfma_f32_16x16x32_bf16 v[84:87], a[244:247], v[24:27], v[84:87]
v_mfma_f32_16x16x32_bf16 v[84:87], a[240:243], v[4:7], v[84:87]
ds_read_b64_tr_b16 a[196:197], v239 offset:16392
v_mfma_f32_16x16x32_bf16 v[88:91], a[240:243], v[8:11], v[88:91]
ds_read_b64_tr_b16 a[198:199], v239 offset:17416
v_mfma_f32_16x16x32_bf16 v[88:91], a[244:247], v[28:31], v[88:91]
v_mfma_f32_16x16x32_bf16 v[92:95], a[244:247], v[32:35], v[92:95]
v_mfma_f32_16x16x32_bf16 v[92:95], a[240:243], v[12:15], v[92:95]
v_mfma_f32_16x16x32_bf16 v[96:99], a[240:243], v[16:19], v[96:99]
v_mfma_f32_16x16x32_bf16 v[96:99], a[244:247], v[36:39], v[96:99]
v_mfma_f32_16x16x32_bf16 v[100:103], a[248:251], v[0:3], v[100:103]
ds_read_b64_tr_b16 a[240:241], v238 offset:16384
v_mfma_f32_16x16x32_bf16 v[100:103], a[252:255], v[20:23], v[100:103]
ds_read_b64_tr_b16 a[242:243], v238 offset:17408
v_mfma_f32_16x16x32_bf16 v[104:107], a[252:255], v[24:27], v[104:107]
v_mfma_f32_16x16x32_bf16 v[104:107], a[248:251], v[4:7], v[104:107]
ds_read_b64_tr_b16 a[244:245], v240 offset:16384
v_mfma_f32_16x16x32_bf16 v[108:111], a[248:251], v[8:11], v[108:111]
ds_read_b64_tr_b16 a[246:247], v240 offset:17408
s_mov_b32 s36, 2
s_mov_b32 s100, 6
v_mov_b32 v246, 3
v_mfma_f32_16x16x32_bf16 v[108:111], a[252:255], v[28:31], v[108:111]
s_waitcnt vmcnt(1)
buffer_store_dword v246, v255, s[92:95], 0 offen offset:16 sc1
v_mfma_f32_16x16x32_bf16 v[112:115], a[252:255], v[32:35], v[112:115]
s_waitcnt vmcnt(1)
v_cmp_gt_u32 vcc, 2, v253
v_mfma_f32_16x16x32_bf16 v[112:115], a[248:251], v[12:15], v[112:115]
v_mfma_f32_16x16x32_bf16 v[116:119], a[248:251], v[16:19], v[116:119]
s_and_b32 s49, vcc_lo, 6
s_cbranch_scc1 L_slow_e
L_back_e:
v_mfma_f32_16x16x32_bf16 v[116:119], a[252:255], v[36:39], v[116:119]
s_waitcnt lgkmcnt(4)
buffer_load_dwordx4 v[180:183], v243, s[24:27], s61 offen offset:0 sc1
v_mfma_f32_16x16x32_bf16 v[80:83], a[184:187], a[200:203], v[80:83]
ds_read_b64_tr_b16 a[248:249], v238 offset:16392
v_mfma_f32_16x16x32_bf16 v[80:83], a[188:191], a[220:223], v[80:83]
ds_read_b64_tr_b16 a[250:251], v238 offset:17416
v_mfma_f32_16x16x32_bf16 v[84:87], a[188:191], a[224:227], v[84:87]
ds_read_b64_tr_b16 a[252:253], v240 offset:16392
buffer_load_dwordx4 v[184:187], v243, s[24:27], s61 offen offset:1024 sc1
v_mfma_f32_16x16x32_bf16 v[84:87], a[184:187], a[204:207], v[84:87]
ds_read_b64_tr_b16 a[254:255], v240 offset:17416
v_mfma_f32_16x16x32_bf16 v[88:91], a[184:187], a[208:211], v[88:91]
v_mfma_f32_16x16x32_bf16 v[88:91], a[188:191], a[228:231], v[88:91]
buffer_load_dwordx4 v[188:191], v243, s[24:27], s61 offen offset:2048 sc1
v_mfma_f32_16x16x32_bf16 v[92:95], a[188:191], a[232:235], v[92:95]
v_mfma_f32_16x16x32_bf16 v[92:95], a[184:187], a[212:215], v[92:95]
v_mfma_f32_16x16x32_bf16 v[96:99], a[184:187], a[216:219], v[96:99]
buffer_load_dwordx4 v[192:195], v243, s[24:27], s61 offen offset:3072 sc1
v_mfma_f32_16x16x32_bf16 v[96:99], a[188:191], a[236:239], v[96:99]
v_mfma_f32_16x16x32_bf16 v[100:103], a[192:195], a[200:203], v[100:103]
v_mfma_f32_16x16x32_bf16 v[100:103], a[196:199], a[220:223], v[100:103]
buffer_load_dwordx4 v[196:199], v247, s[24:27], s61 offen sc1
v_mfma_f32_16x16x32_bf16 v[104:107], a[196:199], a[224:227], v[104:107]
v_mfma_f32_16x16x32_bf16 v[104:107], a[192:195], a[204:207], v[104:107]
v_mfma_f32_16x16x32_bf16 v[108:111], a[192:195], a[208:211], v[108:111]
buffer_load_dwordx4 v[200:203], v243, s[24:27], s60 offen offset:0 sc1
v_mfma_f32_16x16x32_bf16 v[108:111], a[196:199], a[228:231], v[108:111]
v_mfma_f32_16x16x32_bf16 v[112:115], a[196:199], a[232:235], v[112:115]
v_mfma_f32_16x16x32_bf16 v[112:115], a[192:195], a[212:215], v[112:115]
buffer_load_dwordx4 v[204:207], v243, s[24:27], s60 offen offset:1024 sc1
v_mfma_f32_16x16x32_bf16 v[116:119], a[192:195], a[216:219], v[116:119]
v_mfma_f32_16x16x32_bf16 v[116:119], a[196:199], a[236:239], v[116:119]
s_waitcnt lgkmcnt(0)
v_mfma_f32_16x16x32_bf16 v[80:83], a[240:243], a[120:123], v[80:83]
buffer_load_dwordx4 v[208:211], v243, s[24:27], s60 offen offset:2048 sc1
v_mfma_f32_16x16x32_bf16 v[80:83], a[244:247], a[140:143], v[80:83]
v_mfma_f32_16x16x32_bf16 v[84:87], a[244:247], a[144:147], v[84:87]
v_mfma_f32_16x16x32_bf16 v[84:87], a[240:243], a[124:127], v[84:87]
buffer_load_dwordx4 v[212:215], v243, s[24:27], s60 offen offset:3072 sc1
v_mfma_f32_16x16x32_bf16 v[88:91], a[240:243], a[128:131], v[88:91]
v_mfma_f32_16x16x32_bf16 v[88:91], a[244:247], a[148:151], v[88:91]
v_mfma_f32_16x16x32_bf16 v[92:95], a[244:247], a[152:155], v[92:95]
buffer_load_dwordx4 v[216:219], v247, s[24:27], s60 offen sc1
v_mfma_f32_16x16x32_bf16 v[92:95], a[240:243], a[132:135], v[92:95]
v_mfma_f32_16x16x32_bf16 v[96:99], a[240:243], a[136:139], v[96:99]
v_mfma_f32_16x16x32_bf16 v[96:99], a[244:247], a[156:159], v[96:99]
v_mfma_f32_16x16x32_bf16 v[100:103], a[248:251], a[120:123], v[100:103]
buffer_load_dword v253, v252, s[92:95], 0 offen sc1
s_mov_b32 s36, 3
s_mov_b32 s100, 1
v_mfma_f32_16x16x32_bf16 v[100:103], a[252:255], a[140:143], v[100:103]
v_mfma_f32_16x16x32_bf16 v[104:107], a[252:255], a[144:147], v[104:107]
v_mfma_f32_16x16x32_bf16 v[104:107], a[248:251], a[124:127], v[104:107]
v_mfma_f32_16x16x32_bf16 v[108:111], a[248:251], a[128:131], v[108:111]
v_mfma_f32_16x16x32_bf16 v[108:111], a[252:255], a[148:151], v[108:111]
v_mfma_f32_16x16x32_bf16 v[112:115], a[252:255], a[152:155], v[112:115]
v_mfma_f32_16x16x32_bf16 v[112:115], a[248:251], a[132:135], v[112:115]
v_mfma_f32_16x16x32_bf16 v[116:119], a[248:251], a[136:139], v[116:119]
v_mfma_f32_16x16x32_bf16 v[116:119], a[252:255], a[156:159], v[116:119]
s_waitcnt vmcnt(0)
v_cmp_gt_u32 vcc, 3, v253
s_nop 0
s_and_b32 s49, vcc_lo, 1
s_cbranch_scc1 L_slow_f
L_back_f:
buffer_load_dwordx4 v[140:143], v243, s[24:27], s59 offen offset:0 sc1
buffer_load_dwordx4 v[144:147], v243, s[24:27], s59 offen offset:1024 sc1
buffer_load_dwordx4 v[148:151], v243, s[24:27], s59 offen offset:2048 sc1
buffer_load_dwordx4 v[152:155], v243, s[24:27], s59 offen offset:3072 sc1
buffer_load_dwordx4 v[156:159], v247, s[24:27], s59 offen sc1
v_dot2c_f32_bf16 v80, s62, v180
v_dot2c_f32_bf16 v81, s63, v180
v_dot2c_f32_bf16 v82, s62, v181
v_dot2c_f32_bf16 v83, s63, v181
v_dot2c_f32_bf16 v100, s62, v182
v_dot2c_f32_bf16 v101, s63, v182
v_dot2c_f32_bf16 v102, s62, v183
v_dot2c_f32_bf16 v103, s63, v183
v_dot2c_f32_bf16 v84, s62, v184
v_dot2c_f32_bf16 v85, s63, v184
v_dot2c_f32_bf16 v86, s62, v185
v_dot2c_f32_bf16 v87, s63, v185
v_dot2c_f32_bf16 v104, s62, v186
v_dot2c_f32_bf16 v105, s63, v186
v_dot2c_f32_bf16 v106, s62, v187
v_dot2c_f32_bf16 v107, s63, v187
v_dot2c_f32_bf16 v88, s62, v188
v_dot2c_f32_bf16 v89, s63, v188
v_dot2c_f32_bf16 v90, s62, v189
v_dot2c_f32_bf16 v91, s63, v189
v_dot2c_f32_bf16 v108, s62, v190
v_dot2c_f32_bf16 v109, s63, v190
v_dot2c_f32_bf16 v110, s62, v191
v_dot2c_f32_bf16 v111, s63, v191
v_dot2c_f32_bf16 v92, s62, v192
v_dot2c_f32_bf16 v93, s63, v192
v_dot2c_f32_bf16 v94, s62, v193
v_dot2c_f32_bf16 v95, s63, v193
v_dot2c_f32_bf16 v112, s62, v194
v_dot2c_f32_bf16 v113, s63, v194
v_dot2c_f32_bf16 v114, s62, v195
v_dot2c_f32_bf16 v115, s63, v195
v_dot2c_f32_bf16 v96, s62, v196
v_dot2c_f32_bf16 v97, s63, v196
v_dot2c_f32_bf16 v98, s62, v197
v_dot2c_f32_bf16 v99, s63, v197
v_dot2c_f32_bf16 v116, s62, v198
v_dot2c_f32_bf16 v117, s63, v198
v_dot2c_f32_bf16 v118, s62, v199
v_dot2c_f32_bf16 v119, s63, v199
v_dot2c_f32_bf16 v80, s62, v200
v_dot2c_f32_bf16 v81, s63, v200
v_dot2c_f32_bf16 v82, s62, v201
v_dot2c_f32_bf16 v83, s63, v201
v_dot2c_f32_bf16 v100, s62, v202
v_dot2c_f32_bf16 v101, s63, v202
v_dot2c_f32_bf16 v102, s62, v203
v_dot2c_f32_bf16 v103, s63, v203
v_dot2c_f32_bf16 v84, s62, v204
v_dot2c_f32_bf16 v85, s63, v204
v_dot2c_f32_bf16 v86, s62, v205
v_dot2c_f32_bf16 v87, s63, v205
v_dot2c_f32_bf16 v104, s62, v206
v_dot2c_f32_bf16 v105, s63, v206
v_dot2c_f32_bf16 v106, s62, v207
v_dot2c_f32_bf16 v107, s63, v207
v_dot2c_f32_bf16 v88, s62, v208
v_dot2c_f32_bf16 v89, s63, v208
v_dot2c_f32_bf16 v90, s62, v209
v_dot2c_f32_bf16 v91, s63, v209
v_dot2c_f32_bf16 v108, s62, v210
v_dot2c_f32_bf16 v109, s63, v210
v_dot2c_f32_bf16 v110, s62, v211
v_dot2c_f32_bf16 v111, s63, v211
v_dot2c_f32_bf16 v92, s62, v212
v_dot2c_f32_bf16 v93, s63, v212
v_dot2c_f32_bf16 v94, s62, v213
v_dot2c_f32_bf16 v95, s63, v213
v_dot2c_f32_bf16 v112, s62, v214
v_dot2c_f32_bf16 v113, s63, v214
v_dot2c_f32_bf16 v114, s62, v215
v_dot2c_f32_bf16 v115, s63, v215
v_dot2c_f32_bf16 v96, s62, v216
v_dot2c_f32_bf16 v97, s63, v216
v_dot2c_f32_bf16 v98, s62, v217
v_dot2c_f32_bf16 v99, s63, v217
v_dot2c_f32_bf16 v116, s62, v218
v_dot2c_f32_bf16 v117, s63, v218
v_dot2c_f32_bf16 v118, s62, v219
v_dot2c_f32_bf16 v119, s63, v219
s_waitcnt vmcnt(4)
v_dot2c_f32_bf16 v80, s62, v140
v_dot2c_f32_bf16 v81, s63, v140
v_dot2c_f32_bf16 v82, s62, v141
v_dot2c_f32_bf16 v83, s63, v141
v_dot2c_f32_bf16 v100, s62, v142
v_dot2c_f32_bf16 v101, s63, v142
v_dot2c_f32_bf16 v102, s62, v143
v_dot2c_f32_bf16 v103, s63, v143
s_mov_b32 s49, 0
v_cvt_pk_bf16_f32 v120, v80, v81
v_cvt_pk_bf16_f32 v121, v82, v83
v_cvt_pk_bf16_f32 v122, v100, v101
v_cvt_pk_bf16_f32 v123, v102, v103
buffer_store_dwordx4 v[120:123], v231, s[16:19], s49 offen
s_waitcnt vmcnt(4)
v_dot2c_f32_bf16 v84, s62, v144
v_dot2c_f32_bf16 v85, s63, v144
v_dot2c_f32_bf16 v86, s62, v145
v_dot2c_f32_bf16 v87, s63, v145
v_dot2c_f32_bf16 v104, s62, v146
v_dot2c_f32_bf16 v105, s63, v146
v_dot2c_f32_bf16 v106, s62, v147
v_dot2c_f32_bf16 v107, s63, v147
s_mov_b32 s49, 65536
v_cvt_pk_bf16_f32 v124, v84, v85
v_cvt_pk_bf16_f32 v125, v86, v87
v_cvt_pk_bf16_f32 v126, v104, v105
v_cvt_pk_bf16_f32 v127, v106, v107
buffer_store_dwordx4 v[124:127], v231, s[16:19], s49 offen
s_waitcnt vmcnt(4)
v_dot2c_f32_bf16 v88, s62, v148
v_dot2c_f32_bf16 v89, s63, v148
v_dot2c_f32_bf16 v90, s62, v149
v_dot2c_f32_bf16 v91, s63, v149
v_dot2c_f32_bf16 v108, s62, v150
v_dot2c_f32_bf16 v109, s63, v150
v_dot2c_f32_bf16 v110, s62, v151
v_dot2c_f32_bf16 v111, s63, v151
s_mov_b32 s49, 131072
v_cvt_pk_bf16_f32 v128, v88, v89
v_cvt_pk_bf16_f32 v129, v90, v91
v_cvt_pk_bf16_f32 v130, v108, v109
v_cvt_pk_bf16_f32 v131, v110, v111
buffer_store_dwordx4 v[128:131], v231, s[16:19], s49 offen
s_waitcnt vmcnt(4)
v_dot2c_f32_bf16 v92, s62, v152
v_dot2c_f32_bf16 v93, s63, v152
v_dot2c_f32_bf16 v94, s62, v153
v_dot2c_f32_bf16 v95, s63, v153
v_dot2c_f32_bf16 v112, s62, v154
v_dot2c_f32_bf16 v113, s63, v154
v_dot2c_f32_bf16 v114, s62, v155
v_dot2c_f32_bf16 v115, s63, v155
s_mov_b32 s49, 196608
v_cvt_pk_bf16_f32 v132, v92, v93
v_cvt_pk_bf16_f32 v133, v94, v95
v_cvt_pk_bf16_f32 v134, v112, v113
v_cvt_pk_bf16_f32 v135, v114, v115
buffer_store_dwordx4 v[132:135], v231, s[16:19], s49 offen
s_waitcnt vmcnt(4)
v_dot2c_f32_bf16 v96, s62, v156
v_dot2c_f32_bf16 v97, s63, v156
v_dot2c_f32_bf16 v98, s62, v157
v_dot2c_f32_bf16 v99, s63, v157
v_dot2c_f32_bf16 v116, s62, v158
v_dot2c_f32_bf16 v117, s63, v158
v_dot2c_f32_bf16 v118, s62, v159
v_dot2c_f32_bf16 v119, s63, v159
s_mov_b32 s49, 262144
v_cvt_pk_bf16_f32 v136, v96, v97
v_cvt_pk_bf16_f32 v137, v98, v99
v_cvt_pk_bf16_f32 v138, v116, v117
v_cvt_pk_bf16_f32 v139, v118, v119
buffer_store_dwordx4 v[136:139], v231, s[16:19], s49 offen
L_done:
s_endpgm
L_famwait:
s_add_u32 s101, s101, 1
s_cmp_gt_u32 s101, 200000
s_cbranch_scc1 L_famok
v_mov_b32 v229, 0
buffer_load_dword v253, v229, s[56:59], 0 offen sc1
s_waitcnt vmcnt(0)
v_readfirstlane_b32 s49, v253
s_nop 1
s_cmp_ge_u32 s49, 16
s_cbranch_scc0 L_famwait
s_branch L_famok
L_slow_a:
s_add_u32 s101, s101, 1
s_cmp_gt_u32 s101, 200000
s_cbranch_scc1 L_back_a
buffer_load_dword v253, v252, s[92:95], 0 offen sc1
s_waitcnt vmcnt(0)
v_cmp_gt_u32 vcc, s36, v253
s_nop 1
s_and_b32 s3, vcc_lo, 0xfff
s_and_b32 s49, s3, s100
s_cbranch_scc1 L_slow_a
s_branch L_back_a
L_slow_b:
s_add_u32 s101, s101, 1
s_cmp_gt_u32 s101, 200000
s_cbranch_scc1 L_back_b
buffer_load_dword v253, v252, s[92:95], 0 offen sc1
s_waitcnt vmcnt(0)
v_cmp_gt_u32 vcc, s36, v253
s_nop 1
s_and_b32 s3, vcc_lo, 0xfff
s_and_b32 s49, s3, s100
s_cbranch_scc1 L_slow_b
s_branch L_back_b
L_slow_c:
s_add_u32 s101, s101, 1
s_cmp_gt_u32 s101, 200000
s_cbranch_scc1 L_back_c
buffer_load_dword v253, v252, s[92:95], 0 offen sc1
s_waitcnt vmcnt(0)
v_cmp_gt_u32 vcc, s36, v253
s_nop 1
s_and_b32 s3, vcc_lo, 0xfff
s_and_b32 s49, s3, s100
s_cbranch_scc1 L_slow_c
s_branch L_back_c
L_slow_d:
s_add_u32 s101, s101, 1
s_cmp_gt_u32 s101, 200000
s_cbranch_scc1 L_back_d
buffer_load_dword v253, v252, s[92:95], 0 offen sc1
s_waitcnt vmcnt(0)
v_cmp_gt_u32 vcc, s36, v253
s_nop 1
s_and_b32 s3, vcc_lo, 0xfff
s_and_b32 s49, s3, s100
s_cbranch_scc1 L_slow_d
s_branch L_back_d
L_slow_e:
s_add_u32 s101, s101, 1
s_cmp_gt_u32 s101, 200000
s_cbranch_scc1 L_back_e
buffer_load_dword v253, v252, s[92:95], 0 offen sc1
s_waitcnt vmcnt(0)
v_cmp_gt_u32 vcc, s36, v253
s_nop 1
s_and_b32 s3, vcc_lo, 0xfff
s_and_b32 s49, s3, s100
s_cbranch_scc1 L_slow_e
s_branch L_back_e
L_slow_f:
s_add_u32 s101, s101, 1
s_cmp_gt_u32 s101, 200000
s_cbranch_scc1 L_back_f
buffer_load_dword v253, v252, s[92:95], 0 offen sc1
s_waitcnt vmcnt(0)
v_cmp_gt_u32 vcc, s36, v253
s_nop 1
s_and_b32 s3, vcc_lo, 0xfff
s_and_b32 s49, s3, s100
s_cbranch_scc1 L_slow_f
s_branch L_back_f
L_fb:
s_waitcnt vmcnt(0) lgkmcnt(0)
s_barrier
s_mov_b32 s53, 0
s_mov_b32 s36, 0
v_mov_b32 v160, 0xff800000
v_mov_b32 v164, 0xff800000
v_mov_b32 v168, 0xff800000
v_mov_b32 v172, 0xff800000
v_mov_b32 v176, 0xff800000
L_fbmax:
s_mov_b32 m0, s48
s_nop 0
buffer_load_dwordx4 v220, s[16:19], s36 offen offset:0 nt lds
buffer_load_dwordx4 v221, s[16:19], s36 offen offset:1024 nt lds
buffer_load_dwordx4 v222, s[16:19], s36 offen offset:2048 nt lds
buffer_load_dwordx4 v223, s[16:19], s36 offen offset:3072 nt lds
s_add_u32 s36, s36, 8192
s_waitcnt vmcnt(0)
s_barrier
ds_read_b128 a[184:187], v204 offset:0
ds_read_b128 a[188:191], v205 offset:0
ds_read_b128 a[192:195], v206 offset:0
ds_read_b128 a[196:199], v207 offset:0
ds_read_b128 a[200:203], v204 offset:4096
ds_read_b128 a[204:207], v205 offset:4096
ds_read_b128 a[208:211], v206 offset:4096
ds_read_b128 a[212:215], v207 offset:4096
s_waitcnt lgkmcnt(0)
s_barrier
v_mfma_f32_16x16x32_bf16 v[80:83], a[184:187], v[0:3], 0
v_mfma_f32_16x16x32_bf16 v[84:87], a[184:187], v[4:7], 0
v_mfma_f32_16x16x32_bf16 v[88:91], a[184:187], v[8:11], 0
v_mfma_f32_16x16x32_bf16 v[92:95], a[184:187], v[12:15], 0
v_mfma_f32_16x16x32_bf16 v[96:99], a[184:187], v[16:19], 0
v_mfma_f32_16x16x32_bf16 v[80:83], a[188:191], v[20:23], v[80:83]
v_mfma_f32_16x16x32_bf16 v[84:87], a[188:191], v[24:27], v[84:87]
v_mfma_f32_16x16x32_bf16 v[88:91], a[188:191], v[28:31], v[88:91]
v_mfma_f32_16x16x32_bf16 v[92:95], a[188:191], v[32:35], v[92:95]
v_mfma_f32_16x16x32_bf16 v[96:99], a[188:191], v[36:39], v[96:99]
v_mfma_f32_16x16x32_bf16 v[80:83], a[192:195], v[40:43], v[80:83]
v_mfma_f32_16x16x32_bf16 v[84:87], a[192:195], v[44:47], v[84:87]
v_mfma_f32_16x16x32_bf16 v[88:91], a[192:195], v[48:51], v[88:91]
v_mfma_f32_16x16x32_bf16 v[92:95], a[192:195], v[52:55], v[92:95]
v_mfma_f32_16x16x32_bf16 v[96:99], a[192:195], v[56:59], v[96:99]
v_mfma_f32_16x16x32_bf16 v[80:83], a[196:199], v[60:63], v[80:83]
v_mfma_f32_16x16x32_bf16 v[84:87], a[196:199], v[64:67], v[84:87]
v_mfma_f32_16x16x32_bf16 v[88:91], a[196:199], v[68:71], v[88:91]
v_mfma_f32_16x16x32_bf16 v[92:95], a[196:199], v[72:75], v[92:95]
v_mfma_f32_16x16x32_bf16 v[96:99], a[196:199], v[76:79], v[96:99]
v_mfma_f32_16x16x32_bf16 v[100:103], a[200:203], v[0:3], 0
v_mfma_f32_16x16x32_bf16 v[104:107], a[200:203], v[4:7], 0
v_mfma_f32_16x16x32_bf16 v[108:111], a[200:203], v[8:11], 0
v_mfma_f32_16x16x32_bf16 v[112:115], a[200:203], v[12:15], 0
v_mfma_f32_16x16x32_bf16 v[116:119], a[200:203], v[16:19], 0
v_mfma_f32_16x16x32_bf16 v[100:103], a[204:207], v[20:23], v[100:103]
v_mfma_f32_16x16x32_bf16 v[104:107], a[204:207], v[24:27], v[104:107]
v_mfma_f32_16x16x32_bf16 v[108:111], a[204:207], v[28:31], v[108:111]
v_mfma_f32_16x16x32_bf16 v[112:115], a[204:207], v[32:35], v[112:115]
v_mfma_f32_16x16x32_bf16 v[116:119], a[204:207], v[36:39], v[116:119]
v_mfma_f32_16x16x32_bf16 v[100:103], a[208:211], v[40:43], v[100:103]
v_mfma_f32_16x16x32_bf16 v[104:107], a[208:211], v[44:47], v[104:107]
v_mfma_f32_16x16x32_bf16 v[108:111], a[208:211], v[48:51], v[108:111]
v_mfma_f32_16x16x32_bf16 v[112:115], a[208:211], v[52:55], v[112:115]
v_mfma_f32_16x16x32_bf16 v[116:119], a[208:211], v[56:59], v[116:119]
v_mfma_f32_16x16x32_bf16 v[100:103], a[212:215], v[60:63], v[100:103]
v_mfma_f32_16x16x32_bf16 v[104:107], a[212:215], v[64:67], v[104:107]
v_mfma_f32_16x16x32_bf16 v[108:111], a[212:215], v[68:71], v[108:111]
v_mfma_f32_16x16x32_bf16 v[112:115], a[212:215], v[72:75], v[112:115]
v_mfma_f32_16x16x32_bf16 v[116:119], a[212:215], v[76:79], v[116:119]
v_max3_f32 v160, v160, v80, v81
v_max3_f32 v160, v160, v82, v83
s_nop 1
v_max3_f32 v160, v160, v100, v101
v_max3_f32 v160, v160, v102, v103
v_max3_f32 v164, v164, v84, v85
v_max3_f32 v164, v164, v86, v87
v_max3_f32 v164, v164, v104, v105
v_max3_f32 v164, v164, v106, v107
v_max3_f32 v168, v168, v88, v89
v_max3_f32 v168, v168, v90, v91
v_max3_f32 v168, v168, v108, v109
v_max3_f32 v168, v168, v110, v111
v_max3_f32 v172, v172, v92, v93
v_max3_f32 v172, v172, v94, v95
v_max3_f32 v172, v172, v112, v113
v_max3_f32 v172, v172, v114, v115
v_max3_f32 v176, v176, v96, v97
v_max3_f32 v176, v176, v98, v99
v_max3_f32 v176, v176, v116, v117
v_max3_f32 v176, v176, v118, v119
s_cmp_lt_u32 s36, 262144
s_cbranch_scc1 L_fbmax
s_add_u32 m0, s48, 0
s_xor_b32 s36, s3, 0
buffer_load_dwordx4 v220, s[16:19], s36 offen offset:0 nt lds
s_add_u32 m0, s48, 0
s_nop 0
buffer_load_dwordx4 v221, s[16:19], s36 offen offset:1024 nt lds
s_add_u32 m0, s48, 0
s_nop 0
buffer_load_dwordx4 v222, s[16:19], s36 offen offset:2048 nt lds
s_add_u32 m0, s48, 0
s_nop 0
buffer_load_dwordx4 v223, s[16:19], s36 offen offset:3072 nt lds
s_add_u32 m0, s48, 16384
s_xor_b32 s37, s3, 0
buffer_load_dwordx4 v220, s[20:23], s37 offen offset:0 nt lds
s_add_u32 m0, s48, 16384
s_nop 0
buffer_load_dwordx4 v221, s[20:23], s37 offen offset:1024 nt lds
s_add_u32 m0, s48, 16384
s_nop 0
buffer_load_dwordx4 v222, s[20:23], s37 offen offset:2048 nt lds
s_add_u32 m0, s48, 16384
s_nop 0
buffer_load_dwordx4 v223, s[20:23], s37 offen offset:3072 nt lds
s_add_u32 m0, s48, 32768
s_xor_b32 s36, s3, 8192
buffer_load_dwordx4 v220, s[16:19], s36 offen offset:0 nt lds
s_add_u32 m0, s48, 32768
s_nop 0
buffer_load_dwordx4 v221, s[16:19], s36 offen offset:1024 nt lds
s_add_u32 m0, s48, 32768
s_nop 0
buffer_load_dwordx4 v222, s[16:19], s36 offen offset:2048 nt lds
s_add_u32 m0, s48, 32768
s_nop 0
buffer_load_dwordx4 v223, s[16:19], s36 offen offset:3072 nt lds
s_add_u32 m0, s48, 49152
s_xor_b32 s37, s3, 8192
buffer_load_dwordx4 v220, s[20:23], s37 offen offset:0 nt lds
s_add_u32 m0, s48, 49152
s_nop 0
buffer_load_dwordx4 v221, s[20:23], s37 offen offset:1024 nt lds
s_add_u32 m0, s48, 49152
s_nop 0
buffer_load_dwordx4 v222, s[20:23], s37 offen offset:2048 nt lds
s_add_u32 m0, s48, 49152
s_nop 0
buffer_load_dwordx4 v223, s[20:23], s37 offen offset:3072 nt lds
s_add_u32 m0, s48, 65536
s_xor_b32 s36, s3, 16384
buffer_load_dwordx4 v220, s[16:19], s36 offen offset:0 nt lds
s_add_u32 m0, s48, 65536
s_nop 0
buffer_load_dwordx4 v221, s[16:19], s36 offen offset:1024 nt lds
s_add_u32 m0, s48, 65536
s_nop 0
buffer_load_dwordx4 v222, s[16:19], s36 offen offset:2048 nt lds
s_add_u32 m0, s48, 65536
s_nop 0
buffer_load_dwordx4 v223, s[16:19], s36 offen offset:3072 nt lds
s_add_u32 m0, s48, 81920
s_xor_b32 s37, s3, 16384
buffer_load_dwordx4 v220, s[20:23], s37 offen offset:0 nt lds
s_add_u32 m0, s48, 81920
s_nop 0
buffer_load_dwordx4 v221, s[20:23], s37 offen offset:1024 nt lds
s_add_u32 m0, s48, 81920
s_nop 0
buffer_load_dwordx4 v222, s[20:23], s37 offen offset:2048 nt lds
s_add_u32 m0, s48, 81920
s_nop 0
buffer_load_dwordx4 v223, s[20:23], s37 offen offset:3072 nt lds
s_add_u32 m0, s48, 98304
s_xor_b32 s36, s3, 24576
buffer_load_dwordx4 v220, s[16:19], s36 offen offset:0 nt lds
s_add_u32 m0, s48, 98304
s_nop 0
buffer_load_dwordx4 v221, s[16:19], s36 offen offset:1024 nt lds
s_add_u32 m0, s48, 98304
s_nop 0
buffer_load_dwordx4 v222, s[16:19], s36 offen offset:2048 nt lds
s_add_u32 m0, s48, 98304
s_nop 0
buffer_load_dwordx4 v223, s[16:19], s36 offen offset:3072 nt lds
s_waitcnt vmcnt(0)
s_barrier
ds_read_b128 a[184:187], v204 offset:0
ds_read_b128 a[188:191], v205 offset:0
ds_read_b128 a[192:195], v206 offset:0
ds_read_b128 a[196:199], v207 offset:0
ds_read_b128 a[200:203], v204 offset:4096
ds_read_b128 a[204:207], v205 offset:4096
ds_read_b128 a[208:211], v206 offset:4096
ds_read_b128 a[212:215], v207 offset:4096
s_waitcnt lgkmcnt(0)
s_barrier
v_mfma_f32_16x16x32_bf16 v[80:83], a[184:187], v[0:3], 0
v_mfma_f32_16x16x32_bf16 v[84:87], a[184:187], v[4:7], 0
v_mfma_f32_16x16x32_bf16 v[88:91], a[184:187], v[8:11], 0
v_mfma_f32_16x16x32_bf16 v[92:95], a[184:187], v[12:15], 0
v_mfma_f32_16x16x32_bf16 v[96:99], a[184:187], v[16:19], 0
v_mfma_f32_16x16x32_bf16 v[80:83], a[188:191], v[20:23], v[80:83]
v_mfma_f32_16x16x32_bf16 v[84:87], a[188:191], v[24:27], v[84:87]
v_mfma_f32_16x16x32_bf16 v[88:91], a[188:191], v[28:31], v[88:91]
v_mfma_f32_16x16x32_bf16 v[92:95], a[188:191], v[32:35], v[92:95]
v_mfma_f32_16x16x32_bf16 v[96:99], a[188:191], v[36:39], v[96:99]
v_mfma_f32_16x16x32_bf16 v[80:83], a[192:195], v[40:43], v[80:83]
v_mfma_f32_16x16x32_bf16 v[84:87], a[192:195], v[44:47], v[84:87]
v_mfma_f32_16x16x32_bf16 v[88:91], a[192:195], v[48:51], v[88:91]
v_mfma_f32_16x16x32_bf16 v[92:95], a[192:195], v[52:55], v[92:95]
v_mfma_f32_16x16x32_bf16 v[96:99], a[192:195], v[56:59], v[96:99]
v_mfma_f32_16x16x32_bf16 v[80:83], a[196:199], v[60:63], v[80:83]
v_mfma_f32_16x16x32_bf16 v[84:87], a[196:199], v[64:67], v[84:87]
v_mfma_f32_16x16x32_bf16 v[88:91], a[196:199], v[68:71], v[88:91]
v_mfma_f32_16x16x32_bf16 v[92:95], a[196:199], v[72:75], v[92:95]
v_mfma_f32_16x16x32_bf16 v[96:99], a[196:199], v[76:79], v[96:99]
v_mfma_f32_16x16x32_bf16 v[100:103], a[200:203], v[0:3], 0
v_mfma_f32_16x16x32_bf16 v[104:107], a[200:203], v[4:7], 0
v_mfma_f32_16x16x32_bf16 v[108:111], a[200:203], v[8:11], 0
v_mfma_f32_16x16x32_bf16 v[112:115], a[200:203], v[12:15], 0
v_mfma_f32_16x16x32_bf16 v[116:119], a[200:203], v[16:19], 0
v_mfma_f32_16x16x32_bf16 v[100:103], a[204:207], v[20:23], v[100:103]
v_mfma_f32_16x16x32_bf16 v[104:107], a[204:207], v[24:27], v[104:107]
v_mfma_f32_16x16x32_bf16 v[108:111], a[204:207], v[28:31], v[108:111]
v_mfma_f32_16x16x32_bf16 v[112:115], a[204:207], v[32:35], v[112:115]
v_mfma_f32_16x16x32_bf16 v[116:119], a[204:207], v[36:39], v[116:119]
v_mfma_f32_16x16x32_bf16 v[100:103], a[208:211], v[40:43], v[100:103]
v_mfma_f32_16x16x32_bf16 v[104:107], a[208:211], v[44:47], v[104:107]
v_mfma_f32_16x16x32_bf16 v[108:111], a[208:211], v[48:51], v[108:111]
v_mfma_f32_16x16x32_bf16 v[112:115], a[208:211], v[52:55], v[112:115]
v_mfma_f32_16x16x32_bf16 v[116:119], a[208:211], v[56:59], v[116:119]
v_mfma_f32_16x16x32_bf16 v[100:103], a[212:215], v[60:63], v[100:103]
v_mfma_f32_16x16x32_bf16 v[104:107], a[212:215], v[64:67], v[104:107]
v_mfma_f32_16x16x32_bf16 v[108:111], a[212:215], v[68:71], v[108:111]
v_mfma_f32_16x16x32_bf16 v[112:115], a[212:215], v[72:75], v[112:115]
v_mfma_f32_16x16x32_bf16 v[116:119], a[212:215], v[76:79], v[116:119]
ds_read_b128 a[184:187], v204 offset:32768
ds_read_b128 a[188:191], v205 offset:32768
ds_read_b128 a[192:195], v206 offset:32768
ds_read_b128 a[196:199], v207 offset:32768
ds_read_b128 a[200:203], v204 offset:36864
ds_read_b128 a[204:207], v205 offset:36864
ds_read_b128 a[208:211], v206 offset:36864
ds_read_b128 a[212:215], v207 offset:36864
s_waitcnt lgkmcnt(0)
s_branch L_aloop
L_end:
.section .rodata,"a"
.p2align 6
.amdhsa_kernel concat_heads__mha_block_cached__gqa_block_cached__near_ridge_kernel
  .amdhsa_next_free_vgpr 512
  .amdhsa_next_free_sgpr 102
  .amdhsa_accum_offset 256
  .amdhsa_group_segment_fixed_size 0
  .amdhsa_kernarg_size 104
  .amdhsa_user_sgpr_count 2
  .amdhsa_user_sgpr_kernarg_segment_ptr 1
  .amdhsa_system_sgpr_workgroup_id_x 1
.end_amdhsa_kernel
```
